```python
import torch

def _softmax(x, axis=-1):
    return torch.softmax(x, dim=axis)

def _gelu(x):
    return torch.nn.functional.gelu(x, approximate='tanh')

def _silu(x):
    return torch.nn.functional.silu(x)

def _sigmoid(x):
    return torch.sigmoid(x)

def _layernorm(x, axis=-1, eps=1e-05):
    m = x.mean(dim=axis, keepdim=True)
    v = x.var(dim=axis, keepdim=True, unbiased=False)
    return (x - m) / torch.sqrt(v + eps)

def _scatter_add(tgt, idx, src, axis=0):
    return tgt.clone().index_add_(axis, idx, src)

def _segment_sum(src, seg, n):
    out = torch.zeros((n,) + src.shape[1:], dtype=src.dtype)
    return out.index_add_(0, seg, src)

def _pad(x, pw):
    flat = tuple((v for pair in reversed(pw) for v in pair))
    return torch.nn.functional.pad(x, flat)
kernel_name = 'parallel_sum__memory_aug_recurrent_mem_tr__dense_activation_squared_relu__prompt'

def setup_inputs():

    _w = lambda a: (lambda t: t.to(torch.bfloat16) if t.is_floating_point() else t)(torch.as_tensor(a))

    def _A_setup():
        B, S, Dm = (1, 2048, 640)
        H, Dh = (32, 192)
        M, seg = (8, 32)
        seg = min(seg, S)
        S = S // seg * seg
        return {'x': _w((lambda *s: torch.randn(*s, dtype=torch.bfloat16) * 0.05)(B, S, Dm)), 'mem0': _w((lambda *s: torch.randn(*s, dtype=torch.bfloat16) * 1.6)(B, M, Dm)), 'Wq': _w((lambda *s: torch.randn(*s, dtype=torch.bfloat16) * 0.8)(Dm, H, Dh) * Dm ** (-0.5)), 'Wk': _w((lambda *s: torch.randn(*s, dtype=torch.bfloat16) * 0.8)(Dm, H, Dh) * Dm ** (-0.5)), 'Wv': _w((lambda *s: torch.randn(*s, dtype=torch.bfloat16) * 1.6)(Dm, H, Dh) * Dm ** (-0.5)), 'Wo': _w((lambda *s: torch.randn(*s, dtype=torch.bfloat16) * 1.6)(H, Dh, Dm) * (H * Dh) ** (-0.5)), 'seg_len': seg}
    _A_in = _A_setup()

    def _B_setup():
        B, S, D, F = (1, 2048, 640, 1536)
        return {'x': _w((lambda *s: torch.randn(*s, dtype=torch.bfloat16) * 0.05)(B, S, D)), 'w1': _w((lambda *s: torch.randn(*s, dtype=torch.bfloat16) * 0.05)(D, F)), 'b1': _w((lambda *s: torch.randn(*s, dtype=torch.bfloat16) * 0.05)(F)), 'w2': _w((lambda *s: torch.randn(*s, dtype=torch.bfloat16) * 0.05)(F, D)), 'b2': _w((lambda *s: torch.randn(*s, dtype=torch.bfloat16) * 0.05)(D))}
    _B_in = _B_setup()
    return {'A_x': _A_in['x'], 'A_mem0': _A_in['mem0'], 'A_Wq': _A_in['Wq'], 'A_Wk': _A_in['Wk'], 'A_Wv': _A_in['Wv'], 'A_Wo': _A_in['Wo'], 'A_seg_len': _A_in['seg_len'], 'B_x': _B_in['x'], 'B_w1': _B_in['w1'], 'B_b1': _B_in['b1'], 'B_w2': _B_in['w2'], 'B_b2': _B_in['b2']}

def reference(A_x, A_mem0, A_Wq, A_Wk, A_Wv, A_Wo, A_seg_len, B_x, B_w1, B_b1, B_w2, B_b2):

    def _A_ref(x, mem0, Wq, Wk, Wv, Wo, seg_len):
        B, S, Dm = x.shape
        H, Dh = (Wq.shape[1], Wq.shape[2])
        M = mem0.shape[1]
        scale = Dh ** (-0.5)
        n_seg = S // seg_len
        L = M + seg_len
        idx = torch.arange(L)
        mask = (idx[:, None] < M) | (idx[:, None] >= idx[None, :])
        mem = mem0
        outs = []
        for s in range(n_seg):
            xs = x[:, s * seg_len:(s + 1) * seg_len, :].clone()
            h = torch.concatenate([mem, xs], axis=1)
            q = torch.einsum('btd,dhe->bhte', h, Wq)
            k = torch.einsum('btd,dhe->bhte', h, Wk)
            v = torch.einsum('btd,dhe->bhte', h, Wv)
            scores = torch.einsum('bhqe,bhke->bhqk', q, k) * scale
            scores = torch.where(mask[None, None], scores, -1000000000.0)
            p = _softmax(scores, axis=-1)
            o = torch.einsum('bhqk,bhke->bhqe', p, v)
            o = torch.einsum('bhte,hed->btd', o, Wo)
            mem = o[:, :M, :].clone()
            outs.append(o[:, M:, :])
        return torch.concatenate(outs, axis=1)

    def _B_ref(x, w1, b1, w2, b2):
        h = torch.einsum('bsd,df->bsf', x, w1) + b1
        zero = torch.zeros_like(h)
        r = torch.where(h > zero, h, zero)
        h = r * r
        out = torch.einsum('bsf,fd->bsd', h, w2) + b2
        return out
    x = A_x
    xn = _layernorm(x, axis=-1)
    return x + _A_ref(xn, A_mem0, A_Wq, A_Wk, A_Wv, A_Wo, A_seg_len) + _B_ref(xn, B_w1, B_b1, B_w2, B_b2)
```

```asm
; @launch kernel=main_kernel grid=(256,1,1) block=(256,1,1) lds=123904
.amdgcn_target "amdgcn-amd-amdhsa--gfx950"
.text
.globl main_kernel
.p2align 8
.type main_kernel,@function
main_kernel:
  s_cmp_ge_u32 s2, 256
  s_cbranch_scc1 L_mend
  s_mov_b32 s22, s2
  s_load_dwordx4 s[40:43], s[0:1], 16
  s_load_dwordx4 s[44:47], s[0:1], 32
  s_load_dwordx2 s[48:49], s[0:1], 112
  s_load_dwordx2 s[50:51], s[0:1], 104
  v_and_b32 v1, 63, v0
  v_lshrrev_b32 v4, 6, v0
  v_and_b32 v2, 15, v0
  v_bfe_u32 v3, v0, 4, 2
  v_readfirstlane_b32 s29, v4
  s_waitcnt lgkmcnt(0)
  s_mov_b32 s4, s48
  s_and_b32 s5, s49, 0xffff
  s_mov_b32 s6, 268435456
  s_mov_b32 s7, 0x00020000
  s_getreg_b32 s20, hwreg(HW_REG_XCC_ID)
  s_and_b32 s20, s20, 7
  s_mov_b32 s12, s50
  s_and_b32 s13, s51, 0xffff
  s_mov_b32 s14, 256
  s_mov_b32 s15, 0x00020000
  s_cmp_lg_u32 s29, 0
  s_cbranch_scc1 L_mw
  s_lshl_b32 s72, s20, 2
  v_mov_b32 v4, s72
  v_mov_b32 v5, 1
  s_mov_b64 exec, 1
  buffer_atomic_add v5, v4, s[12:15], 0 offen sc0
  s_waitcnt vmcnt(0)
  v_mov_b32 v4, 0
  ds_write_b32 v4, v5
  s_waitcnt lgkmcnt(0)
  s_mov_b64 exec, -1
L_mw:
  s_barrier
  v_mov_b32 v4, 0
  ds_read_b32 v5, v4
  s_waitcnt lgkmcnt(0)
  v_readfirstlane_b32 s21, v5
  s_barrier
  s_load_dwordx4 s[84:87], s[0:1], 0
  s_load_dwordx2 s[88:89], s[0:1], 112
  s_waitcnt lgkmcnt(0)
  s_cmp_ge_u32 s22, 128
  s_cbranch_scc1 L_k0fill
  s_mov_b32 s16, s84
  s_and_b32 s17, s85, 0xffff
  s_mov_b32 s18, 2621440
  s_mov_b32 s19, 0x00020000
  s_lshl_b32 s90, s22, 4
  v_add_u32 v4, s90, v2
  s_movk_i32 s91, 1280
  v_mul_lo_u32 v4, v4, s91
  s_mul_i32 s90, s29, 320
  v_lshl_add_u32 v4, v3, 4, v4
  v_add_u32 v4, s90, v4
  buffer_load_dwordx4 v[8:11], v4, s[16:19], 0 offen offset:0
  buffer_load_dwordx4 v[12:15], v4, s[16:19], 0 offen offset:64
  buffer_load_dwordx4 v[16:19], v4, s[16:19], 0 offen offset:128
  buffer_load_dwordx4 v[20:23], v4, s[16:19], 0 offen offset:192
  buffer_load_dwordx4 v[24:27], v4, s[16:19], 0 offen offset:256
  s_waitcnt vmcnt(0)
  v_lshlrev_b32 v32, 16, v8
  v_and_b32 v33, 0xffff0000, v8
  v_lshlrev_b32 v34, 16, v9
  v_and_b32 v35, 0xffff0000, v9
  v_lshlrev_b32 v36, 16, v10
  v_and_b32 v37, 0xffff0000, v10
  v_lshlrev_b32 v38, 16, v11
  v_and_b32 v39, 0xffff0000, v11
  v_lshlrev_b32 v40, 16, v12
  v_and_b32 v41, 0xffff0000, v12
  v_lshlrev_b32 v42, 16, v13
  v_and_b32 v43, 0xffff0000, v13
  v_lshlrev_b32 v44, 16, v14
  v_and_b32 v45, 0xffff0000, v14
  v_lshlrev_b32 v46, 16, v15
  v_and_b32 v47, 0xffff0000, v15
  v_lshlrev_b32 v48, 16, v16
  v_and_b32 v49, 0xffff0000, v16
  v_lshlrev_b32 v50, 16, v17
  v_and_b32 v51, 0xffff0000, v17
  v_lshlrev_b32 v52, 16, v18
  v_and_b32 v53, 0xffff0000, v18
  v_lshlrev_b32 v54, 16, v19
  v_and_b32 v55, 0xffff0000, v19
  v_lshlrev_b32 v56, 16, v20
  v_and_b32 v57, 0xffff0000, v20
  v_lshlrev_b32 v58, 16, v21
  v_and_b32 v59, 0xffff0000, v21
  v_lshlrev_b32 v60, 16, v22
  v_and_b32 v61, 0xffff0000, v22
  v_lshlrev_b32 v62, 16, v23
  v_and_b32 v63, 0xffff0000, v23
  v_lshlrev_b32 v64, 16, v24
  v_and_b32 v65, 0xffff0000, v24
  v_lshlrev_b32 v66, 16, v25
  v_and_b32 v67, 0xffff0000, v25
  v_lshlrev_b32 v68, 16, v26
  v_and_b32 v69, 0xffff0000, v26
  v_lshlrev_b32 v70, 16, v27
  v_and_b32 v71, 0xffff0000, v27
  v_pk_add_f32 v[80:81], v[32:33], v[34:35]
  v_pk_add_f32 v[80:81], v[80:81], v[36:37]
  v_pk_add_f32 v[80:81], v[80:81], v[38:39]
  v_pk_add_f32 v[80:81], v[80:81], v[40:41]
  v_pk_add_f32 v[80:81], v[80:81], v[42:43]
  v_pk_add_f32 v[80:81], v[80:81], v[44:45]
  v_pk_add_f32 v[80:81], v[80:81], v[46:47]
  v_pk_add_f32 v[80:81], v[80:81], v[48:49]
  v_pk_add_f32 v[80:81], v[80:81], v[50:51]
  v_pk_add_f32 v[80:81], v[80:81], v[52:53]
  v_pk_add_f32 v[80:81], v[80:81], v[54:55]
  v_pk_add_f32 v[80:81], v[80:81], v[56:57]
  v_pk_add_f32 v[80:81], v[80:81], v[58:59]
  v_pk_add_f32 v[80:81], v[80:81], v[60:61]
  v_pk_add_f32 v[80:81], v[80:81], v[62:63]
  v_pk_add_f32 v[80:81], v[80:81], v[64:65]
  v_pk_add_f32 v[80:81], v[80:81], v[66:67]
  v_pk_add_f32 v[80:81], v[80:81], v[68:69]
  v_pk_add_f32 v[80:81], v[80:81], v[70:71]
  v_add_f32 v80, v80, v81
  v_mov_b32 v81, v80
  s_nop 1
  v_permlane32_swap_b32 v80, v81
  v_add_f32 v80, v80, v81
  v_mov_b32 v81, v80
  s_nop 1
  v_permlane16_swap_b32 v80, v81
  v_add_f32 v80, v80, v81
  s_lshl_b32 s90, s29, 6
  v_lshlrev_b32 v82, 2, v2
  v_add_u32 v82, 122880, v82
  v_add_u32 v83, s90, v82
  ds_write_b32 v83, v80
  s_waitcnt lgkmcnt(0)
  s_barrier
  ds_read_b32 v84, v82 offset:0
  ds_read_b32 v85, v82 offset:64
  ds_read_b32 v86, v82 offset:128
  ds_read_b32 v87, v82 offset:192
  s_waitcnt lgkmcnt(0)
  v_add_f32 v84, v84, v85
  v_add_f32 v86, v86, v87
  v_add_f32 v80, v84, v86
  s_mov_b32 s90, 0x3acccccd
  v_mul_f32 v80, s90, v80
  v_mov_b32 v90, v80
  v_mov_b32 v91, v80
  v_pk_add_f32 v[100:101], v[32:33], v[90:91] neg_lo:[0,1] neg_hi:[0,1]
  v_pk_mul_f32 v[100:101], v[100:101], v[100:101]
  v_pk_add_f32 v[102:103], v[34:35], v[90:91] neg_lo:[0,1] neg_hi:[0,1]
  v_pk_mul_f32 v[102:103], v[102:103], v[102:103]
  v_pk_add_f32 v[104:105], v[36:37], v[90:91] neg_lo:[0,1] neg_hi:[0,1]
  v_pk_mul_f32 v[104:105], v[104:105], v[104:105]
  v_pk_add_f32 v[106:107], v[38:39], v[90:91] neg_lo:[0,1] neg_hi:[0,1]
  v_pk_mul_f32 v[106:107], v[106:107], v[106:107]
  v_pk_add_f32 v[108:109], v[40:41], v[90:91] neg_lo:[0,1] neg_hi:[0,1]
  v_pk_mul_f32 v[108:109], v[108:109], v[108:109]
  v_pk_add_f32 v[110:111], v[42:43], v[90:91] neg_lo:[0,1] neg_hi:[0,1]
  v_pk_mul_f32 v[110:111], v[110:111], v[110:111]
  v_pk_add_f32 v[112:113], v[44:45], v[90:91] neg_lo:[0,1] neg_hi:[0,1]
  v_pk_mul_f32 v[112:113], v[112:113], v[112:113]
  v_pk_add_f32 v[114:115], v[46:47], v[90:91] neg_lo:[0,1] neg_hi:[0,1]
  v_pk_mul_f32 v[114:115], v[114:115], v[114:115]
  v_pk_add_f32 v[116:117], v[48:49], v[90:91] neg_lo:[0,1] neg_hi:[0,1]
  v_pk_mul_f32 v[116:117], v[116:117], v[116:117]
  v_pk_add_f32 v[118:119], v[50:51], v[90:91] neg_lo:[0,1] neg_hi:[0,1]
  v_pk_mul_f32 v[118:119], v[118:119], v[118:119]
  v_pk_add_f32 v[120:121], v[52:53], v[90:91] neg_lo:[0,1] neg_hi:[0,1]
  v_pk_mul_f32 v[120:121], v[120:121], v[120:121]
  v_pk_add_f32 v[122:123], v[54:55], v[90:91] neg_lo:[0,1] neg_hi:[0,1]
  v_pk_mul_f32 v[122:123], v[122:123], v[122:123]
  v_pk_add_f32 v[124:125], v[56:57], v[90:91] neg_lo:[0,1] neg_hi:[0,1]
  v_pk_mul_f32 v[124:125], v[124:125], v[124:125]
  v_pk_add_f32 v[126:127], v[58:59], v[90:91] neg_lo:[0,1] neg_hi:[0,1]
  v_pk_mul_f32 v[126:127], v[126:127], v[126:127]
  v_pk_add_f32 v[128:129], v[60:61], v[90:91] neg_lo:[0,1] neg_hi:[0,1]
  v_pk_mul_f32 v[128:129], v[128:129], v[128:129]
  v_pk_add_f32 v[130:131], v[62:63], v[90:91] neg_lo:[0,1] neg_hi:[0,1]
  v_pk_mul_f32 v[130:131], v[130:131], v[130:131]
  v_pk_add_f32 v[132:133], v[64:65], v[90:91] neg_lo:[0,1] neg_hi:[0,1]
  v_pk_mul_f32 v[132:133], v[132:133], v[132:133]
  v_pk_add_f32 v[134:135], v[66:67], v[90:91] neg_lo:[0,1] neg_hi:[0,1]
  v_pk_mul_f32 v[134:135], v[134:135], v[134:135]
  v_pk_add_f32 v[136:137], v[68:69], v[90:91] neg_lo:[0,1] neg_hi:[0,1]
  v_pk_mul_f32 v[136:137], v[136:137], v[136:137]
  v_pk_add_f32 v[138:139], v[70:71], v[90:91] neg_lo:[0,1] neg_hi:[0,1]
  v_pk_mul_f32 v[138:139], v[138:139], v[138:139]
  v_pk_add_f32 v[80:81], v[100:101], v[102:103]
  v_pk_add_f32 v[80:81], v[80:81], v[104:105]
  v_pk_add_f32 v[80:81], v[80:81], v[106:107]
  v_pk_add_f32 v[80:81], v[80:81], v[108:109]
  v_pk_add_f32 v[80:81], v[80:81], v[110:111]
  v_pk_add_f32 v[80:81], v[80:81], v[112:113]
  v_pk_add_f32 v[80:81], v[80:81], v[114:115]
  v_pk_add_f32 v[80:81], v[80:81], v[116:117]
  v_pk_add_f32 v[80:81], v[80:81], v[118:119]
  v_pk_add_f32 v[80:81], v[80:81], v[120:121]
  v_pk_add_f32 v[80:81], v[80:81], v[122:123]
  v_pk_add_f32 v[80:81], v[80:81], v[124:125]
  v_pk_add_f32 v[80:81], v[80:81], v[126:127]
  v_pk_add_f32 v[80:81], v[80:81], v[128:129]
  v_pk_add_f32 v[80:81], v[80:81], v[130:131]
  v_pk_add_f32 v[80:81], v[80:81], v[132:133]
  v_pk_add_f32 v[80:81], v[80:81], v[134:135]
  v_pk_add_f32 v[80:81], v[80:81], v[136:137]
  v_pk_add_f32 v[80:81], v[80:81], v[138:139]
  v_add_f32 v80, v80, v81
  v_mov_b32 v81, v80
  s_nop 1
  v_permlane32_swap_b32 v80, v81
  v_add_f32 v80, v80, v81
  v_mov_b32 v81, v80
  s_nop 1
  v_permlane16_swap_b32 v80, v81
  v_add_f32 v80, v80, v81
  s_lshl_b32 s90, s29, 6
  v_lshlrev_b32 v82, 2, v2
  v_add_u32 v82, 123136, v82
  v_add_u32 v83, s90, v82
  ds_write_b32 v83, v80
  s_waitcnt lgkmcnt(0)
  s_barrier
  ds_read_b32 v84, v82 offset:0
  ds_read_b32 v85, v82 offset:64
  ds_read_b32 v86, v82 offset:128
  ds_read_b32 v87, v82 offset:192
  s_waitcnt lgkmcnt(0)
  v_add_f32 v84, v84, v85
  v_add_f32 v86, v86, v87
  v_add_f32 v80, v84, v86
  s_mov_b32 s90, 0x3acccccd
  v_mul_f32 v80, s90, v80
  v_cvt_pk_bf16_f32 v92, v90, v80
  v_lshlrev_b32 v90, 16, v92
  v_and_b32 v93, 0xffff0000, v92
  v_add_f32 v93, 0x3727c5ac, v93
  v_cvt_pk_bf16_f32 v93, v93, v93
  v_lshlrev_b32 v93, 16, v93
  v_sqrt_f32 v93, v93
  s_nop 0
  v_cvt_pk_bf16_f32 v93, v93, v93
  v_lshlrev_b32 v93, 16, v93
  v_rcp_f32 v94, v93
  s_nop 0
  v_mov_b32 v95, v94
  v_mov_b32 v91, v90
  v_pk_add_f32 v[100:101], v[32:33], v[90:91] neg_lo:[0,1] neg_hi:[0,1]
  v_cvt_pk_bf16_f32 v8, v100, v101
  v_lshlrev_b32 v100, 16, v8
  v_and_b32 v101, 0xffff0000, v8
  v_pk_mul_f32 v[100:101], v[100:101], v[94:95]
  v_cvt_pk_bf16_f32 v8, v100, v101
  v_pk_add_f32 v[102:103], v[34:35], v[90:91] neg_lo:[0,1] neg_hi:[0,1]
  v_cvt_pk_bf16_f32 v9, v102, v103
  v_lshlrev_b32 v102, 16, v9
  v_and_b32 v103, 0xffff0000, v9
  v_pk_mul_f32 v[102:103], v[102:103], v[94:95]
  v_cvt_pk_bf16_f32 v9, v102, v103
  v_pk_add_f32 v[104:105], v[36:37], v[90:91] neg_lo:[0,1] neg_hi:[0,1]
  v_cvt_pk_bf16_f32 v10, v104, v105
  v_lshlrev_b32 v104, 16, v10
  v_and_b32 v105, 0xffff0000, v10
  v_pk_mul_f32 v[104:105], v[104:105], v[94:95]
  v_cvt_pk_bf16_f32 v10, v104, v105
  v_pk_add_f32 v[106:107], v[38:39], v[90:91] neg_lo:[0,1] neg_hi:[0,1]
  v_cvt_pk_bf16_f32 v11, v106, v107
  v_lshlrev_b32 v106, 16, v11
  v_and_b32 v107, 0xffff0000, v11
  v_pk_mul_f32 v[106:107], v[106:107], v[94:95]
  v_cvt_pk_bf16_f32 v11, v106, v107
  v_pk_add_f32 v[108:109], v[40:41], v[90:91] neg_lo:[0,1] neg_hi:[0,1]
  v_cvt_pk_bf16_f32 v12, v108, v109
  v_lshlrev_b32 v108, 16, v12
  v_and_b32 v109, 0xffff0000, v12
  v_pk_mul_f32 v[108:109], v[108:109], v[94:95]
  v_cvt_pk_bf16_f32 v12, v108, v109
  v_pk_add_f32 v[110:111], v[42:43], v[90:91] neg_lo:[0,1] neg_hi:[0,1]
  v_cvt_pk_bf16_f32 v13, v110, v111
  v_lshlrev_b32 v110, 16, v13
  v_and_b32 v111, 0xffff0000, v13
  v_pk_mul_f32 v[110:111], v[110:111], v[94:95]
  v_cvt_pk_bf16_f32 v13, v110, v111
  v_pk_add_f32 v[112:113], v[44:45], v[90:91] neg_lo:[0,1] neg_hi:[0,1]
  v_cvt_pk_bf16_f32 v14, v112, v113
  v_lshlrev_b32 v112, 16, v14
  v_and_b32 v113, 0xffff0000, v14
  v_pk_mul_f32 v[112:113], v[112:113], v[94:95]
  v_cvt_pk_bf16_f32 v14, v112, v113
  v_pk_add_f32 v[114:115], v[46:47], v[90:91] neg_lo:[0,1] neg_hi:[0,1]
  v_cvt_pk_bf16_f32 v15, v114, v115
  v_lshlrev_b32 v114, 16, v15
  v_and_b32 v115, 0xffff0000, v15
  v_pk_mul_f32 v[114:115], v[114:115], v[94:95]
  v_cvt_pk_bf16_f32 v15, v114, v115
  v_pk_add_f32 v[116:117], v[48:49], v[90:91] neg_lo:[0,1] neg_hi:[0,1]
  v_cvt_pk_bf16_f32 v16, v116, v117
  v_lshlrev_b32 v116, 16, v16
  v_and_b32 v117, 0xffff0000, v16
  v_pk_mul_f32 v[116:117], v[116:117], v[94:95]
  v_cvt_pk_bf16_f32 v16, v116, v117
  v_pk_add_f32 v[118:119], v[50:51], v[90:91] neg_lo:[0,1] neg_hi:[0,1]
  v_cvt_pk_bf16_f32 v17, v118, v119
  v_lshlrev_b32 v118, 16, v17
  v_and_b32 v119, 0xffff0000, v17
  v_pk_mul_f32 v[118:119], v[118:119], v[94:95]
  v_cvt_pk_bf16_f32 v17, v118, v119
  v_pk_add_f32 v[120:121], v[52:53], v[90:91] neg_lo:[0,1] neg_hi:[0,1]
  v_cvt_pk_bf16_f32 v18, v120, v121
  v_lshlrev_b32 v120, 16, v18
  v_and_b32 v121, 0xffff0000, v18
  v_pk_mul_f32 v[120:121], v[120:121], v[94:95]
  v_cvt_pk_bf16_f32 v18, v120, v121
  v_pk_add_f32 v[122:123], v[54:55], v[90:91] neg_lo:[0,1] neg_hi:[0,1]
  v_cvt_pk_bf16_f32 v19, v122, v123
  v_lshlrev_b32 v122, 16, v19
  v_and_b32 v123, 0xffff0000, v19
  v_pk_mul_f32 v[122:123], v[122:123], v[94:95]
  v_cvt_pk_bf16_f32 v19, v122, v123
  v_pk_add_f32 v[124:125], v[56:57], v[90:91] neg_lo:[0,1] neg_hi:[0,1]
  v_cvt_pk_bf16_f32 v20, v124, v125
  v_lshlrev_b32 v124, 16, v20
  v_and_b32 v125, 0xffff0000, v20
  v_pk_mul_f32 v[124:125], v[124:125], v[94:95]
  v_cvt_pk_bf16_f32 v20, v124, v125
  v_pk_add_f32 v[126:127], v[58:59], v[90:91] neg_lo:[0,1] neg_hi:[0,1]
  v_cvt_pk_bf16_f32 v21, v126, v127
  v_lshlrev_b32 v126, 16, v21
  v_and_b32 v127, 0xffff0000, v21
  v_pk_mul_f32 v[126:127], v[126:127], v[94:95]
  v_cvt_pk_bf16_f32 v21, v126, v127
  v_pk_add_f32 v[128:129], v[60:61], v[90:91] neg_lo:[0,1] neg_hi:[0,1]
  v_cvt_pk_bf16_f32 v22, v128, v129
  v_lshlrev_b32 v128, 16, v22
  v_and_b32 v129, 0xffff0000, v22
  v_pk_mul_f32 v[128:129], v[128:129], v[94:95]
  v_cvt_pk_bf16_f32 v22, v128, v129
  v_pk_add_f32 v[130:131], v[62:63], v[90:91] neg_lo:[0,1] neg_hi:[0,1]
  v_cvt_pk_bf16_f32 v23, v130, v131
  v_lshlrev_b32 v130, 16, v23
  v_and_b32 v131, 0xffff0000, v23
  v_pk_mul_f32 v[130:131], v[130:131], v[94:95]
  v_cvt_pk_bf16_f32 v23, v130, v131
  v_pk_add_f32 v[132:133], v[64:65], v[90:91] neg_lo:[0,1] neg_hi:[0,1]
  v_cvt_pk_bf16_f32 v24, v132, v133
  v_lshlrev_b32 v132, 16, v24
  v_and_b32 v133, 0xffff0000, v24
  v_pk_mul_f32 v[132:133], v[132:133], v[94:95]
  v_cvt_pk_bf16_f32 v24, v132, v133
  v_pk_add_f32 v[134:135], v[66:67], v[90:91] neg_lo:[0,1] neg_hi:[0,1]
  v_cvt_pk_bf16_f32 v25, v134, v135
  v_lshlrev_b32 v134, 16, v25
  v_and_b32 v135, 0xffff0000, v25
  v_pk_mul_f32 v[134:135], v[134:135], v[94:95]
  v_cvt_pk_bf16_f32 v25, v134, v135
  v_pk_add_f32 v[136:137], v[68:69], v[90:91] neg_lo:[0,1] neg_hi:[0,1]
  v_cvt_pk_bf16_f32 v26, v136, v137
  v_lshlrev_b32 v136, 16, v26
  v_and_b32 v137, 0xffff0000, v26
  v_pk_mul_f32 v[136:137], v[136:137], v[94:95]
  v_cvt_pk_bf16_f32 v26, v136, v137
  v_pk_add_f32 v[138:139], v[70:71], v[90:91] neg_lo:[0,1] neg_hi:[0,1]
  v_cvt_pk_bf16_f32 v27, v138, v139
  v_lshlrev_b32 v138, 16, v27
  v_and_b32 v139, 0xffff0000, v27
  v_pk_mul_f32 v[138:139], v[138:139], v[94:95]
  v_cvt_pk_bf16_f32 v27, v138, v139
  s_mul_i32 s90, s22, 20480
  s_mul_i32 s91, s29, 5120
  s_add_u32 s90, s90, s91
  s_add_u32 s90, s90, 0
  v_lshlrev_b32 v4, 4, v1
  buffer_store_dwordx4 v[8:11], v4, s[4:7], s90 offen offset:0 sc1
  buffer_store_dwordx4 v[12:15], v4, s[4:7], s90 offen offset:1024 sc1
  buffer_store_dwordx4 v[16:19], v4, s[4:7], s90 offen offset:2048 sc1
  buffer_store_dwordx4 v[20:23], v4, s[4:7], s90 offen offset:3072 sc1
  s_add_u32 s90, s90, 4096
  buffer_store_dwordx4 v[24:27], v4, s[4:7], s90 offen sc1
  s_branch L_k0done
L_k0fill:
  s_sub_u32 s90, s22, 128
  s_lshl_b32 s90, s90, 2
  s_add_u32 s90, s90, s29
  v_lshlrev_b32 v4, 4, v1
  v_mov_b32 v8, -1
  v_mov_b32 v12, 0
  v_mov_b32 v9, -1
  v_mov_b32 v13, 0
  v_mov_b32 v10, -1
  v_mov_b32 v14, 0
  v_mov_b32 v11, -1
  v_mov_b32 v15, 0
  s_add_u32 s16, s88, 103284736
  s_addc_u32 s17, s89, 0
  s_and_b32 s17, s17, 0xffff
  s_mov_b32 s18, 4456448
  s_mov_b32 s19, 0x00020000
  s_mul_i32 s91, s90, 9216
  s_add_u32 s83, s91, 0
  buffer_store_dwordx4 v[8:11], v4, s[16:19], s83 offen sc1
  s_add_u32 s83, s91, 1024
  buffer_store_dwordx4 v[8:11], v4, s[16:19], s83 offen sc1
  s_add_u32 s83, s91, 2048
  buffer_store_dwordx4 v[8:11], v4, s[16:19], s83 offen sc1
  s_add_u32 s83, s91, 3072
  buffer_store_dwordx4 v[8:11], v4, s[16:19], s83 offen sc1
  s_add_u32 s83, s91, 4096
  buffer_store_dwordx4 v[8:11], v4, s[16:19], s83 offen sc1
  s_add_u32 s83, s91, 5120
  buffer_store_dwordx4 v[8:11], v4, s[16:19], s83 offen sc1
  s_add_u32 s83, s91, 6144
  buffer_store_dwordx4 v[8:11], v4, s[16:19], s83 offen sc1
  s_add_u32 s83, s91, 7168
  buffer_store_dwordx4 v[8:11], v4, s[16:19], s83 offen sc1
  s_add_u32 s83, s91, 8192
  buffer_store_dwordx4 v[8:11], v4, s[16:19], s83 offen sc1
  s_add_u32 s16, s88, 108068864
  s_addc_u32 s17, s89, 0
  s_and_b32 s17, s17, 0xffff
  s_mov_b32 s18, 573440
  s_mul_i32 s91, s90, 2048
  s_add_u32 s83, s91, 0
  buffer_store_dwordx4 v[12:15], v4, s[16:19], s83 offen sc1
  s_add_u32 s83, s91, 1024
  buffer_store_dwordx4 v[12:15], v4, s[16:19], s83 offen sc1
  s_cmp_ge_u32 s90, 32
  s_cbranch_scc1 L_k0done
  s_mul_i32 s91, s90, 10240
  s_add_u32 s91, s91, 107741184
  s_and_b32 s83, s90, 3
  s_cmp_eq_u32 s83, 0
  s_cbranch_scc1 L_k0mem
  s_add_u32 s83, s91, 0
  buffer_store_dwordx4 v[8:11], v4, s[4:7], s83 offen sc1
  s_add_u32 s83, s91, 1024
  buffer_store_dwordx4 v[8:11], v4, s[4:7], s83 offen sc1
  s_add_u32 s83, s91, 2048
  buffer_store_dwordx4 v[8:11], v4, s[4:7], s83 offen sc1
  s_add_u32 s83, s91, 3072
  buffer_store_dwordx4 v[8:11], v4, s[4:7], s83 offen sc1
  s_add_u32 s83, s91, 4096
  buffer_store_dwordx4 v[8:11], v4, s[4:7], s83 offen sc1
  s_add_u32 s83, s91, 5120
  buffer_store_dwordx4 v[8:11], v4, s[4:7], s83 offen sc1
  s_add_u32 s83, s91, 6144
  buffer_store_dwordx4 v[8:11], v4, s[4:7], s83 offen sc1
  s_add_u32 s83, s91, 7168
  buffer_store_dwordx4 v[8:11], v4, s[4:7], s83 offen sc1
  s_add_u32 s83, s91, 8192
  buffer_store_dwordx4 v[8:11], v4, s[4:7], s83 offen sc1
  s_add_u32 s83, s91, 9216
  buffer_store_dwordx4 v[8:11], v4, s[4:7], s83 offen sc1
  s_branch L_k0done
L_k0mem:
  s_mov_b32 s16, s86
  s_and_b32 s17, s87, 0xffff
  s_mov_b32 s18, 10240
  s_mov_b32 s19, 0x00020000
  v_add_u32 v5, 0, v1
  v_lshrrev_b32 v6, 5, v5
  v_lshlrev_b32 v6, 6, v6
  v_bfe_u32 v7, v5, 3, 2
  v_lshl_add_u32 v6, v7, 4, v6
  v_and_b32 v7, 7, v5
  s_movk_i32 s83, 1280
  v_mad_u32_u24 v6, v7, s83, v6
  buffer_load_dwordx4 v[16:19], v6, s[16:19], 0 offen
  v_add_u32 v5, 64, v1
  v_lshrrev_b32 v6, 5, v5
  v_lshlrev_b32 v6, 6, v6
  v_bfe_u32 v7, v5, 3, 2
  v_lshl_add_u32 v6, v7, 4, v6
  v_and_b32 v7, 7, v5
  s_movk_i32 s83, 1280
  v_mad_u32_u24 v6, v7, s83, v6
  buffer_load_dwordx4 v[20:23], v6, s[16:19], 0 offen
  v_add_u32 v5, 128, v1
  v_lshrrev_b32 v6, 5, v5
  v_lshlrev_b32 v6, 6, v6
  v_bfe_u32 v7, v5, 3, 2
  v_lshl_add_u32 v6, v7, 4, v6
  v_and_b32 v7, 7, v5
  s_movk_i32 s83, 1280
  v_mad_u32_u24 v6, v7, s83, v6
  buffer_load_dwordx4 v[24:27], v6, s[16:19], 0 offen
  v_add_u32 v5, 192, v1
  v_lshrrev_b32 v6, 5, v5
  v_lshlrev_b32 v6, 6, v6
  v_bfe_u32 v7, v5, 3, 2
  v_lshl_add_u32 v6, v7, 4, v6
  v_and_b32 v7, 7, v5
  s_movk_i32 s83, 1280
  v_mad_u32_u24 v6, v7, s83, v6
  buffer_load_dwordx4 v[28:31], v6, s[16:19], 0 offen
  v_add_u32 v5, 256, v1
  v_lshrrev_b32 v6, 5, v5
  v_lshlrev_b32 v6, 6, v6
  v_bfe_u32 v7, v5, 3, 2
  v_lshl_add_u32 v6, v7, 4, v6
  v_and_b32 v7, 7, v5
  s_movk_i32 s83, 1280
  v_mad_u32_u24 v6, v7, s83, v6
  buffer_load_dwordx4 v[32:35], v6, s[16:19], 0 offen
  v_add_u32 v5, 320, v1
  v_lshrrev_b32 v6, 5, v5
  v_lshlrev_b32 v6, 6, v6
  v_bfe_u32 v7, v5, 3, 2
  v_lshl_add_u32 v6, v7, 4, v6
  v_and_b32 v7, 7, v5
  s_movk_i32 s83, 1280
  v_mad_u32_u24 v6, v7, s83, v6
  buffer_load_dwordx4 v[36:39], v6, s[16:19], 0 offen
  v_add_u32 v5, 384, v1
  v_lshrrev_b32 v6, 5, v5
  v_lshlrev_b32 v6, 6, v6
  v_bfe_u32 v7, v5, 3, 2
  v_lshl_add_u32 v6, v7, 4, v6
  v_and_b32 v7, 7, v5
  s_movk_i32 s83, 1280
  v_mad_u32_u24 v6, v7, s83, v6
  buffer_load_dwordx4 v[40:43], v6, s[16:19], 0 offen
  v_add_u32 v5, 448, v1
  v_lshrrev_b32 v6, 5, v5
  v_lshlrev_b32 v6, 6, v6
  v_bfe_u32 v7, v5, 3, 2
  v_lshl_add_u32 v6, v7, 4, v6
  v_and_b32 v7, 7, v5
  s_movk_i32 s83, 1280
  v_mad_u32_u24 v6, v7, s83, v6
  buffer_load_dwordx4 v[44:47], v6, s[16:19], 0 offen
  v_add_u32 v5, 512, v1
  v_lshrrev_b32 v6, 5, v5
  v_lshlrev_b32 v6, 6, v6
  v_bfe_u32 v7, v5, 3, 2
  v_lshl_add_u32 v6, v7, 4, v6
  v_and_b32 v7, 7, v5
  s_movk_i32 s83, 1280
  v_mad_u32_u24 v6, v7, s83, v6
  buffer_load_dwordx4 v[48:51], v6, s[16:19], 0 offen
  v_add_u32 v5, 576, v1
  v_lshrrev_b32 v6, 5, v5
  v_lshlrev_b32 v6, 6, v6
  v_bfe_u32 v7, v5, 3, 2
  v_lshl_add_u32 v6, v7, 4, v6
  v_and_b32 v7, 7, v5
  s_movk_i32 s83, 1280
  v_mad_u32_u24 v6, v7, s83, v6
  buffer_load_dwordx4 v[52:55], v6, s[16:19], 0 offen
  s_waitcnt vmcnt(0)
  s_add_u32 s83, s91, 0
  buffer_store_dwordx4 v[16:19], v4, s[4:7], s83 offen sc1
  s_add_u32 s83, s91, 1024
  buffer_store_dwordx4 v[20:23], v4, s[4:7], s83 offen sc1
  s_add_u32 s83, s91, 2048
  buffer_store_dwordx4 v[24:27], v4, s[4:7], s83 offen sc1
  s_add_u32 s83, s91, 3072
  buffer_store_dwordx4 v[28:31], v4, s[4:7], s83 offen sc1
  s_add_u32 s83, s91, 4096
  buffer_store_dwordx4 v[32:35], v4, s[4:7], s83 offen sc1
  s_add_u32 s83, s91, 5120
  buffer_store_dwordx4 v[36:39], v4, s[4:7], s83 offen sc1
  s_add_u32 s83, s91, 6144
  buffer_store_dwordx4 v[40:43], v4, s[4:7], s83 offen sc1
  s_add_u32 s83, s91, 7168
  buffer_store_dwordx4 v[44:47], v4, s[4:7], s83 offen sc1
  s_add_u32 s83, s91, 8192
  buffer_store_dwordx4 v[48:51], v4, s[4:7], s83 offen sc1
  s_add_u32 s83, s91, 9216
  buffer_store_dwordx4 v[52:55], v4, s[4:7], s83 offen sc1
L_k0done:
  s_waitcnt vmcnt(0)
  s_barrier
  s_cmp_lg_u32 s29, 0
  s_cbranch_scc1 L_k0c
  s_mov_b32 s12, s50
  s_and_b32 s13, s51, 0xffff
  s_mov_b32 s14, 256
  s_mov_b32 s15, 0x00020000
  v_mov_b32 v4, 32
  v_mov_b32 v5, 1
  s_mov_b64 exec, 1
  buffer_atomic_add v5, v4, s[12:15], 0 offen
  s_mov_b64 exec, -1
L_k0c:
  s_cmp_ge_u32 s21, 32
  s_cbranch_scc1 L_slow
  s_mov_b32 s24, s20
  s_cmp_ge_u32 s21, 16
  s_cbranch_scc1 L_fastx
  s_mov_b32 s25, s21
  s_branch L_fastc
L_fastc:
  s_mov_b32 s71, 0
  s_lshr_b32 s26, s25, 2
  s_and_b32 s27, s25, 3
  s_lshl_b32 s28, s24, 2
  s_add_u32 s31, s28, s29
  s_add_u32 s28, s28, s26
  s_mov_b32 s70, 0x3dd53b95
  s_mov_b32 s10, 7864320
  s_mov_b32 s11, 0x00020000
  v_lshrrev_b32 v4, 2, v2
  v_and_b32 v5, 3, v2
  s_mul_i32 s72, s29, 160
  v_lshl_add_u32 v6, v3, 3, v4
  v_add_u32 v6, s72, v6
  v_mul_u32_u24 v6, 96, v6
  v_lshl_add_u32 v20, v5, 3, v6
  v_lshl_add_u32 v6, v3, 2, v4
  v_mul_u32_u24 v6, 96, v6
  v_lshl_add_u32 v21, v5, 3, v6
  s_mul_i32 s72, s29, 18432
  v_add_u32 v21, s72, v21
  s_mul_i32 s72, s29, 960
  s_add_u32 s72, s72, 0
  v_add_u32 v6, s72, v1
  s_mov_b32 s73, 43691
  v_mul_lo_u32 v7, v6, s73
  v_lshrrev_b32 v7, 18, v7
  v_mul_u32_u24 v30, 6, v7
  v_sub_u32 v30, v6, v30
  v_lshlrev_b32 v30, 4, v30
  s_movk_i32 s73, 12288
  v_mad_u32_u24 v30, v7, s73, v30
  v_add_u32 v6, 0, v1
  s_mov_b32 s73, 43691
  v_mul_lo_u32 v7, v6, s73
  v_lshrrev_b32 v7, 18, v7
  v_mul_u32_u24 v50, 6, v7
  v_sub_u32 v50, v6, v50
  v_lshlrev_b32 v50, 4, v50
  s_movk_i32 s73, 1280
  v_mad_u32_u24 v50, v7, s73, v50
  s_mul_i32 s72, s29, 960
  s_add_u32 s72, s72, 64
  v_add_u32 v6, s72, v1
  s_mov_b32 s73, 43691
  v_mul_lo_u32 v7, v6, s73
  v_lshrrev_b32 v7, 18, v7
  v_mul_u32_u24 v31, 6, v7
  v_sub_u32 v31, v6, v31
  v_lshlrev_b32 v31, 4, v31
  s_movk_i32 s73, 12288
  v_mad_u32_u24 v31, v7, s73, v31
  v_add_u32 v6, 64, v1
  s_mov_b32 s73, 43691
  v_mul_lo_u32 v7, v6, s73
  v_lshrrev_b32 v7, 18, v7
  v_mul_u32_u24 v51, 6, v7
  v_sub_u32 v51, v6, v51
  v_lshlrev_b32 v51, 4, v51
  s_movk_i32 s73, 1280
  v_mad_u32_u24 v51, v7, s73, v51
  s_mul_i32 s72, s29, 960
  s_add_u32 s72, s72, 128
  v_add_u32 v6, s72, v1
  s_mov_b32 s73, 43691
  v_mul_lo_u32 v7, v6, s73
  v_lshrrev_b32 v7, 18, v7
  v_mul_u32_u24 v32, 6, v7
  v_sub_u32 v32, v6, v32
  v_lshlrev_b32 v32, 4, v32
  s_movk_i32 s73, 12288
  v_mad_u32_u24 v32, v7, s73, v32
  v_add_u32 v6, 128, v1
  s_mov_b32 s73, 43691
  v_mul_lo_u32 v7, v6, s73
  v_lshrrev_b32 v7, 18, v7
  v_mul_u32_u24 v52, 6, v7
  v_sub_u32 v52, v6, v52
  v_lshlrev_b32 v52, 4, v52
  s_movk_i32 s73, 1280
  v_mad_u32_u24 v52, v7, s73, v52
  s_mul_i32 s72, s29, 960
  s_add_u32 s72, s72, 192
  v_add_u32 v6, s72, v1
  s_mov_b32 s73, 43691
  v_mul_lo_u32 v7, v6, s73
  v_lshrrev_b32 v7, 18, v7
  v_mul_u32_u24 v33, 6, v7
  v_sub_u32 v33, v6, v33
  v_lshlrev_b32 v33, 4, v33
  s_movk_i32 s73, 12288
  v_mad_u32_u24 v33, v7, s73, v33
  v_add_u32 v6, 192, v1
  s_mov_b32 s73, 43691
  v_mul_lo_u32 v7, v6, s73
  v_lshrrev_b32 v7, 18, v7
  v_mul_u32_u24 v53, 6, v7
  v_sub_u32 v53, v6, v53
  v_lshlrev_b32 v53, 4, v53
  s_movk_i32 s73, 1280
  v_mad_u32_u24 v53, v7, s73, v53
  s_mul_i32 s72, s29, 960
  s_add_u32 s72, s72, 256
  v_add_u32 v6, s72, v1
  s_mov_b32 s73, 43691
  v_mul_lo_u32 v7, v6, s73
  v_lshrrev_b32 v7, 18, v7
  v_mul_u32_u24 v34, 6, v7
  v_sub_u32 v34, v6, v34
  v_lshlrev_b32 v34, 4, v34
  s_movk_i32 s73, 12288
  v_mad_u32_u24 v34, v7, s73, v34
  v_add_u32 v6, 256, v1
  s_mov_b32 s73, 43691
  v_mul_lo_u32 v7, v6, s73
  v_lshrrev_b32 v7, 18, v7
  v_mul_u32_u24 v54, 6, v7
  v_sub_u32 v54, v6, v54
  v_lshlrev_b32 v54, 4, v54
  s_movk_i32 s73, 1280
  v_mad_u32_u24 v54, v7, s73, v54
  s_mul_i32 s72, s29, 960
  s_add_u32 s72, s72, 320
  v_add_u32 v6, s72, v1
  s_mov_b32 s73, 43691
  v_mul_lo_u32 v7, v6, s73
  v_lshrrev_b32 v7, 18, v7
  v_mul_u32_u24 v35, 6, v7
  v_sub_u32 v35, v6, v35
  v_lshlrev_b32 v35, 4, v35
  s_movk_i32 s73, 12288
  v_mad_u32_u24 v35, v7, s73, v35
  v_add_u32 v6, 320, v1
  s_mov_b32 s73, 43691
  v_mul_lo_u32 v7, v6, s73
  v_lshrrev_b32 v7, 18, v7
  v_mul_u32_u24 v55, 6, v7
  v_sub_u32 v55, v6, v55
  v_lshlrev_b32 v55, 4, v55
  s_movk_i32 s73, 1280
  v_mad_u32_u24 v55, v7, s73, v55
  s_mul_i32 s72, s29, 960
  s_add_u32 s72, s72, 384
  v_add_u32 v6, s72, v1
  s_mov_b32 s73, 43691
  v_mul_lo_u32 v7, v6, s73
  v_lshrrev_b32 v7, 18, v7
  v_mul_u32_u24 v36, 6, v7
  v_sub_u32 v36, v6, v36
  v_lshlrev_b32 v36, 4, v36
  s_movk_i32 s73, 12288
  v_mad_u32_u24 v36, v7, s73, v36
  v_add_u32 v6, 384, v1
  s_mov_b32 s73, 43691
  v_mul_lo_u32 v7, v6, s73
  v_lshrrev_b32 v7, 18, v7
  v_mul_u32_u24 v56, 6, v7
  v_sub_u32 v56, v6, v56
  v_lshlrev_b32 v56, 4, v56
  s_movk_i32 s73, 1280
  v_mad_u32_u24 v56, v7, s73, v56
  s_mul_i32 s72, s29, 960
  s_add_u32 s72, s72, 448
  v_add_u32 v6, s72, v1
  s_mov_b32 s73, 43691
  v_mul_lo_u32 v7, v6, s73
  v_lshrrev_b32 v7, 18, v7
  v_mul_u32_u24 v37, 6, v7
  v_sub_u32 v37, v6, v37
  v_lshlrev_b32 v37, 4, v37
  s_movk_i32 s73, 12288
  v_mad_u32_u24 v37, v7, s73, v37
  v_add_u32 v6, 448, v1
  s_mov_b32 s73, 43691
  v_mul_lo_u32 v7, v6, s73
  v_lshrrev_b32 v7, 18, v7
  v_mul_u32_u24 v57, 6, v7
  v_sub_u32 v57, v6, v57
  v_lshlrev_b32 v57, 4, v57
  s_movk_i32 s73, 1280
  v_mad_u32_u24 v57, v7, s73, v57
  s_mul_i32 s72, s29, 960
  s_add_u32 s72, s72, 512
  v_add_u32 v6, s72, v1
  s_mov_b32 s73, 43691
  v_mul_lo_u32 v7, v6, s73
  v_lshrrev_b32 v7, 18, v7
  v_mul_u32_u24 v38, 6, v7
  v_sub_u32 v38, v6, v38
  v_lshlrev_b32 v38, 4, v38
  s_movk_i32 s73, 12288
  v_mad_u32_u24 v38, v7, s73, v38
  v_add_u32 v6, 512, v1
  s_mov_b32 s73, 43691
  v_mul_lo_u32 v7, v6, s73
  v_lshrrev_b32 v7, 18, v7
  v_mul_u32_u24 v58, 6, v7
  v_sub_u32 v58, v6, v58
  v_lshlrev_b32 v58, 4, v58
  s_movk_i32 s73, 1280
  v_mad_u32_u24 v58, v7, s73, v58
  s_mul_i32 s72, s29, 960
  s_add_u32 s72, s72, 576
  v_add_u32 v6, s72, v1
  s_mov_b32 s73, 43691
  v_mul_lo_u32 v7, v6, s73
  v_lshrrev_b32 v7, 18, v7
  v_mul_u32_u24 v39, 6, v7
  v_sub_u32 v39, v6, v39
  v_lshlrev_b32 v39, 4, v39
  s_movk_i32 s73, 12288
  v_mad_u32_u24 v39, v7, s73, v39
  v_add_u32 v6, 576, v1
  s_mov_b32 s73, 43691
  v_mul_lo_u32 v7, v6, s73
  v_lshrrev_b32 v7, 18, v7
  v_mul_u32_u24 v59, 6, v7
  v_sub_u32 v59, v6, v59
  v_lshlrev_b32 v59, 4, v59
  s_movk_i32 s73, 1280
  v_mad_u32_u24 v59, v7, s73, v59
  s_mul_i32 s72, s29, 960
  s_add_u32 s72, s72, 640
  v_add_u32 v6, s72, v1
  s_mov_b32 s73, 43691
  v_mul_lo_u32 v7, v6, s73
  v_lshrrev_b32 v7, 18, v7
  v_mul_u32_u24 v40, 6, v7
  v_sub_u32 v40, v6, v40
  v_lshlrev_b32 v40, 4, v40
  s_movk_i32 s73, 12288
  v_mad_u32_u24 v40, v7, s73, v40
  v_add_u32 v6, 640, v1
  s_mov_b32 s73, 43691
  v_mul_lo_u32 v7, v6, s73
  v_lshrrev_b32 v7, 18, v7
  v_mul_u32_u24 v60, 6, v7
  v_sub_u32 v60, v6, v60
  v_lshlrev_b32 v60, 4, v60
  s_movk_i32 s73, 1280
  v_mad_u32_u24 v60, v7, s73, v60
  s_mul_i32 s72, s29, 960
  s_add_u32 s72, s72, 704
  v_add_u32 v6, s72, v1
  s_mov_b32 s73, 43691
  v_mul_lo_u32 v7, v6, s73
  v_lshrrev_b32 v7, 18, v7
  v_mul_u32_u24 v41, 6, v7
  v_sub_u32 v41, v6, v41
  v_lshlrev_b32 v41, 4, v41
  s_movk_i32 s73, 12288
  v_mad_u32_u24 v41, v7, s73, v41
  v_add_u32 v6, 704, v1
  s_mov_b32 s73, 43691
  v_mul_lo_u32 v7, v6, s73
  v_lshrrev_b32 v7, 18, v7
  v_mul_u32_u24 v61, 6, v7
  v_sub_u32 v61, v6, v61
  v_lshlrev_b32 v61, 4, v61
  s_movk_i32 s73, 1280
  v_mad_u32_u24 v61, v7, s73, v61
  s_mul_i32 s72, s29, 960
  s_add_u32 s72, s72, 768
  v_add_u32 v6, s72, v1
  s_mov_b32 s73, 43691
  v_mul_lo_u32 v7, v6, s73
  v_lshrrev_b32 v7, 18, v7
  v_mul_u32_u24 v42, 6, v7
  v_sub_u32 v42, v6, v42
  v_lshlrev_b32 v42, 4, v42
  s_movk_i32 s73, 12288
  v_mad_u32_u24 v42, v7, s73, v42
  v_add_u32 v6, 768, v1
  s_mov_b32 s73, 43691
  v_mul_lo_u32 v7, v6, s73
  v_lshrrev_b32 v7, 18, v7
  v_mul_u32_u24 v62, 6, v7
  v_sub_u32 v62, v6, v62
  v_lshlrev_b32 v62, 4, v62
  s_movk_i32 s73, 1280
  v_mad_u32_u24 v62, v7, s73, v62
  s_mul_i32 s72, s29, 960
  s_add_u32 s72, s72, 832
  v_add_u32 v6, s72, v1
  s_mov_b32 s73, 43691
  v_mul_lo_u32 v7, v6, s73
  v_lshrrev_b32 v7, 18, v7
  v_mul_u32_u24 v43, 6, v7
  v_sub_u32 v43, v6, v43
  v_lshlrev_b32 v43, 4, v43
  s_movk_i32 s73, 12288
  v_mad_u32_u24 v43, v7, s73, v43
  v_add_u32 v6, 832, v1
  s_mov_b32 s73, 43691
  v_mul_lo_u32 v7, v6, s73
  v_lshrrev_b32 v7, 18, v7
  v_mul_u32_u24 v63, 6, v7
  v_sub_u32 v63, v6, v63
  v_lshlrev_b32 v63, 4, v63
  s_movk_i32 s73, 1280
  v_mad_u32_u24 v63, v7, s73, v63
  s_mul_i32 s72, s29, 960
  s_add_u32 s72, s72, 896
  v_add_u32 v6, s72, v1
  s_mov_b32 s73, 43691
  v_mul_lo_u32 v7, v6, s73
  v_lshrrev_b32 v7, 18, v7
  v_mul_u32_u24 v44, 6, v7
  v_sub_u32 v44, v6, v44
  v_lshlrev_b32 v44, 4, v44
  s_movk_i32 s73, 12288
  v_mad_u32_u24 v44, v7, s73, v44
  v_add_u32 v6, 896, v1
  s_mov_b32 s73, 43691
  v_mul_lo_u32 v7, v6, s73
  v_lshrrev_b32 v7, 18, v7
  v_mul_u32_u24 v64, 6, v7
  v_sub_u32 v64, v6, v64
  v_lshlrev_b32 v64, 4, v64
  s_movk_i32 s73, 1280
  v_mad_u32_u24 v64, v7, s73, v64
  v_add_u32 v6, 960, v1
  s_mov_b32 s73, 43691
  v_mul_lo_u32 v7, v6, s73
  v_lshrrev_b32 v7, 18, v7
  v_mul_u32_u24 v65, 6, v7
  v_sub_u32 v65, v6, v65
  v_lshlrev_b32 v65, 4, v65
  s_movk_i32 s73, 1280
  v_mad_u32_u24 v65, v7, s73, v65
  v_add_u32 v6, 1024, v1
  s_mov_b32 s73, 43691
  v_mul_lo_u32 v7, v6, s73
  v_lshrrev_b32 v7, 18, v7
  v_mul_u32_u24 v66, 6, v7
  v_sub_u32 v66, v6, v66
  v_lshlrev_b32 v66, 4, v66
  s_movk_i32 s73, 1280
  v_mad_u32_u24 v66, v7, s73, v66
  v_add_u32 v6, 1088, v1
  s_mov_b32 s73, 43691
  v_mul_lo_u32 v7, v6, s73
  v_lshrrev_b32 v7, 18, v7
  v_mul_u32_u24 v67, 6, v7
  v_sub_u32 v67, v6, v67
  v_lshlrev_b32 v67, 4, v67
  s_movk_i32 s73, 1280
  v_mad_u32_u24 v67, v7, s73, v67
  s_mul_i32 s74, s28, 384
  s_mul_i32 s72, s27, 96
  s_add_u32 s74, s74, s72
  s_mul_i32 s75, s31, 245760
  s_mul_i32 s72, s25, 80
  s_add_u32 s75, s75, s72
  v_add_u32 v22, 61440, v20
  s_mov_b32 s8, s40
  s_and_b32 s9, s41, 0xffff
  s_mul_i32 s72, s29, 15360
  s_add_u32 s72, s72, 0
  s_add_u32 m0, s72, 0
  s_nop 0
  buffer_load_dwordx4 v30, s[8:11], s74 offen lds
  s_add_u32 m0, s72, 1024
  s_nop 0
  buffer_load_dwordx4 v31, s[8:11], s74 offen lds
  s_add_u32 m0, s72, 2048
  s_nop 0
  buffer_load_dwordx4 v32, s[8:11], s74 offen lds
  s_add_u32 m0, s72, 3072
  s_nop 0
  buffer_load_dwordx4 v33, s[8:11], s74 offen lds
  s_add_u32 m0, s72, 4096
  s_nop 0
  buffer_load_dwordx4 v34, s[8:11], s74 offen lds
  s_add_u32 m0, s72, 5120
  s_nop 0
  buffer_load_dwordx4 v35, s[8:11], s74 offen lds
  s_add_u32 m0, s72, 6144
  s_nop 0
  buffer_load_dwordx4 v36, s[8:11], s74 offen lds
  s_add_u32 m0, s72, 7168
  s_nop 0
  buffer_load_dwordx4 v37, s[8:11], s74 offen lds
  s_add_u32 m0, s72, 8192
  s_nop 0
  buffer_load_dwordx4 v38, s[8:11], s74 offen lds
  s_add_u32 m0, s72, 9216
  s_nop 0
  buffer_load_dwordx4 v39, s[8:11], s74 offen lds
  s_add_u32 m0, s72, 10240
  s_nop 0
  buffer_load_dwordx4 v40, s[8:11], s74 offen lds
  s_add_u32 m0, s72, 11264
  s_nop 0
  buffer_load_dwordx4 v41, s[8:11], s74 offen lds
  s_add_u32 m0, s72, 12288
  s_nop 0
  buffer_load_dwordx4 v42, s[8:11], s74 offen lds
  s_add_u32 m0, s72, 13312
  s_nop 0
  buffer_load_dwordx4 v43, s[8:11], s74 offen lds
  s_add_u32 m0, s72, 14336
  s_nop 0
  buffer_load_dwordx4 v44, s[8:11], s74 offen lds
  s_mov_b32 s8, s42
  s_and_b32 s9, s43, 0xffff
  s_mul_i32 s72, s29, 15360
  s_add_u32 s72, s72, 61440
  s_add_u32 m0, s72, 0
  s_nop 0
  buffer_load_dwordx4 v30, s[8:11], s74 offen lds
  s_add_u32 m0, s72, 1024
  s_nop 0
  buffer_load_dwordx4 v31, s[8:11], s74 offen lds
  s_add_u32 m0, s72, 2048
  s_nop 0
  buffer_load_dwordx4 v32, s[8:11], s74 offen lds
  s_add_u32 m0, s72, 3072
  s_nop 0
  buffer_load_dwordx4 v33, s[8:11], s74 offen lds
  s_add_u32 m0, s72, 4096
  s_nop 0
  buffer_load_dwordx4 v34, s[8:11], s74 offen lds
  s_add_u32 m0, s72, 5120
  s_nop 0
  buffer_load_dwordx4 v35, s[8:11], s74 offen lds
  s_add_u32 m0, s72, 6144
  s_nop 0
  buffer_load_dwordx4 v36, s[8:11], s74 offen lds
  s_add_u32 m0, s72, 7168
  s_nop 0
  buffer_load_dwordx4 v37, s[8:11], s74 offen lds
  s_add_u32 m0, s72, 8192
  s_nop 0
  buffer_load_dwordx4 v38, s[8:11], s74 offen lds
  s_add_u32 m0, s72, 9216
  s_nop 0
  buffer_load_dwordx4 v39, s[8:11], s74 offen lds
  s_add_u32 m0, s72, 10240
  s_nop 0
  buffer_load_dwordx4 v40, s[8:11], s74 offen lds
  s_add_u32 m0, s72, 11264
  s_nop 0
  buffer_load_dwordx4 v41, s[8:11], s74 offen lds
  s_add_u32 m0, s72, 12288
  s_nop 0
  buffer_load_dwordx4 v42, s[8:11], s74 offen lds
  s_add_u32 m0, s72, 13312
  s_nop 0
  buffer_load_dwordx4 v43, s[8:11], s74 offen lds
  s_add_u32 m0, s72, 14336
  s_nop 0
  buffer_load_dwordx4 v44, s[8:11], s74 offen lds
  s_waitcnt vmcnt(15)
  s_barrier
  ds_read_b64_tr_b16 a[0:1], v20 offset:0
  ds_read_b64_tr_b16 a[2:3], v20 offset:384
  ds_read_b64_tr_b16 a[4:5], v20 offset:3072
  ds_read_b64_tr_b16 a[6:7], v20 offset:3456
  ds_read_b64_tr_b16 a[8:9], v20 offset:6144
  ds_read_b64_tr_b16 a[10:11], v20 offset:6528
  ds_read_b64_tr_b16 a[12:13], v20 offset:9216
  ds_read_b64_tr_b16 a[14:15], v20 offset:9600
  ds_read_b64_tr_b16 a[16:17], v20 offset:12288
  ds_read_b64_tr_b16 a[18:19], v20 offset:12672
  ds_read_b64_tr_b16 a[20:21], v20 offset:32
  ds_read_b64_tr_b16 a[22:23], v20 offset:416
  ds_read_b64_tr_b16 a[24:25], v20 offset:3104
  ds_read_b64_tr_b16 a[26:27], v20 offset:3488
  ds_read_b64_tr_b16 a[28:29], v20 offset:6176
  ds_read_b64_tr_b16 a[30:31], v20 offset:6560
  ds_read_b64_tr_b16 a[32:33], v20 offset:9248
  ds_read_b64_tr_b16 a[34:35], v20 offset:9632
  ds_read_b64_tr_b16 a[36:37], v20 offset:12320
  ds_read_b64_tr_b16 a[38:39], v20 offset:12704
  ds_read_b64_tr_b16 a[40:41], v20 offset:64
  ds_read_b64_tr_b16 a[42:43], v20 offset:448
  ds_read_b64_tr_b16 a[44:45], v20 offset:3136
  ds_read_b64_tr_b16 a[46:47], v20 offset:3520
  ds_read_b64_tr_b16 a[48:49], v20 offset:6208
  ds_read_b64_tr_b16 a[50:51], v20 offset:6592
  ds_read_b64_tr_b16 a[52:53], v20 offset:9280
  ds_read_b64_tr_b16 a[54:55], v20 offset:9664
  ds_read_b64_tr_b16 a[56:57], v20 offset:12352
  ds_read_b64_tr_b16 a[58:59], v20 offset:12736
  s_waitcnt lgkmcnt(0)
  s_waitcnt vmcnt(0)
  s_barrier
  s_mov_b32 s8, s44
  s_and_b32 s9, s45, 0xffff
  s_mul_i32 s72, s29, 15360
  s_add_u32 s72, s72, 0
  s_add_u32 m0, s72, 0
  s_nop 0
  buffer_load_dwordx4 v30, s[8:11], s74 offen lds
  s_add_u32 m0, s72, 1024
  s_nop 0
  buffer_load_dwordx4 v31, s[8:11], s74 offen lds
  s_add_u32 m0, s72, 2048
  s_nop 0
  buffer_load_dwordx4 v32, s[8:11], s74 offen lds
  s_add_u32 m0, s72, 3072
  s_nop 0
  buffer_load_dwordx4 v33, s[8:11], s74 offen lds
  s_add_u32 m0, s72, 4096
  s_nop 0
  buffer_load_dwordx4 v34, s[8:11], s74 offen lds
  s_add_u32 m0, s72, 5120
  s_nop 0
  buffer_load_dwordx4 v35, s[8:11], s74 offen lds
  s_add_u32 m0, s72, 6144
  s_nop 0
  buffer_load_dwordx4 v36, s[8:11], s74 offen lds
  s_add_u32 m0, s72, 7168
  s_nop 0
  buffer_load_dwordx4 v37, s[8:11], s74 offen lds
  s_add_u32 m0, s72, 8192
  s_nop 0
  buffer_load_dwordx4 v38, s[8:11], s74 offen lds
  s_add_u32 m0, s72, 9216
  s_nop 0
  buffer_load_dwordx4 v39, s[8:11], s74 offen lds
  s_add_u32 m0, s72, 10240
  s_nop 0
  buffer_load_dwordx4 v40, s[8:11], s74 offen lds
  s_add_u32 m0, s72, 11264
  s_nop 0
  buffer_load_dwordx4 v41, s[8:11], s74 offen lds
  s_add_u32 m0, s72, 12288
  s_nop 0
  buffer_load_dwordx4 v42, s[8:11], s74 offen lds
  s_add_u32 m0, s72, 13312
  s_nop 0
  buffer_load_dwordx4 v43, s[8:11], s74 offen lds
  s_add_u32 m0, s72, 14336
  s_nop 0
  buffer_load_dwordx4 v44, s[8:11], s74 offen lds
  ds_read_b64_tr_b16 a[60:61], v22 offset:0
  ds_read_b64_tr_b16 a[62:63], v22 offset:384
  ds_read_b64_tr_b16 a[64:65], v22 offset:3072
  ds_read_b64_tr_b16 a[66:67], v22 offset:3456
  ds_read_b64_tr_b16 a[68:69], v22 offset:6144
  ds_read_b64_tr_b16 a[70:71], v22 offset:6528
  ds_read_b64_tr_b16 a[72:73], v22 offset:9216
  ds_read_b64_tr_b16 a[74:75], v22 offset:9600
  ds_read_b64_tr_b16 a[76:77], v22 offset:12288
  ds_read_b64_tr_b16 a[78:79], v22 offset:12672
  ds_read_b64_tr_b16 a[80:81], v22 offset:32
  ds_read_b64_tr_b16 a[82:83], v22 offset:416
  ds_read_b64_tr_b16 a[84:85], v22 offset:3104
  ds_read_b64_tr_b16 a[86:87], v22 offset:3488
  ds_read_b64_tr_b16 a[88:89], v22 offset:6176
  ds_read_b64_tr_b16 a[90:91], v22 offset:6560
  ds_read_b64_tr_b16 a[92:93], v22 offset:9248
  ds_read_b64_tr_b16 a[94:95], v22 offset:9632
  ds_read_b64_tr_b16 a[96:97], v22 offset:12320
  ds_read_b64_tr_b16 a[98:99], v22 offset:12704
  ds_read_b64_tr_b16 a[100:101], v22 offset:64
  ds_read_b64_tr_b16 a[102:103], v22 offset:448
  ds_read_b64_tr_b16 a[104:105], v22 offset:3136
  ds_read_b64_tr_b16 a[106:107], v22 offset:3520
  ds_read_b64_tr_b16 a[108:109], v22 offset:6208
  ds_read_b64_tr_b16 a[110:111], v22 offset:6592
  ds_read_b64_tr_b16 a[112:113], v22 offset:9280
  ds_read_b64_tr_b16 a[114:115], v22 offset:9664
  ds_read_b64_tr_b16 a[116:117], v22 offset:12352
  ds_read_b64_tr_b16 a[118:119], v22 offset:12736
  s_waitcnt lgkmcnt(0)
  s_waitcnt vmcnt(0)
  s_barrier
  ds_read_b64_tr_b16 a[120:121], v20 offset:0
  ds_read_b64_tr_b16 a[122:123], v20 offset:384
  ds_read_b64_tr_b16 a[124:125], v20 offset:3072
  ds_read_b64_tr_b16 a[126:127], v20 offset:3456
  ds_read_b64_tr_b16 a[128:129], v20 offset:6144
  ds_read_b64_tr_b16 a[130:131], v20 offset:6528
  ds_read_b64_tr_b16 a[132:133], v20 offset:9216
  ds_read_b64_tr_b16 a[134:135], v20 offset:9600
  ds_read_b64_tr_b16 a[136:137], v20 offset:12288
  ds_read_b64_tr_b16 a[138:139], v20 offset:12672
  ds_read_b64_tr_b16 a[140:141], v20 offset:32
  ds_read_b64_tr_b16 a[142:143], v20 offset:416
  ds_read_b64_tr_b16 a[144:145], v20 offset:3104
  ds_read_b64_tr_b16 a[146:147], v20 offset:3488
  ds_read_b64_tr_b16 a[148:149], v20 offset:6176
  ds_read_b64_tr_b16 a[150:151], v20 offset:6560
  ds_read_b64_tr_b16 a[152:153], v20 offset:9248
  ds_read_b64_tr_b16 a[154:155], v20 offset:9632
  ds_read_b64_tr_b16 a[156:157], v20 offset:12320
  ds_read_b64_tr_b16 a[158:159], v20 offset:12704
  ds_read_b64_tr_b16 a[160:161], v20 offset:64
  ds_read_b64_tr_b16 a[162:163], v20 offset:448
  ds_read_b64_tr_b16 a[164:165], v20 offset:3136
  ds_read_b64_tr_b16 a[166:167], v20 offset:3520
  ds_read_b64_tr_b16 a[168:169], v20 offset:6208
  ds_read_b64_tr_b16 a[170:171], v20 offset:6592
  ds_read_b64_tr_b16 a[172:173], v20 offset:9280
  ds_read_b64_tr_b16 a[174:175], v20 offset:9664
  ds_read_b64_tr_b16 a[176:177], v20 offset:12352
  ds_read_b64_tr_b16 a[178:179], v20 offset:12736
  s_waitcnt lgkmcnt(0)
  s_barrier
  s_mov_b32 s8, s46
  s_and_b32 s9, s47, 0xffff
  s_mul_i32 s72, s29, 18432
  s_add_u32 s72, s72, 0
  s_add_u32 m0, s72, 0
  s_nop 0
  buffer_load_dwordx4 v50, s[8:11], s75 offen lds
  s_add_u32 m0, s72, 1024
  s_nop 0
  buffer_load_dwordx4 v51, s[8:11], s75 offen lds
  s_add_u32 m0, s72, 2048
  s_nop 0
  buffer_load_dwordx4 v52, s[8:11], s75 offen lds
  s_add_u32 m0, s72, 3072
  s_nop 0
  buffer_load_dwordx4 v53, s[8:11], s75 offen lds
  s_add_u32 m0, s72, 4096
  s_nop 0
  buffer_load_dwordx4 v54, s[8:11], s75 offen lds
  s_add_u32 m0, s72, 5120
  s_nop 0
  buffer_load_dwordx4 v55, s[8:11], s75 offen lds
  s_add_u32 m0, s72, 6144
  s_nop 0
  buffer_load_dwordx4 v56, s[8:11], s75 offen lds
  s_add_u32 m0, s72, 7168
  s_nop 0
  buffer_load_dwordx4 v57, s[8:11], s75 offen lds
  s_add_u32 m0, s72, 8192
  s_nop 0
  buffer_load_dwordx4 v58, s[8:11], s75 offen lds
  s_add_u32 m0, s72, 9216
  s_nop 0
  buffer_load_dwordx4 v59, s[8:11], s75 offen lds
  s_add_u32 m0, s72, 10240
  s_nop 0
  buffer_load_dwordx4 v60, s[8:11], s75 offen lds
  s_add_u32 m0, s72, 11264
  s_nop 0
  buffer_load_dwordx4 v61, s[8:11], s75 offen lds
  s_add_u32 m0, s72, 12288
  s_nop 0
  buffer_load_dwordx4 v62, s[8:11], s75 offen lds
  s_add_u32 m0, s72, 13312
  s_nop 0
  buffer_load_dwordx4 v63, s[8:11], s75 offen lds
  s_add_u32 m0, s72, 14336
  s_nop 0
  buffer_load_dwordx4 v64, s[8:11], s75 offen lds
  s_add_u32 m0, s72, 15360
  s_nop 0
  buffer_load_dwordx4 v65, s[8:11], s75 offen lds
  s_add_u32 m0, s72, 16384
  s_nop 0
  buffer_load_dwordx4 v66, s[8:11], s75 offen lds
  s_add_u32 m0, s72, 17408
  s_nop 0
  buffer_load_dwordx4 v67, s[8:11], s75 offen lds
  s_waitcnt vmcnt(0)
  ds_read_b64_tr_b16 a[180:181], v21 offset:0
  ds_read_b64_tr_b16 a[182:183], v21 offset:1536
  ds_read_b64_tr_b16 a[184:185], v21 offset:3072
  ds_read_b64_tr_b16 a[186:187], v21 offset:4608
  ds_read_b64_tr_b16 a[188:189], v21 offset:6144
  ds_read_b64_tr_b16 a[190:191], v21 offset:7680
  ds_read_b64_tr_b16 a[192:193], v21 offset:9216
  ds_read_b64_tr_b16 a[194:195], v21 offset:10752
  ds_read_b64_tr_b16 a[196:197], v21 offset:12288
  ds_read_b64_tr_b16 a[198:199], v21 offset:13824
  ds_read_b64_tr_b16 a[200:201], v21 offset:15360
  ds_read_b64_tr_b16 a[202:203], v21 offset:16896
  ds_read_b64_tr_b16 a[204:205], v21 offset:32
  ds_read_b64_tr_b16 a[206:207], v21 offset:1568
  ds_read_b64_tr_b16 a[208:209], v21 offset:3104
  ds_read_b64_tr_b16 a[210:211], v21 offset:4640
  ds_read_b64_tr_b16 a[212:213], v21 offset:6176
  ds_read_b64_tr_b16 a[214:215], v21 offset:7712
  ds_read_b64_tr_b16 a[216:217], v21 offset:9248
  ds_read_b64_tr_b16 a[218:219], v21 offset:10784
  ds_read_b64_tr_b16 a[220:221], v21 offset:12320
  ds_read_b64_tr_b16 a[222:223], v21 offset:13856
  ds_read_b64_tr_b16 a[224:225], v21 offset:15392
  ds_read_b64_tr_b16 a[226:227], v21 offset:16928
  ds_read_b64_tr_b16 a[228:229], v21 offset:64
  ds_read_b64_tr_b16 a[230:231], v21 offset:1600
  ds_read_b64_tr_b16 a[232:233], v21 offset:3136
  ds_read_b64_tr_b16 a[234:235], v21 offset:4672
  ds_read_b64_tr_b16 a[236:237], v21 offset:6208
  ds_read_b64_tr_b16 a[238:239], v21 offset:7744
  ds_read_b64_tr_b16 a[240:241], v21 offset:9280
  ds_read_b64_tr_b16 a[242:243], v21 offset:10816
  ds_read_b64_tr_b16 a[244:245], v21 offset:12352
  ds_read_b64_tr_b16 a[246:247], v21 offset:13888
  ds_read_b64_tr_b16 a[248:249], v21 offset:15424
  ds_read_b64_tr_b16 a[250:251], v21 offset:16960
  s_waitcnt lgkmcnt(0)
  s_barrier
  v_and_b32 v5, 7, v2
  v_lshl_add_u32 v6, v3, 3, v5
  v_lshlrev_b32 v237, 4, v6
  s_mul_i32 s72, s29, 2560
  v_add_u32 v230, s72, v237
  v_lshlrev_b32 v237, 4, v1
  v_lshlrev_b32 v238, 4, v1
  v_add_u32 v238, 6144, v238
  v_lshlrev_b32 v239, 4, v1
  v_lshl_add_u32 v6, v3, 3, v2
  v_lshlrev_b32 v6, 4, v6
  s_mul_i32 s72, s29, 4608
  v_add_u32 v231, s72, v6
  s_mul_i32 s73, s29, 1536
  s_add_u32 s73, s73, 18432
  v_add_u32 v240, s73, v6
  v_lshlrev_b32 v7, 4, v1
  v_add_u32 v7, 24576, v7
  v_cmp_gt_u32 vcc, 8, v2
  s_nop 1
  v_cndmask_b32 v231, v7, v231, vcc
  v_cndmask_b32 v240, v7, v240, vcc
  v_lshlrev_b32 v232, 4, v1
  v_add_u32 v232, s72, v232
  v_cmp_gt_u32 vcc, 32, v1
  s_nop 1
  v_cndmask_b32 v232, v7, v232, vcc
  s_mul_i32 s72, s29, 48
  v_add_u32 v7, s72, v1
  v_lshlrev_b32 v233, 4, v7
  v_lshrrev_b32 v6, 5, v7
  v_and_b32 v7, 31, v7
  v_cmp_le_u32 vcc, 3, v6
  v_mov_b32 v4, 0
  v_mov_b32 v5, 3
  v_cndmask_b32 v5, v4, v5, vcc
  v_sub_u32 v6, v6, v5
  v_mov_b32 v5, 128
  v_cndmask_b32 v235, v4, v5, vcc
  v_lshrrev_b32 v4, 3, v7
  v_lshlrev_b32 v4, 2, v4
  v_lshl_add_u32 v6, v6, 4, v4
  s_mul_i32 s72, s27, 48
  v_add_u32 v6, s72, v6
  v_and_b32 v7, 7, v7
  v_lshrrev_b32 v4, 5, v6
  v_lshl_add_u32 v235, v4, 10, v235
  v_bfe_u32 v4, v6, 3, 2
  v_lshl_add_u32 v4, v4, 4, v7
  v_lshl_add_u32 v235, v4, 4, v235
  v_bfe_u32 v4, v6, 2, 1
  v_lshl_add_u32 v235, v4, 3, v235
  s_mul_i32 s72, s29, 24
  v_add_u32 v7, s72, v1
  v_lshlrev_b32 v234, 4, v7
  v_add_u32 v234, 3072, v234
  v_lshrrev_b32 v6, 5, v7
  v_and_b32 v7, 31, v7
  s_mul_i32 s72, s27, 3
  v_add_u32 v6, s72, v6
  v_lshrrev_b32 v236, 2, v6
  v_lshlrev_b32 v236, 10, v236
  v_add_u32 v236, 6144, v236
  v_bfe_u32 v4, v6, 1, 1
  v_lshl_add_u32 v236, v4, 3, v236
  v_and_b32 v4, 1, v6
  v_xor_b32 v4, 1, v4
  v_lshlrev_b32 v4, 1, v4
  v_lshrrev_b32 v5, 4, v7
  v_add_u32 v4, v4, v5
  v_and_b32 v5, 15, v7
  v_lshl_add_u32 v4, v4, 4, v5
  v_lshl_add_u32 v236, v4, 4, v236
  s_lshl_b32 s100, s25, 1
  s_and_b32 s73, s29, 1
  s_add_u32 s100, s100, s73
  v_lshlrev_b32 v6, 4, v1
  s_mul_i32 s72, s100, 5120
  v_add_u32 v243, s72, v6
  v_add_u32 v244, 2560, v243
  s_mul_i32 s74, s24, 640
  v_add_u32 v242, s74, v243
  v_and_b32 v6, 7, v1
  v_lshrrev_b32 v7, 3, v1
  s_mul_i32 s72, s100, 20
  v_lshl_add_u32 v4, v7, 2, s72
  v_lshrrev_b32 v245, 5, v4
  v_lshlrev_b32 v245, 9, v245
  v_bfe_u32 v5, v4, 3, 2
  v_lshl_add_u32 v5, v5, 3, v6
  v_lshl_add_u32 v245, v5, 4, v245
  v_bfe_u32 v5, v4, 2, 1
  v_lshl_add_u32 v245, v5, 3, v245
  s_and_b32 s73, s29, 1
  s_mul_i32 s73, s73, 5
  v_add_u32 v7, s73, v7
  v_lshrrev_b32 v241, 2, v7
  v_lshlrev_b32 v241, 9, v241
  v_and_b32 v7, 3, v7
  v_lshl_add_u32 v7, v7, 3, v6
  v_lshl_add_u32 v241, v7, 4, v241
  v_add_u32 v241, 18432, v241
  v_min_u32 v241, 19952, v241
  v_mov_b32 v7, 0x80000000
  v_cmp_gt_u32 vcc, 8, v2
  s_nop 1
  v_cndmask_b32 v230, v7, v230, vcc
  v_cmp_gt_u32 vcc, 48, v1
  s_nop 1
  v_cndmask_b32 v235, v7, v235, vcc
  v_cmp_gt_u32 vcc, 24, v1
  s_nop 1
  v_cndmask_b32 v236, v7, v236, vcc
  v_cmp_gt_u32 vcc, 40, v1
  s_nop 1
  v_cndmask_b32 v243, v7, v243, vcc
  v_cndmask_b32 v244, v7, v244, vcc
  v_cndmask_b32 v242, v7, v242, vcc
  v_cndmask_b32 v245, v7, v245, vcc
  v_mov_b32 v126, 1
  v_mov_b32 v4, 0
  v_cmp_eq_u32 vcc, 0, v1
  s_nop 1
  v_cndmask_b32 v128, v7, v4, vcc
  v_cmp_gt_u32 vcc, 2, v3
  v_mov_b32 v6, 0
  v_mov_b32 v7, 0xf149f2ca
  v_cndmask_b32 v248, v6, v7, vcc
  v_mov_b32 v252, -1
  v_cndmask_b32 v249, v6, v7, vcc
  v_mov_b32 v253, -1
  v_cndmask_b32 v250, v6, v7, vcc
  v_mov_b32 v254, -1
  v_cndmask_b32 v251, v6, v7, vcc
  v_mov_b32 v255, -1
  v_and_b32 v246, 15, v1
  v_lshlrev_b32 v246, 2, v246
  s_mul_i32 s72, s24, 40960
  s_add_u32 s52, s72, 107741184
  s_mul_i32 s72, s28, 9216
  s_add_u32 s56, s72, 103284736
  s_mul_i32 s72, s31, 9216
  s_add_u32 s60, s72, 103284736
  s_mov_b32 s64, 107085824
  s_mul_i32 s72, s24, 40960
  s_add_u32 s53, s72, 107751424
  s_mul_i32 s72, s28, 9216
  s_add_u32 s57, s72, 103579648
  s_mul_i32 s72, s31, 9216
  s_add_u32 s61, s72, 103579648
  s_mov_b32 s65, 107249664
  s_mul_i32 s72, s24, 40960
  s_add_u32 s54, s72, 107761664
  s_mul_i32 s72, s28, 9216
  s_add_u32 s58, s72, 103874560
  s_mul_i32 s72, s31, 9216
  s_add_u32 s62, s72, 103874560
  s_mov_b32 s66, 107413504
  s_mul_i32 s72, s24, 40960
  s_add_u32 s55, s72, 107771904
  s_mul_i32 s72, s28, 9216
  s_add_u32 s59, s72, 104169472
  s_mul_i32 s72, s31, 9216
  s_add_u32 s63, s72, 104169472
  s_mov_b32 s67, 107577344
  s_mul_i32 s68, s28, 9216
  s_add_u32 s68, s68, 84410368
  s_lshl_b32 s101, s28, 12
  s_lshl_b32 s72, s27, 4
  s_lshl_b32 s73, s29, 2
  s_add_u32 s101, s101, s72
  s_add_u32 s101, s101, s73
  s_add_u32 s101, s101, 108363776
  s_mul_i32 s69, s31, 1572864
  s_add_u32 s69, s69, 27787264
  s_lshl_b32 s23, s31, 12
  s_add_u32 s23, s23, 108068864
  s_add_u32 s33, s69, 12288
  s_mul_i32 s72, s25, 6
  s_and_b32 s73, s29, 1
  s_mul_i32 s73, s73, 3
  s_add_u32 s72, s72, s73
  s_mul_i32 s73, s72, 2731
  s_lshr_b32 s73, s73, 16
  s_mul_i32 s74, s73, 24
  s_sub_u32 s72, s72, s74
  s_lshl_b32 s74, s24, 2
  s_add_u32 s73, s73, s74
  s_mul_i32 s34, s73, 1572864
  s_lshl_b32 s72, s72, 10
  s_add_u32 s34, s34, s72
  s_add_u32 s34, s34, 27836416
  s_mov_b32 s30, 0
  s_mov_b32 s71, 0
  s_mov_b32 s12, s50
  s_and_b32 s13, s51, 0xffff
  s_mov_b32 s14, 256
  s_mov_b32 s15, 0x00020000
  v_and_b32 v4, 15, v1
  v_lshlrev_b32 v4, 2, v4
L_hk_fc:
  buffer_load_dword v5, v4, s[12:15], 0 offen sc1
  s_waitcnt vmcnt(0)
  v_readlane_b32 s72, v5, 0
  v_readlane_b32 s73, v5, 1
  v_readlane_b32 s74, v5, 2
  v_readlane_b32 s75, v5, 3
  v_readlane_b32 s76, v5, 4
  v_readlane_b32 s77, v5, 5
  v_readlane_b32 s78, v5, 6
  v_readlane_b32 s79, v5, 7
  v_readlane_b32 s84, v5, 8
  s_nop 3
  s_add_u32 s80, s72, s73
  s_add_u32 s81, s74, s75
  s_add_u32 s82, s76, s77
  s_add_u32 s83, s78, s79
  s_add_u32 s80, s80, s81
  s_add_u32 s82, s82, s83
  s_add_u32 s80, s80, s82
  s_add_u32 s80, s80, s84
  s_cmp_eq_u32 s80, 512
  s_cbranch_scc1 L_hk2_fc
  s_add_u32 s71, s71, 1
  s_cmp_gt_u32 s71, 400000
  s_cbranch_scc1 L_mend
  s_sleep 2
  s_branch L_hk_fc
L_hk2_fc:
  s_mov_b64 exec, 0xff
  v_cmp_ne_u32 vcc, 32, v5
  s_mov_b64 exec, -1
  s_cbranch_vccnz L_slow
L_kv0_fc:
  buffer_load_dword v127, v246, s[4:7], s23 offen sc1
  s_waitcnt vmcnt(0)
  v_cmp_eq_u32 vcc, 0, v127
  s_cbranch_vccz L_kv0ok_fc
  s_add_u32 s71, s71, 1
  s_cmp_gt_u32 s71, 400000
  s_cbranch_scc1 L_done_fc
  s_sleep 4
  s_branch L_kv0_fc
L_kv0ok_fc:
  s_add_u32 s23, s23, 64
  buffer_load_dwordx4 v[134:137], v239, s[4:7], s69 offen offset:0 sc1
  buffer_load_dwordx4 v[138:141], v239, s[4:7], s69 offen offset:1024 sc1
  buffer_load_dwordx4 v[142:145], v239, s[4:7], s69 offen offset:2048 sc1
  buffer_load_dwordx4 v[146:149], v239, s[4:7], s69 offen offset:3072 sc1
  s_add_u32 s69, s69, 4096
  buffer_load_dwordx4 v[150:153], v239, s[4:7], s69 offen offset:0 sc1
  buffer_load_dwordx4 v[154:157], v239, s[4:7], s69 offen offset:1024 sc1
  buffer_load_dwordx4 v[158:161], v239, s[4:7], s69 offen offset:2048 sc1
  buffer_load_dwordx4 v[162:165], v239, s[4:7], s69 offen offset:3072 sc1
  s_add_u32 s69, s69, 4096
  buffer_load_dwordx4 v[166:169], v239, s[4:7], s69 offen offset:0 sc1
  buffer_load_dwordx4 v[170:173], v239, s[4:7], s69 offen offset:1024 sc1
  buffer_load_dwordx4 v[174:177], v239, s[4:7], s69 offen offset:2048 sc1
  buffer_load_dwordx4 v[178:181], v239, s[4:7], s69 offen offset:3072 sc1
  s_add_u32 s69, s69, 16384
  buffer_load_dwordx4 v[182:185], v239, s[4:7], s33 offen offset:0 sc1
  buffer_load_dwordx4 v[186:189], v239, s[4:7], s33 offen offset:1024 sc1
  buffer_load_dwordx4 v[190:193], v239, s[4:7], s33 offen offset:2048 sc1
  buffer_load_dwordx4 v[194:197], v239, s[4:7], s33 offen offset:3072 sc1
  s_add_u32 s33, s33, 4096
  buffer_load_dwordx4 v[198:201], v239, s[4:7], s33 offen offset:0 sc1
  buffer_load_dwordx4 v[202:205], v239, s[4:7], s33 offen offset:1024 sc1
  buffer_load_dwordx4 v[206:209], v239, s[4:7], s33 offen offset:2048 sc1
  buffer_load_dwordx4 v[210:213], v239, s[4:7], s33 offen offset:3072 sc1
  s_add_u32 s33, s33, 4096
  buffer_load_dwordx4 v[214:217], v239, s[4:7], s33 offen offset:0 sc1
  buffer_load_dwordx4 v[218:221], v239, s[4:7], s33 offen offset:1024 sc1
  buffer_load_dwordx4 v[222:225], v239, s[4:7], s33 offen offset:2048 sc1
  buffer_load_dwordx4 v[226:229], v239, s[4:7], s33 offen offset:3072 sc1
  s_add_u32 s33, s33, 16384
  s_waitcnt vmcnt(0)
L_loop_fc:
  buffer_load_dwordx4 v[8:11], v230, s[4:7], s52 offen offset:0 sc1
  buffer_load_dwordx4 v[12:15], v230, s[4:7], s52 offen offset:512 sc1
  buffer_load_dwordx4 v[16:19], v230, s[4:7], s52 offen offset:1024 sc1
  buffer_load_dwordx4 v[20:23], v230, s[4:7], s52 offen offset:1536 sc1
  buffer_load_dwordx4 v[24:27], v230, s[4:7], s52 offen offset:2048 sc1
  s_waitcnt vmcnt(0)
K_C_0_fc:
  v_mfma_f32_16x16x32_bf16 v[28:31], a[0:3], v[8:11], 0
  v_max3_u32 v4, v8, v9, v10
  v_max3_u32 v5, v11, v12, v13
  v_mfma_f32_16x16x32_bf16 v[28:31], a[4:7], v[12:15], v[28:31]
  v_max3_u32 v6, v14, v15, v16
  v_max3_u32 v7, v17, v18, v19
  v_mfma_f32_16x16x32_bf16 v[28:31], a[8:11], v[16:19], v[28:31]
  v_max3_u32 v4, v4, v20, v21
  v_max3_u32 v5, v5, v22, v23
  v_mfma_f32_16x16x32_bf16 v[28:31], a[12:15], v[20:23], v[28:31]
  v_max3_u32 v6, v6, v24, v25
  v_max3_u32 v7, v7, v26, v27
  v_mfma_f32_16x16x32_bf16 v[28:31], a[16:19], v[24:27], v[28:31]
  v_max3_u32 v4, v4, v5, v6
  v_max_u32 v4, v4, v7
  v_mfma_f32_16x16x32_bf16 v[32:35], a[20:23], v[8:11], 0
  v_cmp_eq_u32 vcc, -1, v4
  s_cbranch_vccnz R_C_0_fc
  v_mfma_f32_16x16x32_bf16 v[32:35], a[24:27], v[12:15], v[32:35]
  v_mfma_f32_16x16x32_bf16 v[32:35], a[28:31], v[16:19], v[32:35]
  v_mfma_f32_16x16x32_bf16 v[32:35], a[32:35], v[20:23], v[32:35]
  ds_write_b128 v231, v[28:31] offset:0
  v_mfma_f32_16x16x32_bf16 v[32:35], a[36:39], v[24:27], v[32:35]
  v_mfma_f32_16x16x32_bf16 v[36:39], a[40:43], v[8:11], 0
  v_mfma_f32_16x16x32_bf16 v[36:39], a[44:47], v[12:15], v[36:39]
  v_mfma_f32_16x16x32_bf16 v[36:39], a[48:51], v[16:19], v[36:39]
  v_mfma_f32_16x16x32_bf16 v[36:39], a[52:55], v[20:23], v[36:39]
  ds_write_b128 v231, v[32:35] offset:512
  v_mfma_f32_16x16x32_bf16 v[36:39], a[56:59], v[24:27], v[36:39]
  v_mfma_f32_16x16x32_bf16 v[40:43], a[60:63], v[8:11], 0
  v_mfma_f32_16x16x32_bf16 v[40:43], a[64:67], v[12:15], v[40:43]
  v_mfma_f32_16x16x32_bf16 v[40:43], a[68:71], v[16:19], v[40:43]
  v_mfma_f32_16x16x32_bf16 v[40:43], a[72:75], v[20:23], v[40:43]
  ds_write_b128 v231, v[36:39] offset:1024
  v_mfma_f32_16x16x32_bf16 v[40:43], a[76:79], v[24:27], v[40:43]
  v_mfma_f32_16x16x32_bf16 v[44:47], a[80:83], v[8:11], 0
  v_mfma_f32_16x16x32_bf16 v[44:47], a[84:87], v[12:15], v[44:47]
  v_mfma_f32_16x16x32_bf16 v[44:47], a[88:91], v[16:19], v[44:47]
  v_mfma_f32_16x16x32_bf16 v[44:47], a[92:95], v[20:23], v[44:47]
  ds_write_b128 v231, v[40:43] offset:1536
  v_mfma_f32_16x16x32_bf16 v[44:47], a[96:99], v[24:27], v[44:47]
  v_mfma_f32_16x16x32_bf16 v[48:51], a[100:103], v[8:11], 0
  v_mfma_f32_16x16x32_bf16 v[48:51], a[104:107], v[12:15], v[48:51]
  v_mfma_f32_16x16x32_bf16 v[48:51], a[108:111], v[16:19], v[48:51]
  v_mfma_f32_16x16x32_bf16 v[48:51], a[112:115], v[20:23], v[48:51]
  ds_write_b128 v231, v[44:47] offset:2048
  v_mfma_f32_16x16x32_bf16 v[48:51], a[116:119], v[24:27], v[48:51]
  v_mfma_f32_16x16x32_bf16 v[52:55], v[8:11], a[120:123], 0
  v_mfma_f32_16x16x32_bf16 v[52:55], v[12:15], a[124:127], v[52:55]
  v_mfma_f32_16x16x32_bf16 v[52:55], v[16:19], a[128:131], v[52:55]
  ds_write_b128 v231, v[48:51] offset:2560
  v_mfma_f32_16x16x32_bf16 v[52:55], v[20:23], a[132:135], v[52:55]
  v_mfma_f32_16x16x32_bf16 v[52:55], v[24:27], a[136:139], v[52:55]
  s_waitcnt lgkmcnt(0)
  s_barrier
  ds_read_b128 v[64:67], v233 offset:0
  ds_read_b128 v[68:71], v233 offset:4608
  ds_read_b128 v[72:75], v233 offset:9216
  ds_read_b128 v[76:79], v233 offset:13824
  v_mfma_f32_16x16x32_bf16 v[56:59], v[8:11], a[140:143], 0
  v_mfma_f32_16x16x32_bf16 v[56:59], v[12:15], a[144:147], v[56:59]
  v_mfma_f32_16x16x32_bf16 v[56:59], v[16:19], a[148:151], v[56:59]
  v_mfma_f32_16x16x32_bf16 v[56:59], v[20:23], a[152:155], v[56:59]
  ds_write_b128 v232, v[52:55] offset:3072
  v_mfma_f32_16x16x32_bf16 v[56:59], v[24:27], a[156:159], v[56:59]
  s_waitcnt lgkmcnt(1)
  v_pk_add_f32 v[64:65], v[64:65], v[68:69]
  v_pk_add_f32 v[66:67], v[66:67], v[70:71]
  v_pk_add_f32 v[72:73], v[72:73], v[76:77]
  v_pk_add_f32 v[74:75], v[74:75], v[78:79]
  v_pk_add_f32 v[64:65], v[64:65], v[72:73]
  v_pk_add_f32 v[66:67], v[66:67], v[74:75]
  v_cvt_pk_bf16_f32 v98, v64, v65
  v_cvt_pk_bf16_f32 v99, v66, v67
  buffer_store_dwordx2 v[98:99], v235, s[4:7], s56 offen
  v_mfma_f32_16x16x32_bf16 v[60:63], v[8:11], a[160:163], 0
  v_mfma_f32_16x16x32_bf16 v[60:63], v[12:15], a[164:167], v[60:63]
  v_mfma_f32_16x16x32_bf16 v[60:63], v[16:19], a[168:171], v[60:63]
  ds_write_b128 v232, v[56:59] offset:3584
  v_mfma_f32_16x16x32_bf16 v[60:63], v[20:23], a[172:175], v[60:63]
  v_mfma_f32_16x16x32_bf16 v[60:63], v[24:27], a[176:179], v[60:63]
  s_add_u32 s32, s60, 4096
  s_nop 6
  ds_write_b128 v232, v[60:63] offset:4096
  buffer_load_dwordx4 v[102:105], v237, s[4:7], s60 offen offset:0 sc1
  buffer_load_dwordx4 v[106:109], v237, s[4:7], s60 offen offset:1024 sc1
  buffer_load_dwordx4 v[110:113], v237, s[4:7], s60 offen offset:2048 sc1
  buffer_load_dwordx4 v[114:117], v237, s[4:7], s60 offen offset:3072 sc1
  buffer_load_dwordx4 v[118:121], v237, s[4:7], s32 offen offset:0 sc1
  buffer_load_dwordx4 v[122:125], v237, s[4:7], s32 offen offset:1024 sc1
  buffer_load_dword v127, v246, s[4:7], s23 offen sc1
  s_waitcnt lgkmcnt(0)
  s_barrier
  ds_read_b128 v[64:67], v234 offset:0
  ds_read_b128 v[68:71], v234 offset:4608
  ds_read_b128 v[72:75], v234 offset:9216
  ds_read_b128 v[76:79], v234 offset:13824
  s_waitcnt lgkmcnt(0)
  v_pk_add_f32 v[64:65], v[64:65], v[68:69]
  v_pk_add_f32 v[66:67], v[66:67], v[70:71]
  v_pk_add_f32 v[72:73], v[72:73], v[76:77]
  v_pk_add_f32 v[74:75], v[74:75], v[78:79]
  v_pk_add_f32 v[64:65], v[64:65], v[72:73]
  v_pk_add_f32 v[66:67], v[66:67], v[74:75]
  v_cvt_pk_bf16_f32 v100, v64, v65
  v_cvt_pk_bf16_f32 v101, v66, v67
  buffer_store_dwordx2 v[100:101], v236, s[4:7], s56 offen
  s_waitcnt vmcnt(1)
K_A_0_fc:
  v_mfma_f32_16x16x32_bf16 v[80:83], v[102:105], v[102:105], v[248:251]
  v_max3_u32 v4, v102, v103, v104
  v_max3_u32 v5, v105, v106, v107
  v_mfma_f32_16x16x32_bf16 v[84:87], v[134:137], v[102:105], 0
  v_max3_u32 v6, v108, v109, v110
  v_max3_u32 v7, v111, v112, v113
  v_mfma_f32_16x16x32_bf16 v[88:91], v[158:161], v[102:105], 0
  v_max3_u32 v4, v4, v114, v115
  v_max3_u32 v5, v5, v116, v117
  v_mfma_f32_16x16x32_bf16 v[80:83], v[106:109], v[106:109], v[80:83]
  v_max3_u32 v6, v6, v118, v119
  v_max3_u32 v7, v7, v120, v121
  v_mfma_f32_16x16x32_bf16 v[84:87], v[138:141], v[106:109], v[84:87]
  v_max3_u32 v4, v4, v122, v123
  v_max3_u32 v5, v5, v124, v125
  v_mfma_f32_16x16x32_bf16 v[88:91], v[162:165], v[106:109], v[88:91]
  v_max3_u32 v4, v4, v5, v6
  v_max_u32 v4, v4, v7
  v_mfma_f32_16x16x32_bf16 v[80:83], v[110:113], v[110:113], v[80:83]
  v_cmp_eq_u32 vcc, -1, v4
  v_mfma_f32_16x16x32_bf16 v[84:87], v[142:145], v[110:113], v[84:87]
  v_mfma_f32_16x16x32_bf16 v[88:91], v[166:169], v[110:113], v[88:91]
  v_mfma_f32_16x16x32_bf16 v[80:83], v[114:117], v[114:117], v[80:83]
  v_mfma_f32_16x16x32_bf16 v[84:87], v[146:149], v[114:117], v[84:87]
  v_mfma_f32_16x16x32_bf16 v[88:91], v[170:173], v[114:117], v[88:91]
  v_mfma_f32_16x16x32_bf16 v[80:83], v[118:121], v[118:121], v[80:83]
  v_mfma_f32_16x16x32_bf16 v[84:87], v[150:153], v[118:121], v[84:87]
  v_mfma_f32_16x16x32_bf16 v[88:91], v[174:177], v[118:121], v[88:91]
  v_mfma_f32_16x16x32_bf16 v[80:83], v[122:125], v[122:125], v[80:83]
  v_mfma_f32_16x16x32_bf16 v[84:87], v[154:157], v[122:125], v[84:87]
  v_mfma_f32_16x16x32_bf16 v[88:91], v[178:181], v[122:125], v[88:91]
  s_cbranch_vccnz R_A_0_fc
  buffer_load_dwordx4 v[56:59], v238, s[4:7], s60 offen offset:0 sc1
  buffer_load_dwordx4 v[60:63], v238, s[4:7], s60 offen offset:1024 sc1
  buffer_load_dwordx4 v[64:67], v238, s[4:7], s60 offen offset:2048 sc1
  s_cmp_eq_u32 s30, 63
  s_cbranch_scc1 L_last_fc
  buffer_store_dwordx2 v[252:253], v235, s[4:7], s58 offen
  buffer_store_dwordx2 v[252:253], v236, s[4:7], s58 offen
  buffer_store_dwordx2 v[98:99], v235, s[4:7], s68 offen
  buffer_store_dwordx2 v[100:101], v236, s[4:7], s68 offen
  s_add_u32 s68, s68, 294912
  s_nop 1
  v_cmp_eq_u32 vcc, 0, v127
  s_cbranch_vccnz R_F_0_fc
K_F_0_fc:
  s_add_u32 s23, s23, 64
  s_nop 3
  v_max3_f32 v4, v80, v81, v82
  v_max3_f32 v5, v83, v84, v85
  v_max3_f32 v6, v86, v87, v88
  v_max3_f32 v7, v89, v90, v91
  v_max3_f32 v4, v4, v5, v6
  v_max_f32 v4, v4, v7
  v_mov_b32 v5, v4
  s_nop 1
  v_permlane32_swap_b32 v4, v5
  v_max_f32 v4, v4, v5
  v_mov_b32 v5, v4
  s_nop 1
  v_permlane16_swap_b32 v4, v5
  v_max_f32 v4, v4, v5
  v_mul_f32 v4, s70, v4
  v_fma_f32 v80, v80, s70, -v4
  v_fma_f32 v81, v81, s70, -v4
  v_fma_f32 v82, v82, s70, -v4
  v_fma_f32 v83, v83, s70, -v4
  v_fma_f32 v84, v84, s70, -v4
  v_fma_f32 v85, v85, s70, -v4
  v_fma_f32 v86, v86, s70, -v4
  v_fma_f32 v87, v87, s70, -v4
  v_fma_f32 v88, v88, s70, -v4
  v_fma_f32 v89, v89, s70, -v4
  v_fma_f32 v90, v90, s70, -v4
  v_fma_f32 v91, v91, s70, -v4
  v_exp_f32 v80, v80
  v_exp_f32 v81, v81
  v_exp_f32 v82, v82
  v_exp_f32 v83, v83
  v_exp_f32 v84, v84
  v_exp_f32 v85, v85
  v_exp_f32 v86, v86
  v_exp_f32 v87, v87
  v_exp_f32 v88, v88
  v_exp_f32 v89, v89
  v_exp_f32 v90, v90
  v_exp_f32 v91, v91
  s_waitcnt vmcnt(4)
  v_cvt_pk_bf16_f32 v94, v84, v85
  v_cvt_pk_bf16_f32 v95, v86, v87
  v_cvt_pk_bf16_f32 v96, v88, v89
  v_cvt_pk_bf16_f32 v97, v90, v91
  v_cvt_pk_bf16_f32 v92, v80, v81
  v_cvt_pk_bf16_f32 v93, v82, v83
  v_mov_b32 v132, 0
  v_mov_b32 v133, 0
  v_mov_b32 v4, v92
  v_mov_b32 v5, v93
  s_nop 1
  v_permlane32_swap_b32 v4, v132
  v_permlane32_swap_b32 v5, v133
  v_max3_u32 v4, v56, v57, v58
  v_max3_u32 v5, v59, v60, v61
  v_max3_u32 v6, v62, v63, v64
  v_max3_u32 v7, v65, v66, v67
  v_max3_u32 v4, v4, v5, v6
  v_max_u32 v4, v4, v7
  v_cmp_eq_u32 vcc, -1, v4
  s_cbranch_vccnz R_V_0_fc
K_V_0_fc:
  v_mfma_f32_16x16x32_bf16 v[102:105], v[182:185], v[94:97], 0
  v_pk_add_f32 v[80:81], v[80:81], v[82:83]
  v_pk_add_f32 v[84:85], v[84:85], v[86:87]
  buffer_load_dwordx4 v[134:137], v239, s[4:7], s69 offen offset:0 sc1
  buffer_load_dwordx4 v[138:141], v239, s[4:7], s69 offen offset:1024 sc1
  buffer_load_dwordx4 v[142:145], v239, s[4:7], s69 offen offset:2048 sc1
  v_mfma_f32_16x16x32_bf16 v[106:109], v[186:189], v[94:97], 0
  v_pk_add_f32 v[88:89], v[88:89], v[90:91]
  v_pk_add_f32 v[80:81], v[80:81], v[84:85]
  buffer_load_dwordx4 v[146:149], v239, s[4:7], s69 offen offset:3072 sc1
  s_add_u32 s69, s69, 4096
  buffer_load_dwordx4 v[150:153], v239, s[4:7], s69 offen offset:0 sc1
  v_mfma_f32_16x16x32_bf16 v[110:113], v[190:193], v[94:97], 0
  v_pk_add_f32 v[80:81], v[80:81], v[88:89]
  v_add_f32 v4, v80, v81
  buffer_load_dwordx4 v[154:157], v239, s[4:7], s69 offen offset:1024 sc1
  buffer_load_dwordx4 v[158:161], v239, s[4:7], s69 offen offset:2048 sc1
  buffer_load_dwordx4 v[162:165], v239, s[4:7], s69 offen offset:3072 sc1
  v_mfma_f32_16x16x32_bf16 v[114:117], v[194:197], v[94:97], 0
  v_mov_b32 v5, v4
  s_nop 1
  s_add_u32 s69, s69, 4096
  buffer_load_dwordx4 v[166:169], v239, s[4:7], s69 offen offset:0 sc1
  buffer_load_dwordx4 v[170:173], v239, s[4:7], s69 offen offset:1024 sc1
  v_mfma_f32_16x16x32_bf16 v[118:121], v[198:201], v[94:97], 0
  v_permlane32_swap_b32 v4, v5
  v_add_f32 v4, v4, v5
  buffer_load_dwordx4 v[174:177], v239, s[4:7], s69 offen offset:2048 sc1
  buffer_load_dwordx4 v[178:181], v239, s[4:7], s69 offen offset:3072 sc1
  s_add_u32 s69, s69, 16384
  v_mfma_f32_16x16x32_bf16 v[122:125], v[202:205], v[94:97], 0
  v_mov_b32 v5, v4
  s_nop 1
  v_mfma_f32_16x16x16_bf16 v[102:105], v[56:57], v[92:93], v[102:105]
  v_permlane16_swap_b32 v4, v5
  v_add_f32 v4, v4, v5
  v_mfma_f32_16x16x16_bf16 v[106:109], v[56:57], v[132:133], v[106:109]
  v_rcp_f32 v130, v4
  s_nop 0
  v_mfma_f32_16x16x16_bf16 v[110:113], v[58:59], v[92:93], v[110:113]
  v_mov_b32 v131, v130
  v_mfma_f32_16x16x16_bf16 v[114:117], v[58:59], v[132:133], v[114:117]
  v_mfma_f32_16x16x16_bf16 v[118:121], v[60:61], v[92:93], v[118:121]
  v_mfma_f32_16x16x16_bf16 v[122:125], v[60:61], v[132:133], v[122:125]
  v_mfma_f32_16x16x32_bf16 v[28:31], v[206:209], v[94:97], 0
  v_cvt_pk_bf16_f32 v8, v102, v103
  v_cvt_pk_bf16_f32 v9, v104, v105
  v_mfma_f32_16x16x32_bf16 v[32:35], v[210:213], v[94:97], 0
  v_cvt_pk_bf16_f32 v10, v106, v107
  v_cvt_pk_bf16_f32 v11, v108, v109
  v_mfma_f32_16x16x32_bf16 v[36:39], v[214:217], v[94:97], 0
  v_cvt_pk_bf16_f32 v12, v110, v111
  v_cvt_pk_bf16_f32 v13, v112, v113
  v_mfma_f32_16x16x32_bf16 v[40:43], v[218:221], v[94:97], 0
  v_cvt_pk_bf16_f32 v14, v114, v115
  v_cvt_pk_bf16_f32 v15, v116, v117
  v_mfma_f32_16x16x32_bf16 v[44:47], v[222:225], v[94:97], 0
  v_cvt_pk_bf16_f32 v16, v118, v119
  v_cvt_pk_bf16_f32 v17, v120, v121
  v_mfma_f32_16x16x32_bf16 v[48:51], v[226:229], v[94:97], 0
  v_cvt_pk_bf16_f32 v18, v122, v123
  v_cvt_pk_bf16_f32 v19, v124, v125
  v_mfma_f32_16x16x16_bf16 v[28:31], v[62:63], v[92:93], v[28:31]
  v_mfma_f32_16x16x16_bf16 v[32:35], v[62:63], v[132:133], v[32:35]
  v_mfma_f32_16x16x16_bf16 v[36:39], v[64:65], v[92:93], v[36:39]
  v_mfma_f32_16x16x16_bf16 v[40:43], v[64:65], v[132:133], v[40:43]
  v_mfma_f32_16x16x16_bf16 v[44:47], v[66:67], v[92:93], v[44:47]
  v_mfma_f32_16x16x16_bf16 v[48:51], v[66:67], v[132:133], v[48:51]
  s_nop 3
  v_cvt_pk_bf16_f32 v20, v28, v29
  v_cvt_pk_bf16_f32 v21, v30, v31
  v_cvt_pk_bf16_f32 v22, v32, v33
  v_cvt_pk_bf16_f32 v23, v34, v35
  v_cvt_pk_bf16_f32 v24, v36, v37
  v_cvt_pk_bf16_f32 v25, v38, v39
  v_cvt_pk_bf16_f32 v26, v40, v41
  v_cvt_pk_bf16_f32 v27, v42, v43
  v_cvt_pk_bf16_f32 v52, v44, v45
  v_cvt_pk_bf16_f32 v53, v46, v47
  v_cvt_pk_bf16_f32 v54, v48, v49
  v_cvt_pk_bf16_f32 v55, v50, v51
  s_nop 1
  v_mfma_f32_16x16x32_bf16 v[102:105], a[180:183], v[8:11], 0
  buffer_load_dwordx4 v[182:185], v239, s[4:7], s33 offen offset:0 sc1
  v_mfma_f32_16x16x32_bf16 v[106:109], a[204:207], v[8:11], 0
  buffer_load_dwordx4 v[186:189], v239, s[4:7], s33 offen offset:1024 sc1
  v_mfma_f32_16x16x32_bf16 v[110:113], a[228:231], v[8:11], 0
  buffer_load_dwordx4 v[190:193], v239, s[4:7], s33 offen offset:2048 sc1
  v_mfma_f32_16x16x32_bf16 v[102:105], a[184:187], v[12:15], v[102:105]
  buffer_load_dwordx4 v[194:197], v239, s[4:7], s33 offen offset:3072 sc1
  v_mfma_f32_16x16x32_bf16 v[106:109], a[208:211], v[12:15], v[106:109]
  s_add_u32 s33, s33, 4096
  v_mfma_f32_16x16x32_bf16 v[110:113], a[232:235], v[12:15], v[110:113]
  buffer_load_dwordx4 v[198:201], v239, s[4:7], s33 offen offset:0 sc1
  v_mfma_f32_16x16x32_bf16 v[102:105], a[188:191], v[16:19], v[102:105]
  buffer_load_dwordx4 v[202:205], v239, s[4:7], s33 offen offset:1024 sc1
  v_mfma_f32_16x16x32_bf16 v[106:109], a[212:215], v[16:19], v[106:109]
  buffer_load_dwordx4 v[206:209], v239, s[4:7], s33 offen offset:2048 sc1
  v_mfma_f32_16x16x32_bf16 v[110:113], a[236:239], v[16:19], v[110:113]
  buffer_load_dwordx4 v[210:213], v239, s[4:7], s33 offen offset:3072 sc1
  v_mfma_f32_16x16x32_bf16 v[102:105], a[192:195], v[20:23], v[102:105]
  s_add_u32 s33, s33, 4096
  v_mfma_f32_16x16x32_bf16 v[106:109], a[216:219], v[20:23], v[106:109]
  buffer_load_dwordx4 v[214:217], v239, s[4:7], s33 offen offset:0 sc1
  v_mfma_f32_16x16x32_bf16 v[110:113], a[240:243], v[20:23], v[110:113]
  buffer_load_dwordx4 v[218:221], v239, s[4:7], s33 offen offset:1024 sc1
  v_mfma_f32_16x16x32_bf16 v[102:105], a[196:199], v[24:27], v[102:105]
  buffer_load_dwordx4 v[222:225], v239, s[4:7], s33 offen offset:2048 sc1
  v_mfma_f32_16x16x32_bf16 v[106:109], a[220:223], v[24:27], v[106:109]
  buffer_load_dwordx4 v[226:229], v239, s[4:7], s33 offen offset:3072 sc1
  v_mfma_f32_16x16x32_bf16 v[110:113], a[244:247], v[24:27], v[110:113]
  s_add_u32 s33, s33, 16384
  v_mfma_f32_16x16x32_bf16 v[102:105], a[200:203], v[52:55], v[102:105]
  v_mfma_f32_16x16x32_bf16 v[106:109], a[224:227], v[52:55], v[106:109]
  v_mfma_f32_16x16x32_bf16 v[110:113], a[248:251], v[52:55], v[110:113]
  s_nop 6
  v_pk_mul_f32 v[102:103], v[102:103], v[130:131]
  v_pk_mul_f32 v[104:105], v[104:105], v[130:131]
  v_pk_mul_f32 v[106:107], v[106:107], v[130:131]
  v_pk_mul_f32 v[108:109], v[108:109], v[130:131]
  v_pk_mul_f32 v[110:111], v[110:111], v[130:131]
  v_pk_mul_f32 v[112:113], v[112:113], v[130:131]
  ds_write_b128 v240, v[102:105] offset:0
  ds_write_b128 v240, v[106:109] offset:512
  ds_write_b128 v240, v[110:113] offset:1024
  s_waitcnt lgkmcnt(0)
  s_barrier
  s_cmp_ge_u32 s29, 2
  s_cbranch_scc1 L_idle_0_fc
  ds_read_b128 v[28:31], v241 offset:0
  ds_read_b128 v[32:35], v241 offset:1536
  ds_read_b128 v[36:39], v241 offset:3072
  ds_read_b128 v[40:43], v241 offset:4608
  s_waitcnt lgkmcnt(0)
  v_pk_add_f32 v[28:29], v[28:29], v[32:33]
  v_pk_add_f32 v[30:31], v[30:31], v[34:35]
  v_pk_add_f32 v[36:37], v[36:37], v[40:41]
  v_pk_add_f32 v[38:39], v[38:39], v[42:43]
  v_pk_add_f32 v[28:29], v[28:29], v[36:37]
  v_pk_add_f32 v[30:31], v[30:31], v[38:39]
  buffer_store_dwordx4 v[28:31], v242, s[4:7], s64 offen sc1
  s_sleep 14
  buffer_load_dwordx4 v[56:59], v243, s[4:7], s64 offen offset:0 sc1
  buffer_load_dwordx4 v[60:63], v243, s[4:7], s64 offen offset:640 sc1
  buffer_load_dwordx4 v[64:67], v243, s[4:7], s64 offen offset:1280 sc1
  buffer_load_dwordx4 v[68:71], v243, s[4:7], s64 offen offset:1920 sc1
  buffer_load_dwordx4 v[72:75], v244, s[4:7], s64 offen offset:0 sc1
  buffer_load_dwordx4 v[76:79], v244, s[4:7], s64 offen offset:640 sc1
  buffer_load_dwordx4 v[80:83], v244, s[4:7], s64 offen offset:1280 sc1
  buffer_load_dwordx4 v[84:87], v244, s[4:7], s64 offen offset:1920 sc1
  s_waitcnt vmcnt(0)
  v_pk_add_f32 v[56:57], v[56:57], v[60:61]
  v_pk_add_f32 v[58:59], v[58:59], v[62:63]
  v_pk_add_f32 v[64:65], v[64:65], v[68:69]
  v_pk_add_f32 v[66:67], v[66:67], v[70:71]
  v_pk_add_f32 v[72:73], v[72:73], v[76:77]
  v_pk_add_f32 v[74:75], v[74:75], v[78:79]
  v_pk_add_f32 v[80:81], v[80:81], v[84:85]
  v_pk_add_f32 v[82:83], v[82:83], v[86:87]
  v_pk_add_f32 v[56:57], v[56:57], v[64:65]
  v_pk_add_f32 v[58:59], v[58:59], v[66:67]
  v_pk_add_f32 v[72:73], v[72:73], v[80:81]
  v_pk_add_f32 v[74:75], v[74:75], v[82:83]
  v_pk_add_f32 v[56:57], v[56:57], v[72:73]
  v_pk_add_f32 v[58:59], v[58:59], v[74:75]
  v_cmp_u_f32 vcc, v56, v57
  v_cmp_u_f32 s[74:75], v58, v59
  s_or_b64 vcc, vcc, s[74:75]
  s_cbranch_vccnz R_B2_0_fc
K_B2_0_fc:
  v_cvt_pk_bf16_f32 v60, v56, v57
  v_cvt_pk_bf16_f32 v61, v58, v59
  buffer_store_dwordx2 v[60:61], v245, s[4:7], s53 offen
  buffer_store_dword v126, v128, s[4:7], s101 offen
  s_branch L_join_0_fc
L_idle_0_fc:
  buffer_load_dwordx4 v[56:59], v239, s[4:7], s34 offen offset:0
  buffer_load_dwordx4 v[60:63], v239, s[4:7], s34 offen offset:1024
  buffer_load_dwordx4 v[64:67], v239, s[4:7], s34 offen offset:2048
  buffer_store_dwordx4 v[252:255], v242, s[4:7], s66 offen sc1
  buffer_store_dwordx2 v[252:253], v245, s[4:7], s55 offen
  s_waitcnt vmcnt(0)
  buffer_store_dword v126, v128, s[4:7], s101 offen
L_join_0_fc:
  s_add_u32 s101, s101, 64
  s_add_u32 s34, s34, 24576
  s_add_u32 s30, s30, 1
  s_mov_b32 s72, s52
  s_mov_b32 s52, s53
  s_mov_b32 s53, s54
  s_mov_b32 s54, s55
  s_mov_b32 s55, s72
  s_mov_b32 s72, s56
  s_mov_b32 s56, s57
  s_mov_b32 s57, s58
  s_mov_b32 s58, s59
  s_mov_b32 s59, s72
  s_mov_b32 s72, s60
  s_mov_b32 s60, s61
  s_mov_b32 s61, s62
  s_mov_b32 s62, s63
  s_mov_b32 s63, s72
  s_mov_b32 s72, s64
  s_mov_b32 s64, s65
  s_mov_b32 s65, s66
  s_mov_b32 s66, s67
  s_mov_b32 s67, s72
  s_barrier
  s_branch L_loop_fc
R_C_0_fc:
  s_add_u32 s96, s96, 1
  s_add_u32 s71, s71, 1
  s_cmp_gt_u32 s71, 400000
  s_cbranch_scc1 L_done_fc
  buffer_load_dwordx4 v[8:11], v230, s[4:7], s52 offen offset:0 sc1
  buffer_load_dwordx4 v[12:15], v230, s[4:7], s52 offen offset:512 sc1
  buffer_load_dwordx4 v[16:19], v230, s[4:7], s52 offen offset:1024 sc1
  buffer_load_dwordx4 v[20:23], v230, s[4:7], s52 offen offset:1536 sc1
  buffer_load_dwordx4 v[24:27], v230, s[4:7], s52 offen offset:2048 sc1
  s_waitcnt vmcnt(0)
  s_branch K_C_0_fc
R_A_0_fc:
  s_add_u32 s97, s97, 1
  s_add_u32 s71, s71, 1
  s_cmp_gt_u32 s71, 400000
  s_cbranch_scc1 L_done_fc
  buffer_load_dwordx4 v[102:105], v237, s[4:7], s60 offen offset:0 sc1
  buffer_load_dwordx4 v[106:109], v237, s[4:7], s60 offen offset:1024 sc1
  buffer_load_dwordx4 v[110:113], v237, s[4:7], s60 offen offset:2048 sc1
  buffer_load_dwordx4 v[114:117], v237, s[4:7], s60 offen offset:3072 sc1
  buffer_load_dwordx4 v[118:121], v237, s[4:7], s32 offen offset:0 sc1
  buffer_load_dwordx4 v[122:125], v237, s[4:7], s32 offen offset:1024 sc1
  s_waitcnt vmcnt(0)
  s_branch K_A_0_fc
R_F_0_fc:
  s_add_u32 s98, s98, 1
  s_add_u32 s71, s71, 1
  s_cmp_gt_u32 s71, 400000
  s_cbranch_scc1 L_done_fc
  buffer_load_dword v127, v246, s[4:7], s23 offen sc1
  s_waitcnt vmcnt(0)
  v_cmp_eq_u32 vcc, 0, v127
  s_cbranch_vccnz R_F_0_fc
  s_branch K_F_0_fc
R_V_0_fc:
  s_add_u32 s98, s98, 1
  s_add_u32 s71, s71, 1
  s_cmp_gt_u32 s71, 400000
  s_cbranch_scc1 L_done_fc
  buffer_load_dwordx4 v[56:59], v238, s[4:7], s60 offen offset:0 sc1
  buffer_load_dwordx4 v[60:63], v238, s[4:7], s60 offen offset:1024 sc1
  buffer_load_dwordx4 v[64:67], v238, s[4:7], s60 offen offset:2048 sc1
  s_waitcnt vmcnt(0)
  v_max3_u32 v4, v56, v57, v58
  v_max3_u32 v5, v59, v60, v61
  v_max3_u32 v6, v62, v63, v64
  v_max3_u32 v7, v65, v66, v67
  v_max3_u32 v4, v4, v5, v6
  v_max_u32 v4, v4, v7
  v_cmp_eq_u32 vcc, -1, v4
  s_cbranch_vccnz R_V_0_fc
  s_branch K_V_0_fc
R_B2_0_fc:
  s_add_u32 s99, s99, 1
  s_add_u32 s71, s71, 1
  s_cmp_gt_u32 s71, 400000
  s_cbranch_scc1 L_done_fc
  buffer_load_dwordx4 v[56:59], v243, s[4:7], s64 offen offset:0 sc1
  buffer_load_dwordx4 v[60:63], v243, s[4:7], s64 offen offset:640 sc1
  buffer_load_dwordx4 v[64:67], v243, s[4:7], s64 offen offset:1280 sc1
  buffer_load_dwordx4 v[68:71], v243, s[4:7], s64 offen offset:1920 sc1
  buffer_load_dwordx4 v[72:75], v244, s[4:7], s64 offen offset:0 sc1
  buffer_load_dwordx4 v[76:79], v244, s[4:7], s64 offen offset:640 sc1
  buffer_load_dwordx4 v[80:83], v244, s[4:7], s64 offen offset:1280 sc1
  buffer_load_dwordx4 v[84:87], v244, s[4:7], s64 offen offset:1920 sc1
  s_waitcnt vmcnt(0)
  v_pk_add_f32 v[56:57], v[56:57], v[60:61]
  v_pk_add_f32 v[58:59], v[58:59], v[62:63]
  v_pk_add_f32 v[64:65], v[64:65], v[68:69]
  v_pk_add_f32 v[66:67], v[66:67], v[70:71]
  v_pk_add_f32 v[72:73], v[72:73], v[76:77]
  v_pk_add_f32 v[74:75], v[74:75], v[78:79]
  v_pk_add_f32 v[80:81], v[80:81], v[84:85]
  v_pk_add_f32 v[82:83], v[82:83], v[86:87]
  v_pk_add_f32 v[56:57], v[56:57], v[64:65]
  v_pk_add_f32 v[58:59], v[58:59], v[66:67]
  v_pk_add_f32 v[72:73], v[72:73], v[80:81]
  v_pk_add_f32 v[74:75], v[74:75], v[82:83]
  v_pk_add_f32 v[56:57], v[56:57], v[72:73]
  v_pk_add_f32 v[58:59], v[58:59], v[74:75]
  v_cmp_u_f32 vcc, v56, v57
  v_cmp_u_f32 s[74:75], v58, v59
  s_or_b64 vcc, vcc, s[74:75]
  s_cbranch_vccnz R_B2_0_fc
  s_branch K_B2_0_fc
L_last_fc:
  buffer_store_dwordx2 v[98:99], v235, s[4:7], s68 offen
  buffer_store_dwordx2 v[100:101], v236, s[4:7], s68 offen
  s_waitcnt vmcnt(0)
  buffer_store_dword v126, v128, s[4:7], s101 offen
L_done_fc:
  s_branch L_mend
L_fastx:
  s_sub_u32 s25, s21, 16
  s_load_dwordx4 s[52:55], s[0:1], 64
  s_load_dwordx4 s[56:59], s[0:1], 80
  s_load_dwordx2 s[60:61], s[0:1], 0
  s_load_dwordx2 s[62:63], s[0:1], 96
  s_lshr_b32 s26, s25, 2
  s_and_b32 s27, s25, 3
  s_lshl_b32 s28, s24, 2
  s_add_u32 s28, s28, s26
  s_lshr_b32 s34, s29, 1
  s_and_b32 s35, s29, 1
  s_mov_b32 s71, 0
  s_waitcnt lgkmcnt(0)
  v_lshlrev_b32 v200, 4, v1
  v_mov_b32 v205, 1
  v_mov_b32 v210, 0x80000000
  v_cmp_eq_u32 vcc, 0, v1
  v_mov_b32 v4, 0
  v_cndmask_b32 v204, v210, v4, vcc
  s_mul_i32 s72, s29, 960
  s_add_u32 s72, s72, 0
  v_add_u32 v6, s72, v1
  s_mov_b32 s73, 43691
  v_mul_lo_u32 v7, v6, s73
  v_lshrrev_b32 v7, 18, v7
  v_mul_u32_u24 v30, 6, v7
  v_sub_u32 v30, v6, v30
  v_lshlrev_b32 v30, 4, v30
  s_mov_b32 s73, 12288
  v_mad_u32_u24 v30, v7, s73, v30
  s_mul_i32 s72, s29, 960
  s_add_u32 s72, s72, 64
  v_add_u32 v6, s72, v1
  s_mov_b32 s73, 43691
  v_mul_lo_u32 v7, v6, s73
  v_lshrrev_b32 v7, 18, v7
  v_mul_u32_u24 v31, 6, v7
  v_sub_u32 v31, v6, v31
  v_lshlrev_b32 v31, 4, v31
  s_mov_b32 s73, 12288
  v_mad_u32_u24 v31, v7, s73, v31
  s_mul_i32 s72, s29, 960
  s_add_u32 s72, s72, 128
  v_add_u32 v6, s72, v1
  s_mov_b32 s73, 43691
  v_mul_lo_u32 v7, v6, s73
  v_lshrrev_b32 v7, 18, v7
  v_mul_u32_u24 v32, 6, v7
  v_sub_u32 v32, v6, v32
  v_lshlrev_b32 v32, 4, v32
  s_mov_b32 s73, 12288
  v_mad_u32_u24 v32, v7, s73, v32
  s_mul_i32 s72, s29, 960
  s_add_u32 s72, s72, 192
  v_add_u32 v6, s72, v1
  s_mov_b32 s73, 43691
  v_mul_lo_u32 v7, v6, s73
  v_lshrrev_b32 v7, 18, v7
  v_mul_u32_u24 v33, 6, v7
  v_sub_u32 v33, v6, v33
  v_lshlrev_b32 v33, 4, v33
  s_mov_b32 s73, 12288
  v_mad_u32_u24 v33, v7, s73, v33
  s_mul_i32 s72, s29, 960
  s_add_u32 s72, s72, 256
  v_add_u32 v6, s72, v1
  s_mov_b32 s73, 43691
  v_mul_lo_u32 v7, v6, s73
  v_lshrrev_b32 v7, 18, v7
  v_mul_u32_u24 v34, 6, v7
  v_sub_u32 v34, v6, v34
  v_lshlrev_b32 v34, 4, v34
  s_mov_b32 s73, 12288
  v_mad_u32_u24 v34, v7, s73, v34
  s_mul_i32 s72, s29, 960
  s_add_u32 s72, s72, 320
  v_add_u32 v6, s72, v1
  s_mov_b32 s73, 43691
  v_mul_lo_u32 v7, v6, s73
  v_lshrrev_b32 v7, 18, v7
  v_mul_u32_u24 v35, 6, v7
  v_sub_u32 v35, v6, v35
  v_lshlrev_b32 v35, 4, v35
  s_mov_b32 s73, 12288
  v_mad_u32_u24 v35, v7, s73, v35
  s_mul_i32 s72, s29, 960
  s_add_u32 s72, s72, 384
  v_add_u32 v6, s72, v1
  s_mov_b32 s73, 43691
  v_mul_lo_u32 v7, v6, s73
  v_lshrrev_b32 v7, 18, v7
  v_mul_u32_u24 v36, 6, v7
  v_sub_u32 v36, v6, v36
  v_lshlrev_b32 v36, 4, v36
  s_mov_b32 s73, 12288
  v_mad_u32_u24 v36, v7, s73, v36
  s_mul_i32 s72, s29, 960
  s_add_u32 s72, s72, 448
  v_add_u32 v6, s72, v1
  s_mov_b32 s73, 43691
  v_mul_lo_u32 v7, v6, s73
  v_lshrrev_b32 v7, 18, v7
  v_mul_u32_u24 v37, 6, v7
  v_sub_u32 v37, v6, v37
  v_lshlrev_b32 v37, 4, v37
  s_mov_b32 s73, 12288
  v_mad_u32_u24 v37, v7, s73, v37
  s_mul_i32 s72, s29, 960
  s_add_u32 s72, s72, 512
  v_add_u32 v6, s72, v1
  s_mov_b32 s73, 43691
  v_mul_lo_u32 v7, v6, s73
  v_lshrrev_b32 v7, 18, v7
  v_mul_u32_u24 v38, 6, v7
  v_sub_u32 v38, v6, v38
  v_lshlrev_b32 v38, 4, v38
  s_mov_b32 s73, 12288
  v_mad_u32_u24 v38, v7, s73, v38
  s_mul_i32 s72, s29, 960
  s_add_u32 s72, s72, 576
  v_add_u32 v6, s72, v1
  s_mov_b32 s73, 43691
  v_mul_lo_u32 v7, v6, s73
  v_lshrrev_b32 v7, 18, v7
  v_mul_u32_u24 v39, 6, v7
  v_sub_u32 v39, v6, v39
  v_lshlrev_b32 v39, 4, v39
  s_mov_b32 s73, 12288
  v_mad_u32_u24 v39, v7, s73, v39
  s_mul_i32 s72, s29, 960
  s_add_u32 s72, s72, 640
  v_add_u32 v6, s72, v1
  s_mov_b32 s73, 43691
  v_mul_lo_u32 v7, v6, s73
  v_lshrrev_b32 v7, 18, v7
  v_mul_u32_u24 v40, 6, v7
  v_sub_u32 v40, v6, v40
  v_lshlrev_b32 v40, 4, v40
  s_mov_b32 s73, 12288
  v_mad_u32_u24 v40, v7, s73, v40
  s_mul_i32 s72, s29, 960
  s_add_u32 s72, s72, 704
  v_add_u32 v6, s72, v1
  s_mov_b32 s73, 43691
  v_mul_lo_u32 v7, v6, s73
  v_lshrrev_b32 v7, 18, v7
  v_mul_u32_u24 v41, 6, v7
  v_sub_u32 v41, v6, v41
  v_lshlrev_b32 v41, 4, v41
  s_mov_b32 s73, 12288
  v_mad_u32_u24 v41, v7, s73, v41
  s_mul_i32 s72, s29, 960
  s_add_u32 s72, s72, 768
  v_add_u32 v6, s72, v1
  s_mov_b32 s73, 43691
  v_mul_lo_u32 v7, v6, s73
  v_lshrrev_b32 v7, 18, v7
  v_mul_u32_u24 v42, 6, v7
  v_sub_u32 v42, v6, v42
  v_lshlrev_b32 v42, 4, v42
  s_mov_b32 s73, 12288
  v_mad_u32_u24 v42, v7, s73, v42
  s_mul_i32 s72, s29, 960
  s_add_u32 s72, s72, 832
  v_add_u32 v6, s72, v1
  s_mov_b32 s73, 43691
  v_mul_lo_u32 v7, v6, s73
  v_lshrrev_b32 v7, 18, v7
  v_mul_u32_u24 v43, 6, v7
  v_sub_u32 v43, v6, v43
  v_lshlrev_b32 v43, 4, v43
  s_mov_b32 s73, 12288
  v_mad_u32_u24 v43, v7, s73, v43
  s_mul_i32 s72, s29, 960
  s_add_u32 s72, s72, 896
  v_add_u32 v6, s72, v1
  s_mov_b32 s73, 43691
  v_mul_lo_u32 v7, v6, s73
  v_lshrrev_b32 v7, 18, v7
  v_mul_u32_u24 v44, 6, v7
  v_sub_u32 v44, v6, v44
  v_lshlrev_b32 v44, 4, v44
  s_mov_b32 s73, 12288
  v_mad_u32_u24 v44, v7, s73, v44
  s_mul_i32 s74, s28, 384
  s_mul_i32 s72, s27, 96
  s_add_u32 s74, s74, s72
  s_mov_b32 s36, s74
  s_mov_b32 s8, s42
  s_and_b32 s9, s43, 0xffff
  s_mov_b32 s10, 7864320
  s_mov_b32 s11, 0x00020000
  s_mul_i32 s72, s29, 15360
  s_add_u32 s72, s72, 0
  s_add_u32 m0, s72, 0
  s_nop 0
  buffer_load_dwordx4 v30, s[8:11], s74 offen lds
  s_add_u32 m0, s72, 1024
  s_nop 0
  buffer_load_dwordx4 v31, s[8:11], s74 offen lds
  s_add_u32 m0, s72, 2048
  s_nop 0
  buffer_load_dwordx4 v32, s[8:11], s74 offen lds
  s_add_u32 m0, s72, 3072
  s_nop 0
  buffer_load_dwordx4 v33, s[8:11], s74 offen lds
  s_add_u32 m0, s72, 4096
  s_nop 0
  buffer_load_dwordx4 v34, s[8:11], s74 offen lds
  s_add_u32 m0, s72, 5120
  s_nop 0
  buffer_load_dwordx4 v35, s[8:11], s74 offen lds
  s_add_u32 m0, s72, 6144
  s_nop 0
  buffer_load_dwordx4 v36, s[8:11], s74 offen lds
  s_add_u32 m0, s72, 7168
  s_nop 0
  buffer_load_dwordx4 v37, s[8:11], s74 offen lds
  s_add_u32 m0, s72, 8192
  s_nop 0
  buffer_load_dwordx4 v38, s[8:11], s74 offen lds
  s_add_u32 m0, s72, 9216
  s_nop 0
  buffer_load_dwordx4 v39, s[8:11], s74 offen lds
  s_add_u32 m0, s72, 10240
  s_nop 0
  buffer_load_dwordx4 v40, s[8:11], s74 offen lds
  s_add_u32 m0, s72, 11264
  s_nop 0
  buffer_load_dwordx4 v41, s[8:11], s74 offen lds
  s_add_u32 m0, s72, 12288
  s_nop 0
  buffer_load_dwordx4 v42, s[8:11], s74 offen lds
  s_add_u32 m0, s72, 13312
  s_nop 0
  buffer_load_dwordx4 v43, s[8:11], s74 offen lds
  s_add_u32 m0, s72, 14336
  s_nop 0
  buffer_load_dwordx4 v44, s[8:11], s74 offen lds
  s_mov_b32 s8, s44
  s_and_b32 s9, s45, 0xffff
  s_mov_b32 s10, 7864320
  s_mov_b32 s11, 0x00020000
  s_mul_i32 s72, s29, 15360
  s_add_u32 s72, s72, 61440
  s_add_u32 m0, s72, 0
  s_nop 0
  buffer_load_dwordx4 v30, s[8:11], s74 offen lds
  s_add_u32 m0, s72, 1024
  s_nop 0
  buffer_load_dwordx4 v31, s[8:11], s74 offen lds
  s_add_u32 m0, s72, 2048
  s_nop 0
  buffer_load_dwordx4 v32, s[8:11], s74 offen lds
  s_add_u32 m0, s72, 3072
  s_nop 0
  buffer_load_dwordx4 v33, s[8:11], s74 offen lds
  s_add_u32 m0, s72, 4096
  s_nop 0
  buffer_load_dwordx4 v34, s[8:11], s74 offen lds
  s_add_u32 m0, s72, 5120
  s_nop 0
  buffer_load_dwordx4 v35, s[8:11], s74 offen lds
  s_add_u32 m0, s72, 6144
  s_nop 0
  buffer_load_dwordx4 v36, s[8:11], s74 offen lds
  s_add_u32 m0, s72, 7168
  s_nop 0
  buffer_load_dwordx4 v37, s[8:11], s74 offen lds
  s_add_u32 m0, s72, 8192
  s_nop 0
  buffer_load_dwordx4 v38, s[8:11], s74 offen lds
  s_add_u32 m0, s72, 9216
  s_nop 0
  buffer_load_dwordx4 v39, s[8:11], s74 offen lds
  s_add_u32 m0, s72, 10240
  s_nop 0
  buffer_load_dwordx4 v40, s[8:11], s74 offen lds
  s_add_u32 m0, s72, 11264
  s_nop 0
  buffer_load_dwordx4 v41, s[8:11], s74 offen lds
  s_add_u32 m0, s72, 12288
  s_nop 0
  buffer_load_dwordx4 v42, s[8:11], s74 offen lds
  s_add_u32 m0, s72, 13312
  s_nop 0
  buffer_load_dwordx4 v43, s[8:11], s74 offen lds
  s_add_u32 m0, s72, 14336
  s_nop 0
  buffer_load_dwordx4 v44, s[8:11], s74 offen lds
  v_lshrrev_b32 v4, 2, v2
  v_and_b32 v5, 3, v2
  v_lshl_add_u32 v6, v3, 3, v4
  v_mul_u32_u24 v20, 96, v6
  v_lshl_add_u32 v20, v5, 3, v20
  v_add_u32 v21, 61440, v20
  v_lshlrev_b32 v22, 5, v6
  v_lshl_add_u32 v22, v5, 3, v22
  v_add_u32 v22, 61440, v22
  s_waitcnt vmcnt(0)
  s_barrier
  s_cmp_eq_u32 s29, 0
  s_cbranch_scc0 L_w1a_fx
  ds_read_b64_tr_b16 a[0:1], v20 offset:0
  ds_read_b64_tr_b16 a[2:3], v20 offset:384
  ds_read_b64_tr_b16 a[4:5], v20 offset:3072
  ds_read_b64_tr_b16 a[6:7], v20 offset:3456
  ds_read_b64_tr_b16 a[8:9], v20 offset:6144
  ds_read_b64_tr_b16 a[10:11], v20 offset:6528
  ds_read_b64_tr_b16 a[12:13], v20 offset:9216
  ds_read_b64_tr_b16 a[14:15], v20 offset:9600
  s_waitcnt lgkmcnt(0)
  ds_read_b64_tr_b16 a[16:17], v20 offset:12288
  ds_read_b64_tr_b16 a[18:19], v20 offset:12672
  ds_read_b64_tr_b16 a[20:21], v20 offset:15360
  ds_read_b64_tr_b16 a[22:23], v20 offset:15744
  ds_read_b64_tr_b16 a[24:25], v20 offset:18432
  ds_read_b64_tr_b16 a[26:27], v20 offset:18816
  ds_read_b64_tr_b16 a[28:29], v20 offset:21504
  ds_read_b64_tr_b16 a[30:31], v20 offset:21888
  s_waitcnt lgkmcnt(0)
  ds_read_b64_tr_b16 a[32:33], v20 offset:24576
  ds_read_b64_tr_b16 a[34:35], v20 offset:24960
  ds_read_b64_tr_b16 a[36:37], v20 offset:27648
  ds_read_b64_tr_b16 a[38:39], v20 offset:28032
  ds_read_b64_tr_b16 a[40:41], v20 offset:30720
  ds_read_b64_tr_b16 a[42:43], v20 offset:31104
  ds_read_b64_tr_b16 a[44:45], v20 offset:33792
  ds_read_b64_tr_b16 a[46:47], v20 offset:34176
  s_waitcnt lgkmcnt(0)
  ds_read_b64_tr_b16 a[48:49], v20 offset:36864
  ds_read_b64_tr_b16 a[50:51], v20 offset:37248
  ds_read_b64_tr_b16 a[52:53], v20 offset:39936
  ds_read_b64_tr_b16 a[54:55], v20 offset:40320
  ds_read_b64_tr_b16 a[56:57], v20 offset:43008
  ds_read_b64_tr_b16 a[58:59], v20 offset:43392
  ds_read_b64_tr_b16 a[60:61], v20 offset:46080
  ds_read_b64_tr_b16 a[62:63], v20 offset:46464
  s_waitcnt lgkmcnt(0)
  ds_read_b64_tr_b16 a[64:65], v20 offset:49152
  ds_read_b64_tr_b16 a[66:67], v20 offset:49536
  ds_read_b64_tr_b16 a[68:69], v20 offset:52224
  ds_read_b64_tr_b16 a[70:71], v20 offset:52608
  ds_read_b64_tr_b16 a[72:73], v20 offset:55296
  ds_read_b64_tr_b16 a[74:75], v20 offset:55680
  ds_read_b64_tr_b16 a[76:77], v20 offset:58368
  ds_read_b64_tr_b16 a[78:79], v20 offset:58752
  s_waitcnt lgkmcnt(0)
  ds_read_b64_tr_b16 a[80:81], v20 offset:32
  ds_read_b64_tr_b16 a[82:83], v20 offset:416
  ds_read_b64_tr_b16 a[84:85], v20 offset:3104
  ds_read_b64_tr_b16 a[86:87], v20 offset:3488
  ds_read_b64_tr_b16 a[88:89], v20 offset:6176
  ds_read_b64_tr_b16 a[90:91], v20 offset:6560
  ds_read_b64_tr_b16 a[92:93], v20 offset:9248
  ds_read_b64_tr_b16 a[94:95], v20 offset:9632
  s_waitcnt lgkmcnt(0)
  ds_read_b64_tr_b16 a[96:97], v20 offset:12320
  ds_read_b64_tr_b16 a[98:99], v20 offset:12704
  ds_read_b64_tr_b16 a[100:101], v20 offset:15392
  ds_read_b64_tr_b16 a[102:103], v20 offset:15776
  ds_read_b64_tr_b16 a[104:105], v20 offset:18464
  ds_read_b64_tr_b16 a[106:107], v20 offset:18848
  ds_read_b64_tr_b16 a[108:109], v20 offset:21536
  ds_read_b64_tr_b16 a[110:111], v20 offset:21920
  s_waitcnt lgkmcnt(0)
  ds_read_b64_tr_b16 a[112:113], v20 offset:24608
  ds_read_b64_tr_b16 a[114:115], v20 offset:24992
  ds_read_b64_tr_b16 a[116:117], v20 offset:27680
  ds_read_b64_tr_b16 a[118:119], v20 offset:28064
  ds_read_b64_tr_b16 a[120:121], v20 offset:30752
  ds_read_b64_tr_b16 a[122:123], v20 offset:31136
  ds_read_b64_tr_b16 a[124:125], v20 offset:33824
  ds_read_b64_tr_b16 a[126:127], v20 offset:34208
  s_waitcnt lgkmcnt(0)
  ds_read_b64_tr_b16 a[128:129], v20 offset:36896
  ds_read_b64_tr_b16 a[130:131], v20 offset:37280
  ds_read_b64_tr_b16 a[132:133], v20 offset:39968
  ds_read_b64_tr_b16 a[134:135], v20 offset:40352
  ds_read_b64_tr_b16 a[136:137], v20 offset:43040
  ds_read_b64_tr_b16 a[138:139], v20 offset:43424
  ds_read_b64_tr_b16 a[140:141], v20 offset:46112
  ds_read_b64_tr_b16 a[142:143], v20 offset:46496
  s_waitcnt lgkmcnt(0)
  ds_read_b64_tr_b16 a[144:145], v20 offset:49184
  ds_read_b64_tr_b16 a[146:147], v20 offset:49568
  ds_read_b64_tr_b16 a[148:149], v20 offset:52256
  ds_read_b64_tr_b16 a[150:151], v20 offset:52640
  ds_read_b64_tr_b16 a[152:153], v20 offset:55328
  ds_read_b64_tr_b16 a[154:155], v20 offset:55712
  ds_read_b64_tr_b16 a[156:157], v20 offset:58400
  ds_read_b64_tr_b16 a[158:159], v20 offset:58784
  s_waitcnt lgkmcnt(0)
  ds_read_b64_tr_b16 a[160:161], v20 offset:64
  ds_read_b64_tr_b16 a[162:163], v20 offset:448
  ds_read_b64_tr_b16 a[164:165], v20 offset:3136
  ds_read_b64_tr_b16 a[166:167], v20 offset:3520
  ds_read_b64_tr_b16 a[168:169], v20 offset:6208
  ds_read_b64_tr_b16 a[170:171], v20 offset:6592
  ds_read_b64_tr_b16 a[172:173], v20 offset:9280
  ds_read_b64_tr_b16 a[174:175], v20 offset:9664
  s_waitcnt lgkmcnt(0)
  ds_read_b64_tr_b16 a[176:177], v20 offset:12352
  ds_read_b64_tr_b16 a[178:179], v20 offset:12736
  ds_read_b64_tr_b16 a[180:181], v20 offset:15424
  ds_read_b64_tr_b16 a[182:183], v20 offset:15808
  ds_read_b64_tr_b16 a[184:185], v20 offset:18496
  ds_read_b64_tr_b16 a[186:187], v20 offset:18880
  ds_read_b64_tr_b16 a[188:189], v20 offset:21568
  ds_read_b64_tr_b16 a[190:191], v20 offset:21952
  s_waitcnt lgkmcnt(0)
  ds_read_b64_tr_b16 a[192:193], v20 offset:24640
  ds_read_b64_tr_b16 a[194:195], v20 offset:25024
  ds_read_b64_tr_b16 a[196:197], v20 offset:27712
  ds_read_b64_tr_b16 a[198:199], v20 offset:28096
  ds_read_b64_tr_b16 a[200:201], v20 offset:30784
  ds_read_b64_tr_b16 a[202:203], v20 offset:31168
  ds_read_b64_tr_b16 a[204:205], v20 offset:33856
  ds_read_b64_tr_b16 a[206:207], v20 offset:34240
  s_waitcnt lgkmcnt(0)
  ds_read_b64_tr_b16 a[208:209], v20 offset:36928
  ds_read_b64_tr_b16 a[210:211], v20 offset:37312
  ds_read_b64_tr_b16 a[212:213], v20 offset:40000
  ds_read_b64_tr_b16 a[214:215], v20 offset:40384
  ds_read_b64_tr_b16 a[216:217], v20 offset:43072
  ds_read_b64_tr_b16 a[218:219], v20 offset:43456
  ds_read_b64_tr_b16 a[220:221], v20 offset:46144
  ds_read_b64_tr_b16 a[222:223], v20 offset:46528
  s_waitcnt lgkmcnt(0)
  ds_read_b64_tr_b16 a[224:225], v20 offset:49216
  ds_read_b64_tr_b16 a[226:227], v20 offset:49600
  ds_read_b64_tr_b16 a[228:229], v20 offset:52288
  ds_read_b64_tr_b16 a[230:231], v20 offset:52672
  ds_read_b64_tr_b16 a[232:233], v20 offset:55360
  ds_read_b64_tr_b16 a[234:235], v20 offset:55744
  ds_read_b64_tr_b16 a[236:237], v20 offset:58432
  ds_read_b64_tr_b16 a[238:239], v20 offset:58816
  s_waitcnt lgkmcnt(0)
L_w1a_fx:
  s_cmp_eq_u32 s29, 1
  s_cbranch_scc0 L_w1b_fx
  ds_read_b64_tr_b16 a[0:1], v21 offset:0
  ds_read_b64_tr_b16 a[2:3], v21 offset:384
  ds_read_b64_tr_b16 a[4:5], v21 offset:3072
  ds_read_b64_tr_b16 a[6:7], v21 offset:3456
  ds_read_b64_tr_b16 a[8:9], v21 offset:6144
  ds_read_b64_tr_b16 a[10:11], v21 offset:6528
  ds_read_b64_tr_b16 a[12:13], v21 offset:9216
  ds_read_b64_tr_b16 a[14:15], v21 offset:9600
  s_waitcnt lgkmcnt(0)
  ds_read_b64_tr_b16 a[16:17], v21 offset:12288
  ds_read_b64_tr_b16 a[18:19], v21 offset:12672
  ds_read_b64_tr_b16 a[20:21], v21 offset:15360
  ds_read_b64_tr_b16 a[22:23], v21 offset:15744
  ds_read_b64_tr_b16 a[24:25], v21 offset:18432
  ds_read_b64_tr_b16 a[26:27], v21 offset:18816
  ds_read_b64_tr_b16 a[28:29], v21 offset:21504
  ds_read_b64_tr_b16 a[30:31], v21 offset:21888
  s_waitcnt lgkmcnt(0)
  ds_read_b64_tr_b16 a[32:33], v21 offset:24576
  ds_read_b64_tr_b16 a[34:35], v21 offset:24960
  ds_read_b64_tr_b16 a[36:37], v21 offset:27648
  ds_read_b64_tr_b16 a[38:39], v21 offset:28032
  ds_read_b64_tr_b16 a[40:41], v21 offset:30720
  ds_read_b64_tr_b16 a[42:43], v21 offset:31104
  ds_read_b64_tr_b16 a[44:45], v21 offset:33792
  ds_read_b64_tr_b16 a[46:47], v21 offset:34176
  s_waitcnt lgkmcnt(0)
  ds_read_b64_tr_b16 a[48:49], v21 offset:36864
  ds_read_b64_tr_b16 a[50:51], v21 offset:37248
  ds_read_b64_tr_b16 a[52:53], v21 offset:39936
  ds_read_b64_tr_b16 a[54:55], v21 offset:40320
  ds_read_b64_tr_b16 a[56:57], v21 offset:43008
  ds_read_b64_tr_b16 a[58:59], v21 offset:43392
  ds_read_b64_tr_b16 a[60:61], v21 offset:46080
  ds_read_b64_tr_b16 a[62:63], v21 offset:46464
  s_waitcnt lgkmcnt(0)
  ds_read_b64_tr_b16 a[64:65], v21 offset:49152
  ds_read_b64_tr_b16 a[66:67], v21 offset:49536
  ds_read_b64_tr_b16 a[68:69], v21 offset:52224
  ds_read_b64_tr_b16 a[70:71], v21 offset:52608
  ds_read_b64_tr_b16 a[72:73], v21 offset:55296
  ds_read_b64_tr_b16 a[74:75], v21 offset:55680
  ds_read_b64_tr_b16 a[76:77], v21 offset:58368
  ds_read_b64_tr_b16 a[78:79], v21 offset:58752
  s_waitcnt lgkmcnt(0)
  ds_read_b64_tr_b16 a[80:81], v21 offset:32
  ds_read_b64_tr_b16 a[82:83], v21 offset:416
  ds_read_b64_tr_b16 a[84:85], v21 offset:3104
  ds_read_b64_tr_b16 a[86:87], v21 offset:3488
  ds_read_b64_tr_b16 a[88:89], v21 offset:6176
  ds_read_b64_tr_b16 a[90:91], v21 offset:6560
  ds_read_b64_tr_b16 a[92:93], v21 offset:9248
  ds_read_b64_tr_b16 a[94:95], v21 offset:9632
  s_waitcnt lgkmcnt(0)
  ds_read_b64_tr_b16 a[96:97], v21 offset:12320
  ds_read_b64_tr_b16 a[98:99], v21 offset:12704
  ds_read_b64_tr_b16 a[100:101], v21 offset:15392
  ds_read_b64_tr_b16 a[102:103], v21 offset:15776
  ds_read_b64_tr_b16 a[104:105], v21 offset:18464
  ds_read_b64_tr_b16 a[106:107], v21 offset:18848
  ds_read_b64_tr_b16 a[108:109], v21 offset:21536
  ds_read_b64_tr_b16 a[110:111], v21 offset:21920
  s_waitcnt lgkmcnt(0)
  ds_read_b64_tr_b16 a[112:113], v21 offset:24608
  ds_read_b64_tr_b16 a[114:115], v21 offset:24992
  ds_read_b64_tr_b16 a[116:117], v21 offset:27680
  ds_read_b64_tr_b16 a[118:119], v21 offset:28064
  ds_read_b64_tr_b16 a[120:121], v21 offset:30752
  ds_read_b64_tr_b16 a[122:123], v21 offset:31136
  ds_read_b64_tr_b16 a[124:125], v21 offset:33824
  ds_read_b64_tr_b16 a[126:127], v21 offset:34208
  s_waitcnt lgkmcnt(0)
  ds_read_b64_tr_b16 a[128:129], v21 offset:36896
  ds_read_b64_tr_b16 a[130:131], v21 offset:37280
  ds_read_b64_tr_b16 a[132:133], v21 offset:39968
  ds_read_b64_tr_b16 a[134:135], v21 offset:40352
  ds_read_b64_tr_b16 a[136:137], v21 offset:43040
  ds_read_b64_tr_b16 a[138:139], v21 offset:43424
  ds_read_b64_tr_b16 a[140:141], v21 offset:46112
  ds_read_b64_tr_b16 a[142:143], v21 offset:46496
  s_waitcnt lgkmcnt(0)
  ds_read_b64_tr_b16 a[144:145], v21 offset:49184
  ds_read_b64_tr_b16 a[146:147], v21 offset:49568
  ds_read_b64_tr_b16 a[148:149], v21 offset:52256
  ds_read_b64_tr_b16 a[150:151], v21 offset:52640
  ds_read_b64_tr_b16 a[152:153], v21 offset:55328
  ds_read_b64_tr_b16 a[154:155], v21 offset:55712
  ds_read_b64_tr_b16 a[156:157], v21 offset:58400
  ds_read_b64_tr_b16 a[158:159], v21 offset:58784
  s_waitcnt lgkmcnt(0)
  ds_read_b64_tr_b16 a[160:161], v21 offset:64
  ds_read_b64_tr_b16 a[162:163], v21 offset:448
  ds_read_b64_tr_b16 a[164:165], v21 offset:3136
  ds_read_b64_tr_b16 a[166:167], v21 offset:3520
  ds_read_b64_tr_b16 a[168:169], v21 offset:6208
  ds_read_b64_tr_b16 a[170:171], v21 offset:6592
  ds_read_b64_tr_b16 a[172:173], v21 offset:9280
  ds_read_b64_tr_b16 a[174:175], v21 offset:9664
  s_waitcnt lgkmcnt(0)
  ds_read_b64_tr_b16 a[176:177], v21 offset:12352
  ds_read_b64_tr_b16 a[178:179], v21 offset:12736
  ds_read_b64_tr_b16 a[180:181], v21 offset:15424
  ds_read_b64_tr_b16 a[182:183], v21 offset:15808
  ds_read_b64_tr_b16 a[184:185], v21 offset:18496
  ds_read_b64_tr_b16 a[186:187], v21 offset:18880
  ds_read_b64_tr_b16 a[188:189], v21 offset:21568
  ds_read_b64_tr_b16 a[190:191], v21 offset:21952
  s_waitcnt lgkmcnt(0)
  ds_read_b64_tr_b16 a[192:193], v21 offset:24640
  ds_read_b64_tr_b16 a[194:195], v21 offset:25024
  ds_read_b64_tr_b16 a[196:197], v21 offset:27712
  ds_read_b64_tr_b16 a[198:199], v21 offset:28096
  ds_read_b64_tr_b16 a[200:201], v21 offset:30784
  ds_read_b64_tr_b16 a[202:203], v21 offset:31168
  ds_read_b64_tr_b16 a[204:205], v21 offset:33856
  ds_read_b64_tr_b16 a[206:207], v21 offset:34240
  s_waitcnt lgkmcnt(0)
  ds_read_b64_tr_b16 a[208:209], v21 offset:36928
  ds_read_b64_tr_b16 a[210:211], v21 offset:37312
  ds_read_b64_tr_b16 a[212:213], v21 offset:40000
  ds_read_b64_tr_b16 a[214:215], v21 offset:40384
  ds_read_b64_tr_b16 a[216:217], v21 offset:43072
  ds_read_b64_tr_b16 a[218:219], v21 offset:43456
  ds_read_b64_tr_b16 a[220:221], v21 offset:46144
  ds_read_b64_tr_b16 a[222:223], v21 offset:46528
  s_waitcnt lgkmcnt(0)
  ds_read_b64_tr_b16 a[224:225], v21 offset:49216
  ds_read_b64_tr_b16 a[226:227], v21 offset:49600
  ds_read_b64_tr_b16 a[228:229], v21 offset:52288
  ds_read_b64_tr_b16 a[230:231], v21 offset:52672
  ds_read_b64_tr_b16 a[232:233], v21 offset:55360
  ds_read_b64_tr_b16 a[234:235], v21 offset:55744
  ds_read_b64_tr_b16 a[236:237], v21 offset:58432
  ds_read_b64_tr_b16 a[238:239], v21 offset:58816
  s_waitcnt lgkmcnt(0)
L_w1b_fx:
  s_waitcnt lgkmcnt(0)
  s_barrier
  s_mov_b32 s8, s40
  s_and_b32 s9, s41, 0xffff
  s_mov_b32 s10, 7864320
  s_mov_b32 s11, 0x00020000
  s_mul_i32 s72, s29, 15360
  s_add_u32 s72, s72, 0
  s_add_u32 m0, s72, 0
  s_nop 0
  buffer_load_dwordx4 v30, s[8:11], s36 offen lds
  s_add_u32 m0, s72, 1024
  s_nop 0
  buffer_load_dwordx4 v31, s[8:11], s36 offen lds
  s_add_u32 m0, s72, 2048
  s_nop 0
  buffer_load_dwordx4 v32, s[8:11], s36 offen lds
  s_add_u32 m0, s72, 3072
  s_nop 0
  buffer_load_dwordx4 v33, s[8:11], s36 offen lds
  s_add_u32 m0, s72, 4096
  s_nop 0
  buffer_load_dwordx4 v34, s[8:11], s36 offen lds
  s_add_u32 m0, s72, 5120
  s_nop 0
  buffer_load_dwordx4 v35, s[8:11], s36 offen lds
  s_add_u32 m0, s72, 6144
  s_nop 0
  buffer_load_dwordx4 v36, s[8:11], s36 offen lds
  s_add_u32 m0, s72, 7168
  s_nop 0
  buffer_load_dwordx4 v37, s[8:11], s36 offen lds
  s_add_u32 m0, s72, 8192
  s_nop 0
  buffer_load_dwordx4 v38, s[8:11], s36 offen lds
  s_add_u32 m0, s72, 9216
  s_nop 0
  buffer_load_dwordx4 v39, s[8:11], s36 offen lds
  s_add_u32 m0, s72, 10240
  s_nop 0
  buffer_load_dwordx4 v40, s[8:11], s36 offen lds
  s_add_u32 m0, s72, 11264
  s_nop 0
  buffer_load_dwordx4 v41, s[8:11], s36 offen lds
  s_add_u32 m0, s72, 12288
  s_nop 0
  buffer_load_dwordx4 v42, s[8:11], s36 offen lds
  s_add_u32 m0, s72, 13312
  s_nop 0
  buffer_load_dwordx4 v43, s[8:11], s36 offen lds
  s_add_u32 m0, s72, 14336
  s_nop 0
  buffer_load_dwordx4 v44, s[8:11], s36 offen lds
  s_mul_i32 s72, s29, 320
  s_add_u32 s72, s72, 0
  v_add_u32 v6, s72, v1
  s_mov_b32 s73, 1
  v_mul_lo_u32 v7, v6, s73
  v_lshrrev_b32 v7, 1, v7
  v_mul_u32_u24 v50, 2, v7
  v_sub_u32 v50, v6, v50
  v_lshlrev_b32 v50, 4, v50
  s_mov_b32 s73, 3072
  v_mad_u32_u24 v50, v7, s73, v50
  s_mul_i32 s72, s29, 320
  s_add_u32 s72, s72, 64
  v_add_u32 v6, s72, v1
  s_mov_b32 s73, 1
  v_mul_lo_u32 v7, v6, s73
  v_lshrrev_b32 v7, 1, v7
  v_mul_u32_u24 v51, 2, v7
  v_sub_u32 v51, v6, v51
  v_lshlrev_b32 v51, 4, v51
  s_mov_b32 s73, 3072
  v_mad_u32_u24 v51, v7, s73, v51
  s_mul_i32 s72, s29, 320
  s_add_u32 s72, s72, 128
  v_add_u32 v6, s72, v1
  s_mov_b32 s73, 1
  v_mul_lo_u32 v7, v6, s73
  v_lshrrev_b32 v7, 1, v7
  v_mul_u32_u24 v52, 2, v7
  v_sub_u32 v52, v6, v52
  v_lshlrev_b32 v52, 4, v52
  s_mov_b32 s73, 3072
  v_mad_u32_u24 v52, v7, s73, v52
  s_mul_i32 s72, s29, 320
  s_add_u32 s72, s72, 192
  v_add_u32 v6, s72, v1
  s_mov_b32 s73, 1
  v_mul_lo_u32 v7, v6, s73
  v_lshrrev_b32 v7, 1, v7
  v_mul_u32_u24 v53, 2, v7
  v_sub_u32 v53, v6, v53
  v_lshlrev_b32 v53, 4, v53
  s_mov_b32 s73, 3072
  v_mad_u32_u24 v53, v7, s73, v53
  s_mul_i32 s72, s29, 320
  s_add_u32 s72, s72, 256
  v_add_u32 v6, s72, v1
  s_mov_b32 s73, 1
  v_mul_lo_u32 v7, v6, s73
  v_lshrrev_b32 v7, 1, v7
  v_mul_u32_u24 v54, 2, v7
  v_sub_u32 v54, v6, v54
  v_lshlrev_b32 v54, 4, v54
  s_mov_b32 s73, 3072
  v_mad_u32_u24 v54, v7, s73, v54
  s_mul_i32 s74, s28, 3
  s_add_u32 s74, s74, s27
  s_min_u32 s74, s74, 95
  s_lshl_b32 s74, s74, 5
  s_mov_b32 s75, s74
  s_mov_b32 s8, s52
  s_and_b32 s9, s53, 0xffff
  s_mov_b32 s10, 1966080
  s_mov_b32 s11, 0x00020000
  s_mul_i32 s72, s29, 5120
  s_add_u32 s72, s72, 61440
  s_add_u32 m0, s72, 0
  s_nop 0
  buffer_load_dwordx4 v50, s[8:11], s74 offen lds
  s_add_u32 m0, s72, 1024
  s_nop 0
  buffer_load_dwordx4 v51, s[8:11], s74 offen lds
  s_add_u32 m0, s72, 2048
  s_nop 0
  buffer_load_dwordx4 v52, s[8:11], s74 offen lds
  s_add_u32 m0, s72, 3072
  s_nop 0
  buffer_load_dwordx4 v53, s[8:11], s74 offen lds
  s_add_u32 m0, s72, 4096
  s_nop 0
  buffer_load_dwordx4 v54, s[8:11], s74 offen lds
  s_mov_b32 s8, s54
  s_and_b32 s9, s55, 0xffff
  s_mov_b32 s10, 3072
  v_lshlrev_b32 v4, 3, v3
  buffer_load_dwordx2 v[26:27], v4, s[8:11], s75 offen
  s_waitcnt vmcnt(0)
  s_barrier
  v_lshlrev_b32 v206, 16, v26
  v_and_b32 v207, 0xffff0000, v26
  v_lshlrev_b32 v208, 16, v27
  v_and_b32 v209, 0xffff0000, v27
  s_cmp_eq_u32 s29, 2
  s_cbranch_scc0 L_w1c_fx
  ds_read_b64_tr_b16 a[0:1], v20 offset:0
  ds_read_b64_tr_b16 a[2:3], v20 offset:384
  ds_read_b64_tr_b16 a[4:5], v20 offset:3072
  ds_read_b64_tr_b16 a[6:7], v20 offset:3456
  ds_read_b64_tr_b16 a[8:9], v20 offset:6144
  ds_read_b64_tr_b16 a[10:11], v20 offset:6528
  ds_read_b64_tr_b16 a[12:13], v20 offset:9216
  ds_read_b64_tr_b16 a[14:15], v20 offset:9600
  s_waitcnt lgkmcnt(0)
  ds_read_b64_tr_b16 a[16:17], v20 offset:12288
  ds_read_b64_tr_b16 a[18:19], v20 offset:12672
  ds_read_b64_tr_b16 a[20:21], v20 offset:15360
  ds_read_b64_tr_b16 a[22:23], v20 offset:15744
  ds_read_b64_tr_b16 a[24:25], v20 offset:18432
  ds_read_b64_tr_b16 a[26:27], v20 offset:18816
  ds_read_b64_tr_b16 a[28:29], v20 offset:21504
  ds_read_b64_tr_b16 a[30:31], v20 offset:21888
  s_waitcnt lgkmcnt(0)
  ds_read_b64_tr_b16 a[32:33], v20 offset:24576
  ds_read_b64_tr_b16 a[34:35], v20 offset:24960
  ds_read_b64_tr_b16 a[36:37], v20 offset:27648
  ds_read_b64_tr_b16 a[38:39], v20 offset:28032
  ds_read_b64_tr_b16 a[40:41], v20 offset:30720
  ds_read_b64_tr_b16 a[42:43], v20 offset:31104
  ds_read_b64_tr_b16 a[44:45], v20 offset:33792
  ds_read_b64_tr_b16 a[46:47], v20 offset:34176
  s_waitcnt lgkmcnt(0)
  ds_read_b64_tr_b16 a[48:49], v20 offset:36864
  ds_read_b64_tr_b16 a[50:51], v20 offset:37248
  ds_read_b64_tr_b16 a[52:53], v20 offset:39936
  ds_read_b64_tr_b16 a[54:55], v20 offset:40320
  ds_read_b64_tr_b16 a[56:57], v20 offset:43008
  ds_read_b64_tr_b16 a[58:59], v20 offset:43392
  ds_read_b64_tr_b16 a[60:61], v20 offset:46080
  ds_read_b64_tr_b16 a[62:63], v20 offset:46464
  s_waitcnt lgkmcnt(0)
  ds_read_b64_tr_b16 a[64:65], v20 offset:49152
  ds_read_b64_tr_b16 a[66:67], v20 offset:49536
  ds_read_b64_tr_b16 a[68:69], v20 offset:52224
  ds_read_b64_tr_b16 a[70:71], v20 offset:52608
  ds_read_b64_tr_b16 a[72:73], v20 offset:55296
  ds_read_b64_tr_b16 a[74:75], v20 offset:55680
  ds_read_b64_tr_b16 a[76:77], v20 offset:58368
  ds_read_b64_tr_b16 a[78:79], v20 offset:58752
  s_waitcnt lgkmcnt(0)
  ds_read_b64_tr_b16 a[80:81], v20 offset:32
  ds_read_b64_tr_b16 a[82:83], v20 offset:416
  ds_read_b64_tr_b16 a[84:85], v20 offset:3104
  ds_read_b64_tr_b16 a[86:87], v20 offset:3488
  ds_read_b64_tr_b16 a[88:89], v20 offset:6176
  ds_read_b64_tr_b16 a[90:91], v20 offset:6560
  ds_read_b64_tr_b16 a[92:93], v20 offset:9248
  ds_read_b64_tr_b16 a[94:95], v20 offset:9632
  s_waitcnt lgkmcnt(0)
  ds_read_b64_tr_b16 a[96:97], v20 offset:12320
  ds_read_b64_tr_b16 a[98:99], v20 offset:12704
  ds_read_b64_tr_b16 a[100:101], v20 offset:15392
  ds_read_b64_tr_b16 a[102:103], v20 offset:15776
  ds_read_b64_tr_b16 a[104:105], v20 offset:18464
  ds_read_b64_tr_b16 a[106:107], v20 offset:18848
  ds_read_b64_tr_b16 a[108:109], v20 offset:21536
  ds_read_b64_tr_b16 a[110:111], v20 offset:21920
  s_waitcnt lgkmcnt(0)
  ds_read_b64_tr_b16 a[112:113], v20 offset:24608
  ds_read_b64_tr_b16 a[114:115], v20 offset:24992
  ds_read_b64_tr_b16 a[116:117], v20 offset:27680
  ds_read_b64_tr_b16 a[118:119], v20 offset:28064
  ds_read_b64_tr_b16 a[120:121], v20 offset:30752
  ds_read_b64_tr_b16 a[122:123], v20 offset:31136
  ds_read_b64_tr_b16 a[124:125], v20 offset:33824
  ds_read_b64_tr_b16 a[126:127], v20 offset:34208
  s_waitcnt lgkmcnt(0)
  ds_read_b64_tr_b16 a[128:129], v20 offset:36896
  ds_read_b64_tr_b16 a[130:131], v20 offset:37280
  ds_read_b64_tr_b16 a[132:133], v20 offset:39968
  ds_read_b64_tr_b16 a[134:135], v20 offset:40352
  ds_read_b64_tr_b16 a[136:137], v20 offset:43040
  ds_read_b64_tr_b16 a[138:139], v20 offset:43424
  ds_read_b64_tr_b16 a[140:141], v20 offset:46112
  ds_read_b64_tr_b16 a[142:143], v20 offset:46496
  s_waitcnt lgkmcnt(0)
  ds_read_b64_tr_b16 a[144:145], v20 offset:49184
  ds_read_b64_tr_b16 a[146:147], v20 offset:49568
  ds_read_b64_tr_b16 a[148:149], v20 offset:52256
  ds_read_b64_tr_b16 a[150:151], v20 offset:52640
  ds_read_b64_tr_b16 a[152:153], v20 offset:55328
  ds_read_b64_tr_b16 a[154:155], v20 offset:55712
  ds_read_b64_tr_b16 a[156:157], v20 offset:58400
  ds_read_b64_tr_b16 a[158:159], v20 offset:58784
  s_waitcnt lgkmcnt(0)
  ds_read_b64_tr_b16 a[160:161], v20 offset:64
  ds_read_b64_tr_b16 a[162:163], v20 offset:448
  ds_read_b64_tr_b16 a[164:165], v20 offset:3136
  ds_read_b64_tr_b16 a[166:167], v20 offset:3520
  ds_read_b64_tr_b16 a[168:169], v20 offset:6208
  ds_read_b64_tr_b16 a[170:171], v20 offset:6592
  ds_read_b64_tr_b16 a[172:173], v20 offset:9280
  ds_read_b64_tr_b16 a[174:175], v20 offset:9664
  s_waitcnt lgkmcnt(0)
  ds_read_b64_tr_b16 a[176:177], v20 offset:12352
  ds_read_b64_tr_b16 a[178:179], v20 offset:12736
  ds_read_b64_tr_b16 a[180:181], v20 offset:15424
  ds_read_b64_tr_b16 a[182:183], v20 offset:15808
  ds_read_b64_tr_b16 a[184:185], v20 offset:18496
  ds_read_b64_tr_b16 a[186:187], v20 offset:18880
  ds_read_b64_tr_b16 a[188:189], v20 offset:21568
  ds_read_b64_tr_b16 a[190:191], v20 offset:21952
  s_waitcnt lgkmcnt(0)
  ds_read_b64_tr_b16 a[192:193], v20 offset:24640
  ds_read_b64_tr_b16 a[194:195], v20 offset:25024
  ds_read_b64_tr_b16 a[196:197], v20 offset:27712
  ds_read_b64_tr_b16 a[198:199], v20 offset:28096
  ds_read_b64_tr_b16 a[200:201], v20 offset:30784
  ds_read_b64_tr_b16 a[202:203], v20 offset:31168
  ds_read_b64_tr_b16 a[204:205], v20 offset:33856
  ds_read_b64_tr_b16 a[206:207], v20 offset:34240
  s_waitcnt lgkmcnt(0)
  ds_read_b64_tr_b16 a[208:209], v20 offset:36928
  ds_read_b64_tr_b16 a[210:211], v20 offset:37312
  ds_read_b64_tr_b16 a[212:213], v20 offset:40000
  ds_read_b64_tr_b16 a[214:215], v20 offset:40384
  ds_read_b64_tr_b16 a[216:217], v20 offset:43072
  ds_read_b64_tr_b16 a[218:219], v20 offset:43456
  ds_read_b64_tr_b16 a[220:221], v20 offset:46144
  ds_read_b64_tr_b16 a[222:223], v20 offset:46528
  s_waitcnt lgkmcnt(0)
  ds_read_b64_tr_b16 a[224:225], v20 offset:49216
  ds_read_b64_tr_b16 a[226:227], v20 offset:49600
  ds_read_b64_tr_b16 a[228:229], v20 offset:52288
  ds_read_b64_tr_b16 a[230:231], v20 offset:52672
  ds_read_b64_tr_b16 a[232:233], v20 offset:55360
  ds_read_b64_tr_b16 a[234:235], v20 offset:55744
  ds_read_b64_tr_b16 a[236:237], v20 offset:58432
  ds_read_b64_tr_b16 a[238:239], v20 offset:58816
  s_waitcnt lgkmcnt(0)
L_w1c_fx:
  s_cmp_eq_u32 s29, 3
  s_cbranch_scc0 L_w1d_fx
  ds_read_b64_tr_b16 a[0:1], v22 offset:0
  ds_read_b64_tr_b16 a[2:3], v22 offset:128
  ds_read_b64_tr_b16 a[4:5], v22 offset:1024
  ds_read_b64_tr_b16 a[6:7], v22 offset:1152
  ds_read_b64_tr_b16 a[8:9], v22 offset:2048
  ds_read_b64_tr_b16 a[10:11], v22 offset:2176
  ds_read_b64_tr_b16 a[12:13], v22 offset:3072
  ds_read_b64_tr_b16 a[14:15], v22 offset:3200
  s_waitcnt lgkmcnt(0)
  ds_read_b64_tr_b16 a[16:17], v22 offset:4096
  ds_read_b64_tr_b16 a[18:19], v22 offset:4224
  ds_read_b64_tr_b16 a[20:21], v22 offset:5120
  ds_read_b64_tr_b16 a[22:23], v22 offset:5248
  ds_read_b64_tr_b16 a[24:25], v22 offset:6144
  ds_read_b64_tr_b16 a[26:27], v22 offset:6272
  ds_read_b64_tr_b16 a[28:29], v22 offset:7168
  ds_read_b64_tr_b16 a[30:31], v22 offset:7296
  s_waitcnt lgkmcnt(0)
  ds_read_b64_tr_b16 a[32:33], v22 offset:8192
  ds_read_b64_tr_b16 a[34:35], v22 offset:8320
  ds_read_b64_tr_b16 a[36:37], v22 offset:9216
  ds_read_b64_tr_b16 a[38:39], v22 offset:9344
  ds_read_b64_tr_b16 a[40:41], v22 offset:10240
  ds_read_b64_tr_b16 a[42:43], v22 offset:10368
  ds_read_b64_tr_b16 a[44:45], v22 offset:11264
  ds_read_b64_tr_b16 a[46:47], v22 offset:11392
  s_waitcnt lgkmcnt(0)
  ds_read_b64_tr_b16 a[48:49], v22 offset:12288
  ds_read_b64_tr_b16 a[50:51], v22 offset:12416
  ds_read_b64_tr_b16 a[52:53], v22 offset:13312
  ds_read_b64_tr_b16 a[54:55], v22 offset:13440
  ds_read_b64_tr_b16 a[56:57], v22 offset:14336
  ds_read_b64_tr_b16 a[58:59], v22 offset:14464
  ds_read_b64_tr_b16 a[60:61], v22 offset:15360
  ds_read_b64_tr_b16 a[62:63], v22 offset:15488
  s_waitcnt lgkmcnt(0)
  ds_read_b64_tr_b16 a[64:65], v22 offset:16384
  ds_read_b64_tr_b16 a[66:67], v22 offset:16512
  ds_read_b64_tr_b16 a[68:69], v22 offset:17408
  ds_read_b64_tr_b16 a[70:71], v22 offset:17536
  ds_read_b64_tr_b16 a[72:73], v22 offset:18432
  ds_read_b64_tr_b16 a[74:75], v22 offset:18560
  ds_read_b64_tr_b16 a[76:77], v22 offset:19456
  ds_read_b64_tr_b16 a[78:79], v22 offset:19584
  s_waitcnt lgkmcnt(0)
L_w1d_fx:
  s_waitcnt lgkmcnt(0)
  s_barrier
  v_lshlrev_b32 v211, 4, v1
  v_add_u32 v219, 40960, v211
  s_mul_i32 s72, s29, 10240
  v_add_u32 v212, s72, v211
  s_mul_i32 s72, s27, 48
  s_add_u32 s72, s72, 0
  v_lshl_add_u32 v4, v3, 2, s72
  v_lshrrev_b32 v5, 5, v4
  v_lshlrev_b32 v5, 10, v5
  v_bfe_u32 v6, v4, 3, 2
  v_lshl_add_u32 v6, v6, 4, v2
  v_lshl_add_u32 v5, v6, 4, v5
  v_bfe_u32 v6, v4, 2, 1
  v_lshl_add_u32 v213, v6, 3, v5
  v_add_u32 v214, 6144, v213
  s_mul_i32 s72, s27, 48
  s_add_u32 s72, s72, 16
  v_lshl_add_u32 v4, v3, 2, s72
  v_lshrrev_b32 v5, 5, v4
  v_lshlrev_b32 v5, 10, v5
  v_bfe_u32 v6, v4, 3, 2
  v_lshl_add_u32 v6, v6, 4, v2
  v_lshl_add_u32 v5, v6, 4, v5
  v_bfe_u32 v6, v4, 2, 1
  v_lshl_add_u32 v215, v6, 3, v5
  v_add_u32 v216, 6144, v215
  s_mul_i32 s72, s27, 48
  s_add_u32 s72, s72, 32
  v_lshl_add_u32 v4, v3, 2, s72
  v_lshrrev_b32 v5, 5, v4
  v_lshlrev_b32 v5, 10, v5
  v_bfe_u32 v6, v4, 3, 2
  v_lshl_add_u32 v6, v6, 4, v2
  v_lshl_add_u32 v5, v6, 4, v5
  v_bfe_u32 v6, v4, 2, 1
  v_lshl_add_u32 v217, v6, 3, v5
  v_add_u32 v218, 6144, v217
  s_lshl_b32 s33, s28, 12
  s_lshl_b32 s72, s27, 4
  s_lshl_b32 s73, s29, 2
  s_add_u32 s33, s33, s72
  s_add_u32 s33, s33, s73
  s_add_u32 s33, s33, 108068864
  s_mov_b32 s12, s50
  s_and_b32 s13, s51, 0xffff
  s_mov_b32 s14, 256
  s_mov_b32 s15, 0x00020000
  v_and_b32 v4, 15, v1
  v_lshlrev_b32 v4, 2, v4
L_hk_fx:
  buffer_load_dword v5, v4, s[12:15], 0 offen sc1
  s_waitcnt vmcnt(0)
  v_readlane_b32 s72, v5, 0
  v_readlane_b32 s73, v5, 1
  v_readlane_b32 s74, v5, 2
  v_readlane_b32 s75, v5, 3
  v_readlane_b32 s76, v5, 4
  v_readlane_b32 s77, v5, 5
  v_readlane_b32 s78, v5, 6
  v_readlane_b32 s79, v5, 7
  v_readlane_b32 s84, v5, 8
  s_nop 3
  s_add_u32 s80, s72, s73
  s_add_u32 s81, s74, s75
  s_add_u32 s82, s76, s77
  s_add_u32 s83, s78, s79
  s_add_u32 s80, s80, s81
  s_add_u32 s82, s82, s83
  s_add_u32 s80, s80, s82
  s_add_u32 s80, s80, s84
  s_cmp_eq_u32 s80, 512
  s_cbranch_scc1 L_hk2_fx
  s_add_u32 s71, s71, 1
  s_cmp_gt_u32 s71, 400000
  s_cbranch_scc1 L_mend
  s_sleep 2
  s_branch L_hk_fx
L_hk2_fx:
  s_mov_b64 exec, 0xff
  v_cmp_ne_u32 vcc, 32, v5
  s_mov_b64 exec, -1
  s_cbranch_vccnz L_slow
  s_mul_i32 s31, s29, 10240
  s_add_u32 s31, s31, 0
  buffer_load_dwordx4 v[40:43], v200, s[4:7], s31 offen offset:0
  buffer_load_dwordx4 v[44:47], v200, s[4:7], s31 offen offset:1024
  buffer_load_dwordx4 v[48:51], v200, s[4:7], s31 offen offset:2048
  buffer_load_dwordx4 v[52:55], v200, s[4:7], s31 offen offset:3072
  s_add_u32 s31, s31, 4096
  buffer_load_dwordx4 v[56:59], v200, s[4:7], s31 offen offset:0
  buffer_load_dwordx4 v[60:63], v200, s[4:7], s31 offen offset:1024
  buffer_load_dwordx4 v[64:67], v200, s[4:7], s31 offen offset:2048
  buffer_load_dwordx4 v[68:71], v200, s[4:7], s31 offen offset:3072
  s_add_u32 s31, s31, 4096
  buffer_load_dwordx4 v[72:75], v200, s[4:7], s31 offen offset:0
  buffer_load_dwordx4 v[76:79], v200, s[4:7], s31 offen offset:1024
  s_add_u32 s31, s31, 32768
  s_waitcnt vmcnt(0)
  ds_write_b128 v212, v[40:43] offset:0
  ds_write_b128 v212, v[44:47] offset:1024
  ds_write_b128 v212, v[48:51] offset:2048
  ds_write_b128 v212, v[52:55] offset:3072
  ds_write_b128 v212, v[56:59] offset:4096
  ds_write_b128 v212, v[60:63] offset:5120
  ds_write_b128 v212, v[64:67] offset:6144
  ds_write_b128 v212, v[68:71] offset:7168
  ds_write_b128 v212, v[72:75] offset:8192
  ds_write_b128 v212, v[76:79] offset:9216
  s_waitcnt lgkmcnt(0)
  buffer_load_dwordx4 v[40:43], v200, s[4:7], s31 offen offset:0
  buffer_load_dwordx4 v[44:47], v200, s[4:7], s31 offen offset:1024
  buffer_load_dwordx4 v[48:51], v200, s[4:7], s31 offen offset:2048
  buffer_load_dwordx4 v[52:55], v200, s[4:7], s31 offen offset:3072
  s_add_u32 s31, s31, 4096
  buffer_load_dwordx4 v[56:59], v200, s[4:7], s31 offen offset:0
  buffer_load_dwordx4 v[60:63], v200, s[4:7], s31 offen offset:1024
  buffer_load_dwordx4 v[64:67], v200, s[4:7], s31 offen offset:2048
  buffer_load_dwordx4 v[68:71], v200, s[4:7], s31 offen offset:3072
  s_add_u32 s31, s31, 4096
  buffer_load_dwordx4 v[72:75], v200, s[4:7], s31 offen offset:0
  buffer_load_dwordx4 v[76:79], v200, s[4:7], s31 offen offset:1024
  s_add_u32 s31, s31, 32768
  s_waitcnt vmcnt(0)
  s_mov_b32 s30, 0
  s_cmp_eq_u32 s29, 1
  s_cbranch_scc1 L_x1V_fx
  s_cmp_eq_u32 s29, 3
  s_cbranch_scc1 L_x1F_fx
  s_cmp_eq_u32 s29, 2
  s_cbranch_scc1 L_x1Q_fx
  s_mul_i32 s32, s28, 1572864
  s_add_u32 s32, s32, 27787264
L_xlK_fx:
  s_waitcnt lgkmcnt(0)
  s_barrier
  ds_read_b128 v[8:11], v211 offset:0
  ds_read_b128 v[12:15], v211 offset:20480
  ds_read_b128 v[16:19], v211 offset:1024
  ds_read_b128 v[20:23], v211 offset:21504
  ds_read_b128 v[24:27], v211 offset:2048
  ds_read_b128 v[28:31], v211 offset:22528
  s_waitcnt lgkmcnt(5)
  v_mfma_f32_16x16x32_bf16 v[80:83], a[0:3], v[8:11], 0
  v_mfma_f32_16x16x32_bf16 v[88:91], a[80:83], v[8:11], 0
  v_mfma_f32_16x16x32_bf16 v[96:99], a[160:163], v[8:11], 0
  ds_read_b128 v[32:35], v211 offset:3072
  s_waitcnt lgkmcnt(5)
  v_mfma_f32_16x16x32_bf16 v[84:87], a[0:3], v[12:15], 0
  v_mfma_f32_16x16x32_bf16 v[92:95], a[80:83], v[12:15], 0
  v_mfma_f32_16x16x32_bf16 v[100:103], a[160:163], v[12:15], 0
  ds_read_b128 v[36:39], v211 offset:23552
  s_waitcnt lgkmcnt(5)
  v_mfma_f32_16x16x32_bf16 v[80:83], a[4:7], v[16:19], v[80:83]
  v_mfma_f32_16x16x32_bf16 v[88:91], a[84:87], v[16:19], v[88:91]
  v_mfma_f32_16x16x32_bf16 v[96:99], a[164:167], v[16:19], v[96:99]
  ds_read_b128 v[8:11], v211 offset:4096
  s_waitcnt vmcnt(7)
  ds_write_b128 v212, v[40:43] offset:40960
  s_waitcnt lgkmcnt(6)
  v_mfma_f32_16x16x32_bf16 v[84:87], a[4:7], v[20:23], v[84:87]
  v_mfma_f32_16x16x32_bf16 v[92:95], a[84:87], v[20:23], v[92:95]
  v_mfma_f32_16x16x32_bf16 v[100:103], a[164:167], v[20:23], v[100:103]
  ds_read_b128 v[12:15], v211 offset:24576
  ds_write_b128 v212, v[44:47] offset:41984
  s_waitcnt lgkmcnt(7)
  v_mfma_f32_16x16x32_bf16 v[80:83], a[8:11], v[24:27], v[80:83]
  v_mfma_f32_16x16x32_bf16 v[88:91], a[88:91], v[24:27], v[88:91]
  v_mfma_f32_16x16x32_bf16 v[96:99], a[168:171], v[24:27], v[96:99]
  ds_read_b128 v[16:19], v211 offset:5120
  ds_write_b128 v212, v[48:51] offset:43008
  s_waitcnt lgkmcnt(8)
  v_mfma_f32_16x16x32_bf16 v[84:87], a[8:11], v[28:31], v[84:87]
  v_mfma_f32_16x16x32_bf16 v[92:95], a[88:91], v[28:31], v[92:95]
  v_mfma_f32_16x16x32_bf16 v[100:103], a[168:171], v[28:31], v[100:103]
  ds_read_b128 v[20:23], v211 offset:25600
  ds_write_b128 v212, v[52:55] offset:44032
  s_waitcnt lgkmcnt(9)
  v_mfma_f32_16x16x32_bf16 v[80:83], a[12:15], v[32:35], v[80:83]
  v_mfma_f32_16x16x32_bf16 v[88:91], a[92:95], v[32:35], v[88:91]
  v_mfma_f32_16x16x32_bf16 v[96:99], a[172:175], v[32:35], v[96:99]
  ds_read_b128 v[24:27], v211 offset:6144
  ds_write_b128 v212, v[56:59] offset:45056
  s_waitcnt lgkmcnt(10)
  v_mfma_f32_16x16x32_bf16 v[84:87], a[12:15], v[36:39], v[84:87]
  v_mfma_f32_16x16x32_bf16 v[92:95], a[92:95], v[36:39], v[92:95]
  v_mfma_f32_16x16x32_bf16 v[100:103], a[172:175], v[36:39], v[100:103]
  ds_read_b128 v[28:31], v211 offset:26624
  ds_write_b128 v212, v[60:63] offset:46080
  s_waitcnt lgkmcnt(11)
  v_mfma_f32_16x16x32_bf16 v[80:83], a[16:19], v[8:11], v[80:83]
  v_mfma_f32_16x16x32_bf16 v[88:91], a[96:99], v[8:11], v[88:91]
  v_mfma_f32_16x16x32_bf16 v[96:99], a[176:179], v[8:11], v[96:99]
  ds_read_b128 v[32:35], v211 offset:7168
  ds_write_b128 v212, v[64:67] offset:47104
  s_waitcnt lgkmcnt(11)
  v_mfma_f32_16x16x32_bf16 v[84:87], a[16:19], v[12:15], v[84:87]
  v_mfma_f32_16x16x32_bf16 v[92:95], a[96:99], v[12:15], v[92:95]
  v_mfma_f32_16x16x32_bf16 v[100:103], a[176:179], v[12:15], v[100:103]
  ds_read_b128 v[36:39], v211 offset:27648
  ds_write_b128 v212, v[68:71] offset:48128
  s_waitcnt lgkmcnt(11)
  v_mfma_f32_16x16x32_bf16 v[80:83], a[20:23], v[16:19], v[80:83]
  v_mfma_f32_16x16x32_bf16 v[88:91], a[100:103], v[16:19], v[88:91]
  v_mfma_f32_16x16x32_bf16 v[96:99], a[180:183], v[16:19], v[96:99]
  ds_read_b128 v[8:11], v211 offset:8192
  ds_write_b128 v212, v[72:75] offset:49152
  s_waitcnt lgkmcnt(11)
  v_mfma_f32_16x16x32_bf16 v[84:87], a[20:23], v[20:23], v[84:87]
  v_mfma_f32_16x16x32_bf16 v[92:95], a[100:103], v[20:23], v[92:95]
  v_mfma_f32_16x16x32_bf16 v[100:103], a[180:183], v[20:23], v[100:103]
  ds_read_b128 v[12:15], v211 offset:28672
  ds_write_b128 v212, v[76:79] offset:50176
  s_waitcnt lgkmcnt(11)
  v_mfma_f32_16x16x32_bf16 v[80:83], a[24:27], v[24:27], v[80:83]
  v_mfma_f32_16x16x32_bf16 v[88:91], a[104:107], v[24:27], v[88:91]
  v_mfma_f32_16x16x32_bf16 v[96:99], a[184:187], v[24:27], v[96:99]
  ds_read_b128 v[16:19], v211 offset:9216
  s_waitcnt lgkmcnt(1)
  buffer_load_dwordx4 v[40:43], v200, s[4:7], s31 offen offset:0
  v_mfma_f32_16x16x32_bf16 v[84:87], a[24:27], v[28:31], v[84:87]
  v_mfma_f32_16x16x32_bf16 v[92:95], a[104:107], v[28:31], v[92:95]
  v_mfma_f32_16x16x32_bf16 v[100:103], a[184:187], v[28:31], v[100:103]
  ds_read_b128 v[20:23], v211 offset:29696
  buffer_load_dwordx4 v[44:47], v200, s[4:7], s31 offen offset:1024
  v_mfma_f32_16x16x32_bf16 v[80:83], a[28:31], v[32:35], v[80:83]
  v_mfma_f32_16x16x32_bf16 v[88:91], a[108:111], v[32:35], v[88:91]
  v_mfma_f32_16x16x32_bf16 v[96:99], a[188:191], v[32:35], v[96:99]
  ds_read_b128 v[24:27], v211 offset:10240
  buffer_load_dwordx4 v[48:51], v200, s[4:7], s31 offen offset:2048
  v_mfma_f32_16x16x32_bf16 v[84:87], a[28:31], v[36:39], v[84:87]
  v_mfma_f32_16x16x32_bf16 v[92:95], a[108:111], v[36:39], v[92:95]
  v_mfma_f32_16x16x32_bf16 v[100:103], a[188:191], v[36:39], v[100:103]
  ds_read_b128 v[28:31], v211 offset:30720
  buffer_load_dwordx4 v[52:55], v200, s[4:7], s31 offen offset:3072
  v_mfma_f32_16x16x32_bf16 v[80:83], a[32:35], v[8:11], v[80:83]
  v_mfma_f32_16x16x32_bf16 v[88:91], a[112:115], v[8:11], v[88:91]
  v_mfma_f32_16x16x32_bf16 v[96:99], a[192:195], v[8:11], v[96:99]
  ds_read_b128 v[32:35], v211 offset:11264
  s_add_u32 s31, s31, 4096
  buffer_load_dwordx4 v[56:59], v200, s[4:7], s31 offen offset:0
  v_mfma_f32_16x16x32_bf16 v[84:87], a[32:35], v[12:15], v[84:87]
  v_mfma_f32_16x16x32_bf16 v[92:95], a[112:115], v[12:15], v[92:95]
  v_mfma_f32_16x16x32_bf16 v[100:103], a[192:195], v[12:15], v[100:103]
  ds_read_b128 v[36:39], v211 offset:31744
  buffer_load_dwordx4 v[60:63], v200, s[4:7], s31 offen offset:1024
  s_waitcnt lgkmcnt(5)
  v_mfma_f32_16x16x32_bf16 v[80:83], a[36:39], v[16:19], v[80:83]
  v_mfma_f32_16x16x32_bf16 v[88:91], a[116:119], v[16:19], v[88:91]
  v_mfma_f32_16x16x32_bf16 v[96:99], a[196:199], v[16:19], v[96:99]
  ds_read_b128 v[8:11], v211 offset:12288
  buffer_load_dwordx4 v[64:67], v200, s[4:7], s31 offen offset:2048
  s_waitcnt lgkmcnt(5)
  v_mfma_f32_16x16x32_bf16 v[84:87], a[36:39], v[20:23], v[84:87]
  v_mfma_f32_16x16x32_bf16 v[92:95], a[116:119], v[20:23], v[92:95]
  v_mfma_f32_16x16x32_bf16 v[100:103], a[196:199], v[20:23], v[100:103]
  ds_read_b128 v[12:15], v211 offset:32768
  buffer_load_dwordx4 v[68:71], v200, s[4:7], s31 offen offset:3072
  s_waitcnt lgkmcnt(5)
  v_mfma_f32_16x16x32_bf16 v[80:83], a[40:43], v[24:27], v[80:83]
  v_mfma_f32_16x16x32_bf16 v[88:91], a[120:123], v[24:27], v[88:91]
  v_mfma_f32_16x16x32_bf16 v[96:99], a[200:203], v[24:27], v[96:99]
  ds_read_b128 v[16:19], v211 offset:13312
  s_add_u32 s31, s31, 4096
  buffer_load_dwordx4 v[72:75], v200, s[4:7], s31 offen offset:0
  s_waitcnt lgkmcnt(5)
  v_mfma_f32_16x16x32_bf16 v[84:87], a[40:43], v[28:31], v[84:87]
  v_mfma_f32_16x16x32_bf16 v[92:95], a[120:123], v[28:31], v[92:95]
  v_mfma_f32_16x16x32_bf16 v[100:103], a[200:203], v[28:31], v[100:103]
  ds_read_b128 v[20:23], v211 offset:33792
  buffer_load_dwordx4 v[76:79], v200, s[4:7], s31 offen offset:1024
  s_add_u32 s31, s31, 32768
  s_waitcnt lgkmcnt(5)
  v_mfma_f32_16x16x32_bf16 v[80:83], a[44:47], v[32:35], v[80:83]
  v_mfma_f32_16x16x32_bf16 v[88:91], a[124:127], v[32:35], v[88:91]
  v_mfma_f32_16x16x32_bf16 v[96:99], a[204:207], v[32:35], v[96:99]
  ds_read_b128 v[24:27], v211 offset:14336
  s_waitcnt lgkmcnt(5)
  v_mfma_f32_16x16x32_bf16 v[84:87], a[44:47], v[36:39], v[84:87]
  v_mfma_f32_16x16x32_bf16 v[92:95], a[124:127], v[36:39], v[92:95]
  v_mfma_f32_16x16x32_bf16 v[100:103], a[204:207], v[36:39], v[100:103]
  ds_read_b128 v[28:31], v211 offset:34816
  s_waitcnt lgkmcnt(5)
  v_mfma_f32_16x16x32_bf16 v[80:83], a[48:51], v[8:11], v[80:83]
  v_mfma_f32_16x16x32_bf16 v[88:91], a[128:131], v[8:11], v[88:91]
  v_mfma_f32_16x16x32_bf16 v[96:99], a[208:211], v[8:11], v[96:99]
  ds_read_b128 v[32:35], v211 offset:15360
  s_waitcnt lgkmcnt(5)
  v_mfma_f32_16x16x32_bf16 v[84:87], a[48:51], v[12:15], v[84:87]
  v_mfma_f32_16x16x32_bf16 v[92:95], a[128:131], v[12:15], v[92:95]
  v_mfma_f32_16x16x32_bf16 v[100:103], a[208:211], v[12:15], v[100:103]
  ds_read_b128 v[36:39], v211 offset:35840
  s_waitcnt lgkmcnt(5)
  v_mfma_f32_16x16x32_bf16 v[80:83], a[52:55], v[16:19], v[80:83]
  v_mfma_f32_16x16x32_bf16 v[88:91], a[132:135], v[16:19], v[88:91]
  v_mfma_f32_16x16x32_bf16 v[96:99], a[212:215], v[16:19], v[96:99]
  ds_read_b128 v[8:11], v211 offset:16384
  s_waitcnt lgkmcnt(5)
  v_mfma_f32_16x16x32_bf16 v[84:87], a[52:55], v[20:23], v[84:87]
  v_mfma_f32_16x16x32_bf16 v[92:95], a[132:135], v[20:23], v[92:95]
  v_mfma_f32_16x16x32_bf16 v[100:103], a[212:215], v[20:23], v[100:103]
  ds_read_b128 v[12:15], v211 offset:36864
  s_waitcnt lgkmcnt(5)
  v_mfma_f32_16x16x32_bf16 v[80:83], a[56:59], v[24:27], v[80:83]
  v_mfma_f32_16x16x32_bf16 v[88:91], a[136:139], v[24:27], v[88:91]
  v_mfma_f32_16x16x32_bf16 v[96:99], a[216:219], v[24:27], v[96:99]
  ds_read_b128 v[16:19], v211 offset:17408
  s_waitcnt lgkmcnt(5)
  v_mfma_f32_16x16x32_bf16 v[84:87], a[56:59], v[28:31], v[84:87]
  v_mfma_f32_16x16x32_bf16 v[92:95], a[136:139], v[28:31], v[92:95]
  v_mfma_f32_16x16x32_bf16 v[100:103], a[216:219], v[28:31], v[100:103]
  ds_read_b128 v[20:23], v211 offset:37888
  s_waitcnt lgkmcnt(5)
  v_mfma_f32_16x16x32_bf16 v[80:83], a[60:63], v[32:35], v[80:83]
  v_mfma_f32_16x16x32_bf16 v[88:91], a[140:143], v[32:35], v[88:91]
  v_mfma_f32_16x16x32_bf16 v[96:99], a[220:223], v[32:35], v[96:99]
  ds_read_b128 v[24:27], v211 offset:18432
  s_waitcnt lgkmcnt(5)
  v_mfma_f32_16x16x32_bf16 v[84:87], a[60:63], v[36:39], v[84:87]
  v_mfma_f32_16x16x32_bf16 v[92:95], a[140:143], v[36:39], v[92:95]
  v_mfma_f32_16x16x32_bf16 v[100:103], a[220:223], v[36:39], v[100:103]
  ds_read_b128 v[28:31], v211 offset:38912
  s_waitcnt lgkmcnt(5)
  v_mfma_f32_16x16x32_bf16 v[80:83], a[64:67], v[8:11], v[80:83]
  v_mfma_f32_16x16x32_bf16 v[88:91], a[144:147], v[8:11], v[88:91]
  v_mfma_f32_16x16x32_bf16 v[96:99], a[224:227], v[8:11], v[96:99]
  ds_read_b128 v[32:35], v211 offset:19456
  s_waitcnt lgkmcnt(5)
  v_mfma_f32_16x16x32_bf16 v[84:87], a[64:67], v[12:15], v[84:87]
  v_mfma_f32_16x16x32_bf16 v[92:95], a[144:147], v[12:15], v[92:95]
  v_mfma_f32_16x16x32_bf16 v[100:103], a[224:227], v[12:15], v[100:103]
  ds_read_b128 v[36:39], v211 offset:39936
  s_waitcnt lgkmcnt(5)
  v_mfma_f32_16x16x32_bf16 v[80:83], a[68:71], v[16:19], v[80:83]
  v_mfma_f32_16x16x32_bf16 v[88:91], a[148:151], v[16:19], v[88:91]
  v_mfma_f32_16x16x32_bf16 v[96:99], a[228:231], v[16:19], v[96:99]
  s_waitcnt lgkmcnt(4)
  v_mfma_f32_16x16x32_bf16 v[84:87], a[68:71], v[20:23], v[84:87]
  v_mfma_f32_16x16x32_bf16 v[92:95], a[148:151], v[20:23], v[92:95]
  v_mfma_f32_16x16x32_bf16 v[100:103], a[228:231], v[20:23], v[100:103]
  s_waitcnt lgkmcnt(3)
  v_mfma_f32_16x16x32_bf16 v[80:83], a[72:75], v[24:27], v[80:83]
  v_mfma_f32_16x16x32_bf16 v[88:91], a[152:155], v[24:27], v[88:91]
  v_mfma_f32_16x16x32_bf16 v[96:99], a[232:235], v[24:27], v[96:99]
  s_waitcnt lgkmcnt(2)
  v_mfma_f32_16x16x32_bf16 v[84:87], a[72:75], v[28:31], v[84:87]
  v_mfma_f32_16x16x32_bf16 v[92:95], a[152:155], v[28:31], v[92:95]
  v_mfma_f32_16x16x32_bf16 v[100:103], a[232:235], v[28:31], v[100:103]
  s_waitcnt lgkmcnt(1)
  v_mfma_f32_16x16x32_bf16 v[80:83], a[76:79], v[32:35], v[80:83]
  v_mfma_f32_16x16x32_bf16 v[88:91], a[156:159], v[32:35], v[88:91]
  v_mfma_f32_16x16x32_bf16 v[96:99], a[236:239], v[32:35], v[96:99]
  s_waitcnt lgkmcnt(0)
  v_mfma_f32_16x16x32_bf16 v[84:87], a[76:79], v[36:39], v[84:87]
  v_mfma_f32_16x16x32_bf16 v[92:95], a[156:159], v[36:39], v[92:95]
  v_mfma_f32_16x16x32_bf16 v[100:103], a[236:239], v[36:39], v[100:103]
  s_cmp_lt_u32 s30, 2
  s_cbranch_scc1 L_x1nfK0_fx
  buffer_store_dword v205, v204, s[4:7], s33 offen
  s_add_u32 s33, s33, 64
  s_branch L_x1eK0_fx
L_x1nfK0_fx:
  buffer_store_dword v205, v210, s[4:7], s33 offen
L_x1eK0_fx:
  s_nop 4
  v_cvt_pk_bf16_f32 v128, v80, v81
  v_cvt_pk_bf16_f32 v129, v82, v83
  v_cvt_pk_bf16_f32 v130, v84, v85
  v_cvt_pk_bf16_f32 v131, v86, v87
  v_cvt_pk_bf16_f32 v132, v88, v89
  v_cvt_pk_bf16_f32 v133, v90, v91
  v_cvt_pk_bf16_f32 v134, v92, v93
  v_cvt_pk_bf16_f32 v135, v94, v95
  v_cvt_pk_bf16_f32 v136, v96, v97
  v_cvt_pk_bf16_f32 v137, v98, v99
  v_cvt_pk_bf16_f32 v138, v100, v101
  v_cvt_pk_bf16_f32 v139, v102, v103
  buffer_store_dwordx2 v[128:129], v213, s[4:7], s32 offen
  buffer_store_dwordx2 v[130:131], v214, s[4:7], s32 offen
  buffer_store_dwordx2 v[132:133], v215, s[4:7], s32 offen
  buffer_store_dwordx2 v[134:135], v216, s[4:7], s32 offen
  buffer_store_dwordx2 v[136:137], v217, s[4:7], s32 offen
  buffer_store_dwordx2 v[138:139], v218, s[4:7], s32 offen
  s_add_u32 s32, s32, 24576
  s_cmp_ge_u32 s30, 2
  s_cbranch_scc1 L_x1efK0_fx
  s_waitcnt vmcnt(0)
  buffer_store_dword v205, v204, s[4:7], s33 offen offset:0
L_x1efK0_fx:
  s_add_u32 s30, s30, 1
  s_waitcnt lgkmcnt(0)
  s_barrier
  ds_read_b128 v[8:11], v211 offset:40960
  ds_read_b128 v[12:15], v211 offset:61440
  ds_read_b128 v[16:19], v211 offset:41984
  ds_read_b128 v[20:23], v211 offset:62464
  ds_read_b128 v[24:27], v211 offset:43008
  ds_read_b128 v[28:31], v211 offset:63488
  s_waitcnt lgkmcnt(5)
  v_mfma_f32_16x16x32_bf16 v[104:107], a[0:3], v[8:11], 0
  v_mfma_f32_16x16x32_bf16 v[112:115], a[80:83], v[8:11], 0
  v_mfma_f32_16x16x32_bf16 v[120:123], a[160:163], v[8:11], 0
  ds_read_b128 v[32:35], v211 offset:44032
  s_waitcnt lgkmcnt(5)
  v_mfma_f32_16x16x32_bf16 v[108:111], a[0:3], v[12:15], 0
  v_mfma_f32_16x16x32_bf16 v[116:119], a[80:83], v[12:15], 0
  v_mfma_f32_16x16x32_bf16 v[124:127], a[160:163], v[12:15], 0
  ds_read_b128 v[36:39], v211 offset:64512
  s_waitcnt lgkmcnt(5)
  v_mfma_f32_16x16x32_bf16 v[104:107], a[4:7], v[16:19], v[104:107]
  v_mfma_f32_16x16x32_bf16 v[112:115], a[84:87], v[16:19], v[112:115]
  v_mfma_f32_16x16x32_bf16 v[120:123], a[164:167], v[16:19], v[120:123]
  ds_read_b128 v[8:11], v211 offset:45056
  s_waitcnt vmcnt(7)
  ds_write_b128 v212, v[40:43] offset:0
  s_waitcnt lgkmcnt(6)
  v_mfma_f32_16x16x32_bf16 v[108:111], a[4:7], v[20:23], v[108:111]
  v_mfma_f32_16x16x32_bf16 v[116:119], a[84:87], v[20:23], v[116:119]
  v_mfma_f32_16x16x32_bf16 v[124:127], a[164:167], v[20:23], v[124:127]
  ds_read_b128 v[12:15], v219 offset:24576
  ds_write_b128 v212, v[44:47] offset:1024
  s_waitcnt lgkmcnt(7)
  v_mfma_f32_16x16x32_bf16 v[104:107], a[8:11], v[24:27], v[104:107]
  v_mfma_f32_16x16x32_bf16 v[112:115], a[88:91], v[24:27], v[112:115]
  v_mfma_f32_16x16x32_bf16 v[120:123], a[168:171], v[24:27], v[120:123]
  ds_read_b128 v[16:19], v211 offset:46080
  ds_write_b128 v212, v[48:51] offset:2048
  s_waitcnt lgkmcnt(8)
  v_mfma_f32_16x16x32_bf16 v[108:111], a[8:11], v[28:31], v[108:111]
  v_mfma_f32_16x16x32_bf16 v[116:119], a[88:91], v[28:31], v[116:119]
  v_mfma_f32_16x16x32_bf16 v[124:127], a[168:171], v[28:31], v[124:127]
  ds_read_b128 v[20:23], v219 offset:25600
  ds_write_b128 v212, v[52:55] offset:3072
  s_waitcnt lgkmcnt(9)
  v_mfma_f32_16x16x32_bf16 v[104:107], a[12:15], v[32:35], v[104:107]
  v_mfma_f32_16x16x32_bf16 v[112:115], a[92:95], v[32:35], v[112:115]
  v_mfma_f32_16x16x32_bf16 v[120:123], a[172:175], v[32:35], v[120:123]
  ds_read_b128 v[24:27], v211 offset:47104
  ds_write_b128 v212, v[56:59] offset:4096
  s_waitcnt lgkmcnt(10)
  v_mfma_f32_16x16x32_bf16 v[108:111], a[12:15], v[36:39], v[108:111]
  v_mfma_f32_16x16x32_bf16 v[116:119], a[92:95], v[36:39], v[116:119]
  v_mfma_f32_16x16x32_bf16 v[124:127], a[172:175], v[36:39], v[124:127]
  ds_read_b128 v[28:31], v219 offset:26624
  ds_write_b128 v212, v[60:63] offset:5120
  s_waitcnt lgkmcnt(11)
  v_mfma_f32_16x16x32_bf16 v[104:107], a[16:19], v[8:11], v[104:107]
  v_mfma_f32_16x16x32_bf16 v[112:115], a[96:99], v[8:11], v[112:115]
  v_mfma_f32_16x16x32_bf16 v[120:123], a[176:179], v[8:11], v[120:123]
  ds_read_b128 v[32:35], v211 offset:48128
  ds_write_b128 v212, v[64:67] offset:6144
  s_waitcnt lgkmcnt(11)
  v_mfma_f32_16x16x32_bf16 v[108:111], a[16:19], v[12:15], v[108:111]
  v_mfma_f32_16x16x32_bf16 v[116:119], a[96:99], v[12:15], v[116:119]
  v_mfma_f32_16x16x32_bf16 v[124:127], a[176:179], v[12:15], v[124:127]
  ds_read_b128 v[36:39], v219 offset:27648
  ds_write_b128 v212, v[68:71] offset:7168
  s_waitcnt lgkmcnt(11)
  v_mfma_f32_16x16x32_bf16 v[104:107], a[20:23], v[16:19], v[104:107]
  v_mfma_f32_16x16x32_bf16 v[112:115], a[100:103], v[16:19], v[112:115]
  v_mfma_f32_16x16x32_bf16 v[120:123], a[180:183], v[16:19], v[120:123]
  ds_read_b128 v[8:11], v211 offset:49152
  ds_write_b128 v212, v[72:75] offset:8192
  s_waitcnt lgkmcnt(11)
  v_mfma_f32_16x16x32_bf16 v[108:111], a[20:23], v[20:23], v[108:111]
  v_mfma_f32_16x16x32_bf16 v[116:119], a[100:103], v[20:23], v[116:119]
  v_mfma_f32_16x16x32_bf16 v[124:127], a[180:183], v[20:23], v[124:127]
  ds_read_b128 v[12:15], v219 offset:28672
  ds_write_b128 v212, v[76:79] offset:9216
  s_waitcnt lgkmcnt(11)
  v_mfma_f32_16x16x32_bf16 v[104:107], a[24:27], v[24:27], v[104:107]
  v_mfma_f32_16x16x32_bf16 v[112:115], a[104:107], v[24:27], v[112:115]
  v_mfma_f32_16x16x32_bf16 v[120:123], a[184:187], v[24:27], v[120:123]
  ds_read_b128 v[16:19], v211 offset:50176
  s_waitcnt lgkmcnt(1)
  buffer_load_dwordx4 v[40:43], v200, s[4:7], s31 offen offset:0
  v_mfma_f32_16x16x32_bf16 v[108:111], a[24:27], v[28:31], v[108:111]
  v_mfma_f32_16x16x32_bf16 v[116:119], a[104:107], v[28:31], v[116:119]
  v_mfma_f32_16x16x32_bf16 v[124:127], a[184:187], v[28:31], v[124:127]
  ds_read_b128 v[20:23], v219 offset:29696
  buffer_load_dwordx4 v[44:47], v200, s[4:7], s31 offen offset:1024
  v_mfma_f32_16x16x32_bf16 v[104:107], a[28:31], v[32:35], v[104:107]
  v_mfma_f32_16x16x32_bf16 v[112:115], a[108:111], v[32:35], v[112:115]
  v_mfma_f32_16x16x32_bf16 v[120:123], a[188:191], v[32:35], v[120:123]
  ds_read_b128 v[24:27], v211 offset:51200
  buffer_load_dwordx4 v[48:51], v200, s[4:7], s31 offen offset:2048
  v_mfma_f32_16x16x32_bf16 v[108:111], a[28:31], v[36:39], v[108:111]
  v_mfma_f32_16x16x32_bf16 v[116:119], a[108:111], v[36:39], v[116:119]
  v_mfma_f32_16x16x32_bf16 v[124:127], a[188:191], v[36:39], v[124:127]
  ds_read_b128 v[28:31], v219 offset:30720
  buffer_load_dwordx4 v[52:55], v200, s[4:7], s31 offen offset:3072
  v_mfma_f32_16x16x32_bf16 v[104:107], a[32:35], v[8:11], v[104:107]
  v_mfma_f32_16x16x32_bf16 v[112:115], a[112:115], v[8:11], v[112:115]
  v_mfma_f32_16x16x32_bf16 v[120:123], a[192:195], v[8:11], v[120:123]
  ds_read_b128 v[32:35], v211 offset:52224
  s_add_u32 s31, s31, 4096
  buffer_load_dwordx4 v[56:59], v200, s[4:7], s31 offen offset:0
  v_mfma_f32_16x16x32_bf16 v[108:111], a[32:35], v[12:15], v[108:111]
  v_mfma_f32_16x16x32_bf16 v[116:119], a[112:115], v[12:15], v[116:119]
  v_mfma_f32_16x16x32_bf16 v[124:127], a[192:195], v[12:15], v[124:127]
  ds_read_b128 v[36:39], v219 offset:31744
  buffer_load_dwordx4 v[60:63], v200, s[4:7], s31 offen offset:1024
  s_waitcnt lgkmcnt(5)
  v_mfma_f32_16x16x32_bf16 v[104:107], a[36:39], v[16:19], v[104:107]
  v_mfma_f32_16x16x32_bf16 v[112:115], a[116:119], v[16:19], v[112:115]
  v_mfma_f32_16x16x32_bf16 v[120:123], a[196:199], v[16:19], v[120:123]
  ds_read_b128 v[8:11], v211 offset:53248
  buffer_load_dwordx4 v[64:67], v200, s[4:7], s31 offen offset:2048
  s_waitcnt lgkmcnt(5)
  v_mfma_f32_16x16x32_bf16 v[108:111], a[36:39], v[20:23], v[108:111]
  v_mfma_f32_16x16x32_bf16 v[116:119], a[116:119], v[20:23], v[116:119]
  v_mfma_f32_16x16x32_bf16 v[124:127], a[196:199], v[20:23], v[124:127]
  ds_read_b128 v[12:15], v219 offset:32768
  buffer_load_dwordx4 v[68:71], v200, s[4:7], s31 offen offset:3072
  s_waitcnt lgkmcnt(5)
  v_mfma_f32_16x16x32_bf16 v[104:107], a[40:43], v[24:27], v[104:107]
  v_mfma_f32_16x16x32_bf16 v[112:115], a[120:123], v[24:27], v[112:115]
  v_mfma_f32_16x16x32_bf16 v[120:123], a[200:203], v[24:27], v[120:123]
  ds_read_b128 v[16:19], v211 offset:54272
  s_add_u32 s31, s31, 4096
  buffer_load_dwordx4 v[72:75], v200, s[4:7], s31 offen offset:0
  s_waitcnt lgkmcnt(5)
  v_mfma_f32_16x16x32_bf16 v[108:111], a[40:43], v[28:31], v[108:111]
  v_mfma_f32_16x16x32_bf16 v[116:119], a[120:123], v[28:31], v[116:119]
  v_mfma_f32_16x16x32_bf16 v[124:127], a[200:203], v[28:31], v[124:127]
  ds_read_b128 v[20:23], v219 offset:33792
  buffer_load_dwordx4 v[76:79], v200, s[4:7], s31 offen offset:1024
  s_add_u32 s31, s31, 32768
  s_waitcnt lgkmcnt(5)
  v_mfma_f32_16x16x32_bf16 v[104:107], a[44:47], v[32:35], v[104:107]
  v_mfma_f32_16x16x32_bf16 v[112:115], a[124:127], v[32:35], v[112:115]
  v_mfma_f32_16x16x32_bf16 v[120:123], a[204:207], v[32:35], v[120:123]
  ds_read_b128 v[24:27], v211 offset:55296
  s_waitcnt lgkmcnt(5)
  v_mfma_f32_16x16x32_bf16 v[108:111], a[44:47], v[36:39], v[108:111]
  v_mfma_f32_16x16x32_bf16 v[116:119], a[124:127], v[36:39], v[116:119]
  v_mfma_f32_16x16x32_bf16 v[124:127], a[204:207], v[36:39], v[124:127]
  ds_read_b128 v[28:31], v219 offset:34816
  s_waitcnt lgkmcnt(5)
  v_mfma_f32_16x16x32_bf16 v[104:107], a[48:51], v[8:11], v[104:107]
  v_mfma_f32_16x16x32_bf16 v[112:115], a[128:131], v[8:11], v[112:115]
  v_mfma_f32_16x16x32_bf16 v[120:123], a[208:211], v[8:11], v[120:123]
  ds_read_b128 v[32:35], v211 offset:56320
  s_waitcnt lgkmcnt(5)
  v_mfma_f32_16x16x32_bf16 v[108:111], a[48:51], v[12:15], v[108:111]
  v_mfma_f32_16x16x32_bf16 v[116:119], a[128:131], v[12:15], v[116:119]
  v_mfma_f32_16x16x32_bf16 v[124:127], a[208:211], v[12:15], v[124:127]
  ds_read_b128 v[36:39], v219 offset:35840
  s_waitcnt lgkmcnt(5)
  v_mfma_f32_16x16x32_bf16 v[104:107], a[52:55], v[16:19], v[104:107]
  v_mfma_f32_16x16x32_bf16 v[112:115], a[132:135], v[16:19], v[112:115]
  v_mfma_f32_16x16x32_bf16 v[120:123], a[212:215], v[16:19], v[120:123]
  ds_read_b128 v[8:11], v211 offset:57344
  s_waitcnt lgkmcnt(5)
  v_mfma_f32_16x16x32_bf16 v[108:111], a[52:55], v[20:23], v[108:111]
  v_mfma_f32_16x16x32_bf16 v[116:119], a[132:135], v[20:23], v[116:119]
  v_mfma_f32_16x16x32_bf16 v[124:127], a[212:215], v[20:23], v[124:127]
  ds_read_b128 v[12:15], v219 offset:36864
  s_waitcnt lgkmcnt(5)
  v_mfma_f32_16x16x32_bf16 v[104:107], a[56:59], v[24:27], v[104:107]
  v_mfma_f32_16x16x32_bf16 v[112:115], a[136:139], v[24:27], v[112:115]
  v_mfma_f32_16x16x32_bf16 v[120:123], a[216:219], v[24:27], v[120:123]
  ds_read_b128 v[16:19], v211 offset:58368
  s_waitcnt lgkmcnt(5)
  v_mfma_f32_16x16x32_bf16 v[108:111], a[56:59], v[28:31], v[108:111]
  v_mfma_f32_16x16x32_bf16 v[116:119], a[136:139], v[28:31], v[116:119]
  v_mfma_f32_16x16x32_bf16 v[124:127], a[216:219], v[28:31], v[124:127]
  ds_read_b128 v[20:23], v219 offset:37888
  s_waitcnt lgkmcnt(5)
  v_mfma_f32_16x16x32_bf16 v[104:107], a[60:63], v[32:35], v[104:107]
  v_mfma_f32_16x16x32_bf16 v[112:115], a[140:143], v[32:35], v[112:115]
  v_mfma_f32_16x16x32_bf16 v[120:123], a[220:223], v[32:35], v[120:123]
  ds_read_b128 v[24:27], v211 offset:59392
  s_waitcnt lgkmcnt(5)
  v_mfma_f32_16x16x32_bf16 v[108:111], a[60:63], v[36:39], v[108:111]
  v_mfma_f32_16x16x32_bf16 v[116:119], a[140:143], v[36:39], v[116:119]
  v_mfma_f32_16x16x32_bf16 v[124:127], a[220:223], v[36:39], v[124:127]
  ds_read_b128 v[28:31], v219 offset:38912
  s_waitcnt lgkmcnt(5)
  v_mfma_f32_16x16x32_bf16 v[104:107], a[64:67], v[8:11], v[104:107]
  v_mfma_f32_16x16x32_bf16 v[112:115], a[144:147], v[8:11], v[112:115]
  v_mfma_f32_16x16x32_bf16 v[120:123], a[224:227], v[8:11], v[120:123]
  ds_read_b128 v[32:35], v211 offset:60416
  s_waitcnt lgkmcnt(5)
  v_mfma_f32_16x16x32_bf16 v[108:111], a[64:67], v[12:15], v[108:111]
  v_mfma_f32_16x16x32_bf16 v[116:119], a[144:147], v[12:15], v[116:119]
  v_mfma_f32_16x16x32_bf16 v[124:127], a[224:227], v[12:15], v[124:127]
  ds_read_b128 v[36:39], v219 offset:39936
  s_waitcnt lgkmcnt(5)
  v_mfma_f32_16x16x32_bf16 v[104:107], a[68:71], v[16:19], v[104:107]
  v_mfma_f32_16x16x32_bf16 v[112:115], a[148:151], v[16:19], v[112:115]
  v_mfma_f32_16x16x32_bf16 v[120:123], a[228:231], v[16:19], v[120:123]
  s_waitcnt lgkmcnt(4)
  v_mfma_f32_16x16x32_bf16 v[108:111], a[68:71], v[20:23], v[108:111]
  v_mfma_f32_16x16x32_bf16 v[116:119], a[148:151], v[20:23], v[116:119]
  v_mfma_f32_16x16x32_bf16 v[124:127], a[228:231], v[20:23], v[124:127]
  s_waitcnt lgkmcnt(3)
  v_mfma_f32_16x16x32_bf16 v[104:107], a[72:75], v[24:27], v[104:107]
  v_mfma_f32_16x16x32_bf16 v[112:115], a[152:155], v[24:27], v[112:115]
  v_mfma_f32_16x16x32_bf16 v[120:123], a[232:235], v[24:27], v[120:123]
  s_waitcnt lgkmcnt(2)
  v_mfma_f32_16x16x32_bf16 v[108:111], a[72:75], v[28:31], v[108:111]
  v_mfma_f32_16x16x32_bf16 v[116:119], a[152:155], v[28:31], v[116:119]
  v_mfma_f32_16x16x32_bf16 v[124:127], a[232:235], v[28:31], v[124:127]
  s_waitcnt lgkmcnt(1)
  v_mfma_f32_16x16x32_bf16 v[104:107], a[76:79], v[32:35], v[104:107]
  v_mfma_f32_16x16x32_bf16 v[112:115], a[156:159], v[32:35], v[112:115]
  v_mfma_f32_16x16x32_bf16 v[120:123], a[236:239], v[32:35], v[120:123]
  s_waitcnt lgkmcnt(0)
  v_mfma_f32_16x16x32_bf16 v[108:111], a[76:79], v[36:39], v[108:111]
  v_mfma_f32_16x16x32_bf16 v[116:119], a[156:159], v[36:39], v[116:119]
  v_mfma_f32_16x16x32_bf16 v[124:127], a[236:239], v[36:39], v[124:127]
  s_cmp_lt_u32 s30, 2
  s_cbranch_scc1 L_x1nfK1_fx
  buffer_store_dword v205, v204, s[4:7], s33 offen
  s_add_u32 s33, s33, 64
  s_branch L_x1eK1_fx
L_x1nfK1_fx:
  buffer_store_dword v205, v210, s[4:7], s33 offen
L_x1eK1_fx:
  s_nop 4
  v_cvt_pk_bf16_f32 v128, v104, v105
  v_cvt_pk_bf16_f32 v129, v106, v107
  v_cvt_pk_bf16_f32 v130, v108, v109
  v_cvt_pk_bf16_f32 v131, v110, v111
  v_cvt_pk_bf16_f32 v132, v112, v113
  v_cvt_pk_bf16_f32 v133, v114, v115
  v_cvt_pk_bf16_f32 v134, v116, v117
  v_cvt_pk_bf16_f32 v135, v118, v119
  v_cvt_pk_bf16_f32 v136, v120, v121
  v_cvt_pk_bf16_f32 v137, v122, v123
  v_cvt_pk_bf16_f32 v138, v124, v125
  v_cvt_pk_bf16_f32 v139, v126, v127
  buffer_store_dwordx2 v[128:129], v213, s[4:7], s32 offen
  buffer_store_dwordx2 v[130:131], v214, s[4:7], s32 offen
  buffer_store_dwordx2 v[132:133], v215, s[4:7], s32 offen
  buffer_store_dwordx2 v[134:135], v216, s[4:7], s32 offen
  buffer_store_dwordx2 v[136:137], v217, s[4:7], s32 offen
  buffer_store_dwordx2 v[138:139], v218, s[4:7], s32 offen
  s_add_u32 s32, s32, 24576
  s_cmp_ge_u32 s30, 2
  s_cbranch_scc1 L_x1efK1_fx
  s_waitcnt vmcnt(0)
  buffer_store_dword v205, v204, s[4:7], s33 offen offset:64
L_x1efK1_fx:
  s_add_u32 s30, s30, 1
  s_cmp_lt_u32 s30, 64
  s_cbranch_scc1 L_xlK_fx
  s_waitcnt vmcnt(0)
  buffer_store_dword v205, v204, s[4:7], s33 offen
  buffer_store_dword v205, v204, s[4:7], s33 offen offset:64
  s_branch L_x1done_fx
L_x1Q_fx:
  s_mul_i32 s32, s28, 786432
  s_add_u32 s32, s32, 2621440
L_xlQ_fx:
  s_waitcnt lgkmcnt(0)
  s_barrier
  ds_read_b128 v[8:11], v211 offset:0
  ds_read_b128 v[12:15], v211 offset:20480
  ds_read_b128 v[16:19], v211 offset:1024
  ds_read_b128 v[20:23], v211 offset:21504
  ds_read_b128 v[24:27], v211 offset:2048
  ds_read_b128 v[28:31], v211 offset:22528
  s_waitcnt lgkmcnt(5)
  v_mfma_f32_16x16x32_bf16 v[80:83], a[0:3], v[8:11], 0
  v_mfma_f32_16x16x32_bf16 v[88:91], a[80:83], v[8:11], 0
  v_mfma_f32_16x16x32_bf16 v[96:99], a[160:163], v[8:11], 0
  ds_read_b128 v[32:35], v211 offset:3072
  s_waitcnt lgkmcnt(5)
  v_mfma_f32_16x16x32_bf16 v[84:87], a[0:3], v[12:15], 0
  v_mfma_f32_16x16x32_bf16 v[92:95], a[80:83], v[12:15], 0
  v_mfma_f32_16x16x32_bf16 v[100:103], a[160:163], v[12:15], 0
  ds_read_b128 v[36:39], v211 offset:23552
  s_waitcnt lgkmcnt(5)
  v_mfma_f32_16x16x32_bf16 v[80:83], a[4:7], v[16:19], v[80:83]
  v_mfma_f32_16x16x32_bf16 v[88:91], a[84:87], v[16:19], v[88:91]
  v_mfma_f32_16x16x32_bf16 v[96:99], a[164:167], v[16:19], v[96:99]
  ds_read_b128 v[8:11], v211 offset:4096
  s_waitcnt vmcnt(7)
  ds_write_b128 v212, v[40:43] offset:40960
  s_waitcnt lgkmcnt(6)
  v_mfma_f32_16x16x32_bf16 v[84:87], a[4:7], v[20:23], v[84:87]
  v_mfma_f32_16x16x32_bf16 v[92:95], a[84:87], v[20:23], v[92:95]
  v_mfma_f32_16x16x32_bf16 v[100:103], a[164:167], v[20:23], v[100:103]
  ds_read_b128 v[12:15], v211 offset:24576
  ds_write_b128 v212, v[44:47] offset:41984
  s_waitcnt lgkmcnt(7)
  v_mfma_f32_16x16x32_bf16 v[80:83], a[8:11], v[24:27], v[80:83]
  v_mfma_f32_16x16x32_bf16 v[88:91], a[88:91], v[24:27], v[88:91]
  v_mfma_f32_16x16x32_bf16 v[96:99], a[168:171], v[24:27], v[96:99]
  ds_read_b128 v[16:19], v211 offset:5120
  ds_write_b128 v212, v[48:51] offset:43008
  s_waitcnt lgkmcnt(8)
  v_mfma_f32_16x16x32_bf16 v[84:87], a[8:11], v[28:31], v[84:87]
  v_mfma_f32_16x16x32_bf16 v[92:95], a[88:91], v[28:31], v[92:95]
  v_mfma_f32_16x16x32_bf16 v[100:103], a[168:171], v[28:31], v[100:103]
  ds_read_b128 v[20:23], v211 offset:25600
  ds_write_b128 v212, v[52:55] offset:44032
  s_waitcnt lgkmcnt(9)
  v_mfma_f32_16x16x32_bf16 v[80:83], a[12:15], v[32:35], v[80:83]
  v_mfma_f32_16x16x32_bf16 v[88:91], a[92:95], v[32:35], v[88:91]
  v_mfma_f32_16x16x32_bf16 v[96:99], a[172:175], v[32:35], v[96:99]
  ds_read_b128 v[24:27], v211 offset:6144
  ds_write_b128 v212, v[56:59] offset:45056
  s_waitcnt lgkmcnt(10)
  v_mfma_f32_16x16x32_bf16 v[84:87], a[12:15], v[36:39], v[84:87]
  v_mfma_f32_16x16x32_bf16 v[92:95], a[92:95], v[36:39], v[92:95]
  v_mfma_f32_16x16x32_bf16 v[100:103], a[172:175], v[36:39], v[100:103]
  ds_read_b128 v[28:31], v211 offset:26624
  ds_write_b128 v212, v[60:63] offset:46080
  s_waitcnt lgkmcnt(11)
  v_mfma_f32_16x16x32_bf16 v[80:83], a[16:19], v[8:11], v[80:83]
  v_mfma_f32_16x16x32_bf16 v[88:91], a[96:99], v[8:11], v[88:91]
  v_mfma_f32_16x16x32_bf16 v[96:99], a[176:179], v[8:11], v[96:99]
  ds_read_b128 v[32:35], v211 offset:7168
  ds_write_b128 v212, v[64:67] offset:47104
  s_waitcnt lgkmcnt(11)
  v_mfma_f32_16x16x32_bf16 v[84:87], a[16:19], v[12:15], v[84:87]
  v_mfma_f32_16x16x32_bf16 v[92:95], a[96:99], v[12:15], v[92:95]
  v_mfma_f32_16x16x32_bf16 v[100:103], a[176:179], v[12:15], v[100:103]
  ds_read_b128 v[36:39], v211 offset:27648
  ds_write_b128 v212, v[68:71] offset:48128
  s_waitcnt lgkmcnt(11)
  v_mfma_f32_16x16x32_bf16 v[80:83], a[20:23], v[16:19], v[80:83]
  v_mfma_f32_16x16x32_bf16 v[88:91], a[100:103], v[16:19], v[88:91]
  v_mfma_f32_16x16x32_bf16 v[96:99], a[180:183], v[16:19], v[96:99]
  ds_read_b128 v[8:11], v211 offset:8192
  ds_write_b128 v212, v[72:75] offset:49152
  s_waitcnt lgkmcnt(11)
  v_mfma_f32_16x16x32_bf16 v[84:87], a[20:23], v[20:23], v[84:87]
  v_mfma_f32_16x16x32_bf16 v[92:95], a[100:103], v[20:23], v[92:95]
  v_mfma_f32_16x16x32_bf16 v[100:103], a[180:183], v[20:23], v[100:103]
  ds_read_b128 v[12:15], v211 offset:28672
  ds_write_b128 v212, v[76:79] offset:50176
  s_waitcnt lgkmcnt(11)
  v_mfma_f32_16x16x32_bf16 v[80:83], a[24:27], v[24:27], v[80:83]
  v_mfma_f32_16x16x32_bf16 v[88:91], a[104:107], v[24:27], v[88:91]
  v_mfma_f32_16x16x32_bf16 v[96:99], a[184:187], v[24:27], v[96:99]
  ds_read_b128 v[16:19], v211 offset:9216
  s_waitcnt lgkmcnt(1)
  buffer_load_dwordx4 v[40:43], v200, s[4:7], s31 offen offset:0
  v_mfma_f32_16x16x32_bf16 v[84:87], a[24:27], v[28:31], v[84:87]
  v_mfma_f32_16x16x32_bf16 v[92:95], a[104:107], v[28:31], v[92:95]
  v_mfma_f32_16x16x32_bf16 v[100:103], a[184:187], v[28:31], v[100:103]
  ds_read_b128 v[20:23], v211 offset:29696
  buffer_load_dwordx4 v[44:47], v200, s[4:7], s31 offen offset:1024
  v_mfma_f32_16x16x32_bf16 v[80:83], a[28:31], v[32:35], v[80:83]
  v_mfma_f32_16x16x32_bf16 v[88:91], a[108:111], v[32:35], v[88:91]
  v_mfma_f32_16x16x32_bf16 v[96:99], a[188:191], v[32:35], v[96:99]
  ds_read_b128 v[24:27], v211 offset:10240
  buffer_load_dwordx4 v[48:51], v200, s[4:7], s31 offen offset:2048
  v_mfma_f32_16x16x32_bf16 v[84:87], a[28:31], v[36:39], v[84:87]
  v_mfma_f32_16x16x32_bf16 v[92:95], a[108:111], v[36:39], v[92:95]
  v_mfma_f32_16x16x32_bf16 v[100:103], a[188:191], v[36:39], v[100:103]
  ds_read_b128 v[28:31], v211 offset:30720
  buffer_load_dwordx4 v[52:55], v200, s[4:7], s31 offen offset:3072
  v_mfma_f32_16x16x32_bf16 v[80:83], a[32:35], v[8:11], v[80:83]
  v_mfma_f32_16x16x32_bf16 v[88:91], a[112:115], v[8:11], v[88:91]
  v_mfma_f32_16x16x32_bf16 v[96:99], a[192:195], v[8:11], v[96:99]
  ds_read_b128 v[32:35], v211 offset:11264
  s_add_u32 s31, s31, 4096
  buffer_load_dwordx4 v[56:59], v200, s[4:7], s31 offen offset:0
  v_mfma_f32_16x16x32_bf16 v[84:87], a[32:35], v[12:15], v[84:87]
  v_mfma_f32_16x16x32_bf16 v[92:95], a[112:115], v[12:15], v[92:95]
  v_mfma_f32_16x16x32_bf16 v[100:103], a[192:195], v[12:15], v[100:103]
  ds_read_b128 v[36:39], v211 offset:31744
  buffer_load_dwordx4 v[60:63], v200, s[4:7], s31 offen offset:1024
  s_waitcnt lgkmcnt(5)
  v_mfma_f32_16x16x32_bf16 v[80:83], a[36:39], v[16:19], v[80:83]
  v_mfma_f32_16x16x32_bf16 v[88:91], a[116:119], v[16:19], v[88:91]
  v_mfma_f32_16x16x32_bf16 v[96:99], a[196:199], v[16:19], v[96:99]
  ds_read_b128 v[8:11], v211 offset:12288
  buffer_load_dwordx4 v[64:67], v200, s[4:7], s31 offen offset:2048
  s_waitcnt lgkmcnt(5)
  v_mfma_f32_16x16x32_bf16 v[84:87], a[36:39], v[20:23], v[84:87]
  v_mfma_f32_16x16x32_bf16 v[92:95], a[116:119], v[20:23], v[92:95]
  v_mfma_f32_16x16x32_bf16 v[100:103], a[196:199], v[20:23], v[100:103]
  ds_read_b128 v[12:15], v211 offset:32768
  buffer_load_dwordx4 v[68:71], v200, s[4:7], s31 offen offset:3072
  s_waitcnt lgkmcnt(5)
  v_mfma_f32_16x16x32_bf16 v[80:83], a[40:43], v[24:27], v[80:83]
  v_mfma_f32_16x16x32_bf16 v[88:91], a[120:123], v[24:27], v[88:91]
  v_mfma_f32_16x16x32_bf16 v[96:99], a[200:203], v[24:27], v[96:99]
  ds_read_b128 v[16:19], v211 offset:13312
  s_add_u32 s31, s31, 4096
  buffer_load_dwordx4 v[72:75], v200, s[4:7], s31 offen offset:0
  s_waitcnt lgkmcnt(5)
  v_mfma_f32_16x16x32_bf16 v[84:87], a[40:43], v[28:31], v[84:87]
  v_mfma_f32_16x16x32_bf16 v[92:95], a[120:123], v[28:31], v[92:95]
  v_mfma_f32_16x16x32_bf16 v[100:103], a[200:203], v[28:31], v[100:103]
  ds_read_b128 v[20:23], v211 offset:33792
  buffer_load_dwordx4 v[76:79], v200, s[4:7], s31 offen offset:1024
  s_add_u32 s31, s31, 32768
  s_waitcnt lgkmcnt(5)
  v_mfma_f32_16x16x32_bf16 v[80:83], a[44:47], v[32:35], v[80:83]
  v_mfma_f32_16x16x32_bf16 v[88:91], a[124:127], v[32:35], v[88:91]
  v_mfma_f32_16x16x32_bf16 v[96:99], a[204:207], v[32:35], v[96:99]
  ds_read_b128 v[24:27], v211 offset:14336
  s_waitcnt lgkmcnt(5)
  v_mfma_f32_16x16x32_bf16 v[84:87], a[44:47], v[36:39], v[84:87]
  v_mfma_f32_16x16x32_bf16 v[92:95], a[124:127], v[36:39], v[92:95]
  v_mfma_f32_16x16x32_bf16 v[100:103], a[204:207], v[36:39], v[100:103]
  ds_read_b128 v[28:31], v211 offset:34816
  s_waitcnt lgkmcnt(5)
  v_mfma_f32_16x16x32_bf16 v[80:83], a[48:51], v[8:11], v[80:83]
  v_mfma_f32_16x16x32_bf16 v[88:91], a[128:131], v[8:11], v[88:91]
  v_mfma_f32_16x16x32_bf16 v[96:99], a[208:211], v[8:11], v[96:99]
  ds_read_b128 v[32:35], v211 offset:15360
  s_waitcnt lgkmcnt(5)
  v_mfma_f32_16x16x32_bf16 v[84:87], a[48:51], v[12:15], v[84:87]
  v_mfma_f32_16x16x32_bf16 v[92:95], a[128:131], v[12:15], v[92:95]
  v_mfma_f32_16x16x32_bf16 v[100:103], a[208:211], v[12:15], v[100:103]
  ds_read_b128 v[36:39], v211 offset:35840
  s_waitcnt lgkmcnt(5)
  v_mfma_f32_16x16x32_bf16 v[80:83], a[52:55], v[16:19], v[80:83]
  v_mfma_f32_16x16x32_bf16 v[88:91], a[132:135], v[16:19], v[88:91]
  v_mfma_f32_16x16x32_bf16 v[96:99], a[212:215], v[16:19], v[96:99]
  ds_read_b128 v[8:11], v211 offset:16384
  s_waitcnt lgkmcnt(5)
  v_mfma_f32_16x16x32_bf16 v[84:87], a[52:55], v[20:23], v[84:87]
  v_mfma_f32_16x16x32_bf16 v[92:95], a[132:135], v[20:23], v[92:95]
  v_mfma_f32_16x16x32_bf16 v[100:103], a[212:215], v[20:23], v[100:103]
  ds_read_b128 v[12:15], v211 offset:36864
  s_waitcnt lgkmcnt(5)
  v_mfma_f32_16x16x32_bf16 v[80:83], a[56:59], v[24:27], v[80:83]
  v_mfma_f32_16x16x32_bf16 v[88:91], a[136:139], v[24:27], v[88:91]
  v_mfma_f32_16x16x32_bf16 v[96:99], a[216:219], v[24:27], v[96:99]
  ds_read_b128 v[16:19], v211 offset:17408
  s_waitcnt lgkmcnt(5)
  v_mfma_f32_16x16x32_bf16 v[84:87], a[56:59], v[28:31], v[84:87]
  v_mfma_f32_16x16x32_bf16 v[92:95], a[136:139], v[28:31], v[92:95]
  v_mfma_f32_16x16x32_bf16 v[100:103], a[216:219], v[28:31], v[100:103]
  ds_read_b128 v[20:23], v211 offset:37888
  s_waitcnt lgkmcnt(5)
  v_mfma_f32_16x16x32_bf16 v[80:83], a[60:63], v[32:35], v[80:83]
  v_mfma_f32_16x16x32_bf16 v[88:91], a[140:143], v[32:35], v[88:91]
  v_mfma_f32_16x16x32_bf16 v[96:99], a[220:223], v[32:35], v[96:99]
  ds_read_b128 v[24:27], v211 offset:18432
  s_waitcnt lgkmcnt(5)
  v_mfma_f32_16x16x32_bf16 v[84:87], a[60:63], v[36:39], v[84:87]
  v_mfma_f32_16x16x32_bf16 v[92:95], a[140:143], v[36:39], v[92:95]
  v_mfma_f32_16x16x32_bf16 v[100:103], a[220:223], v[36:39], v[100:103]
  ds_read_b128 v[28:31], v211 offset:38912
  s_waitcnt lgkmcnt(5)
  v_mfma_f32_16x16x32_bf16 v[80:83], a[64:67], v[8:11], v[80:83]
  v_mfma_f32_16x16x32_bf16 v[88:91], a[144:147], v[8:11], v[88:91]
  v_mfma_f32_16x16x32_bf16 v[96:99], a[224:227], v[8:11], v[96:99]
  ds_read_b128 v[32:35], v211 offset:19456
  s_waitcnt lgkmcnt(5)
  v_mfma_f32_16x16x32_bf16 v[84:87], a[64:67], v[12:15], v[84:87]
  v_mfma_f32_16x16x32_bf16 v[92:95], a[144:147], v[12:15], v[92:95]
  v_mfma_f32_16x16x32_bf16 v[100:103], a[224:227], v[12:15], v[100:103]
  ds_read_b128 v[36:39], v211 offset:39936
  s_waitcnt lgkmcnt(5)
  v_mfma_f32_16x16x32_bf16 v[80:83], a[68:71], v[16:19], v[80:83]
  v_mfma_f32_16x16x32_bf16 v[88:91], a[148:151], v[16:19], v[88:91]
  v_mfma_f32_16x16x32_bf16 v[96:99], a[228:231], v[16:19], v[96:99]
  s_waitcnt lgkmcnt(4)
  v_mfma_f32_16x16x32_bf16 v[84:87], a[68:71], v[20:23], v[84:87]
  v_mfma_f32_16x16x32_bf16 v[92:95], a[148:151], v[20:23], v[92:95]
  v_mfma_f32_16x16x32_bf16 v[100:103], a[228:231], v[20:23], v[100:103]
  s_waitcnt lgkmcnt(3)
  v_mfma_f32_16x16x32_bf16 v[80:83], a[72:75], v[24:27], v[80:83]
  v_mfma_f32_16x16x32_bf16 v[88:91], a[152:155], v[24:27], v[88:91]
  v_mfma_f32_16x16x32_bf16 v[96:99], a[232:235], v[24:27], v[96:99]
  s_waitcnt lgkmcnt(2)
  v_mfma_f32_16x16x32_bf16 v[84:87], a[72:75], v[28:31], v[84:87]
  v_mfma_f32_16x16x32_bf16 v[92:95], a[152:155], v[28:31], v[92:95]
  v_mfma_f32_16x16x32_bf16 v[100:103], a[232:235], v[28:31], v[100:103]
  s_waitcnt lgkmcnt(1)
  v_mfma_f32_16x16x32_bf16 v[80:83], a[76:79], v[32:35], v[80:83]
  v_mfma_f32_16x16x32_bf16 v[88:91], a[156:159], v[32:35], v[88:91]
  v_mfma_f32_16x16x32_bf16 v[96:99], a[236:239], v[32:35], v[96:99]
  s_waitcnt lgkmcnt(0)
  v_mfma_f32_16x16x32_bf16 v[84:87], a[76:79], v[36:39], v[84:87]
  v_mfma_f32_16x16x32_bf16 v[92:95], a[156:159], v[36:39], v[92:95]
  v_mfma_f32_16x16x32_bf16 v[100:103], a[236:239], v[36:39], v[100:103]
  s_cmp_lt_u32 s30, 2
  s_cbranch_scc1 L_x1nfQ0_fx
  buffer_store_dword v205, v204, s[4:7], s33 offen
  s_add_u32 s33, s33, 64
  s_branch L_x1eQ0_fx
L_x1nfQ0_fx:
  buffer_store_dword v205, v210, s[4:7], s33 offen
L_x1eQ0_fx:
  s_nop 4
  v_cvt_pk_bf16_f32 v128, v80, v81
  v_cvt_pk_bf16_f32 v129, v82, v83
  v_cvt_pk_bf16_f32 v130, v84, v85
  v_cvt_pk_bf16_f32 v131, v86, v87
  v_cvt_pk_bf16_f32 v132, v88, v89
  v_cvt_pk_bf16_f32 v133, v90, v91
  v_cvt_pk_bf16_f32 v134, v92, v93
  v_cvt_pk_bf16_f32 v135, v94, v95
  v_cvt_pk_bf16_f32 v136, v96, v97
  v_cvt_pk_bf16_f32 v137, v98, v99
  v_cvt_pk_bf16_f32 v138, v100, v101
  v_cvt_pk_bf16_f32 v139, v102, v103
  buffer_store_dwordx2 v[128:129], v213, s[4:7], s32 offen
  buffer_store_dwordx2 v[130:131], v214, s[4:7], s32 offen
  buffer_store_dwordx2 v[132:133], v215, s[4:7], s32 offen
  buffer_store_dwordx2 v[134:135], v216, s[4:7], s32 offen
  buffer_store_dwordx2 v[136:137], v217, s[4:7], s32 offen
  buffer_store_dwordx2 v[138:139], v218, s[4:7], s32 offen
  s_add_u32 s32, s32, 12288
  s_cmp_ge_u32 s30, 2
  s_cbranch_scc1 L_x1efQ0_fx
  s_waitcnt vmcnt(0)
  buffer_store_dword v205, v204, s[4:7], s33 offen offset:0
L_x1efQ0_fx:
  s_add_u32 s30, s30, 1
  s_waitcnt lgkmcnt(0)
  s_barrier
  ds_read_b128 v[8:11], v211 offset:40960
  ds_read_b128 v[12:15], v211 offset:61440
  ds_read_b128 v[16:19], v211 offset:41984
  ds_read_b128 v[20:23], v211 offset:62464
  ds_read_b128 v[24:27], v211 offset:43008
  ds_read_b128 v[28:31], v211 offset:63488
  s_waitcnt lgkmcnt(5)
  v_mfma_f32_16x16x32_bf16 v[104:107], a[0:3], v[8:11], 0
  v_mfma_f32_16x16x32_bf16 v[112:115], a[80:83], v[8:11], 0
  v_mfma_f32_16x16x32_bf16 v[120:123], a[160:163], v[8:11], 0
  ds_read_b128 v[32:35], v211 offset:44032
  s_waitcnt lgkmcnt(5)
  v_mfma_f32_16x16x32_bf16 v[108:111], a[0:3], v[12:15], 0
  v_mfma_f32_16x16x32_bf16 v[116:119], a[80:83], v[12:15], 0
  v_mfma_f32_16x16x32_bf16 v[124:127], a[160:163], v[12:15], 0
  ds_read_b128 v[36:39], v211 offset:64512
  s_waitcnt lgkmcnt(5)
  v_mfma_f32_16x16x32_bf16 v[104:107], a[4:7], v[16:19], v[104:107]
  v_mfma_f32_16x16x32_bf16 v[112:115], a[84:87], v[16:19], v[112:115]
  v_mfma_f32_16x16x32_bf16 v[120:123], a[164:167], v[16:19], v[120:123]
  ds_read_b128 v[8:11], v211 offset:45056
  s_waitcnt vmcnt(7)
  ds_write_b128 v212, v[40:43] offset:0
  s_waitcnt lgkmcnt(6)
  v_mfma_f32_16x16x32_bf16 v[108:111], a[4:7], v[20:23], v[108:111]
  v_mfma_f32_16x16x32_bf16 v[116:119], a[84:87], v[20:23], v[116:119]
  v_mfma_f32_16x16x32_bf16 v[124:127], a[164:167], v[20:23], v[124:127]
  ds_read_b128 v[12:15], v219 offset:24576
  ds_write_b128 v212, v[44:47] offset:1024
  s_waitcnt lgkmcnt(7)
  v_mfma_f32_16x16x32_bf16 v[104:107], a[8:11], v[24:27], v[104:107]
  v_mfma_f32_16x16x32_bf16 v[112:115], a[88:91], v[24:27], v[112:115]
  v_mfma_f32_16x16x32_bf16 v[120:123], a[168:171], v[24:27], v[120:123]
  ds_read_b128 v[16:19], v211 offset:46080
  ds_write_b128 v212, v[48:51] offset:2048
  s_waitcnt lgkmcnt(8)
  v_mfma_f32_16x16x32_bf16 v[108:111], a[8:11], v[28:31], v[108:111]
  v_mfma_f32_16x16x32_bf16 v[116:119], a[88:91], v[28:31], v[116:119]
  v_mfma_f32_16x16x32_bf16 v[124:127], a[168:171], v[28:31], v[124:127]
  ds_read_b128 v[20:23], v219 offset:25600
  ds_write_b128 v212, v[52:55] offset:3072
  s_waitcnt lgkmcnt(9)
  v_mfma_f32_16x16x32_bf16 v[104:107], a[12:15], v[32:35], v[104:107]
  v_mfma_f32_16x16x32_bf16 v[112:115], a[92:95], v[32:35], v[112:115]
  v_mfma_f32_16x16x32_bf16 v[120:123], a[172:175], v[32:35], v[120:123]
  ds_read_b128 v[24:27], v211 offset:47104
  ds_write_b128 v212, v[56:59] offset:4096
  s_waitcnt lgkmcnt(10)
  v_mfma_f32_16x16x32_bf16 v[108:111], a[12:15], v[36:39], v[108:111]
  v_mfma_f32_16x16x32_bf16 v[116:119], a[92:95], v[36:39], v[116:119]
  v_mfma_f32_16x16x32_bf16 v[124:127], a[172:175], v[36:39], v[124:127]
  ds_read_b128 v[28:31], v219 offset:26624
  ds_write_b128 v212, v[60:63] offset:5120
  s_waitcnt lgkmcnt(11)
  v_mfma_f32_16x16x32_bf16 v[104:107], a[16:19], v[8:11], v[104:107]
  v_mfma_f32_16x16x32_bf16 v[112:115], a[96:99], v[8:11], v[112:115]
  v_mfma_f32_16x16x32_bf16 v[120:123], a[176:179], v[8:11], v[120:123]
  ds_read_b128 v[32:35], v211 offset:48128
  ds_write_b128 v212, v[64:67] offset:6144
  s_waitcnt lgkmcnt(11)
  v_mfma_f32_16x16x32_bf16 v[108:111], a[16:19], v[12:15], v[108:111]
  v_mfma_f32_16x16x32_bf16 v[116:119], a[96:99], v[12:15], v[116:119]
  v_mfma_f32_16x16x32_bf16 v[124:127], a[176:179], v[12:15], v[124:127]
  ds_read_b128 v[36:39], v219 offset:27648
  ds_write_b128 v212, v[68:71] offset:7168
  s_waitcnt lgkmcnt(11)
  v_mfma_f32_16x16x32_bf16 v[104:107], a[20:23], v[16:19], v[104:107]
  v_mfma_f32_16x16x32_bf16 v[112:115], a[100:103], v[16:19], v[112:115]
  v_mfma_f32_16x16x32_bf16 v[120:123], a[180:183], v[16:19], v[120:123]
  ds_read_b128 v[8:11], v211 offset:49152
  ds_write_b128 v212, v[72:75] offset:8192
  s_waitcnt lgkmcnt(11)
  v_mfma_f32_16x16x32_bf16 v[108:111], a[20:23], v[20:23], v[108:111]
  v_mfma_f32_16x16x32_bf16 v[116:119], a[100:103], v[20:23], v[116:119]
  v_mfma_f32_16x16x32_bf16 v[124:127], a[180:183], v[20:23], v[124:127]
  ds_read_b128 v[12:15], v219 offset:28672
  ds_write_b128 v212, v[76:79] offset:9216
  s_waitcnt lgkmcnt(11)
  v_mfma_f32_16x16x32_bf16 v[104:107], a[24:27], v[24:27], v[104:107]
  v_mfma_f32_16x16x32_bf16 v[112:115], a[104:107], v[24:27], v[112:115]
  v_mfma_f32_16x16x32_bf16 v[120:123], a[184:187], v[24:27], v[120:123]
  ds_read_b128 v[16:19], v211 offset:50176
  s_waitcnt lgkmcnt(1)
  buffer_load_dwordx4 v[40:43], v200, s[4:7], s31 offen offset:0
  v_mfma_f32_16x16x32_bf16 v[108:111], a[24:27], v[28:31], v[108:111]
  v_mfma_f32_16x16x32_bf16 v[116:119], a[104:107], v[28:31], v[116:119]
  v_mfma_f32_16x16x32_bf16 v[124:127], a[184:187], v[28:31], v[124:127]
  ds_read_b128 v[20:23], v219 offset:29696
  buffer_load_dwordx4 v[44:47], v200, s[4:7], s31 offen offset:1024
  v_mfma_f32_16x16x32_bf16 v[104:107], a[28:31], v[32:35], v[104:107]
  v_mfma_f32_16x16x32_bf16 v[112:115], a[108:111], v[32:35], v[112:115]
  v_mfma_f32_16x16x32_bf16 v[120:123], a[188:191], v[32:35], v[120:123]
  ds_read_b128 v[24:27], v211 offset:51200
  buffer_load_dwordx4 v[48:51], v200, s[4:7], s31 offen offset:2048
  v_mfma_f32_16x16x32_bf16 v[108:111], a[28:31], v[36:39], v[108:111]
  v_mfma_f32_16x16x32_bf16 v[116:119], a[108:111], v[36:39], v[116:119]
  v_mfma_f32_16x16x32_bf16 v[124:127], a[188:191], v[36:39], v[124:127]
  ds_read_b128 v[28:31], v219 offset:30720
  buffer_load_dwordx4 v[52:55], v200, s[4:7], s31 offen offset:3072
  v_mfma_f32_16x16x32_bf16 v[104:107], a[32:35], v[8:11], v[104:107]
  v_mfma_f32_16x16x32_bf16 v[112:115], a[112:115], v[8:11], v[112:115]
  v_mfma_f32_16x16x32_bf16 v[120:123], a[192:195], v[8:11], v[120:123]
  ds_read_b128 v[32:35], v211 offset:52224
  s_add_u32 s31, s31, 4096
  buffer_load_dwordx4 v[56:59], v200, s[4:7], s31 offen offset:0
  v_mfma_f32_16x16x32_bf16 v[108:111], a[32:35], v[12:15], v[108:111]
  v_mfma_f32_16x16x32_bf16 v[116:119], a[112:115], v[12:15], v[116:119]
  v_mfma_f32_16x16x32_bf16 v[124:127], a[192:195], v[12:15], v[124:127]
  ds_read_b128 v[36:39], v219 offset:31744
  buffer_load_dwordx4 v[60:63], v200, s[4:7], s31 offen offset:1024
  s_waitcnt lgkmcnt(5)
  v_mfma_f32_16x16x32_bf16 v[104:107], a[36:39], v[16:19], v[104:107]
  v_mfma_f32_16x16x32_bf16 v[112:115], a[116:119], v[16:19], v[112:115]
  v_mfma_f32_16x16x32_bf16 v[120:123], a[196:199], v[16:19], v[120:123]
  ds_read_b128 v[8:11], v211 offset:53248
  buffer_load_dwordx4 v[64:67], v200, s[4:7], s31 offen offset:2048
  s_waitcnt lgkmcnt(5)
  v_mfma_f32_16x16x32_bf16 v[108:111], a[36:39], v[20:23], v[108:111]
  v_mfma_f32_16x16x32_bf16 v[116:119], a[116:119], v[20:23], v[116:119]
  v_mfma_f32_16x16x32_bf16 v[124:127], a[196:199], v[20:23], v[124:127]
  ds_read_b128 v[12:15], v219 offset:32768
  buffer_load_dwordx4 v[68:71], v200, s[4:7], s31 offen offset:3072
  s_waitcnt lgkmcnt(5)
  v_mfma_f32_16x16x32_bf16 v[104:107], a[40:43], v[24:27], v[104:107]
  v_mfma_f32_16x16x32_bf16 v[112:115], a[120:123], v[24:27], v[112:115]
  v_mfma_f32_16x16x32_bf16 v[120:123], a[200:203], v[24:27], v[120:123]
  ds_read_b128 v[16:19], v211 offset:54272
  s_add_u32 s31, s31, 4096
  buffer_load_dwordx4 v[72:75], v200, s[4:7], s31 offen offset:0
  s_waitcnt lgkmcnt(5)
  v_mfma_f32_16x16x32_bf16 v[108:111], a[40:43], v[28:31], v[108:111]
  v_mfma_f32_16x16x32_bf16 v[116:119], a[120:123], v[28:31], v[116:119]
  v_mfma_f32_16x16x32_bf16 v[124:127], a[200:203], v[28:31], v[124:127]
  ds_read_b128 v[20:23], v219 offset:33792
  buffer_load_dwordx4 v[76:79], v200, s[4:7], s31 offen offset:1024
  s_add_u32 s31, s31, 32768
  s_waitcnt lgkmcnt(5)
  v_mfma_f32_16x16x32_bf16 v[104:107], a[44:47], v[32:35], v[104:107]
  v_mfma_f32_16x16x32_bf16 v[112:115], a[124:127], v[32:35], v[112:115]
  v_mfma_f32_16x16x32_bf16 v[120:123], a[204:207], v[32:35], v[120:123]
  ds_read_b128 v[24:27], v211 offset:55296
  s_waitcnt lgkmcnt(5)
  v_mfma_f32_16x16x32_bf16 v[108:111], a[44:47], v[36:39], v[108:111]
  v_mfma_f32_16x16x32_bf16 v[116:119], a[124:127], v[36:39], v[116:119]
  v_mfma_f32_16x16x32_bf16 v[124:127], a[204:207], v[36:39], v[124:127]
  ds_read_b128 v[28:31], v219 offset:34816
  s_waitcnt lgkmcnt(5)
  v_mfma_f32_16x16x32_bf16 v[104:107], a[48:51], v[8:11], v[104:107]
  v_mfma_f32_16x16x32_bf16 v[112:115], a[128:131], v[8:11], v[112:115]
  v_mfma_f32_16x16x32_bf16 v[120:123], a[208:211], v[8:11], v[120:123]
  ds_read_b128 v[32:35], v211 offset:56320
  s_waitcnt lgkmcnt(5)
  v_mfma_f32_16x16x32_bf16 v[108:111], a[48:51], v[12:15], v[108:111]
  v_mfma_f32_16x16x32_bf16 v[116:119], a[128:131], v[12:15], v[116:119]
  v_mfma_f32_16x16x32_bf16 v[124:127], a[208:211], v[12:15], v[124:127]
  ds_read_b128 v[36:39], v219 offset:35840
  s_waitcnt lgkmcnt(5)
  v_mfma_f32_16x16x32_bf16 v[104:107], a[52:55], v[16:19], v[104:107]
  v_mfma_f32_16x16x32_bf16 v[112:115], a[132:135], v[16:19], v[112:115]
  v_mfma_f32_16x16x32_bf16 v[120:123], a[212:215], v[16:19], v[120:123]
  ds_read_b128 v[8:11], v211 offset:57344
  s_waitcnt lgkmcnt(5)
  v_mfma_f32_16x16x32_bf16 v[108:111], a[52:55], v[20:23], v[108:111]
  v_mfma_f32_16x16x32_bf16 v[116:119], a[132:135], v[20:23], v[116:119]
  v_mfma_f32_16x16x32_bf16 v[124:127], a[212:215], v[20:23], v[124:127]
  ds_read_b128 v[12:15], v219 offset:36864
  s_waitcnt lgkmcnt(5)
  v_mfma_f32_16x16x32_bf16 v[104:107], a[56:59], v[24:27], v[104:107]
  v_mfma_f32_16x16x32_bf16 v[112:115], a[136:139], v[24:27], v[112:115]
  v_mfma_f32_16x16x32_bf16 v[120:123], a[216:219], v[24:27], v[120:123]
  ds_read_b128 v[16:19], v211 offset:58368
  s_waitcnt lgkmcnt(5)
  v_mfma_f32_16x16x32_bf16 v[108:111], a[56:59], v[28:31], v[108:111]
  v_mfma_f32_16x16x32_bf16 v[116:119], a[136:139], v[28:31], v[116:119]
  v_mfma_f32_16x16x32_bf16 v[124:127], a[216:219], v[28:31], v[124:127]
  ds_read_b128 v[20:23], v219 offset:37888
  s_waitcnt lgkmcnt(5)
  v_mfma_f32_16x16x32_bf16 v[104:107], a[60:63], v[32:35], v[104:107]
  v_mfma_f32_16x16x32_bf16 v[112:115], a[140:143], v[32:35], v[112:115]
  v_mfma_f32_16x16x32_bf16 v[120:123], a[220:223], v[32:35], v[120:123]
  ds_read_b128 v[24:27], v211 offset:59392
  s_waitcnt lgkmcnt(5)
  v_mfma_f32_16x16x32_bf16 v[108:111], a[60:63], v[36:39], v[108:111]
  v_mfma_f32_16x16x32_bf16 v[116:119], a[140:143], v[36:39], v[116:119]
  v_mfma_f32_16x16x32_bf16 v[124:127], a[220:223], v[36:39], v[124:127]
  ds_read_b128 v[28:31], v219 offset:38912
  s_waitcnt lgkmcnt(5)
  v_mfma_f32_16x16x32_bf16 v[104:107], a[64:67], v[8:11], v[104:107]
  v_mfma_f32_16x16x32_bf16 v[112:115], a[144:147], v[8:11], v[112:115]
  v_mfma_f32_16x16x32_bf16 v[120:123], a[224:227], v[8:11], v[120:123]
  ds_read_b128 v[32:35], v211 offset:60416
  s_waitcnt lgkmcnt(5)
  v_mfma_f32_16x16x32_bf16 v[108:111], a[64:67], v[12:15], v[108:111]
  v_mfma_f32_16x16x32_bf16 v[116:119], a[144:147], v[12:15], v[116:119]
  v_mfma_f32_16x16x32_bf16 v[124:127], a[224:227], v[12:15], v[124:127]
  ds_read_b128 v[36:39], v219 offset:39936
  s_waitcnt lgkmcnt(5)
  v_mfma_f32_16x16x32_bf16 v[104:107], a[68:71], v[16:19], v[104:107]
  v_mfma_f32_16x16x32_bf16 v[112:115], a[148:151], v[16:19], v[112:115]
  v_mfma_f32_16x16x32_bf16 v[120:123], a[228:231], v[16:19], v[120:123]
  s_waitcnt lgkmcnt(4)
  v_mfma_f32_16x16x32_bf16 v[108:111], a[68:71], v[20:23], v[108:111]
  v_mfma_f32_16x16x32_bf16 v[116:119], a[148:151], v[20:23], v[116:119]
  v_mfma_f32_16x16x32_bf16 v[124:127], a[228:231], v[20:23], v[124:127]
  s_waitcnt lgkmcnt(3)
  v_mfma_f32_16x16x32_bf16 v[104:107], a[72:75], v[24:27], v[104:107]
  v_mfma_f32_16x16x32_bf16 v[112:115], a[152:155], v[24:27], v[112:115]
  v_mfma_f32_16x16x32_bf16 v[120:123], a[232:235], v[24:27], v[120:123]
  s_waitcnt lgkmcnt(2)
  v_mfma_f32_16x16x32_bf16 v[108:111], a[72:75], v[28:31], v[108:111]
  v_mfma_f32_16x16x32_bf16 v[116:119], a[152:155], v[28:31], v[116:119]
  v_mfma_f32_16x16x32_bf16 v[124:127], a[232:235], v[28:31], v[124:127]
  s_waitcnt lgkmcnt(1)
  v_mfma_f32_16x16x32_bf16 v[104:107], a[76:79], v[32:35], v[104:107]
  v_mfma_f32_16x16x32_bf16 v[112:115], a[156:159], v[32:35], v[112:115]
  v_mfma_f32_16x16x32_bf16 v[120:123], a[236:239], v[32:35], v[120:123]
  s_waitcnt lgkmcnt(0)
  v_mfma_f32_16x16x32_bf16 v[108:111], a[76:79], v[36:39], v[108:111]
  v_mfma_f32_16x16x32_bf16 v[116:119], a[156:159], v[36:39], v[116:119]
  v_mfma_f32_16x16x32_bf16 v[124:127], a[236:239], v[36:39], v[124:127]
  s_cmp_lt_u32 s30, 2
  s_cbranch_scc1 L_x1nfQ1_fx
  buffer_store_dword v205, v204, s[4:7], s33 offen
  s_add_u32 s33, s33, 64
  s_branch L_x1eQ1_fx
L_x1nfQ1_fx:
  buffer_store_dword v205, v210, s[4:7], s33 offen
L_x1eQ1_fx:
  s_nop 4
  v_cvt_pk_bf16_f32 v128, v104, v105
  v_cvt_pk_bf16_f32 v129, v106, v107
  v_cvt_pk_bf16_f32 v130, v108, v109
  v_cvt_pk_bf16_f32 v131, v110, v111
  v_cvt_pk_bf16_f32 v132, v112, v113
  v_cvt_pk_bf16_f32 v133, v114, v115
  v_cvt_pk_bf16_f32 v134, v116, v117
  v_cvt_pk_bf16_f32 v135, v118, v119
  v_cvt_pk_bf16_f32 v136, v120, v121
  v_cvt_pk_bf16_f32 v137, v122, v123
  v_cvt_pk_bf16_f32 v138, v124, v125
  v_cvt_pk_bf16_f32 v139, v126, v127
  buffer_store_dwordx2 v[128:129], v213, s[4:7], s32 offen
  buffer_store_dwordx2 v[130:131], v214, s[4:7], s32 offen
  buffer_store_dwordx2 v[132:133], v215, s[4:7], s32 offen
  buffer_store_dwordx2 v[134:135], v216, s[4:7], s32 offen
  buffer_store_dwordx2 v[136:137], v217, s[4:7], s32 offen
  buffer_store_dwordx2 v[138:139], v218, s[4:7], s32 offen
  s_add_u32 s32, s32, 12288
  s_cmp_ge_u32 s30, 2
  s_cbranch_scc1 L_x1efQ1_fx
  s_waitcnt vmcnt(0)
  buffer_store_dword v205, v204, s[4:7], s33 offen offset:64
L_x1efQ1_fx:
  s_add_u32 s30, s30, 1
  s_cmp_lt_u32 s30, 64
  s_cbranch_scc1 L_xlQ_fx
  s_waitcnt vmcnt(0)
  buffer_store_dword v205, v204, s[4:7], s33 offen
  buffer_store_dword v205, v204, s[4:7], s33 offen offset:64
  s_branch L_x1done_fx
L_x1V_fx:
  s_mul_i32 s32, s28, 1572864
  s_add_u32 s32, s32, 27799552
  s_mul_i32 s72, s27, 3072
  s_add_u32 s32, s32, s72
  v_mov_b32 v213, v200
L_xlV_fx:
  s_waitcnt lgkmcnt(0)
  s_barrier
  ds_read_b128 v[8:11], v211 offset:0
  ds_read_b128 v[12:15], v211 offset:20480
  ds_read_b128 v[16:19], v211 offset:1024
  ds_read_b128 v[20:23], v211 offset:21504
  ds_read_b128 v[24:27], v211 offset:2048
  ds_read_b128 v[28:31], v211 offset:22528
  s_waitcnt lgkmcnt(5)
  v_mfma_f32_16x16x32_bf16 v[80:83], v[8:11], a[0:3], 0
  v_mfma_f32_16x16x32_bf16 v[88:91], v[8:11], a[80:83], 0
  v_mfma_f32_16x16x32_bf16 v[96:99], v[8:11], a[160:163], 0
  ds_read_b128 v[32:35], v211 offset:3072
  s_waitcnt lgkmcnt(5)
  v_mfma_f32_16x16x32_bf16 v[84:87], v[12:15], a[0:3], 0
  v_mfma_f32_16x16x32_bf16 v[92:95], v[12:15], a[80:83], 0
  v_mfma_f32_16x16x32_bf16 v[100:103], v[12:15], a[160:163], 0
  ds_read_b128 v[36:39], v211 offset:23552
  s_waitcnt lgkmcnt(5)
  v_mfma_f32_16x16x32_bf16 v[80:83], v[16:19], a[4:7], v[80:83]
  v_mfma_f32_16x16x32_bf16 v[88:91], v[16:19], a[84:87], v[88:91]
  v_mfma_f32_16x16x32_bf16 v[96:99], v[16:19], a[164:167], v[96:99]
  ds_read_b128 v[8:11], v211 offset:4096
  s_waitcnt vmcnt(4)
  ds_write_b128 v212, v[40:43] offset:40960
  s_waitcnt lgkmcnt(6)
  v_mfma_f32_16x16x32_bf16 v[84:87], v[20:23], a[4:7], v[84:87]
  v_mfma_f32_16x16x32_bf16 v[92:95], v[20:23], a[84:87], v[92:95]
  v_mfma_f32_16x16x32_bf16 v[100:103], v[20:23], a[164:167], v[100:103]
  ds_read_b128 v[12:15], v211 offset:24576
  ds_write_b128 v212, v[44:47] offset:41984
  s_waitcnt lgkmcnt(7)
  v_mfma_f32_16x16x32_bf16 v[80:83], v[24:27], a[8:11], v[80:83]
  v_mfma_f32_16x16x32_bf16 v[88:91], v[24:27], a[88:91], v[88:91]
  v_mfma_f32_16x16x32_bf16 v[96:99], v[24:27], a[168:171], v[96:99]
  ds_read_b128 v[16:19], v211 offset:5120
  ds_write_b128 v212, v[48:51] offset:43008
  s_waitcnt lgkmcnt(8)
  v_mfma_f32_16x16x32_bf16 v[84:87], v[28:31], a[8:11], v[84:87]
  v_mfma_f32_16x16x32_bf16 v[92:95], v[28:31], a[88:91], v[92:95]
  v_mfma_f32_16x16x32_bf16 v[100:103], v[28:31], a[168:171], v[100:103]
  ds_read_b128 v[20:23], v211 offset:25600
  ds_write_b128 v212, v[52:55] offset:44032
  s_waitcnt lgkmcnt(9)
  v_mfma_f32_16x16x32_bf16 v[80:83], v[32:35], a[12:15], v[80:83]
  v_mfma_f32_16x16x32_bf16 v[88:91], v[32:35], a[92:95], v[88:91]
  v_mfma_f32_16x16x32_bf16 v[96:99], v[32:35], a[172:175], v[96:99]
  ds_read_b128 v[24:27], v211 offset:6144
  ds_write_b128 v212, v[56:59] offset:45056
  s_waitcnt lgkmcnt(10)
  v_mfma_f32_16x16x32_bf16 v[84:87], v[36:39], a[12:15], v[84:87]
  v_mfma_f32_16x16x32_bf16 v[92:95], v[36:39], a[92:95], v[92:95]
  v_mfma_f32_16x16x32_bf16 v[100:103], v[36:39], a[172:175], v[100:103]
  ds_read_b128 v[28:31], v211 offset:26624
  ds_write_b128 v212, v[60:63] offset:46080
  s_waitcnt lgkmcnt(11)
  v_mfma_f32_16x16x32_bf16 v[80:83], v[8:11], a[16:19], v[80:83]
  v_mfma_f32_16x16x32_bf16 v[88:91], v[8:11], a[96:99], v[88:91]
  v_mfma_f32_16x16x32_bf16 v[96:99], v[8:11], a[176:179], v[96:99]
  ds_read_b128 v[32:35], v211 offset:7168
  ds_write_b128 v212, v[64:67] offset:47104
  s_waitcnt lgkmcnt(11)
  v_mfma_f32_16x16x32_bf16 v[84:87], v[12:15], a[16:19], v[84:87]
  v_mfma_f32_16x16x32_bf16 v[92:95], v[12:15], a[96:99], v[92:95]
  v_mfma_f32_16x16x32_bf16 v[100:103], v[12:15], a[176:179], v[100:103]
  ds_read_b128 v[36:39], v211 offset:27648
  ds_write_b128 v212, v[68:71] offset:48128
  s_waitcnt lgkmcnt(11)
  v_mfma_f32_16x16x32_bf16 v[80:83], v[16:19], a[20:23], v[80:83]
  v_mfma_f32_16x16x32_bf16 v[88:91], v[16:19], a[100:103], v[88:91]
  v_mfma_f32_16x16x32_bf16 v[96:99], v[16:19], a[180:183], v[96:99]
  ds_read_b128 v[8:11], v211 offset:8192
  ds_write_b128 v212, v[72:75] offset:49152
  s_waitcnt lgkmcnt(11)
  v_mfma_f32_16x16x32_bf16 v[84:87], v[20:23], a[20:23], v[84:87]
  v_mfma_f32_16x16x32_bf16 v[92:95], v[20:23], a[100:103], v[92:95]
  v_mfma_f32_16x16x32_bf16 v[100:103], v[20:23], a[180:183], v[100:103]
  ds_read_b128 v[12:15], v211 offset:28672
  ds_write_b128 v212, v[76:79] offset:50176
  s_waitcnt lgkmcnt(11)
  v_mfma_f32_16x16x32_bf16 v[80:83], v[24:27], a[24:27], v[80:83]
  v_mfma_f32_16x16x32_bf16 v[88:91], v[24:27], a[104:107], v[88:91]
  v_mfma_f32_16x16x32_bf16 v[96:99], v[24:27], a[184:187], v[96:99]
  ds_read_b128 v[16:19], v211 offset:9216
  s_waitcnt lgkmcnt(1)
  buffer_load_dwordx4 v[40:43], v200, s[4:7], s31 offen offset:0
  v_mfma_f32_16x16x32_bf16 v[84:87], v[28:31], a[24:27], v[84:87]
  v_mfma_f32_16x16x32_bf16 v[92:95], v[28:31], a[104:107], v[92:95]
  v_mfma_f32_16x16x32_bf16 v[100:103], v[28:31], a[184:187], v[100:103]
  ds_read_b128 v[20:23], v211 offset:29696
  buffer_load_dwordx4 v[44:47], v200, s[4:7], s31 offen offset:1024
  v_mfma_f32_16x16x32_bf16 v[80:83], v[32:35], a[28:31], v[80:83]
  v_mfma_f32_16x16x32_bf16 v[88:91], v[32:35], a[108:111], v[88:91]
  v_mfma_f32_16x16x32_bf16 v[96:99], v[32:35], a[188:191], v[96:99]
  ds_read_b128 v[24:27], v211 offset:10240
  buffer_load_dwordx4 v[48:51], v200, s[4:7], s31 offen offset:2048
  v_mfma_f32_16x16x32_bf16 v[84:87], v[36:39], a[28:31], v[84:87]
  v_mfma_f32_16x16x32_bf16 v[92:95], v[36:39], a[108:111], v[92:95]
  v_mfma_f32_16x16x32_bf16 v[100:103], v[36:39], a[188:191], v[100:103]
  ds_read_b128 v[28:31], v211 offset:30720
  buffer_load_dwordx4 v[52:55], v200, s[4:7], s31 offen offset:3072
  v_mfma_f32_16x16x32_bf16 v[80:83], v[8:11], a[32:35], v[80:83]
  v_mfma_f32_16x16x32_bf16 v[88:91], v[8:11], a[112:115], v[88:91]
  v_mfma_f32_16x16x32_bf16 v[96:99], v[8:11], a[192:195], v[96:99]
  ds_read_b128 v[32:35], v211 offset:11264
  s_add_u32 s31, s31, 4096
  buffer_load_dwordx4 v[56:59], v200, s[4:7], s31 offen offset:0
  v_mfma_f32_16x16x32_bf16 v[84:87], v[12:15], a[32:35], v[84:87]
  v_mfma_f32_16x16x32_bf16 v[92:95], v[12:15], a[112:115], v[92:95]
  v_mfma_f32_16x16x32_bf16 v[100:103], v[12:15], a[192:195], v[100:103]
  ds_read_b128 v[36:39], v211 offset:31744
  buffer_load_dwordx4 v[60:63], v200, s[4:7], s31 offen offset:1024
  s_waitcnt lgkmcnt(5)
  v_mfma_f32_16x16x32_bf16 v[80:83], v[16:19], a[36:39], v[80:83]
  v_mfma_f32_16x16x32_bf16 v[88:91], v[16:19], a[116:119], v[88:91]
  v_mfma_f32_16x16x32_bf16 v[96:99], v[16:19], a[196:199], v[96:99]
  ds_read_b128 v[8:11], v211 offset:12288
  buffer_load_dwordx4 v[64:67], v200, s[4:7], s31 offen offset:2048
  s_waitcnt lgkmcnt(5)
  v_mfma_f32_16x16x32_bf16 v[84:87], v[20:23], a[36:39], v[84:87]
  v_mfma_f32_16x16x32_bf16 v[92:95], v[20:23], a[116:119], v[92:95]
  v_mfma_f32_16x16x32_bf16 v[100:103], v[20:23], a[196:199], v[100:103]
  ds_read_b128 v[12:15], v211 offset:32768
  buffer_load_dwordx4 v[68:71], v200, s[4:7], s31 offen offset:3072
  s_waitcnt lgkmcnt(5)
  v_mfma_f32_16x16x32_bf16 v[80:83], v[24:27], a[40:43], v[80:83]
  v_mfma_f32_16x16x32_bf16 v[88:91], v[24:27], a[120:123], v[88:91]
  v_mfma_f32_16x16x32_bf16 v[96:99], v[24:27], a[200:203], v[96:99]
  ds_read_b128 v[16:19], v211 offset:13312
  s_add_u32 s31, s31, 4096
  buffer_load_dwordx4 v[72:75], v200, s[4:7], s31 offen offset:0
  s_waitcnt lgkmcnt(5)
  v_mfma_f32_16x16x32_bf16 v[84:87], v[28:31], a[40:43], v[84:87]
  v_mfma_f32_16x16x32_bf16 v[92:95], v[28:31], a[120:123], v[92:95]
  v_mfma_f32_16x16x32_bf16 v[100:103], v[28:31], a[200:203], v[100:103]
  ds_read_b128 v[20:23], v211 offset:33792
  buffer_load_dwordx4 v[76:79], v200, s[4:7], s31 offen offset:1024
  s_add_u32 s31, s31, 32768
  s_waitcnt lgkmcnt(5)
  v_mfma_f32_16x16x32_bf16 v[80:83], v[32:35], a[44:47], v[80:83]
  v_mfma_f32_16x16x32_bf16 v[88:91], v[32:35], a[124:127], v[88:91]
  v_mfma_f32_16x16x32_bf16 v[96:99], v[32:35], a[204:207], v[96:99]
  ds_read_b128 v[24:27], v211 offset:14336
  s_waitcnt lgkmcnt(5)
  v_mfma_f32_16x16x32_bf16 v[84:87], v[36:39], a[44:47], v[84:87]
  v_mfma_f32_16x16x32_bf16 v[92:95], v[36:39], a[124:127], v[92:95]
  v_mfma_f32_16x16x32_bf16 v[100:103], v[36:39], a[204:207], v[100:103]
  ds_read_b128 v[28:31], v211 offset:34816
  s_waitcnt lgkmcnt(5)
  v_mfma_f32_16x16x32_bf16 v[80:83], v[8:11], a[48:51], v[80:83]
  v_mfma_f32_16x16x32_bf16 v[88:91], v[8:11], a[128:131], v[88:91]
  v_mfma_f32_16x16x32_bf16 v[96:99], v[8:11], a[208:211], v[96:99]
  ds_read_b128 v[32:35], v211 offset:15360
  s_waitcnt lgkmcnt(5)
  v_mfma_f32_16x16x32_bf16 v[84:87], v[12:15], a[48:51], v[84:87]
  v_mfma_f32_16x16x32_bf16 v[92:95], v[12:15], a[128:131], v[92:95]
  v_mfma_f32_16x16x32_bf16 v[100:103], v[12:15], a[208:211], v[100:103]
  ds_read_b128 v[36:39], v211 offset:35840
  s_waitcnt lgkmcnt(5)
  v_mfma_f32_16x16x32_bf16 v[80:83], v[16:19], a[52:55], v[80:83]
  v_mfma_f32_16x16x32_bf16 v[88:91], v[16:19], a[132:135], v[88:91]
  v_mfma_f32_16x16x32_bf16 v[96:99], v[16:19], a[212:215], v[96:99]
  ds_read_b128 v[8:11], v211 offset:16384
  s_waitcnt lgkmcnt(5)
  v_mfma_f32_16x16x32_bf16 v[84:87], v[20:23], a[52:55], v[84:87]
  v_mfma_f32_16x16x32_bf16 v[92:95], v[20:23], a[132:135], v[92:95]
  v_mfma_f32_16x16x32_bf16 v[100:103], v[20:23], a[212:215], v[100:103]
  ds_read_b128 v[12:15], v211 offset:36864
  s_waitcnt lgkmcnt(5)
  v_mfma_f32_16x16x32_bf16 v[80:83], v[24:27], a[56:59], v[80:83]
  v_mfma_f32_16x16x32_bf16 v[88:91], v[24:27], a[136:139], v[88:91]
  v_mfma_f32_16x16x32_bf16 v[96:99], v[24:27], a[216:219], v[96:99]
  ds_read_b128 v[16:19], v211 offset:17408
  s_waitcnt lgkmcnt(5)
  v_mfma_f32_16x16x32_bf16 v[84:87], v[28:31], a[56:59], v[84:87]
  v_mfma_f32_16x16x32_bf16 v[92:95], v[28:31], a[136:139], v[92:95]
  v_mfma_f32_16x16x32_bf16 v[100:103], v[28:31], a[216:219], v[100:103]
  ds_read_b128 v[20:23], v211 offset:37888
  s_waitcnt lgkmcnt(5)
  v_mfma_f32_16x16x32_bf16 v[80:83], v[32:35], a[60:63], v[80:83]
  v_mfma_f32_16x16x32_bf16 v[88:91], v[32:35], a[140:143], v[88:91]
  v_mfma_f32_16x16x32_bf16 v[96:99], v[32:35], a[220:223], v[96:99]
  ds_read_b128 v[24:27], v211 offset:18432
  s_waitcnt lgkmcnt(5)
  v_mfma_f32_16x16x32_bf16 v[84:87], v[36:39], a[60:63], v[84:87]
  v_mfma_f32_16x16x32_bf16 v[92:95], v[36:39], a[140:143], v[92:95]
  v_mfma_f32_16x16x32_bf16 v[100:103], v[36:39], a[220:223], v[100:103]
  ds_read_b128 v[28:31], v211 offset:38912
  s_waitcnt lgkmcnt(5)
  v_mfma_f32_16x16x32_bf16 v[80:83], v[8:11], a[64:67], v[80:83]
  v_mfma_f32_16x16x32_bf16 v[88:91], v[8:11], a[144:147], v[88:91]
  v_mfma_f32_16x16x32_bf16 v[96:99], v[8:11], a[224:227], v[96:99]
  ds_read_b128 v[32:35], v211 offset:19456
  s_waitcnt lgkmcnt(5)
  v_mfma_f32_16x16x32_bf16 v[84:87], v[12:15], a[64:67], v[84:87]
  v_mfma_f32_16x16x32_bf16 v[92:95], v[12:15], a[144:147], v[92:95]
  v_mfma_f32_16x16x32_bf16 v[100:103], v[12:15], a[224:227], v[100:103]
  ds_read_b128 v[36:39], v211 offset:39936
  s_waitcnt lgkmcnt(5)
  v_mfma_f32_16x16x32_bf16 v[80:83], v[16:19], a[68:71], v[80:83]
  v_mfma_f32_16x16x32_bf16 v[88:91], v[16:19], a[148:151], v[88:91]
  v_mfma_f32_16x16x32_bf16 v[96:99], v[16:19], a[228:231], v[96:99]
  s_waitcnt lgkmcnt(4)
  v_mfma_f32_16x16x32_bf16 v[84:87], v[20:23], a[68:71], v[84:87]
  v_mfma_f32_16x16x32_bf16 v[92:95], v[20:23], a[148:151], v[92:95]
  v_mfma_f32_16x16x32_bf16 v[100:103], v[20:23], a[228:231], v[100:103]
  s_waitcnt lgkmcnt(3)
  v_mfma_f32_16x16x32_bf16 v[80:83], v[24:27], a[72:75], v[80:83]
  v_mfma_f32_16x16x32_bf16 v[88:91], v[24:27], a[152:155], v[88:91]
  v_mfma_f32_16x16x32_bf16 v[96:99], v[24:27], a[232:235], v[96:99]
  s_waitcnt lgkmcnt(2)
  v_mfma_f32_16x16x32_bf16 v[84:87], v[28:31], a[72:75], v[84:87]
  v_mfma_f32_16x16x32_bf16 v[92:95], v[28:31], a[152:155], v[92:95]
  v_mfma_f32_16x16x32_bf16 v[100:103], v[28:31], a[232:235], v[100:103]
  s_waitcnt lgkmcnt(1)
  v_mfma_f32_16x16x32_bf16 v[80:83], v[32:35], a[76:79], v[80:83]
  v_mfma_f32_16x16x32_bf16 v[88:91], v[32:35], a[156:159], v[88:91]
  v_mfma_f32_16x16x32_bf16 v[96:99], v[32:35], a[236:239], v[96:99]
  s_waitcnt lgkmcnt(0)
  v_mfma_f32_16x16x32_bf16 v[84:87], v[36:39], a[76:79], v[84:87]
  v_mfma_f32_16x16x32_bf16 v[92:95], v[36:39], a[156:159], v[92:95]
  v_mfma_f32_16x16x32_bf16 v[100:103], v[36:39], a[236:239], v[100:103]
  s_cmp_lt_u32 s30, 2
  s_cbranch_scc1 L_x1nfV0_fx
  buffer_store_dword v205, v204, s[4:7], s33 offen
  s_add_u32 s33, s33, 64
  s_branch L_x1eV0_fx
L_x1nfV0_fx:
  buffer_store_dword v205, v210, s[4:7], s33 offen
L_x1eV0_fx:
  s_nop 4
  v_cvt_pk_bf16_f32 v128, v80, v81
  v_cvt_pk_bf16_f32 v129, v82, v83
  v_cvt_pk_bf16_f32 v130, v84, v85
  v_cvt_pk_bf16_f32 v131, v86, v87
  v_cvt_pk_bf16_f32 v132, v88, v89
  v_cvt_pk_bf16_f32 v133, v90, v91
  v_cvt_pk_bf16_f32 v134, v92, v93
  v_cvt_pk_bf16_f32 v135, v94, v95
  v_cvt_pk_bf16_f32 v136, v96, v97
  v_cvt_pk_bf16_f32 v137, v98, v99
  v_cvt_pk_bf16_f32 v138, v100, v101
  v_cvt_pk_bf16_f32 v139, v102, v103
  buffer_store_dwordx4 v[128:131], v213, s[4:7], s32 offen offset:0
  buffer_store_dwordx4 v[132:135], v213, s[4:7], s32 offen offset:1024
  buffer_store_dwordx4 v[136:139], v213, s[4:7], s32 offen offset:2048
  s_add_u32 s32, s32, 24576
  s_cmp_ge_u32 s30, 2
  s_cbranch_scc1 L_x1efV0_fx
  s_waitcnt vmcnt(0)
  buffer_store_dword v205, v204, s[4:7], s33 offen offset:0
L_x1efV0_fx:
  s_add_u32 s30, s30, 1
  s_waitcnt lgkmcnt(0)
  s_barrier
  ds_read_b128 v[8:11], v211 offset:40960
  ds_read_b128 v[12:15], v211 offset:61440
  ds_read_b128 v[16:19], v211 offset:41984
  ds_read_b128 v[20:23], v211 offset:62464
  ds_read_b128 v[24:27], v211 offset:43008
  ds_read_b128 v[28:31], v211 offset:63488
  s_waitcnt lgkmcnt(5)
  v_mfma_f32_16x16x32_bf16 v[104:107], v[8:11], a[0:3], 0
  v_mfma_f32_16x16x32_bf16 v[112:115], v[8:11], a[80:83], 0
  v_mfma_f32_16x16x32_bf16 v[120:123], v[8:11], a[160:163], 0
  ds_read_b128 v[32:35], v211 offset:44032
  s_waitcnt lgkmcnt(5)
  v_mfma_f32_16x16x32_bf16 v[108:111], v[12:15], a[0:3], 0
  v_mfma_f32_16x16x32_bf16 v[116:119], v[12:15], a[80:83], 0
  v_mfma_f32_16x16x32_bf16 v[124:127], v[12:15], a[160:163], 0
  ds_read_b128 v[36:39], v211 offset:64512
  s_waitcnt lgkmcnt(5)
  v_mfma_f32_16x16x32_bf16 v[104:107], v[16:19], a[4:7], v[104:107]
  v_mfma_f32_16x16x32_bf16 v[112:115], v[16:19], a[84:87], v[112:115]
  v_mfma_f32_16x16x32_bf16 v[120:123], v[16:19], a[164:167], v[120:123]
  ds_read_b128 v[8:11], v211 offset:45056
  s_waitcnt vmcnt(4)
  ds_write_b128 v212, v[40:43] offset:0
  s_waitcnt lgkmcnt(6)
  v_mfma_f32_16x16x32_bf16 v[108:111], v[20:23], a[4:7], v[108:111]
  v_mfma_f32_16x16x32_bf16 v[116:119], v[20:23], a[84:87], v[116:119]
  v_mfma_f32_16x16x32_bf16 v[124:127], v[20:23], a[164:167], v[124:127]
  ds_read_b128 v[12:15], v219 offset:24576
  ds_write_b128 v212, v[44:47] offset:1024
  s_waitcnt lgkmcnt(7)
  v_mfma_f32_16x16x32_bf16 v[104:107], v[24:27], a[8:11], v[104:107]
  v_mfma_f32_16x16x32_bf16 v[112:115], v[24:27], a[88:91], v[112:115]
  v_mfma_f32_16x16x32_bf16 v[120:123], v[24:27], a[168:171], v[120:123]
  ds_read_b128 v[16:19], v211 offset:46080
  ds_write_b128 v212, v[48:51] offset:2048
  s_waitcnt lgkmcnt(8)
  v_mfma_f32_16x16x32_bf16 v[108:111], v[28:31], a[8:11], v[108:111]
  v_mfma_f32_16x16x32_bf16 v[116:119], v[28:31], a[88:91], v[116:119]
  v_mfma_f32_16x16x32_bf16 v[124:127], v[28:31], a[168:171], v[124:127]
  ds_read_b128 v[20:23], v219 offset:25600
  ds_write_b128 v212, v[52:55] offset:3072
  s_waitcnt lgkmcnt(9)
  v_mfma_f32_16x16x32_bf16 v[104:107], v[32:35], a[12:15], v[104:107]
  v_mfma_f32_16x16x32_bf16 v[112:115], v[32:35], a[92:95], v[112:115]
  v_mfma_f32_16x16x32_bf16 v[120:123], v[32:35], a[172:175], v[120:123]
  ds_read_b128 v[24:27], v211 offset:47104
  ds_write_b128 v212, v[56:59] offset:4096
  s_waitcnt lgkmcnt(10)
  v_mfma_f32_16x16x32_bf16 v[108:111], v[36:39], a[12:15], v[108:111]
  v_mfma_f32_16x16x32_bf16 v[116:119], v[36:39], a[92:95], v[116:119]
  v_mfma_f32_16x16x32_bf16 v[124:127], v[36:39], a[172:175], v[124:127]
  ds_read_b128 v[28:31], v219 offset:26624
  ds_write_b128 v212, v[60:63] offset:5120
  s_waitcnt lgkmcnt(11)
  v_mfma_f32_16x16x32_bf16 v[104:107], v[8:11], a[16:19], v[104:107]
  v_mfma_f32_16x16x32_bf16 v[112:115], v[8:11], a[96:99], v[112:115]
  v_mfma_f32_16x16x32_bf16 v[120:123], v[8:11], a[176:179], v[120:123]
  ds_read_b128 v[32:35], v211 offset:48128
  ds_write_b128 v212, v[64:67] offset:6144
  s_waitcnt lgkmcnt(11)
  v_mfma_f32_16x16x32_bf16 v[108:111], v[12:15], a[16:19], v[108:111]
  v_mfma_f32_16x16x32_bf16 v[116:119], v[12:15], a[96:99], v[116:119]
  v_mfma_f32_16x16x32_bf16 v[124:127], v[12:15], a[176:179], v[124:127]
  ds_read_b128 v[36:39], v219 offset:27648
  ds_write_b128 v212, v[68:71] offset:7168
  s_waitcnt lgkmcnt(11)
  v_mfma_f32_16x16x32_bf16 v[104:107], v[16:19], a[20:23], v[104:107]
  v_mfma_f32_16x16x32_bf16 v[112:115], v[16:19], a[100:103], v[112:115]
  v_mfma_f32_16x16x32_bf16 v[120:123], v[16:19], a[180:183], v[120:123]
  ds_read_b128 v[8:11], v211 offset:49152
  ds_write_b128 v212, v[72:75] offset:8192
  s_waitcnt lgkmcnt(11)
  v_mfma_f32_16x16x32_bf16 v[108:111], v[20:23], a[20:23], v[108:111]
  v_mfma_f32_16x16x32_bf16 v[116:119], v[20:23], a[100:103], v[116:119]
  v_mfma_f32_16x16x32_bf16 v[124:127], v[20:23], a[180:183], v[124:127]
  ds_read_b128 v[12:15], v219 offset:28672
  ds_write_b128 v212, v[76:79] offset:9216
  s_waitcnt lgkmcnt(11)
  v_mfma_f32_16x16x32_bf16 v[104:107], v[24:27], a[24:27], v[104:107]
  v_mfma_f32_16x16x32_bf16 v[112:115], v[24:27], a[104:107], v[112:115]
  v_mfma_f32_16x16x32_bf16 v[120:123], v[24:27], a[184:187], v[120:123]
  ds_read_b128 v[16:19], v211 offset:50176
  s_waitcnt lgkmcnt(1)
  buffer_load_dwordx4 v[40:43], v200, s[4:7], s31 offen offset:0
  v_mfma_f32_16x16x32_bf16 v[108:111], v[28:31], a[24:27], v[108:111]
  v_mfma_f32_16x16x32_bf16 v[116:119], v[28:31], a[104:107], v[116:119]
  v_mfma_f32_16x16x32_bf16 v[124:127], v[28:31], a[184:187], v[124:127]
  ds_read_b128 v[20:23], v219 offset:29696
  buffer_load_dwordx4 v[44:47], v200, s[4:7], s31 offen offset:1024
  v_mfma_f32_16x16x32_bf16 v[104:107], v[32:35], a[28:31], v[104:107]
  v_mfma_f32_16x16x32_bf16 v[112:115], v[32:35], a[108:111], v[112:115]
  v_mfma_f32_16x16x32_bf16 v[120:123], v[32:35], a[188:191], v[120:123]
  ds_read_b128 v[24:27], v211 offset:51200
  buffer_load_dwordx4 v[48:51], v200, s[4:7], s31 offen offset:2048
  v_mfma_f32_16x16x32_bf16 v[108:111], v[36:39], a[28:31], v[108:111]
  v_mfma_f32_16x16x32_bf16 v[116:119], v[36:39], a[108:111], v[116:119]
  v_mfma_f32_16x16x32_bf16 v[124:127], v[36:39], a[188:191], v[124:127]
  ds_read_b128 v[28:31], v219 offset:30720
  buffer_load_dwordx4 v[52:55], v200, s[4:7], s31 offen offset:3072
  v_mfma_f32_16x16x32_bf16 v[104:107], v[8:11], a[32:35], v[104:107]
  v_mfma_f32_16x16x32_bf16 v[112:115], v[8:11], a[112:115], v[112:115]
  v_mfma_f32_16x16x32_bf16 v[120:123], v[8:11], a[192:195], v[120:123]
  ds_read_b128 v[32:35], v211 offset:52224
  s_add_u32 s31, s31, 4096
  buffer_load_dwordx4 v[56:59], v200, s[4:7], s31 offen offset:0
  v_mfma_f32_16x16x32_bf16 v[108:111], v[12:15], a[32:35], v[108:111]
  v_mfma_f32_16x16x32_bf16 v[116:119], v[12:15], a[112:115], v[116:119]
  v_mfma_f32_16x16x32_bf16 v[124:127], v[12:15], a[192:195], v[124:127]
  ds_read_b128 v[36:39], v219 offset:31744
  buffer_load_dwordx4 v[60:63], v200, s[4:7], s31 offen offset:1024
  s_waitcnt lgkmcnt(5)
  v_mfma_f32_16x16x32_bf16 v[104:107], v[16:19], a[36:39], v[104:107]
  v_mfma_f32_16x16x32_bf16 v[112:115], v[16:19], a[116:119], v[112:115]
  v_mfma_f32_16x16x32_bf16 v[120:123], v[16:19], a[196:199], v[120:123]
  ds_read_b128 v[8:11], v211 offset:53248
  buffer_load_dwordx4 v[64:67], v200, s[4:7], s31 offen offset:2048
  s_waitcnt lgkmcnt(5)
  v_mfma_f32_16x16x32_bf16 v[108:111], v[20:23], a[36:39], v[108:111]
  v_mfma_f32_16x16x32_bf16 v[116:119], v[20:23], a[116:119], v[116:119]
  v_mfma_f32_16x16x32_bf16 v[124:127], v[20:23], a[196:199], v[124:127]
  ds_read_b128 v[12:15], v219 offset:32768
  buffer_load_dwordx4 v[68:71], v200, s[4:7], s31 offen offset:3072
  s_waitcnt lgkmcnt(5)
  v_mfma_f32_16x16x32_bf16 v[104:107], v[24:27], a[40:43], v[104:107]
  v_mfma_f32_16x16x32_bf16 v[112:115], v[24:27], a[120:123], v[112:115]
  v_mfma_f32_16x16x32_bf16 v[120:123], v[24:27], a[200:203], v[120:123]
  ds_read_b128 v[16:19], v211 offset:54272
  s_add_u32 s31, s31, 4096
  buffer_load_dwordx4 v[72:75], v200, s[4:7], s31 offen offset:0
  s_waitcnt lgkmcnt(5)
  v_mfma_f32_16x16x32_bf16 v[108:111], v[28:31], a[40:43], v[108:111]
  v_mfma_f32_16x16x32_bf16 v[116:119], v[28:31], a[120:123], v[116:119]
  v_mfma_f32_16x16x32_bf16 v[124:127], v[28:31], a[200:203], v[124:127]
  ds_read_b128 v[20:23], v219 offset:33792
  buffer_load_dwordx4 v[76:79], v200, s[4:7], s31 offen offset:1024
  s_add_u32 s31, s31, 32768
  s_waitcnt lgkmcnt(5)
  v_mfma_f32_16x16x32_bf16 v[104:107], v[32:35], a[44:47], v[104:107]
  v_mfma_f32_16x16x32_bf16 v[112:115], v[32:35], a[124:127], v[112:115]
  v_mfma_f32_16x16x32_bf16 v[120:123], v[32:35], a[204:207], v[120:123]
  ds_read_b128 v[24:27], v211 offset:55296
  s_waitcnt lgkmcnt(5)
  v_mfma_f32_16x16x32_bf16 v[108:111], v[36:39], a[44:47], v[108:111]
  v_mfma_f32_16x16x32_bf16 v[116:119], v[36:39], a[124:127], v[116:119]
  v_mfma_f32_16x16x32_bf16 v[124:127], v[36:39], a[204:207], v[124:127]
  ds_read_b128 v[28:31], v219 offset:34816
  s_waitcnt lgkmcnt(5)
  v_mfma_f32_16x16x32_bf16 v[104:107], v[8:11], a[48:51], v[104:107]
  v_mfma_f32_16x16x32_bf16 v[112:115], v[8:11], a[128:131], v[112:115]
  v_mfma_f32_16x16x32_bf16 v[120:123], v[8:11], a[208:211], v[120:123]
  ds_read_b128 v[32:35], v211 offset:56320
  s_waitcnt lgkmcnt(5)
  v_mfma_f32_16x16x32_bf16 v[108:111], v[12:15], a[48:51], v[108:111]
  v_mfma_f32_16x16x32_bf16 v[116:119], v[12:15], a[128:131], v[116:119]
  v_mfma_f32_16x16x32_bf16 v[124:127], v[12:15], a[208:211], v[124:127]
  ds_read_b128 v[36:39], v219 offset:35840
  s_waitcnt lgkmcnt(5)
  v_mfma_f32_16x16x32_bf16 v[104:107], v[16:19], a[52:55], v[104:107]
  v_mfma_f32_16x16x32_bf16 v[112:115], v[16:19], a[132:135], v[112:115]
  v_mfma_f32_16x16x32_bf16 v[120:123], v[16:19], a[212:215], v[120:123]
  ds_read_b128 v[8:11], v211 offset:57344
  s_waitcnt lgkmcnt(5)
  v_mfma_f32_16x16x32_bf16 v[108:111], v[20:23], a[52:55], v[108:111]
  v_mfma_f32_16x16x32_bf16 v[116:119], v[20:23], a[132:135], v[116:119]
  v_mfma_f32_16x16x32_bf16 v[124:127], v[20:23], a[212:215], v[124:127]
  ds_read_b128 v[12:15], v219 offset:36864
  s_waitcnt lgkmcnt(5)
  v_mfma_f32_16x16x32_bf16 v[104:107], v[24:27], a[56:59], v[104:107]
  v_mfma_f32_16x16x32_bf16 v[112:115], v[24:27], a[136:139], v[112:115]
  v_mfma_f32_16x16x32_bf16 v[120:123], v[24:27], a[216:219], v[120:123]
  ds_read_b128 v[16:19], v211 offset:58368
  s_waitcnt lgkmcnt(5)
  v_mfma_f32_16x16x32_bf16 v[108:111], v[28:31], a[56:59], v[108:111]
  v_mfma_f32_16x16x32_bf16 v[116:119], v[28:31], a[136:139], v[116:119]
  v_mfma_f32_16x16x32_bf16 v[124:127], v[28:31], a[216:219], v[124:127]
  ds_read_b128 v[20:23], v219 offset:37888
  s_waitcnt lgkmcnt(5)
  v_mfma_f32_16x16x32_bf16 v[104:107], v[32:35], a[60:63], v[104:107]
  v_mfma_f32_16x16x32_bf16 v[112:115], v[32:35], a[140:143], v[112:115]
  v_mfma_f32_16x16x32_bf16 v[120:123], v[32:35], a[220:223], v[120:123]
  ds_read_b128 v[24:27], v211 offset:59392
  s_waitcnt lgkmcnt(5)
  v_mfma_f32_16x16x32_bf16 v[108:111], v[36:39], a[60:63], v[108:111]
  v_mfma_f32_16x16x32_bf16 v[116:119], v[36:39], a[140:143], v[116:119]
  v_mfma_f32_16x16x32_bf16 v[124:127], v[36:39], a[220:223], v[124:127]
  ds_read_b128 v[28:31], v219 offset:38912
  s_waitcnt lgkmcnt(5)
  v_mfma_f32_16x16x32_bf16 v[104:107], v[8:11], a[64:67], v[104:107]
  v_mfma_f32_16x16x32_bf16 v[112:115], v[8:11], a[144:147], v[112:115]
  v_mfma_f32_16x16x32_bf16 v[120:123], v[8:11], a[224:227], v[120:123]
  ds_read_b128 v[32:35], v211 offset:60416
  s_waitcnt lgkmcnt(5)
  v_mfma_f32_16x16x32_bf16 v[108:111], v[12:15], a[64:67], v[108:111]
  v_mfma_f32_16x16x32_bf16 v[116:119], v[12:15], a[144:147], v[116:119]
  v_mfma_f32_16x16x32_bf16 v[124:127], v[12:15], a[224:227], v[124:127]
  ds_read_b128 v[36:39], v219 offset:39936
  s_waitcnt lgkmcnt(5)
  v_mfma_f32_16x16x32_bf16 v[104:107], v[16:19], a[68:71], v[104:107]
  v_mfma_f32_16x16x32_bf16 v[112:115], v[16:19], a[148:151], v[112:115]
  v_mfma_f32_16x16x32_bf16 v[120:123], v[16:19], a[228:231], v[120:123]
  s_waitcnt lgkmcnt(4)
  v_mfma_f32_16x16x32_bf16 v[108:111], v[20:23], a[68:71], v[108:111]
  v_mfma_f32_16x16x32_bf16 v[116:119], v[20:23], a[148:151], v[116:119]
  v_mfma_f32_16x16x32_bf16 v[124:127], v[20:23], a[228:231], v[124:127]
  s_waitcnt lgkmcnt(3)
  v_mfma_f32_16x16x32_bf16 v[104:107], v[24:27], a[72:75], v[104:107]
  v_mfma_f32_16x16x32_bf16 v[112:115], v[24:27], a[152:155], v[112:115]
  v_mfma_f32_16x16x32_bf16 v[120:123], v[24:27], a[232:235], v[120:123]
  s_waitcnt lgkmcnt(2)
  v_mfma_f32_16x16x32_bf16 v[108:111], v[28:31], a[72:75], v[108:111]
  v_mfma_f32_16x16x32_bf16 v[116:119], v[28:31], a[152:155], v[116:119]
  v_mfma_f32_16x16x32_bf16 v[124:127], v[28:31], a[232:235], v[124:127]
  s_waitcnt lgkmcnt(1)
  v_mfma_f32_16x16x32_bf16 v[104:107], v[32:35], a[76:79], v[104:107]
  v_mfma_f32_16x16x32_bf16 v[112:115], v[32:35], a[156:159], v[112:115]
  v_mfma_f32_16x16x32_bf16 v[120:123], v[32:35], a[236:239], v[120:123]
  s_waitcnt lgkmcnt(0)
  v_mfma_f32_16x16x32_bf16 v[108:111], v[36:39], a[76:79], v[108:111]
  v_mfma_f32_16x16x32_bf16 v[116:119], v[36:39], a[156:159], v[116:119]
  v_mfma_f32_16x16x32_bf16 v[124:127], v[36:39], a[236:239], v[124:127]
  s_cmp_lt_u32 s30, 2
  s_cbranch_scc1 L_x1nfV1_fx
  buffer_store_dword v205, v204, s[4:7], s33 offen
  s_add_u32 s33, s33, 64
  s_branch L_x1eV1_fx
L_x1nfV1_fx:
  buffer_store_dword v205, v210, s[4:7], s33 offen
L_x1eV1_fx:
  s_nop 4
  v_cvt_pk_bf16_f32 v128, v104, v105
  v_cvt_pk_bf16_f32 v129, v106, v107
  v_cvt_pk_bf16_f32 v130, v108, v109
  v_cvt_pk_bf16_f32 v131, v110, v111
  v_cvt_pk_bf16_f32 v132, v112, v113
  v_cvt_pk_bf16_f32 v133, v114, v115
  v_cvt_pk_bf16_f32 v134, v116, v117
  v_cvt_pk_bf16_f32 v135, v118, v119
  v_cvt_pk_bf16_f32 v136, v120, v121
  v_cvt_pk_bf16_f32 v137, v122, v123
  v_cvt_pk_bf16_f32 v138, v124, v125
  v_cvt_pk_bf16_f32 v139, v126, v127
  buffer_store_dwordx4 v[128:131], v213, s[4:7], s32 offen offset:0
  buffer_store_dwordx4 v[132:135], v213, s[4:7], s32 offen offset:1024
  buffer_store_dwordx4 v[136:139], v213, s[4:7], s32 offen offset:2048
  s_add_u32 s32, s32, 24576
  s_cmp_ge_u32 s30, 2
  s_cbranch_scc1 L_x1efV1_fx
  s_waitcnt vmcnt(0)
  buffer_store_dword v205, v204, s[4:7], s33 offen offset:64
L_x1efV1_fx:
  s_add_u32 s30, s30, 1
  s_cmp_lt_u32 s30, 64
  s_cbranch_scc1 L_xlV_fx
  s_waitcnt vmcnt(0)
  buffer_store_dword v205, v204, s[4:7], s33 offen
  buffer_store_dword v205, v204, s[4:7], s33 offen offset:64
  s_branch L_x1done_fx
L_x1F_fx:
  s_mul_i32 s32, s28, 196608
  s_add_u32 s32, s32, 78118912
  v_lshlrev_b32 v213, 4, v1
  s_cmp_eq_u32 s27, 1
  s_cselect_b32 s72, 8, 0
  v_add_u32 v213, s72, v213
  v_lshlrev_b32 v4, 3, v1
  v_add_u32 v4, 1024, v4
  s_cmp_eq_u32 s27, 2
  s_cselect_b64 vcc, -1, 0
  v_cndmask_b32 v213, v213, v4, vcc
  v_add_u32 v214, 1536, v213
  s_cmp_eq_u32 s27, 3
  s_cselect_b64 vcc, -1, 0
  v_cndmask_b32 v213, v213, v210, vcc
  v_cndmask_b32 v214, v214, v210, vcc
L_xlF_fx:
  s_waitcnt lgkmcnt(0)
  s_barrier
  ds_read_b128 v[8:11], v211 offset:0
  ds_read_b128 v[12:15], v211 offset:20480
  ds_read_b128 v[16:19], v211 offset:1024
  ds_read_b128 v[20:23], v211 offset:21504
  ds_read_b128 v[24:27], v211 offset:2048
  ds_read_b128 v[28:31], v211 offset:22528
  s_waitcnt lgkmcnt(5)
  v_mfma_f32_16x16x32_bf16 v[80:83], a[0:3], v[8:11], 0
  ds_read_b128 v[32:35], v211 offset:3072
  s_waitcnt lgkmcnt(5)
  v_mfma_f32_16x16x32_bf16 v[84:87], a[0:3], v[12:15], 0
  ds_read_b128 v[36:39], v211 offset:23552
  s_waitcnt lgkmcnt(5)
  v_mfma_f32_16x16x32_bf16 v[80:83], a[4:7], v[16:19], v[80:83]
  ds_read_b128 v[8:11], v211 offset:4096
  s_waitcnt vmcnt(3)
  ds_write_b128 v212, v[40:43] offset:40960
  s_waitcnt lgkmcnt(6)
  v_mfma_f32_16x16x32_bf16 v[84:87], a[4:7], v[20:23], v[84:87]
  ds_read_b128 v[12:15], v211 offset:24576
  ds_write_b128 v212, v[44:47] offset:41984
  s_waitcnt lgkmcnt(7)
  v_mfma_f32_16x16x32_bf16 v[80:83], a[8:11], v[24:27], v[80:83]
  ds_read_b128 v[16:19], v211 offset:5120
  ds_write_b128 v212, v[48:51] offset:43008
  s_waitcnt lgkmcnt(8)
  v_mfma_f32_16x16x32_bf16 v[84:87], a[8:11], v[28:31], v[84:87]
  ds_read_b128 v[20:23], v211 offset:25600
  ds_write_b128 v212, v[52:55] offset:44032
  s_waitcnt lgkmcnt(9)
  v_mfma_f32_16x16x32_bf16 v[80:83], a[12:15], v[32:35], v[80:83]
  ds_read_b128 v[24:27], v211 offset:6144
  ds_write_b128 v212, v[56:59] offset:45056
  s_waitcnt lgkmcnt(10)
  v_mfma_f32_16x16x32_bf16 v[84:87], a[12:15], v[36:39], v[84:87]
  ds_read_b128 v[28:31], v211 offset:26624
  ds_write_b128 v212, v[60:63] offset:46080
  s_waitcnt lgkmcnt(11)
  v_mfma_f32_16x16x32_bf16 v[80:83], a[16:19], v[8:11], v[80:83]
  ds_read_b128 v[32:35], v211 offset:7168
  ds_write_b128 v212, v[64:67] offset:47104
  s_waitcnt lgkmcnt(11)
  v_mfma_f32_16x16x32_bf16 v[84:87], a[16:19], v[12:15], v[84:87]
  ds_read_b128 v[36:39], v211 offset:27648
  ds_write_b128 v212, v[68:71] offset:48128
  s_waitcnt lgkmcnt(11)
  v_mfma_f32_16x16x32_bf16 v[80:83], a[20:23], v[16:19], v[80:83]
  ds_read_b128 v[8:11], v211 offset:8192
  ds_write_b128 v212, v[72:75] offset:49152
  s_waitcnt lgkmcnt(11)
  v_mfma_f32_16x16x32_bf16 v[84:87], a[20:23], v[20:23], v[84:87]
  ds_read_b128 v[12:15], v211 offset:28672
  ds_write_b128 v212, v[76:79] offset:50176
  s_waitcnt lgkmcnt(11)
  v_mfma_f32_16x16x32_bf16 v[80:83], a[24:27], v[24:27], v[80:83]
  ds_read_b128 v[16:19], v211 offset:9216
  s_waitcnt lgkmcnt(1)
  buffer_load_dwordx4 v[40:43], v200, s[4:7], s31 offen offset:0
  v_mfma_f32_16x16x32_bf16 v[84:87], a[24:27], v[28:31], v[84:87]
  ds_read_b128 v[20:23], v211 offset:29696
  buffer_load_dwordx4 v[44:47], v200, s[4:7], s31 offen offset:1024
  v_mfma_f32_16x16x32_bf16 v[80:83], a[28:31], v[32:35], v[80:83]
  ds_read_b128 v[24:27], v211 offset:10240
  buffer_load_dwordx4 v[48:51], v200, s[4:7], s31 offen offset:2048
  v_mfma_f32_16x16x32_bf16 v[84:87], a[28:31], v[36:39], v[84:87]
  ds_read_b128 v[28:31], v211 offset:30720
  buffer_load_dwordx4 v[52:55], v200, s[4:7], s31 offen offset:3072
  v_mfma_f32_16x16x32_bf16 v[80:83], a[32:35], v[8:11], v[80:83]
  ds_read_b128 v[32:35], v211 offset:11264
  s_add_u32 s31, s31, 4096
  buffer_load_dwordx4 v[56:59], v200, s[4:7], s31 offen offset:0
  v_mfma_f32_16x16x32_bf16 v[84:87], a[32:35], v[12:15], v[84:87]
  ds_read_b128 v[36:39], v211 offset:31744
  buffer_load_dwordx4 v[60:63], v200, s[4:7], s31 offen offset:1024
  s_waitcnt lgkmcnt(5)
  v_mfma_f32_16x16x32_bf16 v[80:83], a[36:39], v[16:19], v[80:83]
  ds_read_b128 v[8:11], v211 offset:12288
  buffer_load_dwordx4 v[64:67], v200, s[4:7], s31 offen offset:2048
  s_waitcnt lgkmcnt(5)
  v_mfma_f32_16x16x32_bf16 v[84:87], a[36:39], v[20:23], v[84:87]
  ds_read_b128 v[12:15], v211 offset:32768
  buffer_load_dwordx4 v[68:71], v200, s[4:7], s31 offen offset:3072
  s_waitcnt lgkmcnt(5)
  v_mfma_f32_16x16x32_bf16 v[80:83], a[40:43], v[24:27], v[80:83]
  ds_read_b128 v[16:19], v211 offset:13312
  s_add_u32 s31, s31, 4096
  buffer_load_dwordx4 v[72:75], v200, s[4:7], s31 offen offset:0
  s_waitcnt lgkmcnt(5)
  v_mfma_f32_16x16x32_bf16 v[84:87], a[40:43], v[28:31], v[84:87]
  ds_read_b128 v[20:23], v211 offset:33792
  buffer_load_dwordx4 v[76:79], v200, s[4:7], s31 offen offset:1024
  s_add_u32 s31, s31, 32768
  s_waitcnt lgkmcnt(5)
  v_mfma_f32_16x16x32_bf16 v[80:83], a[44:47], v[32:35], v[80:83]
  ds_read_b128 v[24:27], v211 offset:14336
  s_waitcnt lgkmcnt(5)
  v_mfma_f32_16x16x32_bf16 v[84:87], a[44:47], v[36:39], v[84:87]
  ds_read_b128 v[28:31], v211 offset:34816
  s_waitcnt lgkmcnt(5)
  v_mfma_f32_16x16x32_bf16 v[80:83], a[48:51], v[8:11], v[80:83]
  ds_read_b128 v[32:35], v211 offset:15360
  s_waitcnt lgkmcnt(5)
  v_mfma_f32_16x16x32_bf16 v[84:87], a[48:51], v[12:15], v[84:87]
  ds_read_b128 v[36:39], v211 offset:35840
  s_waitcnt lgkmcnt(5)
  v_mfma_f32_16x16x32_bf16 v[80:83], a[52:55], v[16:19], v[80:83]
  ds_read_b128 v[8:11], v211 offset:16384
  s_waitcnt lgkmcnt(5)
  v_mfma_f32_16x16x32_bf16 v[84:87], a[52:55], v[20:23], v[84:87]
  ds_read_b128 v[12:15], v211 offset:36864
  s_waitcnt lgkmcnt(5)
  v_mfma_f32_16x16x32_bf16 v[80:83], a[56:59], v[24:27], v[80:83]
  ds_read_b128 v[16:19], v211 offset:17408
  s_waitcnt lgkmcnt(5)
  v_mfma_f32_16x16x32_bf16 v[84:87], a[56:59], v[28:31], v[84:87]
  ds_read_b128 v[20:23], v211 offset:37888
  s_waitcnt lgkmcnt(5)
  v_mfma_f32_16x16x32_bf16 v[80:83], a[60:63], v[32:35], v[80:83]
  ds_read_b128 v[24:27], v211 offset:18432
  s_waitcnt lgkmcnt(5)
  v_mfma_f32_16x16x32_bf16 v[84:87], a[60:63], v[36:39], v[84:87]
  ds_read_b128 v[28:31], v211 offset:38912
  s_waitcnt lgkmcnt(5)
  v_mfma_f32_16x16x32_bf16 v[80:83], a[64:67], v[8:11], v[80:83]
  ds_read_b128 v[32:35], v211 offset:19456
  s_waitcnt lgkmcnt(5)
  v_mfma_f32_16x16x32_bf16 v[84:87], a[64:67], v[12:15], v[84:87]
  ds_read_b128 v[36:39], v211 offset:39936
  s_waitcnt lgkmcnt(5)
  v_mfma_f32_16x16x32_bf16 v[80:83], a[68:71], v[16:19], v[80:83]
  s_waitcnt lgkmcnt(4)
  v_mfma_f32_16x16x32_bf16 v[84:87], a[68:71], v[20:23], v[84:87]
  s_waitcnt lgkmcnt(3)
  v_mfma_f32_16x16x32_bf16 v[80:83], a[72:75], v[24:27], v[80:83]
  s_waitcnt lgkmcnt(2)
  v_mfma_f32_16x16x32_bf16 v[84:87], a[72:75], v[28:31], v[84:87]
  s_waitcnt lgkmcnt(1)
  v_mfma_f32_16x16x32_bf16 v[80:83], a[76:79], v[32:35], v[80:83]
  s_waitcnt lgkmcnt(0)
  v_mfma_f32_16x16x32_bf16 v[84:87], a[76:79], v[36:39], v[84:87]
  s_cmp_lt_u32 s30, 2
  s_cbranch_scc1 L_x1nfF0_fx
  buffer_store_dword v205, v204, s[4:7], s33 offen
  s_add_u32 s33, s33, 64
  s_branch L_x1eF0_fx
L_x1nfF0_fx:
  buffer_store_dword v205, v210, s[4:7], s33 offen
L_x1eF0_fx:
  s_nop 4
  v_cvt_pk_bf16_f32 v128, v80, v81
  v_cvt_pk_bf16_f32 v129, v82, v83
  v_lshlrev_b32 v80, 16, v128
  v_and_b32 v81, 0xffff0000, v128
  v_lshlrev_b32 v82, 16, v129
  v_and_b32 v83, 0xffff0000, v129
  v_pk_add_f32 v[80:81], v[80:81], v[206:207]
  v_pk_add_f32 v[82:83], v[82:83], v[208:209]
  v_cvt_pk_bf16_f32 v128, v80, v81
  v_cvt_pk_bf16_f32 v129, v82, v83
  v_lshlrev_b32 v80, 16, v128
  v_and_b32 v81, 0xffff0000, v128
  v_lshlrev_b32 v82, 16, v129
  v_and_b32 v83, 0xffff0000, v129
  v_max_f32 v80, 0, v80
  v_max_f32 v81, 0, v81
  v_max_f32 v82, 0, v82
  v_max_f32 v83, 0, v83
  v_pk_mul_f32 v[80:81], v[80:81], v[80:81]
  v_pk_mul_f32 v[82:83], v[82:83], v[82:83]
  v_cvt_pk_bf16_f32 v128, v80, v81
  v_cvt_pk_bf16_f32 v129, v82, v83
  buffer_store_dwordx2 v[128:129], v213, s[4:7], s32 offen
  v_cvt_pk_bf16_f32 v130, v84, v85
  v_cvt_pk_bf16_f32 v131, v86, v87
  v_lshlrev_b32 v84, 16, v130
  v_and_b32 v85, 0xffff0000, v130
  v_lshlrev_b32 v86, 16, v131
  v_and_b32 v87, 0xffff0000, v131
  v_pk_add_f32 v[84:85], v[84:85], v[206:207]
  v_pk_add_f32 v[86:87], v[86:87], v[208:209]
  v_cvt_pk_bf16_f32 v130, v84, v85
  v_cvt_pk_bf16_f32 v131, v86, v87
  v_lshlrev_b32 v84, 16, v130
  v_and_b32 v85, 0xffff0000, v130
  v_lshlrev_b32 v86, 16, v131
  v_and_b32 v87, 0xffff0000, v131
  v_max_f32 v84, 0, v84
  v_max_f32 v85, 0, v85
  v_max_f32 v86, 0, v86
  v_max_f32 v87, 0, v87
  v_pk_mul_f32 v[84:85], v[84:85], v[84:85]
  v_pk_mul_f32 v[86:87], v[86:87], v[86:87]
  v_cvt_pk_bf16_f32 v130, v84, v85
  v_cvt_pk_bf16_f32 v131, v86, v87
  buffer_store_dwordx2 v[130:131], v214, s[4:7], s32 offen
  s_add_u32 s32, s32, 3072
  s_cmp_ge_u32 s30, 2
  s_cbranch_scc1 L_x1efF0_fx
  s_waitcnt vmcnt(0)
  buffer_store_dword v205, v204, s[4:7], s33 offen offset:0
L_x1efF0_fx:
  s_add_u32 s30, s30, 1
  s_waitcnt lgkmcnt(0)
  s_barrier
  ds_read_b128 v[8:11], v211 offset:40960
  ds_read_b128 v[12:15], v211 offset:61440
  ds_read_b128 v[16:19], v211 offset:41984
  ds_read_b128 v[20:23], v211 offset:62464
  ds_read_b128 v[24:27], v211 offset:43008
  ds_read_b128 v[28:31], v211 offset:63488
  s_waitcnt lgkmcnt(5)
  v_mfma_f32_16x16x32_bf16 v[104:107], a[0:3], v[8:11], 0
  ds_read_b128 v[32:35], v211 offset:44032
  s_waitcnt lgkmcnt(5)
  v_mfma_f32_16x16x32_bf16 v[108:111], a[0:3], v[12:15], 0
  ds_read_b128 v[36:39], v211 offset:64512
  s_waitcnt lgkmcnt(5)
  v_mfma_f32_16x16x32_bf16 v[104:107], a[4:7], v[16:19], v[104:107]
  ds_read_b128 v[8:11], v211 offset:45056
  s_waitcnt vmcnt(3)
  ds_write_b128 v212, v[40:43] offset:0
  s_waitcnt lgkmcnt(6)
  v_mfma_f32_16x16x32_bf16 v[108:111], a[4:7], v[20:23], v[108:111]
  ds_read_b128 v[12:15], v219 offset:24576
  ds_write_b128 v212, v[44:47] offset:1024
  s_waitcnt lgkmcnt(7)
  v_mfma_f32_16x16x32_bf16 v[104:107], a[8:11], v[24:27], v[104:107]
  ds_read_b128 v[16:19], v211 offset:46080
  ds_write_b128 v212, v[48:51] offset:2048
  s_waitcnt lgkmcnt(8)
  v_mfma_f32_16x16x32_bf16 v[108:111], a[8:11], v[28:31], v[108:111]
  ds_read_b128 v[20:23], v219 offset:25600
  ds_write_b128 v212, v[52:55] offset:3072
  s_waitcnt lgkmcnt(9)
  v_mfma_f32_16x16x32_bf16 v[104:107], a[12:15], v[32:35], v[104:107]
  ds_read_b128 v[24:27], v211 offset:47104
  ds_write_b128 v212, v[56:59] offset:4096
  s_waitcnt lgkmcnt(10)
  v_mfma_f32_16x16x32_bf16 v[108:111], a[12:15], v[36:39], v[108:111]
  ds_read_b128 v[28:31], v219 offset:26624
  ds_write_b128 v212, v[60:63] offset:5120
  s_waitcnt lgkmcnt(11)
  v_mfma_f32_16x16x32_bf16 v[104:107], a[16:19], v[8:11], v[104:107]
  ds_read_b128 v[32:35], v211 offset:48128
  ds_write_b128 v212, v[64:67] offset:6144
  s_waitcnt lgkmcnt(11)
  v_mfma_f32_16x16x32_bf16 v[108:111], a[16:19], v[12:15], v[108:111]
  ds_read_b128 v[36:39], v219 offset:27648
  ds_write_b128 v212, v[68:71] offset:7168
  s_waitcnt lgkmcnt(11)
  v_mfma_f32_16x16x32_bf16 v[104:107], a[20:23], v[16:19], v[104:107]
  ds_read_b128 v[8:11], v211 offset:49152
  ds_write_b128 v212, v[72:75] offset:8192
  s_waitcnt lgkmcnt(11)
  v_mfma_f32_16x16x32_bf16 v[108:111], a[20:23], v[20:23], v[108:111]
  ds_read_b128 v[12:15], v219 offset:28672
  ds_write_b128 v212, v[76:79] offset:9216
  s_waitcnt lgkmcnt(11)
  v_mfma_f32_16x16x32_bf16 v[104:107], a[24:27], v[24:27], v[104:107]
  ds_read_b128 v[16:19], v211 offset:50176
  s_waitcnt lgkmcnt(1)
  buffer_load_dwordx4 v[40:43], v200, s[4:7], s31 offen offset:0
  v_mfma_f32_16x16x32_bf16 v[108:111], a[24:27], v[28:31], v[108:111]
  ds_read_b128 v[20:23], v219 offset:29696
  buffer_load_dwordx4 v[44:47], v200, s[4:7], s31 offen offset:1024
  v_mfma_f32_16x16x32_bf16 v[104:107], a[28:31], v[32:35], v[104:107]
  ds_read_b128 v[24:27], v211 offset:51200
  buffer_load_dwordx4 v[48:51], v200, s[4:7], s31 offen offset:2048
  v_mfma_f32_16x16x32_bf16 v[108:111], a[28:31], v[36:39], v[108:111]
  ds_read_b128 v[28:31], v219 offset:30720
  buffer_load_dwordx4 v[52:55], v200, s[4:7], s31 offen offset:3072
  v_mfma_f32_16x16x32_bf16 v[104:107], a[32:35], v[8:11], v[104:107]
  ds_read_b128 v[32:35], v211 offset:52224
  s_add_u32 s31, s31, 4096
  buffer_load_dwordx4 v[56:59], v200, s[4:7], s31 offen offset:0
  v_mfma_f32_16x16x32_bf16 v[108:111], a[32:35], v[12:15], v[108:111]
  ds_read_b128 v[36:39], v219 offset:31744
  buffer_load_dwordx4 v[60:63], v200, s[4:7], s31 offen offset:1024
  s_waitcnt lgkmcnt(5)
  v_mfma_f32_16x16x32_bf16 v[104:107], a[36:39], v[16:19], v[104:107]
  ds_read_b128 v[8:11], v211 offset:53248
  buffer_load_dwordx4 v[64:67], v200, s[4:7], s31 offen offset:2048
  s_waitcnt lgkmcnt(5)
  v_mfma_f32_16x16x32_bf16 v[108:111], a[36:39], v[20:23], v[108:111]
  ds_read_b128 v[12:15], v219 offset:32768
  buffer_load_dwordx4 v[68:71], v200, s[4:7], s31 offen offset:3072
  s_waitcnt lgkmcnt(5)
  v_mfma_f32_16x16x32_bf16 v[104:107], a[40:43], v[24:27], v[104:107]
  ds_read_b128 v[16:19], v211 offset:54272
  s_add_u32 s31, s31, 4096
  buffer_load_dwordx4 v[72:75], v200, s[4:7], s31 offen offset:0
  s_waitcnt lgkmcnt(5)
  v_mfma_f32_16x16x32_bf16 v[108:111], a[40:43], v[28:31], v[108:111]
  ds_read_b128 v[20:23], v219 offset:33792
  buffer_load_dwordx4 v[76:79], v200, s[4:7], s31 offen offset:1024
  s_add_u32 s31, s31, 32768
  s_waitcnt lgkmcnt(5)
  v_mfma_f32_16x16x32_bf16 v[104:107], a[44:47], v[32:35], v[104:107]
  ds_read_b128 v[24:27], v211 offset:55296
  s_waitcnt lgkmcnt(5)
  v_mfma_f32_16x16x32_bf16 v[108:111], a[44:47], v[36:39], v[108:111]
  ds_read_b128 v[28:31], v219 offset:34816
  s_waitcnt lgkmcnt(5)
  v_mfma_f32_16x16x32_bf16 v[104:107], a[48:51], v[8:11], v[104:107]
  ds_read_b128 v[32:35], v211 offset:56320
  s_waitcnt lgkmcnt(5)
  v_mfma_f32_16x16x32_bf16 v[108:111], a[48:51], v[12:15], v[108:111]
  ds_read_b128 v[36:39], v219 offset:35840
  s_waitcnt lgkmcnt(5)
  v_mfma_f32_16x16x32_bf16 v[104:107], a[52:55], v[16:19], v[104:107]
  ds_read_b128 v[8:11], v211 offset:57344
  s_waitcnt lgkmcnt(5)
  v_mfma_f32_16x16x32_bf16 v[108:111], a[52:55], v[20:23], v[108:111]
  ds_read_b128 v[12:15], v219 offset:36864
  s_waitcnt lgkmcnt(5)
  v_mfma_f32_16x16x32_bf16 v[104:107], a[56:59], v[24:27], v[104:107]
  ds_read_b128 v[16:19], v211 offset:58368
  s_waitcnt lgkmcnt(5)
  v_mfma_f32_16x16x32_bf16 v[108:111], a[56:59], v[28:31], v[108:111]
  ds_read_b128 v[20:23], v219 offset:37888
  s_waitcnt lgkmcnt(5)
  v_mfma_f32_16x16x32_bf16 v[104:107], a[60:63], v[32:35], v[104:107]
  ds_read_b128 v[24:27], v211 offset:59392
  s_waitcnt lgkmcnt(5)
  v_mfma_f32_16x16x32_bf16 v[108:111], a[60:63], v[36:39], v[108:111]
  ds_read_b128 v[28:31], v219 offset:38912
  s_waitcnt lgkmcnt(5)
  v_mfma_f32_16x16x32_bf16 v[104:107], a[64:67], v[8:11], v[104:107]
  ds_read_b128 v[32:35], v211 offset:60416
  s_waitcnt lgkmcnt(5)
  v_mfma_f32_16x16x32_bf16 v[108:111], a[64:67], v[12:15], v[108:111]
  ds_read_b128 v[36:39], v219 offset:39936
  s_waitcnt lgkmcnt(5)
  v_mfma_f32_16x16x32_bf16 v[104:107], a[68:71], v[16:19], v[104:107]
  s_waitcnt lgkmcnt(4)
  v_mfma_f32_16x16x32_bf16 v[108:111], a[68:71], v[20:23], v[108:111]
  s_waitcnt lgkmcnt(3)
  v_mfma_f32_16x16x32_bf16 v[104:107], a[72:75], v[24:27], v[104:107]
  s_waitcnt lgkmcnt(2)
  v_mfma_f32_16x16x32_bf16 v[108:111], a[72:75], v[28:31], v[108:111]
  s_waitcnt lgkmcnt(1)
  v_mfma_f32_16x16x32_bf16 v[104:107], a[76:79], v[32:35], v[104:107]
  s_waitcnt lgkmcnt(0)
  v_mfma_f32_16x16x32_bf16 v[108:111], a[76:79], v[36:39], v[108:111]
  s_cmp_lt_u32 s30, 2
  s_cbranch_scc1 L_x1nfF1_fx
  buffer_store_dword v205, v204, s[4:7], s33 offen
  s_add_u32 s33, s33, 64
  s_branch L_x1eF1_fx
L_x1nfF1_fx:
  buffer_store_dword v205, v210, s[4:7], s33 offen
L_x1eF1_fx:
  s_nop 4
  v_cvt_pk_bf16_f32 v128, v104, v105
  v_cvt_pk_bf16_f32 v129, v106, v107
  v_lshlrev_b32 v104, 16, v128
  v_and_b32 v105, 0xffff0000, v128
  v_lshlrev_b32 v106, 16, v129
  v_and_b32 v107, 0xffff0000, v129
  v_pk_add_f32 v[104:105], v[104:105], v[206:207]
  v_pk_add_f32 v[106:107], v[106:107], v[208:209]
  v_cvt_pk_bf16_f32 v128, v104, v105
  v_cvt_pk_bf16_f32 v129, v106, v107
  v_lshlrev_b32 v104, 16, v128
  v_and_b32 v105, 0xffff0000, v128
  v_lshlrev_b32 v106, 16, v129
  v_and_b32 v107, 0xffff0000, v129
  v_max_f32 v104, 0, v104
  v_max_f32 v105, 0, v105
  v_max_f32 v106, 0, v106
  v_max_f32 v107, 0, v107
  v_pk_mul_f32 v[104:105], v[104:105], v[104:105]
  v_pk_mul_f32 v[106:107], v[106:107], v[106:107]
  v_cvt_pk_bf16_f32 v128, v104, v105
  v_cvt_pk_bf16_f32 v129, v106, v107
  buffer_store_dwordx2 v[128:129], v213, s[4:7], s32 offen
  v_cvt_pk_bf16_f32 v130, v108, v109
  v_cvt_pk_bf16_f32 v131, v110, v111
  v_lshlrev_b32 v108, 16, v130
  v_and_b32 v109, 0xffff0000, v130
  v_lshlrev_b32 v110, 16, v131
  v_and_b32 v111, 0xffff0000, v131
  v_pk_add_f32 v[108:109], v[108:109], v[206:207]
  v_pk_add_f32 v[110:111], v[110:111], v[208:209]
  v_cvt_pk_bf16_f32 v130, v108, v109
  v_cvt_pk_bf16_f32 v131, v110, v111
  v_lshlrev_b32 v108, 16, v130
  v_and_b32 v109, 0xffff0000, v130
  v_lshlrev_b32 v110, 16, v131
  v_and_b32 v111, 0xffff0000, v131
  v_max_f32 v108, 0, v108
  v_max_f32 v109, 0, v109
  v_max_f32 v110, 0, v110
  v_max_f32 v111, 0, v111
  v_pk_mul_f32 v[108:109], v[108:109], v[108:109]
  v_pk_mul_f32 v[110:111], v[110:111], v[110:111]
  v_cvt_pk_bf16_f32 v130, v108, v109
  v_cvt_pk_bf16_f32 v131, v110, v111
  buffer_store_dwordx2 v[130:131], v214, s[4:7], s32 offen
  s_add_u32 s32, s32, 3072
  s_cmp_ge_u32 s30, 2
  s_cbranch_scc1 L_x1efF1_fx
  s_waitcnt vmcnt(0)
  buffer_store_dword v205, v204, s[4:7], s33 offen offset:64
L_x1efF1_fx:
  s_add_u32 s30, s30, 1
  s_cmp_lt_u32 s30, 64
  s_cbranch_scc1 L_xlF_fx
  s_waitcnt vmcnt(0)
  buffer_store_dword v205, v204, s[4:7], s33 offen
  buffer_store_dword v205, v204, s[4:7], s33 offen offset:64
L_x1done_fx:
  s_lshr_b32 s31, s25, 1
  s_and_b32 s32, s25, 1
  s_and_b32 s33, s29, 1
  s_lshr_b32 s34, s29, 1
  s_lshl_b32 s36, s24, 2
  s_add_u32 s36, s36, s29
  s_mov_b32 s35, 0x3dd53b95
  s_cmp_eq_u32 s33, 0
  s_cselect_b32 s65, 0xf149f2ca, 0
  s_mov_b32 s12, s60
  s_and_b32 s13, s61, 0xffff
  s_mov_b32 s14, 2621440
  s_mov_b32 s15, 0x00020000
  s_mov_b32 s16, s62
  s_and_b32 s17, s63, 0xffff
  s_mov_b32 s18, 2621440
  s_mov_b32 s19, 0x00020000
  s_barrier
  v_add_u32 v6, 0, v1
  s_mov_b32 s73, 52429
  v_mul_lo_u32 v7, v6, s73
  v_lshrrev_b32 v7, 19, v7
  v_mul_u32_u24 v8, 10, v7
  v_sub_u32 v8, v6, v8
  v_lshlrev_b32 v8, 4, v8
  s_movk_i32 s73, 1280
  v_mad_u32_u24 v8, v7, s73, v8
  v_add_u32 v6, 64, v1
  s_mov_b32 s73, 52429
  v_mul_lo_u32 v7, v6, s73
  v_lshrrev_b32 v7, 19, v7
  v_mul_u32_u24 v9, 10, v7
  v_sub_u32 v9, v6, v9
  v_lshlrev_b32 v9, 4, v9
  s_movk_i32 s73, 1280
  v_mad_u32_u24 v9, v7, s73, v9
  v_add_u32 v6, 128, v1
  s_mov_b32 s73, 52429
  v_mul_lo_u32 v7, v6, s73
  v_lshrrev_b32 v7, 19, v7
  v_mul_u32_u24 v10, 10, v7
  v_sub_u32 v10, v6, v10
  v_lshlrev_b32 v10, 4, v10
  s_movk_i32 s73, 1280
  v_mad_u32_u24 v10, v7, s73, v10
  v_add_u32 v6, 192, v1
  s_mov_b32 s73, 52429
  v_mul_lo_u32 v7, v6, s73
  v_lshrrev_b32 v7, 19, v7
  v_mul_u32_u24 v11, 10, v7
  v_sub_u32 v11, v6, v11
  v_lshlrev_b32 v11, 4, v11
  s_movk_i32 s73, 1280
  v_mad_u32_u24 v11, v7, s73, v11
  v_add_u32 v6, 256, v1
  s_mov_b32 s73, 52429
  v_mul_lo_u32 v7, v6, s73
  v_lshrrev_b32 v7, 19, v7
  v_mul_u32_u24 v12, 10, v7
  v_sub_u32 v12, v6, v12
  v_lshlrev_b32 v12, 4, v12
  s_movk_i32 s73, 1280
  v_mad_u32_u24 v12, v7, s73, v12
  v_add_u32 v6, 320, v1
  s_mov_b32 s73, 52429
  v_mul_lo_u32 v7, v6, s73
  v_lshrrev_b32 v7, 19, v7
  v_mul_u32_u24 v13, 10, v7
  v_sub_u32 v13, v6, v13
  v_lshlrev_b32 v13, 4, v13
  s_movk_i32 s73, 1280
  v_mad_u32_u24 v13, v7, s73, v13
  v_add_u32 v6, 384, v1
  s_mov_b32 s73, 52429
  v_mul_lo_u32 v7, v6, s73
  v_lshrrev_b32 v7, 19, v7
  v_mul_u32_u24 v14, 10, v7
  v_sub_u32 v14, v6, v14
  v_lshlrev_b32 v14, 4, v14
  s_movk_i32 s73, 1280
  v_mad_u32_u24 v14, v7, s73, v14
  v_add_u32 v6, 448, v1
  s_mov_b32 s73, 52429
  v_mul_lo_u32 v7, v6, s73
  v_lshrrev_b32 v7, 19, v7
  v_mul_u32_u24 v15, 10, v7
  v_sub_u32 v15, v6, v15
  v_lshlrev_b32 v15, 4, v15
  s_movk_i32 s73, 1280
  v_mad_u32_u24 v15, v7, s73, v15
  v_add_u32 v6, 512, v1
  s_mov_b32 s73, 52429
  v_mul_lo_u32 v7, v6, s73
  v_lshrrev_b32 v7, 19, v7
  v_mul_u32_u24 v16, 10, v7
  v_sub_u32 v16, v6, v16
  v_lshlrev_b32 v16, 4, v16
  s_movk_i32 s73, 1280
  v_mad_u32_u24 v16, v7, s73, v16
  v_add_u32 v6, 576, v1
  s_mov_b32 s73, 52429
  v_mul_lo_u32 v7, v6, s73
  v_lshrrev_b32 v7, 19, v7
  v_mul_u32_u24 v17, 10, v7
  v_sub_u32 v17, v6, v17
  v_lshlrev_b32 v17, 4, v17
  s_movk_i32 s73, 1280
  v_mad_u32_u24 v17, v7, s73, v17
  v_add_u32 v6, 640, v1
  s_mov_b32 s73, 52429
  v_mul_lo_u32 v7, v6, s73
  v_lshrrev_b32 v7, 19, v7
  v_mul_u32_u24 v18, 10, v7
  v_sub_u32 v18, v6, v18
  v_lshlrev_b32 v18, 4, v18
  s_movk_i32 s73, 1280
  v_mad_u32_u24 v18, v7, s73, v18
  v_add_u32 v6, 704, v1
  s_mov_b32 s73, 52429
  v_mul_lo_u32 v7, v6, s73
  v_lshrrev_b32 v7, 19, v7
  v_mul_u32_u24 v19, 10, v7
  v_sub_u32 v19, v6, v19
  v_lshlrev_b32 v19, 4, v19
  s_movk_i32 s73, 1280
  v_mad_u32_u24 v19, v7, s73, v19
  v_add_u32 v6, 768, v1
  s_mov_b32 s73, 52429
  v_mul_lo_u32 v7, v6, s73
  v_lshrrev_b32 v7, 19, v7
  v_mul_u32_u24 v20, 10, v7
  v_sub_u32 v20, v6, v20
  v_lshlrev_b32 v20, 4, v20
  s_movk_i32 s73, 1280
  v_mad_u32_u24 v20, v7, s73, v20
  v_add_u32 v6, 832, v1
  s_mov_b32 s73, 52429
  v_mul_lo_u32 v7, v6, s73
  v_lshrrev_b32 v7, 19, v7
  v_mul_u32_u24 v21, 10, v7
  v_sub_u32 v21, v6, v21
  v_lshlrev_b32 v21, 4, v21
  s_movk_i32 s73, 1280
  v_mad_u32_u24 v21, v7, s73, v21
  v_add_u32 v6, 896, v1
  s_mov_b32 s73, 52429
  v_mul_lo_u32 v7, v6, s73
  v_lshrrev_b32 v7, 19, v7
  v_mul_u32_u24 v22, 10, v7
  v_sub_u32 v22, v6, v22
  v_lshlrev_b32 v22, 4, v22
  s_movk_i32 s73, 1280
  v_mad_u32_u24 v22, v7, s73, v22
  v_add_u32 v6, 960, v1
  s_mov_b32 s73, 52429
  v_mul_lo_u32 v7, v6, s73
  v_lshrrev_b32 v7, 19, v7
  v_mul_u32_u24 v23, 10, v7
  v_sub_u32 v23, v6, v23
  v_lshlrev_b32 v23, 4, v23
  s_movk_i32 s73, 1280
  v_mad_u32_u24 v23, v7, s73, v23
  v_add_u32 v6, 1024, v1
  s_mov_b32 s73, 52429
  v_mul_lo_u32 v7, v6, s73
  v_lshrrev_b32 v7, 19, v7
  v_mul_u32_u24 v24, 10, v7
  v_sub_u32 v24, v6, v24
  v_lshlrev_b32 v24, 4, v24
  s_movk_i32 s73, 1280
  v_mad_u32_u24 v24, v7, s73, v24
  v_add_u32 v6, 1088, v1
  s_mov_b32 s73, 52429
  v_mul_lo_u32 v7, v6, s73
  v_lshrrev_b32 v7, 19, v7
  v_mul_u32_u24 v25, 10, v7
  v_sub_u32 v25, v6, v25
  v_lshlrev_b32 v25, 4, v25
  s_movk_i32 s73, 1280
  v_mad_u32_u24 v25, v7, s73, v25
  v_add_u32 v6, 1152, v1
  s_mov_b32 s73, 52429
  v_mul_lo_u32 v7, v6, s73
  v_lshrrev_b32 v7, 19, v7
  v_mul_u32_u24 v26, 10, v7
  v_sub_u32 v26, v6, v26
  v_lshlrev_b32 v26, 4, v26
  s_movk_i32 s73, 1280
  v_mad_u32_u24 v26, v7, s73, v26
  v_add_u32 v6, 1216, v1
  s_mov_b32 s73, 52429
  v_mul_lo_u32 v7, v6, s73
  v_lshrrev_b32 v7, 19, v7
  v_mul_u32_u24 v27, 10, v7
  v_sub_u32 v27, v6, v27
  v_lshlrev_b32 v27, 4, v27
  s_movk_i32 s73, 1280
  v_mad_u32_u24 v27, v7, s73, v27
  v_add_u32 v6, 1280, v1
  s_mov_b32 s73, 52429
  v_mul_lo_u32 v7, v6, s73
  v_lshrrev_b32 v7, 19, v7
  v_mul_u32_u24 v28, 10, v7
  v_sub_u32 v28, v6, v28
  v_lshlrev_b32 v28, 4, v28
  s_movk_i32 s73, 1280
  v_mad_u32_u24 v28, v7, s73, v28
  v_add_u32 v6, 1344, v1
  s_mov_b32 s73, 52429
  v_mul_lo_u32 v7, v6, s73
  v_lshrrev_b32 v7, 19, v7
  v_mul_u32_u24 v29, 10, v7
  v_sub_u32 v29, v6, v29
  v_lshlrev_b32 v29, 4, v29
  s_movk_i32 s73, 1280
  v_mad_u32_u24 v29, v7, s73, v29
  v_add_u32 v6, 1408, v1
  s_mov_b32 s73, 52429
  v_mul_lo_u32 v7, v6, s73
  v_lshrrev_b32 v7, 19, v7
  v_mul_u32_u24 v30, 10, v7
  v_sub_u32 v30, v6, v30
  v_lshlrev_b32 v30, 4, v30
  s_movk_i32 s73, 1280
  v_mad_u32_u24 v30, v7, s73, v30
  v_add_u32 v6, 1472, v1
  s_mov_b32 s73, 52429
  v_mul_lo_u32 v7, v6, s73
  v_lshrrev_b32 v7, 19, v7
  v_mul_u32_u24 v31, 10, v7
  v_sub_u32 v31, v6, v31
  v_lshlrev_b32 v31, 4, v31
  s_movk_i32 s73, 1280
  v_mad_u32_u24 v31, v7, s73, v31
  v_add_u32 v6, 1536, v1
  s_mov_b32 s73, 52429
  v_mul_lo_u32 v7, v6, s73
  v_lshrrev_b32 v7, 19, v7
  v_mul_u32_u24 v32, 10, v7
  v_sub_u32 v32, v6, v32
  v_lshlrev_b32 v32, 4, v32
  s_movk_i32 s73, 1280
  v_mad_u32_u24 v32, v7, s73, v32
  v_add_u32 v6, 1600, v1
  s_mov_b32 s73, 52429
  v_mul_lo_u32 v7, v6, s73
  v_lshrrev_b32 v7, 19, v7
  v_mul_u32_u24 v33, 10, v7
  v_sub_u32 v33, v6, v33
  v_lshlrev_b32 v33, 4, v33
  s_movk_i32 s73, 1280
  v_mad_u32_u24 v33, v7, s73, v33
  v_add_u32 v6, 1664, v1
  s_mov_b32 s73, 52429
  v_mul_lo_u32 v7, v6, s73
  v_lshrrev_b32 v7, 19, v7
  v_mul_u32_u24 v34, 10, v7
  v_sub_u32 v34, v6, v34
  v_lshlrev_b32 v34, 4, v34
  s_movk_i32 s73, 1280
  v_mad_u32_u24 v34, v7, s73, v34
  v_add_u32 v6, 1728, v1
  s_mov_b32 s73, 52429
  v_mul_lo_u32 v7, v6, s73
  v_lshrrev_b32 v7, 19, v7
  v_mul_u32_u24 v35, 10, v7
  v_sub_u32 v35, v6, v35
  v_lshlrev_b32 v35, 4, v35
  s_movk_i32 s73, 1280
  v_mad_u32_u24 v35, v7, s73, v35
  v_add_u32 v6, 1792, v1
  s_mov_b32 s73, 52429
  v_mul_lo_u32 v7, v6, s73
  v_lshrrev_b32 v7, 19, v7
  v_mul_u32_u24 v36, 10, v7
  v_sub_u32 v36, v6, v36
  v_lshlrev_b32 v36, 4, v36
  s_movk_i32 s73, 1280
  v_mad_u32_u24 v36, v7, s73, v36
  v_add_u32 v6, 1856, v1
  s_mov_b32 s73, 52429
  v_mul_lo_u32 v7, v6, s73
  v_lshrrev_b32 v7, 19, v7
  v_mul_u32_u24 v37, 10, v7
  v_sub_u32 v37, v6, v37
  v_lshlrev_b32 v37, 4, v37
  s_movk_i32 s73, 1280
  v_mad_u32_u24 v37, v7, s73, v37
  s_mov_b32 s8, s46
  s_and_b32 s9, s47, 0xffff
  s_mov_b32 s10, 7864320
  s_mov_b32 s11, 0x00020000
  s_mul_i32 s74, s36, 245760
  s_mul_i32 s72, s31, 160
  s_add_u32 s74, s74, s72
  s_mul_i32 s72, s29, 30720
  s_add_u32 m0, s72, 0
  s_nop 0
  buffer_load_dwordx4 v8, s[8:11], s74 offen lds
  s_add_u32 m0, s72, 1024
  s_nop 0
  buffer_load_dwordx4 v9, s[8:11], s74 offen lds
  s_add_u32 m0, s72, 2048
  s_nop 0
  buffer_load_dwordx4 v10, s[8:11], s74 offen lds
  s_add_u32 m0, s72, 3072
  s_nop 0
  buffer_load_dwordx4 v11, s[8:11], s74 offen lds
  s_add_u32 m0, s72, 4096
  s_nop 0
  buffer_load_dwordx4 v12, s[8:11], s74 offen lds
  s_add_u32 m0, s72, 5120
  s_nop 0
  buffer_load_dwordx4 v13, s[8:11], s74 offen lds
  s_add_u32 m0, s72, 6144
  s_nop 0
  buffer_load_dwordx4 v14, s[8:11], s74 offen lds
  s_add_u32 m0, s72, 7168
  s_nop 0
  buffer_load_dwordx4 v15, s[8:11], s74 offen lds
  s_add_u32 m0, s72, 8192
  s_nop 0
  buffer_load_dwordx4 v16, s[8:11], s74 offen lds
  s_add_u32 m0, s72, 9216
  s_nop 0
  buffer_load_dwordx4 v17, s[8:11], s74 offen lds
  s_add_u32 m0, s72, 10240
  s_nop 0
  buffer_load_dwordx4 v18, s[8:11], s74 offen lds
  s_add_u32 m0, s72, 11264
  s_nop 0
  buffer_load_dwordx4 v19, s[8:11], s74 offen lds
  s_add_u32 m0, s72, 12288
  s_nop 0
  buffer_load_dwordx4 v20, s[8:11], s74 offen lds
  s_add_u32 m0, s72, 13312
  s_nop 0
  buffer_load_dwordx4 v21, s[8:11], s74 offen lds
  s_add_u32 m0, s72, 14336
  s_nop 0
  buffer_load_dwordx4 v22, s[8:11], s74 offen lds
  s_add_u32 m0, s72, 15360
  s_nop 0
  buffer_load_dwordx4 v23, s[8:11], s74 offen lds
  s_add_u32 m0, s72, 16384
  s_nop 0
  buffer_load_dwordx4 v24, s[8:11], s74 offen lds
  s_add_u32 m0, s72, 17408
  s_nop 0
  buffer_load_dwordx4 v25, s[8:11], s74 offen lds
  s_add_u32 m0, s72, 18432
  s_nop 0
  buffer_load_dwordx4 v26, s[8:11], s74 offen lds
  s_add_u32 m0, s72, 19456
  s_nop 0
  buffer_load_dwordx4 v27, s[8:11], s74 offen lds
  s_add_u32 m0, s72, 20480
  s_nop 0
  buffer_load_dwordx4 v28, s[8:11], s74 offen lds
  s_add_u32 m0, s72, 21504
  s_nop 0
  buffer_load_dwordx4 v29, s[8:11], s74 offen lds
  s_add_u32 m0, s72, 22528
  s_nop 0
  buffer_load_dwordx4 v30, s[8:11], s74 offen lds
  s_add_u32 m0, s72, 23552
  s_nop 0
  buffer_load_dwordx4 v31, s[8:11], s74 offen lds
  s_add_u32 m0, s72, 24576
  s_nop 0
  buffer_load_dwordx4 v32, s[8:11], s74 offen lds
  s_add_u32 m0, s72, 25600
  s_nop 0
  buffer_load_dwordx4 v33, s[8:11], s74 offen lds
  s_add_u32 m0, s72, 26624
  s_nop 0
  buffer_load_dwordx4 v34, s[8:11], s74 offen lds
  s_add_u32 m0, s72, 27648
  s_nop 0
  buffer_load_dwordx4 v35, s[8:11], s74 offen lds
  s_add_u32 m0, s72, 28672
  s_nop 0
  buffer_load_dwordx4 v36, s[8:11], s74 offen lds
  s_add_u32 m0, s72, 29696
  s_nop 0
  buffer_load_dwordx4 v37, s[8:11], s74 offen lds
  v_lshrrev_b32 v4, 2, v2
  v_and_b32 v5, 3, v2
  v_lshl_add_u32 v6, v3, 2, v4
  v_mul_u32_u24 v40, 160, v6
  v_lshl_add_u32 v40, v5, 3, v40
  v_add_u32 v40, s72, v40
  s_waitcnt vmcnt(0)
  ds_read_b64_tr_b16 a[0:1], v40 offset:0
  ds_read_b64_tr_b16 a[2:3], v40 offset:2560
  ds_read_b64_tr_b16 a[4:5], v40 offset:5120
  ds_read_b64_tr_b16 a[6:7], v40 offset:7680
  ds_read_b64_tr_b16 a[8:9], v40 offset:10240
  ds_read_b64_tr_b16 a[10:11], v40 offset:12800
  ds_read_b64_tr_b16 a[12:13], v40 offset:15360
  ds_read_b64_tr_b16 a[14:15], v40 offset:17920
  ds_read_b64_tr_b16 a[16:17], v40 offset:20480
  ds_read_b64_tr_b16 a[18:19], v40 offset:23040
  ds_read_b64_tr_b16 a[20:21], v40 offset:25600
  ds_read_b64_tr_b16 a[22:23], v40 offset:28160
  s_waitcnt lgkmcnt(0)
  ds_read_b64_tr_b16 a[30:31], v40 offset:32
  ds_read_b64_tr_b16 a[32:33], v40 offset:2592
  ds_read_b64_tr_b16 a[34:35], v40 offset:5152
  ds_read_b64_tr_b16 a[36:37], v40 offset:7712
  ds_read_b64_tr_b16 a[38:39], v40 offset:10272
  ds_read_b64_tr_b16 a[40:41], v40 offset:12832
  ds_read_b64_tr_b16 a[42:43], v40 offset:15392
  ds_read_b64_tr_b16 a[44:45], v40 offset:17952
  ds_read_b64_tr_b16 a[46:47], v40 offset:20512
  ds_read_b64_tr_b16 a[48:49], v40 offset:23072
  ds_read_b64_tr_b16 a[50:51], v40 offset:25632
  ds_read_b64_tr_b16 a[52:53], v40 offset:28192
  s_waitcnt lgkmcnt(0)
  ds_read_b64_tr_b16 a[60:61], v40 offset:64
  ds_read_b64_tr_b16 a[62:63], v40 offset:2624
  ds_read_b64_tr_b16 a[64:65], v40 offset:5184
  ds_read_b64_tr_b16 a[66:67], v40 offset:7744
  ds_read_b64_tr_b16 a[68:69], v40 offset:10304
  ds_read_b64_tr_b16 a[70:71], v40 offset:12864
  ds_read_b64_tr_b16 a[72:73], v40 offset:15424
  ds_read_b64_tr_b16 a[74:75], v40 offset:17984
  ds_read_b64_tr_b16 a[76:77], v40 offset:20544
  ds_read_b64_tr_b16 a[78:79], v40 offset:23104
  ds_read_b64_tr_b16 a[80:81], v40 offset:25664
  ds_read_b64_tr_b16 a[82:83], v40 offset:28224
  s_waitcnt lgkmcnt(0)
  ds_read_b64_tr_b16 a[90:91], v40 offset:96
  ds_read_b64_tr_b16 a[92:93], v40 offset:2656
  ds_read_b64_tr_b16 a[94:95], v40 offset:5216
  ds_read_b64_tr_b16 a[96:97], v40 offset:7776
  ds_read_b64_tr_b16 a[98:99], v40 offset:10336
  ds_read_b64_tr_b16 a[100:101], v40 offset:12896
  ds_read_b64_tr_b16 a[102:103], v40 offset:15456
  ds_read_b64_tr_b16 a[104:105], v40 offset:18016
  ds_read_b64_tr_b16 a[106:107], v40 offset:20576
  ds_read_b64_tr_b16 a[108:109], v40 offset:23136
  ds_read_b64_tr_b16 a[110:111], v40 offset:25696
  ds_read_b64_tr_b16 a[112:113], v40 offset:28256
  s_waitcnt lgkmcnt(0)
  ds_read_b64_tr_b16 a[120:121], v40 offset:128
  ds_read_b64_tr_b16 a[122:123], v40 offset:2688
  ds_read_b64_tr_b16 a[124:125], v40 offset:5248
  ds_read_b64_tr_b16 a[126:127], v40 offset:7808
  ds_read_b64_tr_b16 a[128:129], v40 offset:10368
  ds_read_b64_tr_b16 a[130:131], v40 offset:12928
  ds_read_b64_tr_b16 a[132:133], v40 offset:15488
  ds_read_b64_tr_b16 a[134:135], v40 offset:18048
  ds_read_b64_tr_b16 a[136:137], v40 offset:20608
  ds_read_b64_tr_b16 a[138:139], v40 offset:23168
  ds_read_b64_tr_b16 a[140:141], v40 offset:25728
  ds_read_b64_tr_b16 a[142:143], v40 offset:28288
  s_waitcnt lgkmcnt(0)
  s_mov_b32 s8, s56
  s_and_b32 s9, s57, 0xffff
  s_mov_b32 s10, 1966080
  s_mul_i32 s74, s36, 61440
  s_mul_i32 s73, s31, 160
  s_add_u32 s74, s74, s73
  s_add_u32 m0, s72, 0
  s_nop 0
  buffer_load_dwordx4 v8, s[8:11], s74 offen lds
  s_add_u32 m0, s72, 1024
  s_nop 0
  buffer_load_dwordx4 v9, s[8:11], s74 offen lds
  s_add_u32 m0, s72, 2048
  s_nop 0
  buffer_load_dwordx4 v10, s[8:11], s74 offen lds
  s_add_u32 m0, s72, 3072
  s_nop 0
  buffer_load_dwordx4 v11, s[8:11], s74 offen lds
  s_add_u32 m0, s72, 4096
  s_nop 0
  buffer_load_dwordx4 v12, s[8:11], s74 offen lds
  s_add_u32 m0, s72, 5120
  s_nop 0
  buffer_load_dwordx4 v13, s[8:11], s74 offen lds
  s_add_u32 m0, s72, 6144
  s_nop 0
  buffer_load_dwordx4 v14, s[8:11], s74 offen lds
  s_add_u32 m0, s72, 7168
  s_nop 0
  buffer_load_dwordx4 v15, s[8:11], s74 offen lds
  s_waitcnt vmcnt(0)
  ds_read_b64_tr_b16 a[24:25], v40 offset:0
  ds_read_b64_tr_b16 a[26:27], v40 offset:2560
  ds_read_b64_tr_b16 a[28:29], v40 offset:5120
  ds_read_b64_tr_b16 a[54:55], v40 offset:32
  ds_read_b64_tr_b16 a[56:57], v40 offset:2592
  ds_read_b64_tr_b16 a[58:59], v40 offset:5152
  ds_read_b64_tr_b16 a[84:85], v40 offset:64
  ds_read_b64_tr_b16 a[86:87], v40 offset:2624
  ds_read_b64_tr_b16 a[88:89], v40 offset:5184
  ds_read_b64_tr_b16 a[114:115], v40 offset:96
  ds_read_b64_tr_b16 a[116:117], v40 offset:2656
  ds_read_b64_tr_b16 a[118:119], v40 offset:5216
  ds_read_b64_tr_b16 a[144:145], v40 offset:128
  ds_read_b64_tr_b16 a[146:147], v40 offset:2688
  ds_read_b64_tr_b16 a[148:149], v40 offset:5248
  s_waitcnt lgkmcnt(0)
  s_barrier
  v_mov_b32 v216, 0x80000000
  v_mov_b32 v217, 1
  v_lshlrev_b32 v200, 4, v1
  v_lshlrev_b32 v201, 3, v1
  s_mul_i32 s72, s34, 3072
  v_add_u32 v202, s72, v200
  v_add_u32 v204, 6144, v200
  s_mul_i32 s72, s29, 3072
  v_add_u32 v205, s72, v200
  s_xor_b32 s72, s29, 2
  s_mul_i32 s72, s72, 3072
  v_add_u32 v206, s72, v200
  v_and_b32 v207, 15, v1
  v_lshlrev_b32 v207, 2, v207
  v_and_b32 v208, 7, v1
  v_lshlrev_b32 v208, 2, v208
  v_and_b32 v209, 31, v1
  v_lshlrev_b32 v209, 2, v209
  v_cmp_eq_u32 vcc, 0, v1
  v_mov_b32 v4, 0
  v_cndmask_b32 v210, v216, v4, vcc
  s_mul_i32 s72, s29, 10240
  s_add_u32 s72, s72, 24576
  v_add_u32 v212, s72, v200
  s_lshl_b32 s72, s29, 10
  s_add_u32 s72, s72, 24576
  v_add_u32 v213, s72, v200
  s_lshl_b32 s72, s32, 4
  v_add_u32 v6, s72, v2
  s_movk_i32 s73, 1280
  v_mul_lo_u32 v214, v6, s73
  s_mul_i32 s72, s31, 160
  s_lshl_b32 s73, s29, 5
  s_add_u32 s72, s72, s73
  v_lshl_add_u32 v215, v3, 3, s72
  v_add_u32 v214, v214, v215
  s_mov_b32 s8, s58
  s_and_b32 s9, s59, 0xffff
  s_mov_b32 s10, 1280
  buffer_load_dwordx2 v[8:9], v215, s[8:11], 0 offen
  s_mul_i32 s72, s31, 160
  s_add_u32 s72, s72, 128
  v_lshlrev_b32 v6, 3, v3
  buffer_load_dwordx2 v[10:11], v6, s[8:11], s72 offen
  s_waitcnt vmcnt(0)
  v_lshlrev_b32 v218, 16, v8
  v_and_b32 v219, 0xffff0000, v8
  v_lshlrev_b32 v220, 16, v9
  v_and_b32 v221, 0xffff0000, v9
  v_lshlrev_b32 v222, 16, v10
  v_and_b32 v223, 0xffff0000, v10
  v_lshlrev_b32 v224, 16, v11
  v_and_b32 v225, 0xffff0000, v11
  v_mov_b32 v6, 0
  v_mov_b32 v7, 0xf149f2ca
  v_cmp_gt_u32 vcc, 2, v3
  s_nop 1
  v_cndmask_b32 v188, v6, v7, vcc
  v_cndmask_b32 v189, v6, v7, vcc
  v_cndmask_b32 v190, v6, v7, vcc
  v_cndmask_b32 v191, v6, v7, vcc
  s_cmp_eq_u32 s33, 0
  s_cselect_b64 s[74:75], -1, 0
  v_lshl_add_u32 v4, v3, 2, 0
  v_cmp_gt_u32 vcc, v4, v2
  s_nop 1
  v_cndmask_b32 v5, v6, v7, vcc
  v_cndmask_b32 v192, v6, v5, s[74:75]
  v_cndmask_b32 v196, v5, v7, s[74:75]
  v_lshl_add_u32 v4, v3, 2, 1
  v_cmp_gt_u32 vcc, v4, v2
  s_nop 1
  v_cndmask_b32 v5, v6, v7, vcc
  v_cndmask_b32 v193, v6, v5, s[74:75]
  v_cndmask_b32 v197, v5, v7, s[74:75]
  v_lshl_add_u32 v4, v3, 2, 2
  v_cmp_gt_u32 vcc, v4, v2
  s_nop 1
  v_cndmask_b32 v5, v6, v7, vcc
  v_cndmask_b32 v194, v6, v5, s[74:75]
  v_cndmask_b32 v198, v5, v7, s[74:75]
  v_lshl_add_u32 v4, v3, 2, 3
  v_cmp_gt_u32 vcc, v4, v2
  s_nop 1
  v_cndmask_b32 v5, v6, v7, vcc
  v_cndmask_b32 v195, v6, v5, s[74:75]
  v_cndmask_b32 v199, v5, v7, s[74:75]
  s_mov_b32 s30, 0
  s_mov_b32 s66, 0
  s_mov_b32 s67, 0
L_p2loop_fx:
  s_cmp_ge_u32 s30, 64
  s_cbranch_scc1 L_noat_fx
  s_and_b32 s72, s30, 3
  s_cmp_lg_u32 s72, s27
  s_cbranch_scc1 L_noat_fx
  s_lshl_b32 s37, s28, 6
  s_add_u32 s37, s37, s30
  s_lshl_b32 s72, s37, 6
  s_add_u32 s38, s72, 108068864
L_wfkv_1_fx:
  buffer_load_dword v4, v207, s[4:7], s38 offen sc1
  s_waitcnt vmcnt(0)
  s_cmp_eq_u32 s66, 0
  s_cbranch_scc1 L_fl_3_fx
  buffer_store_dword v217, v210, s[4:7], s66 offen
  s_mov_b32 s66, 0
L_fl_3_fx:
  s_cmp_eq_u32 s67, 0
  s_cbranch_scc1 L_fl_4_fx
  buffer_store_dword v217, v210, s[4:7], s67 offen sc1
  buffer_store_dword v217, v210, s[4:7], s67 offen offset:2048 sc1
  s_mov_b32 s67, 0
L_fl_4_fx:
  v_cmp_eq_u32 vcc, 0, v4
  s_cbranch_vccz L_wkkv_2_fx
  s_add_u32 s71, s71, 1
  s_cmp_gt_u32 s71, 1600000
  s_cbranch_scc1 L_p2done_fx
  s_sleep 6
  s_branch L_wfkv_1_fx
L_wkkv_2_fx:
  s_lshl_b32 s72, s37, 6
  s_add_u32 s38, s72, 108363776
L_wfh_5_fx:
  buffer_load_dword v4, v207, s[4:7], s38 offen sc1
  s_waitcnt vmcnt(0)
  s_cmp_eq_u32 s66, 0
  s_cbranch_scc1 L_fl_7_fx
  buffer_store_dword v217, v210, s[4:7], s66 offen
  s_mov_b32 s66, 0
L_fl_7_fx:
  s_cmp_eq_u32 s67, 0
  s_cbranch_scc1 L_fl_8_fx
  buffer_store_dword v217, v210, s[4:7], s67 offen sc1
  buffer_store_dword v217, v210, s[4:7], s67 offen offset:2048 sc1
  s_mov_b32 s67, 0
L_fl_8_fx:
  v_cmp_eq_u32 vcc, 0, v4
  s_cbranch_vccz L_wkh_6_fx
  s_add_u32 s71, s71, 1
  s_cmp_gt_u32 s71, 1600000
  s_cbranch_scc1 L_p2done_fx
  s_sleep 6
  s_branch L_wfh_5_fx
L_wkh_6_fx:
  s_mul_i32 s72, s34, 3072
  s_mul_i32 s38, s37, 12288
  s_mul_i32 s73, s33, 6144
  s_add_u32 s38, s38, s73
  s_add_u32 s38, s38, s72
  s_add_u32 s38, s38, 2621440
  s_mul_i32 s39, s37, 24576
  s_add_u32 s39, s39, 27787264
  s_add_u32 s64, s39, s72
  s_mul_i32 s73, s30, 294912
  s_mul_i32 s74, s28, 9216
  s_add_u32 s73, s73, s74
  s_add_u32 s73, s73, 84410368
  buffer_load_dwordx4 v[8:11], v200, s[4:7], s38 offen offset:0 sc1
  buffer_load_dwordx4 v[12:15], v200, s[4:7], s38 offen offset:1024 sc1
  buffer_load_dwordx4 v[16:19], v200, s[4:7], s38 offen offset:2048 sc1
  buffer_load_dwordx4 v[228:231], v200, s[4:7], s64 offen offset:0 sc1
  buffer_load_dwordx4 v[232:235], v200, s[4:7], s64 offen offset:1024 sc1
  buffer_load_dwordx4 v[236:239], v200, s[4:7], s64 offen offset:2048 sc1
  s_add_u32 s64, s64, 6144
  buffer_load_dwordx4 v[240:243], v200, s[4:7], s64 offen offset:0 sc1
  buffer_load_dwordx4 v[244:247], v200, s[4:7], s64 offen offset:1024 sc1
  buffer_load_dwordx4 v[248:251], v200, s[4:7], s64 offen offset:2048 sc1
  buffer_load_dwordx4 v[20:23], v202, s[4:7], s73 offen offset:0 sc1
  buffer_load_dwordx4 v[24:27], v202, s[4:7], s73 offen offset:1024 sc1
  buffer_load_dwordx4 v[28:31], v202, s[4:7], s73 offen offset:2048 sc1
  buffer_load_dwordx4 v[36:39], v204, s[4:7], s73 offen offset:0 sc1
  buffer_load_dwordx4 v[40:43], v204, s[4:7], s73 offen offset:1024 sc1
  buffer_load_dwordx4 v[44:47], v204, s[4:7], s73 offen offset:2048 sc1
  s_mul_i32 s72, s34, 6144
  s_add_u32 s39, s39, s72
  s_add_u32 s39, s39, 12288
  s_add_u32 s72, s39, 4096
  buffer_load_dwordx4 v[52:55], v200, s[4:7], s39 offen offset:0 sc1
  buffer_load_dwordx4 v[56:59], v200, s[4:7], s39 offen offset:1024 sc1
  buffer_load_dwordx4 v[60:63], v200, s[4:7], s39 offen offset:2048 sc1
  buffer_load_dwordx4 v[64:67], v200, s[4:7], s39 offen offset:3072 sc1
  buffer_load_dwordx4 v[68:71], v200, s[4:7], s72 offen offset:0 sc1
  buffer_load_dwordx4 v[72:75], v200, s[4:7], s72 offen offset:1024 sc1
  s_waitcnt vmcnt(9)
  v_mfma_f32_16x16x32_bf16 v[76:79], v[20:23], v[8:11], v[188:191]
  v_mfma_f32_16x16x32_bf16 v[80:83], v[228:231], v[8:11], v[192:195]
  v_mfma_f32_16x16x32_bf16 v[84:87], v[240:243], v[8:11], v[196:199]
  v_mfma_f32_16x16x32_bf16 v[76:79], v[24:27], v[12:15], v[76:79]
  v_mfma_f32_16x16x32_bf16 v[80:83], v[232:235], v[12:15], v[80:83]
  v_mfma_f32_16x16x32_bf16 v[84:87], v[244:247], v[12:15], v[84:87]
  v_mfma_f32_16x16x32_bf16 v[76:79], v[28:31], v[16:19], v[76:79]
  v_mfma_f32_16x16x32_bf16 v[80:83], v[236:239], v[16:19], v[80:83]
  v_mfma_f32_16x16x32_bf16 v[84:87], v[248:251], v[16:19], v[84:87]
  s_nop 7
  ds_write_b128 v205, v[76:79] offset:0
  ds_write_b128 v205, v[80:83] offset:1024
  ds_write_b128 v205, v[84:87] offset:2048
  s_waitcnt lgkmcnt(0)
  s_barrier
  ds_read_b128 v[96:99], v206 offset:0
  ds_read_b128 v[100:103], v206 offset:1024
  ds_read_b128 v[104:107], v206 offset:2048
  s_waitcnt lgkmcnt(0)
  v_pk_add_f32 v[96:97], v[96:97], v[76:77]
  v_pk_add_f32 v[98:99], v[98:99], v[78:79]
  v_pk_add_f32 v[100:101], v[100:101], v[80:81]
  v_pk_add_f32 v[102:103], v[102:103], v[82:83]
  v_pk_add_f32 v[104:105], v[104:105], v[84:85]
  v_pk_add_f32 v[106:107], v[106:107], v[86:87]
  v_max3_f32 v4, v96, v97, v98
  v_max3_f32 v5, v99, v100, v101
  v_max3_f32 v6, v102, v103, v104
  v_max3_f32 v7, v105, v106, v107
  v_max3_f32 v4, v4, v5, v6
  v_max_f32 v4, v4, v7
  v_mov_b32 v5, v4
  s_nop 1
  v_permlane32_swap_b32 v4, v5
  v_max_f32 v4, v4, v5
  v_mov_b32 v5, v4
  s_nop 1
  v_permlane16_swap_b32 v4, v5
  v_max_f32 v4, v4, v5
  v_mul_f32 v4, s35, v4
  v_fma_f32 v76, v96, s35, -v4
  v_fma_f32 v77, v97, s35, -v4
  v_fma_f32 v78, v98, s35, -v4
  v_fma_f32 v79, v99, s35, -v4
  v_fma_f32 v80, v100, s35, -v4
  v_fma_f32 v81, v101, s35, -v4
  v_fma_f32 v82, v102, s35, -v4
  v_fma_f32 v83, v103, s35, -v4
  v_fma_f32 v84, v104, s35, -v4
  v_fma_f32 v85, v105, s35, -v4
  v_fma_f32 v86, v106, s35, -v4
  v_fma_f32 v87, v107, s35, -v4
  v_exp_f32 v76, v76
  v_exp_f32 v77, v77
  v_exp_f32 v78, v78
  v_exp_f32 v79, v79
  v_exp_f32 v80, v80
  v_exp_f32 v81, v81
  v_exp_f32 v82, v82
  v_exp_f32 v83, v83
  v_exp_f32 v84, v84
  v_exp_f32 v85, v85
  v_exp_f32 v86, v86
  v_exp_f32 v87, v87
  s_nop 0
  v_pk_add_f32 v[96:97], v[76:77], v[78:79]
  v_pk_add_f32 v[98:99], v[80:81], v[82:83]
  v_pk_add_f32 v[100:101], v[84:85], v[86:87]
  v_pk_add_f32 v[96:97], v[96:97], v[98:99]
  v_pk_add_f32 v[96:97], v[96:97], v[100:101]
  v_add_f32 v4, v96, v97
  v_mov_b32 v5, v4
  s_nop 1
  v_permlane32_swap_b32 v4, v5
  v_add_f32 v4, v4, v5
  v_mov_b32 v5, v4
  s_nop 1
  v_permlane16_swap_b32 v4, v5
  v_add_f32 v4, v4, v5
  v_rcp_f32 v4, v4
  s_nop 0
  v_mov_b32 v5, v4
  v_pk_mul_f32 v[76:77], v[76:77], v[4:5]
  v_pk_mul_f32 v[78:79], v[78:79], v[4:5]
  v_pk_mul_f32 v[80:81], v[80:81], v[4:5]
  v_pk_mul_f32 v[82:83], v[82:83], v[4:5]
  v_pk_mul_f32 v[84:85], v[84:85], v[4:5]
  v_pk_mul_f32 v[86:87], v[86:87], v[4:5]
  v_cvt_pk_bf16_f32 v144, v76, v77
  v_cvt_pk_bf16_f32 v145, v78, v79
  v_cvt_pk_bf16_f32 v146, v80, v81
  v_cvt_pk_bf16_f32 v147, v82, v83
  v_cvt_pk_bf16_f32 v148, v84, v85
  v_cvt_pk_bf16_f32 v149, v86, v87
  v_mov_b32 v48, 0
  v_mov_b32 v49, 0
  v_mov_b32 v4, v144
  v_mov_b32 v5, v145
  s_nop 1
  v_permlane32_swap_b32 v4, v48
  v_permlane32_swap_b32 v5, v49
  s_waitcnt vmcnt(0)
  s_nop 1
  v_mfma_f32_16x16x32_bf16 v[152:155], v[52:55], v[146:149], 0
  v_mfma_f32_16x16x32_bf16 v[156:159], v[56:59], v[146:149], 0
  v_mfma_f32_16x16x32_bf16 v[160:163], v[60:63], v[146:149], 0
  v_mfma_f32_16x16x32_bf16 v[164:167], v[64:67], v[146:149], 0
  v_mfma_f32_16x16x32_bf16 v[168:171], v[68:71], v[146:149], 0
  v_mfma_f32_16x16x32_bf16 v[172:175], v[72:75], v[146:149], 0
  s_cmp_eq_u32 s34, 1
  s_cbranch_scc1 L_pvh1_fx
  v_mfma_f32_16x16x16_bf16 v[152:155], v[36:37], v[144:145], v[152:155]
  v_mfma_f32_16x16x16_bf16 v[156:159], v[36:37], v[48:49], v[156:159]
  v_mfma_f32_16x16x16_bf16 v[160:163], v[38:39], v[144:145], v[160:163]
  v_mfma_f32_16x16x16_bf16 v[164:167], v[38:39], v[48:49], v[164:167]
  v_mfma_f32_16x16x16_bf16 v[168:171], v[40:41], v[144:145], v[168:171]
  v_mfma_f32_16x16x16_bf16 v[172:175], v[40:41], v[48:49], v[172:175]
  s_branch L_pvd_fx
L_pvh1_fx:
  v_mfma_f32_16x16x16_bf16 v[152:155], v[42:43], v[144:145], v[152:155]
  v_mfma_f32_16x16x16_bf16 v[156:159], v[42:43], v[48:49], v[156:159]
  v_mfma_f32_16x16x16_bf16 v[160:163], v[44:45], v[144:145], v[160:163]
  v_mfma_f32_16x16x16_bf16 v[164:167], v[44:45], v[48:49], v[164:167]
  v_mfma_f32_16x16x16_bf16 v[168:171], v[46:47], v[144:145], v[168:171]
  v_mfma_f32_16x16x16_bf16 v[172:175], v[46:47], v[48:49], v[172:175]
L_pvd_fx:
  s_nop 7
  v_cvt_pk_bf16_f32 v176, v152, v153
  v_cvt_pk_bf16_f32 v177, v154, v155
  v_cvt_pk_bf16_f32 v178, v156, v157
  v_cvt_pk_bf16_f32 v179, v158, v159
  v_cvt_pk_bf16_f32 v180, v160, v161
  v_cvt_pk_bf16_f32 v181, v162, v163
  v_cvt_pk_bf16_f32 v182, v164, v165
  v_cvt_pk_bf16_f32 v183, v166, v167
  v_cvt_pk_bf16_f32 v184, v168, v169
  v_cvt_pk_bf16_f32 v185, v170, v171
  v_cvt_pk_bf16_f32 v186, v172, v173
  v_cvt_pk_bf16_f32 v187, v174, v175
  s_lshl_b32 s72, s37, 1
  s_add_u32 s72, s72, s33
  s_mul_i32 s72, s72, 6144
  s_add_u32 s72, s72, 109117440
  s_mul_i32 s73, s34, 3072
  s_add_u32 s73, s73, s72
  buffer_store_dwordx4 v[176:179], v200, s[4:7], s73 offen offset:0
  buffer_store_dwordx4 v[180:183], v200, s[4:7], s73 offen offset:1024
  buffer_store_dwordx4 v[184:187], v200, s[4:7], s73 offen offset:2048
  s_lshl_b32 s72, s37, 4
  s_lshl_b32 s73, s29, 2
  s_add_u32 s72, s72, s73
  s_add_u32 s66, s72, 108331008
  s_barrier
L_noat_fx:
  s_and_b32 s72, s30, 1
  s_cmp_eq_u32 s72, 1
  s_cbranch_scc1 L_nog2_fx
  s_cmp_lt_u32 s30, 6
  s_cbranch_scc1 L_nog2_fx
  s_cmp_gt_u32 s30, 68
  s_cbranch_scc1 L_nog2_fx
  s_sub_u32 s64, s30, 6
  s_lshl_b32 s37, s36, 6
  s_add_u32 s37, s37, s64
  s_lshl_b32 s72, s37, 4
  s_add_u32 s38, s72, 108331008
L_wfat_9_fx:
  buffer_load_dword v4, v208, s[4:7], s38 offen sc1
  s_waitcnt vmcnt(0)
  s_cmp_eq_u32 s66, 0
  s_cbranch_scc1 L_fl_11_fx
  buffer_store_dword v217, v210, s[4:7], s66 offen
  s_mov_b32 s66, 0
L_fl_11_fx:
  s_cmp_eq_u32 s67, 0
  s_cbranch_scc1 L_fl_12_fx
  buffer_store_dword v217, v210, s[4:7], s67 offen sc1
  buffer_store_dword v217, v210, s[4:7], s67 offen offset:2048 sc1
  s_mov_b32 s67, 0
L_fl_12_fx:
  v_cmp_eq_u32 vcc, 0, v4
  s_cbranch_vccz L_wkat_10_fx
  s_add_u32 s71, s71, 1
  s_cmp_gt_u32 s71, 1600000
  s_cbranch_scc1 L_p2done_fx
  s_sleep 6
  s_branch L_wfat_9_fx
L_wkat_10_fx:
  s_lshl_b32 s72, s37, 1
  s_add_u32 s72, s72, s32
  s_mul_i32 s38, s72, 6144
  s_add_u32 s38, s38, 109117440
  s_mul_i32 s73, s72, 1536
  s_add_u32 s73, s73, 78118912
  s_add_u32 s39, s38, 4096
  buffer_load_dwordx4 v[8:11], v200, s[4:7], s38 offen offset:0 sc1
  buffer_load_dwordx4 v[12:15], v200, s[4:7], s38 offen offset:1024 sc1
  buffer_load_dwordx4 v[16:19], v200, s[4:7], s38 offen offset:2048 sc1
  buffer_load_dwordx4 v[20:23], v200, s[4:7], s38 offen offset:3072 sc1
  buffer_load_dwordx4 v[24:27], v200, s[4:7], s39 offen offset:0 sc1
  buffer_load_dwordx4 v[28:31], v200, s[4:7], s39 offen offset:1024 sc1
  buffer_load_dwordx4 v[32:35], v200, s[4:7], s73 offen sc1
  buffer_load_dwordx2 v[36:37], v201, s[4:7], s73 offen offset:1024 sc1
  s_add_u32 s38, s38, 12288
  s_add_u32 s73, s73, 3072
  s_add_u32 s39, s38, 4096
  buffer_load_dwordx4 v[80:83], v200, s[4:7], s38 offen offset:0 sc1
  buffer_load_dwordx4 v[84:87], v200, s[4:7], s38 offen offset:1024 sc1
  buffer_load_dwordx4 v[88:91], v200, s[4:7], s38 offen offset:2048 sc1
  buffer_load_dwordx4 v[92:95], v200, s[4:7], s38 offen offset:3072 sc1
  buffer_load_dwordx4 v[96:99], v200, s[4:7], s39 offen offset:0 sc1
  buffer_load_dwordx4 v[100:103], v200, s[4:7], s39 offen offset:1024 sc1
  buffer_load_dwordx4 v[104:107], v200, s[4:7], s73 offen sc1
  buffer_load_dwordx2 v[108:109], v201, s[4:7], s73 offen offset:1024 sc1
  s_waitcnt vmcnt(8)
  v_mfma_f32_16x16x32_bf16 v[40:43], a[0:3], v[8:11], 0
  v_mfma_f32_16x16x32_bf16 v[44:47], a[30:33], v[8:11], 0
  v_mfma_f32_16x16x32_bf16 v[48:51], a[60:63], v[8:11], 0
  v_mfma_f32_16x16x32_bf16 v[52:55], a[90:93], v[8:11], 0
  v_mfma_f32_16x16x32_bf16 v[56:59], a[120:123], v[8:11], 0
  v_mfma_f32_16x16x32_bf16 v[40:43], a[4:7], v[12:15], v[40:43]
  v_mfma_f32_16x16x32_bf16 v[44:47], a[34:37], v[12:15], v[44:47]
  v_mfma_f32_16x16x32_bf16 v[48:51], a[64:67], v[12:15], v[48:51]
  v_mfma_f32_16x16x32_bf16 v[52:55], a[94:97], v[12:15], v[52:55]
  v_mfma_f32_16x16x32_bf16 v[56:59], a[124:127], v[12:15], v[56:59]
  v_mfma_f32_16x16x32_bf16 v[40:43], a[8:11], v[16:19], v[40:43]
  v_mfma_f32_16x16x32_bf16 v[44:47], a[38:41], v[16:19], v[44:47]
  v_mfma_f32_16x16x32_bf16 v[48:51], a[68:71], v[16:19], v[48:51]
  v_mfma_f32_16x16x32_bf16 v[52:55], a[98:101], v[16:19], v[52:55]
  v_mfma_f32_16x16x32_bf16 v[56:59], a[128:131], v[16:19], v[56:59]
  v_mfma_f32_16x16x32_bf16 v[40:43], a[12:15], v[20:23], v[40:43]
  v_mfma_f32_16x16x32_bf16 v[44:47], a[42:45], v[20:23], v[44:47]
  v_mfma_f32_16x16x32_bf16 v[48:51], a[72:75], v[20:23], v[48:51]
  v_mfma_f32_16x16x32_bf16 v[52:55], a[102:105], v[20:23], v[52:55]
  v_mfma_f32_16x16x32_bf16 v[56:59], a[132:135], v[20:23], v[56:59]
  v_mfma_f32_16x16x32_bf16 v[40:43], a[16:19], v[24:27], v[40:43]
  v_mfma_f32_16x16x32_bf16 v[44:47], a[46:49], v[24:27], v[44:47]
  v_mfma_f32_16x16x32_bf16 v[48:51], a[76:79], v[24:27], v[48:51]
  v_mfma_f32_16x16x32_bf16 v[52:55], a[106:109], v[24:27], v[52:55]
  v_mfma_f32_16x16x32_bf16 v[56:59], a[136:139], v[24:27], v[56:59]
  v_mfma_f32_16x16x32_bf16 v[40:43], a[20:23], v[28:31], v[40:43]
  v_mfma_f32_16x16x32_bf16 v[44:47], a[50:53], v[28:31], v[44:47]
  v_mfma_f32_16x16x32_bf16 v[48:51], a[80:83], v[28:31], v[48:51]
  v_mfma_f32_16x16x32_bf16 v[52:55], a[110:113], v[28:31], v[52:55]
  v_mfma_f32_16x16x32_bf16 v[56:59], a[140:143], v[28:31], v[56:59]
  v_mfma_f32_16x16x32_bf16 v[40:43], a[24:27], v[32:35], v[40:43]
  v_mfma_f32_16x16x32_bf16 v[44:47], a[54:57], v[32:35], v[44:47]
  v_mfma_f32_16x16x32_bf16 v[48:51], a[84:87], v[32:35], v[48:51]
  v_mfma_f32_16x16x32_bf16 v[52:55], a[114:117], v[32:35], v[52:55]
  v_mfma_f32_16x16x32_bf16 v[56:59], a[144:147], v[32:35], v[56:59]
  v_mfma_f32_16x16x16_bf16 v[40:43], a[28:29], v[36:37], v[40:43]
  v_mfma_f32_16x16x16_bf16 v[44:47], a[58:59], v[36:37], v[44:47]
  v_mfma_f32_16x16x16_bf16 v[48:51], a[88:89], v[36:37], v[48:51]
  v_mfma_f32_16x16x16_bf16 v[52:55], a[118:119], v[36:37], v[52:55]
  v_mfma_f32_16x16x16_bf16 v[56:59], a[148:149], v[36:37], v[56:59]
  s_waitcnt vmcnt(0)
  v_mfma_f32_16x16x32_bf16 v[60:63], a[0:3], v[80:83], 0
  v_mfma_f32_16x16x32_bf16 v[64:67], a[30:33], v[80:83], 0
  v_mfma_f32_16x16x32_bf16 v[68:71], a[60:63], v[80:83], 0
  v_mfma_f32_16x16x32_bf16 v[72:75], a[90:93], v[80:83], 0
  v_mfma_f32_16x16x32_bf16 v[76:79], a[120:123], v[80:83], 0
  v_mfma_f32_16x16x32_bf16 v[60:63], a[4:7], v[84:87], v[60:63]
  v_mfma_f32_16x16x32_bf16 v[64:67], a[34:37], v[84:87], v[64:67]
  v_mfma_f32_16x16x32_bf16 v[68:71], a[64:67], v[84:87], v[68:71]
  v_mfma_f32_16x16x32_bf16 v[72:75], a[94:97], v[84:87], v[72:75]
  v_mfma_f32_16x16x32_bf16 v[76:79], a[124:127], v[84:87], v[76:79]
  v_mfma_f32_16x16x32_bf16 v[60:63], a[8:11], v[88:91], v[60:63]
  v_mfma_f32_16x16x32_bf16 v[64:67], a[38:41], v[88:91], v[64:67]
  v_mfma_f32_16x16x32_bf16 v[68:71], a[68:71], v[88:91], v[68:71]
  v_mfma_f32_16x16x32_bf16 v[72:75], a[98:101], v[88:91], v[72:75]
  v_mfma_f32_16x16x32_bf16 v[76:79], a[128:131], v[88:91], v[76:79]
  v_mfma_f32_16x16x32_bf16 v[60:63], a[12:15], v[92:95], v[60:63]
  v_mfma_f32_16x16x32_bf16 v[64:67], a[42:45], v[92:95], v[64:67]
  v_mfma_f32_16x16x32_bf16 v[68:71], a[72:75], v[92:95], v[68:71]
  v_mfma_f32_16x16x32_bf16 v[72:75], a[102:105], v[92:95], v[72:75]
  v_mfma_f32_16x16x32_bf16 v[76:79], a[132:135], v[92:95], v[76:79]
  v_mfma_f32_16x16x32_bf16 v[60:63], a[16:19], v[96:99], v[60:63]
  v_mfma_f32_16x16x32_bf16 v[64:67], a[46:49], v[96:99], v[64:67]
  v_mfma_f32_16x16x32_bf16 v[68:71], a[76:79], v[96:99], v[68:71]
  v_mfma_f32_16x16x32_bf16 v[72:75], a[106:109], v[96:99], v[72:75]
  v_mfma_f32_16x16x32_bf16 v[76:79], a[136:139], v[96:99], v[76:79]
  v_mfma_f32_16x16x32_bf16 v[60:63], a[20:23], v[100:103], v[60:63]
  v_mfma_f32_16x16x32_bf16 v[64:67], a[50:53], v[100:103], v[64:67]
  v_mfma_f32_16x16x32_bf16 v[68:71], a[80:83], v[100:103], v[68:71]
  v_mfma_f32_16x16x32_bf16 v[72:75], a[110:113], v[100:103], v[72:75]
  v_mfma_f32_16x16x32_bf16 v[76:79], a[140:143], v[100:103], v[76:79]
  v_mfma_f32_16x16x32_bf16 v[60:63], a[24:27], v[104:107], v[60:63]
  v_mfma_f32_16x16x32_bf16 v[64:67], a[54:57], v[104:107], v[64:67]
  v_mfma_f32_16x16x32_bf16 v[68:71], a[84:87], v[104:107], v[68:71]
  v_mfma_f32_16x16x32_bf16 v[72:75], a[114:117], v[104:107], v[72:75]
  v_mfma_f32_16x16x32_bf16 v[76:79], a[144:147], v[104:107], v[76:79]
  v_mfma_f32_16x16x16_bf16 v[60:63], a[28:29], v[108:109], v[60:63]
  v_mfma_f32_16x16x16_bf16 v[64:67], a[58:59], v[108:109], v[64:67]
  v_mfma_f32_16x16x16_bf16 v[68:71], a[88:89], v[108:109], v[68:71]
  v_mfma_f32_16x16x16_bf16 v[72:75], a[118:119], v[108:109], v[72:75]
  v_mfma_f32_16x16x16_bf16 v[76:79], a[148:149], v[108:109], v[76:79]
  s_nop 7
  ds_write_b128 v212, v[40:43] offset:0
  ds_write_b128 v212, v[44:47] offset:1024
  ds_write_b128 v212, v[48:51] offset:2048
  ds_write_b128 v212, v[52:55] offset:3072
  ds_write_b128 v212, v[56:59] offset:4096
  ds_write_b128 v212, v[60:63] offset:5120
  ds_write_b128 v212, v[64:67] offset:6144
  ds_write_b128 v212, v[68:71] offset:7168
  ds_write_b128 v212, v[72:75] offset:8192
  ds_write_b128 v212, v[76:79] offset:9216
  s_waitcnt lgkmcnt(0)
  s_barrier
  s_lshl_b32 s72, s64, 4
  s_add_u32 s72, s72, s25
  s_lshl_b32 s72, s72, 3
  s_add_u32 s72, s72, s24
  s_mul_i32 s38, s72, 5120
  s_add_u32 s38, s38, 134283264
  s_lshl_b32 s74, s29, 10
  s_add_u32 s73, s38, s74
  ds_read_b128 v[112:115], v213 offset:0
  ds_read_b128 v[116:119], v213 offset:10240
  ds_read_b128 v[120:123], v213 offset:20480
  ds_read_b128 v[124:127], v213 offset:30720
  s_waitcnt lgkmcnt(0)
  v_pk_add_f32 v[112:113], v[112:113], v[116:117]
  v_pk_add_f32 v[114:115], v[114:115], v[118:119]
  v_pk_add_f32 v[120:121], v[120:121], v[124:125]
  v_pk_add_f32 v[122:123], v[122:123], v[126:127]
  v_pk_add_f32 v[112:113], v[112:113], v[120:121]
  v_pk_add_f32 v[114:115], v[114:115], v[122:123]
  buffer_store_dwordx4 v[112:115], v200, s[4:7], s73 offen sc1
  s_nop 1
  s_add_u32 s73, s73, 655360
  ds_read_b128 v[112:115], v213 offset:5120
  ds_read_b128 v[116:119], v213 offset:15360
  ds_read_b128 v[120:123], v213 offset:25600
  ds_read_b128 v[124:127], v213 offset:35840
  s_waitcnt lgkmcnt(0)
  v_pk_add_f32 v[112:113], v[112:113], v[116:117]
  v_pk_add_f32 v[114:115], v[114:115], v[118:119]
  v_pk_add_f32 v[120:121], v[120:121], v[124:125]
  v_pk_add_f32 v[122:123], v[122:123], v[126:127]
  v_pk_add_f32 v[112:113], v[112:113], v[120:121]
  v_pk_add_f32 v[114:115], v[114:115], v[122:123]
  buffer_store_dwordx4 v[112:115], v200, s[4:7], s73 offen sc1
  s_nop 1
  s_cmp_ge_u32 s29, 2
  s_cbranch_scc1 L_g2f_fx
  s_cmp_eq_u32 s29, 1
  s_cbranch_scc1 L_g2f1_fx
  s_add_u32 s73, s38, 4096
  ds_read_b128 v[112:115], v213 offset:4096
  ds_read_b128 v[116:119], v213 offset:14336
  ds_read_b128 v[120:123], v213 offset:24576
  ds_read_b128 v[124:127], v213 offset:34816
  s_waitcnt lgkmcnt(0)
  v_pk_add_f32 v[112:113], v[112:113], v[116:117]
  v_pk_add_f32 v[114:115], v[114:115], v[118:119]
  v_pk_add_f32 v[120:121], v[120:121], v[124:125]
  v_pk_add_f32 v[122:123], v[122:123], v[126:127]
  v_pk_add_f32 v[112:113], v[112:113], v[120:121]
  v_pk_add_f32 v[114:115], v[114:115], v[122:123]
  buffer_store_dwordx4 v[112:115], v200, s[4:7], s73 offen sc1
  s_nop 1
  s_branch L_g2f_fx
L_g2f1_fx:
  s_add_u32 s73, s38, 659456
  ds_read_b128 v[112:115], v213 offset:8192
  ds_read_b128 v[116:119], v213 offset:18432
  ds_read_b128 v[120:123], v213 offset:28672
  ds_read_b128 v[124:127], v213 offset:38912
  s_waitcnt lgkmcnt(0)
  v_pk_add_f32 v[112:113], v[112:113], v[116:117]
  v_pk_add_f32 v[114:115], v[114:115], v[118:119]
  v_pk_add_f32 v[120:121], v[120:121], v[124:125]
  v_pk_add_f32 v[122:123], v[122:123], v[126:127]
  v_pk_add_f32 v[112:113], v[112:113], v[120:121]
  v_pk_add_f32 v[114:115], v[114:115], v[122:123]
  buffer_store_dwordx4 v[112:115], v200, s[4:7], s73 offen sc1
  s_nop 1
L_g2f_fx:
  s_lshl_b32 s72, s72, 4
  s_lshl_b32 s73, s29, 2
  s_add_u32 s72, s72, s73
  s_add_u32 s67, s72, 108494848
  s_barrier
L_nog2_fx:
  s_cmp_lt_u32 s30, 8
  s_cbranch_scc1 L_nox4_fx
  s_sub_u32 s64, s30, 8
  s_and_b32 s72, s64, 7
  s_cmp_lg_u32 s72, s24
  s_cbranch_scc1 L_nox4_fx
  s_lshl_b32 s72, s64, 4
  s_add_u32 s72, s72, s25
  s_lshl_b32 s38, s72, 7
  s_add_u32 s38, s38, 108494848
L_wfg2_13_fx:
  buffer_load_dword v4, v209, s[4:7], s38 offen sc1
  s_waitcnt vmcnt(0)
  s_cmp_eq_u32 s66, 0
  s_cbranch_scc1 L_fl_15_fx
  buffer_store_dword v217, v210, s[4:7], s66 offen
  s_mov_b32 s66, 0
L_fl_15_fx:
  s_cmp_eq_u32 s67, 0
  s_cbranch_scc1 L_fl_16_fx
  buffer_store_dword v217, v210, s[4:7], s67 offen sc1
  buffer_store_dword v217, v210, s[4:7], s67 offen offset:2048 sc1
  s_mov_b32 s67, 0
L_fl_16_fx:
  v_cmp_eq_u32 vcc, 0, v4
  s_cbranch_vccz L_wkg2_14_fx
  s_add_u32 s71, s71, 1
  s_cmp_gt_u32 s71, 1600000
  s_cbranch_scc1 L_p2done_fx
  s_sleep 6
  s_branch L_wfg2_13_fx
L_wkg2_14_fx:
  s_mul_i32 s38, s72, 40960
  s_add_u32 s38, s38, 134283264
  s_mul_i32 s39, s64, 40960
  s_lshl_b32 s74, s29, 10
  s_mov_b32 s75, 0
  s_add_u32 s73, s38, 0
  s_add_u32 s73, s73, s74
  buffer_load_dwordx4 v[8:11], v200, s[4:7], s73 offen sc1
  s_add_u32 s73, s38, 5120
  s_add_u32 s73, s73, s74
  buffer_load_dwordx4 v[12:15], v200, s[4:7], s73 offen sc1
  s_add_u32 s73, s38, 10240
  s_add_u32 s73, s73, s74
  buffer_load_dwordx4 v[16:19], v200, s[4:7], s73 offen sc1
  s_add_u32 s73, s38, 15360
  s_add_u32 s73, s73, s74
  buffer_load_dwordx4 v[20:23], v200, s[4:7], s73 offen sc1
  s_add_u32 s73, s38, 20480
  s_add_u32 s73, s73, s74
  buffer_load_dwordx4 v[24:27], v200, s[4:7], s73 offen sc1
  s_add_u32 s73, s38, 25600
  s_add_u32 s73, s73, s74
  buffer_load_dwordx4 v[28:31], v200, s[4:7], s73 offen sc1
  s_add_u32 s73, s38, 30720
  s_add_u32 s73, s73, s74
  buffer_load_dwordx4 v[32:35], v200, s[4:7], s73 offen sc1
  s_add_u32 s73, s38, 35840
  s_add_u32 s73, s73, s74
  buffer_load_dwordx4 v[36:39], v200, s[4:7], s73 offen sc1
  s_add_u32 s73, s39, s75
  buffer_load_dwordx2 v[40:41], v214, s[12:15], s73 offen
  s_waitcnt vmcnt(0)
  v_pk_add_f32 v[8:9], v[8:9], v[12:13]
  v_pk_add_f32 v[10:11], v[10:11], v[14:15]
  v_pk_add_f32 v[16:17], v[16:17], v[20:21]
  v_pk_add_f32 v[18:19], v[18:19], v[22:23]
  v_pk_add_f32 v[24:25], v[24:25], v[28:29]
  v_pk_add_f32 v[26:27], v[26:27], v[30:31]
  v_pk_add_f32 v[32:33], v[32:33], v[36:37]
  v_pk_add_f32 v[34:35], v[34:35], v[38:39]
  v_pk_add_f32 v[8:9], v[8:9], v[16:17]
  v_pk_add_f32 v[10:11], v[10:11], v[18:19]
  v_pk_add_f32 v[24:25], v[24:25], v[32:33]
  v_pk_add_f32 v[26:27], v[26:27], v[34:35]
  v_pk_add_f32 v[8:9], v[8:9], v[24:25]
  v_pk_add_f32 v[10:11], v[10:11], v[26:27]
  v_lshlrev_b32 v44, 16, v40
  v_and_b32 v45, 0xffff0000, v40
  v_lshlrev_b32 v46, 16, v41
  v_and_b32 v47, 0xffff0000, v41
  v_pk_add_f32 v[8:9], v[8:9], v[218:219]
  v_pk_add_f32 v[10:11], v[10:11], v[220:221]
  v_pk_add_f32 v[8:9], v[8:9], v[44:45]
  v_pk_add_f32 v[10:11], v[10:11], v[46:47]
  v_cvt_pk_bf16_f32 v48, v8, v9
  v_cvt_pk_bf16_f32 v49, v10, v11
  buffer_store_dwordx2 v[48:49], v214, s[16:19], s73 offen
  s_cmp_lg_u32 s29, 0
  s_cbranch_scc1 L_nox4_fx
  s_movk_i32 s74, 4096
  s_movk_i32 s75, 128
  s_add_u32 s73, s38, 0
  s_add_u32 s73, s73, s74
  buffer_load_dwordx4 v[8:11], v200, s[4:7], s73 offen sc1
  s_add_u32 s73, s38, 5120
  s_add_u32 s73, s73, s74
  buffer_load_dwordx4 v[12:15], v200, s[4:7], s73 offen sc1
  s_add_u32 s73, s38, 10240
  s_add_u32 s73, s73, s74
  buffer_load_dwordx4 v[16:19], v200, s[4:7], s73 offen sc1
  s_add_u32 s73, s38, 15360
  s_add_u32 s73, s73, s74
  buffer_load_dwordx4 v[20:23], v200, s[4:7], s73 offen sc1
  s_add_u32 s73, s38, 20480
  s_add_u32 s73, s73, s74
  buffer_load_dwordx4 v[24:27], v200, s[4:7], s73 offen sc1
  s_add_u32 s73, s38, 25600
  s_add_u32 s73, s73, s74
  buffer_load_dwordx4 v[28:31], v200, s[4:7], s73 offen sc1
  s_add_u32 s73, s38, 30720
  s_add_u32 s73, s73, s74
  buffer_load_dwordx4 v[32:35], v200, s[4:7], s73 offen sc1
  s_add_u32 s73, s38, 35840
  s_add_u32 s73, s73, s74
  buffer_load_dwordx4 v[36:39], v200, s[4:7], s73 offen sc1
  s_add_u32 s73, s39, s75
  buffer_load_dwordx2 v[40:41], v214, s[12:15], s73 offen
  s_waitcnt vmcnt(0)
  v_pk_add_f32 v[8:9], v[8:9], v[12:13]
  v_pk_add_f32 v[10:11], v[10:11], v[14:15]
  v_pk_add_f32 v[16:17], v[16:17], v[20:21]
  v_pk_add_f32 v[18:19], v[18:19], v[22:23]
  v_pk_add_f32 v[24:25], v[24:25], v[28:29]
  v_pk_add_f32 v[26:27], v[26:27], v[30:31]
  v_pk_add_f32 v[32:33], v[32:33], v[36:37]
  v_pk_add_f32 v[34:35], v[34:35], v[38:39]
  v_pk_add_f32 v[8:9], v[8:9], v[16:17]
  v_pk_add_f32 v[10:11], v[10:11], v[18:19]
  v_pk_add_f32 v[24:25], v[24:25], v[32:33]
  v_pk_add_f32 v[26:27], v[26:27], v[34:35]
  v_pk_add_f32 v[8:9], v[8:9], v[24:25]
  v_pk_add_f32 v[10:11], v[10:11], v[26:27]
  v_lshlrev_b32 v44, 16, v40
  v_and_b32 v45, 0xffff0000, v40
  v_lshlrev_b32 v46, 16, v41
  v_and_b32 v47, 0xffff0000, v41
  v_pk_add_f32 v[8:9], v[8:9], v[222:223]
  v_pk_add_f32 v[10:11], v[10:11], v[224:225]
  v_pk_add_f32 v[8:9], v[8:9], v[44:45]
  v_pk_add_f32 v[10:11], v[10:11], v[46:47]
  v_cvt_pk_bf16_f32 v48, v8, v9
  v_cvt_pk_bf16_f32 v49, v10, v11
  buffer_store_dwordx2 v[48:49], v214, s[16:19], s73 offen
L_nox4_fx:
  s_cmp_lt_u32 s30, 63
  s_cbranch_scc1 L_p2nf_fx
  s_waitcnt vmcnt(0)
  s_cmp_eq_u32 s66, 0
  s_cbranch_scc1 L_fl_17_fx
  buffer_store_dword v217, v210, s[4:7], s66 offen
  s_mov_b32 s66, 0
L_fl_17_fx:
  s_cmp_eq_u32 s67, 0
  s_cbranch_scc1 L_fl_18_fx
  buffer_store_dword v217, v210, s[4:7], s67 offen sc1
  buffer_store_dword v217, v210, s[4:7], s67 offen offset:2048 sc1
  s_mov_b32 s67, 0
L_fl_18_fx:
L_p2nf_fx:
  s_add_u32 s30, s30, 1
  s_cmp_lt_u32 s30, 72
  s_cbranch_scc1 L_p2loop_fx
L_p2done_fx:
  s_branch L_mend
L_slow:
  s_waitcnt vmcnt(0) lgkmcnt(0)
  s_barrier
  s_and_b32 s24, s22, 7
  s_lshr_b32 s72, s22, 3
  s_cmp_ge_u32 s72, 16
  s_cbranch_scc1 L_slowx
  s_mov_b32 s25, s72
  s_mov_b32 s71, 0
  s_lshr_b32 s26, s25, 2
  s_and_b32 s27, s25, 3
  s_lshl_b32 s28, s24, 2
  s_add_u32 s31, s28, s29
  s_add_u32 s28, s28, s26
  s_mov_b32 s70, 0x3dd53b95
  s_mov_b32 s10, 7864320
  s_mov_b32 s11, 0x00020000
  v_lshrrev_b32 v4, 2, v2
  v_and_b32 v5, 3, v2
  s_mul_i32 s72, s29, 160
  v_lshl_add_u32 v6, v3, 3, v4
  v_add_u32 v6, s72, v6
  v_mul_u32_u24 v6, 96, v6
  v_lshl_add_u32 v20, v5, 3, v6
  v_lshl_add_u32 v6, v3, 2, v4
  v_mul_u32_u24 v6, 96, v6
  v_lshl_add_u32 v21, v5, 3, v6
  s_mul_i32 s72, s29, 18432
  v_add_u32 v21, s72, v21
  s_mul_i32 s72, s29, 960
  s_add_u32 s72, s72, 0
  v_add_u32 v6, s72, v1
  s_mov_b32 s73, 43691
  v_mul_lo_u32 v7, v6, s73
  v_lshrrev_b32 v7, 18, v7
  v_mul_u32_u24 v30, 6, v7
  v_sub_u32 v30, v6, v30
  v_lshlrev_b32 v30, 4, v30
  s_movk_i32 s73, 12288
  v_mad_u32_u24 v30, v7, s73, v30
  v_add_u32 v6, 0, v1
  s_mov_b32 s73, 43691
  v_mul_lo_u32 v7, v6, s73
  v_lshrrev_b32 v7, 18, v7
  v_mul_u32_u24 v50, 6, v7
  v_sub_u32 v50, v6, v50
  v_lshlrev_b32 v50, 4, v50
  s_movk_i32 s73, 1280
  v_mad_u32_u24 v50, v7, s73, v50
  s_mul_i32 s72, s29, 960
  s_add_u32 s72, s72, 64
  v_add_u32 v6, s72, v1
  s_mov_b32 s73, 43691
  v_mul_lo_u32 v7, v6, s73
  v_lshrrev_b32 v7, 18, v7
  v_mul_u32_u24 v31, 6, v7
  v_sub_u32 v31, v6, v31
  v_lshlrev_b32 v31, 4, v31
  s_movk_i32 s73, 12288
  v_mad_u32_u24 v31, v7, s73, v31
  v_add_u32 v6, 64, v1
  s_mov_b32 s73, 43691
  v_mul_lo_u32 v7, v6, s73
  v_lshrrev_b32 v7, 18, v7
  v_mul_u32_u24 v51, 6, v7
  v_sub_u32 v51, v6, v51
  v_lshlrev_b32 v51, 4, v51
  s_movk_i32 s73, 1280
  v_mad_u32_u24 v51, v7, s73, v51
  s_mul_i32 s72, s29, 960
  s_add_u32 s72, s72, 128
  v_add_u32 v6, s72, v1
  s_mov_b32 s73, 43691
  v_mul_lo_u32 v7, v6, s73
  v_lshrrev_b32 v7, 18, v7
  v_mul_u32_u24 v32, 6, v7
  v_sub_u32 v32, v6, v32
  v_lshlrev_b32 v32, 4, v32
  s_movk_i32 s73, 12288
  v_mad_u32_u24 v32, v7, s73, v32
  v_add_u32 v6, 128, v1
  s_mov_b32 s73, 43691
  v_mul_lo_u32 v7, v6, s73
  v_lshrrev_b32 v7, 18, v7
  v_mul_u32_u24 v52, 6, v7
  v_sub_u32 v52, v6, v52
  v_lshlrev_b32 v52, 4, v52
  s_movk_i32 s73, 1280
  v_mad_u32_u24 v52, v7, s73, v52
  s_mul_i32 s72, s29, 960
  s_add_u32 s72, s72, 192
  v_add_u32 v6, s72, v1
  s_mov_b32 s73, 43691
  v_mul_lo_u32 v7, v6, s73
  v_lshrrev_b32 v7, 18, v7
  v_mul_u32_u24 v33, 6, v7
  v_sub_u32 v33, v6, v33
  v_lshlrev_b32 v33, 4, v33
  s_movk_i32 s73, 12288
  v_mad_u32_u24 v33, v7, s73, v33
  v_add_u32 v6, 192, v1
  s_mov_b32 s73, 43691
  v_mul_lo_u32 v7, v6, s73
  v_lshrrev_b32 v7, 18, v7
  v_mul_u32_u24 v53, 6, v7
  v_sub_u32 v53, v6, v53
  v_lshlrev_b32 v53, 4, v53
  s_movk_i32 s73, 1280
  v_mad_u32_u24 v53, v7, s73, v53
  s_mul_i32 s72, s29, 960
  s_add_u32 s72, s72, 256
  v_add_u32 v6, s72, v1
  s_mov_b32 s73, 43691
  v_mul_lo_u32 v7, v6, s73
  v_lshrrev_b32 v7, 18, v7
  v_mul_u32_u24 v34, 6, v7
  v_sub_u32 v34, v6, v34
  v_lshlrev_b32 v34, 4, v34
  s_movk_i32 s73, 12288
  v_mad_u32_u24 v34, v7, s73, v34
  v_add_u32 v6, 256, v1
  s_mov_b32 s73, 43691
  v_mul_lo_u32 v7, v6, s73
  v_lshrrev_b32 v7, 18, v7
  v_mul_u32_u24 v54, 6, v7
  v_sub_u32 v54, v6, v54
  v_lshlrev_b32 v54, 4, v54
  s_movk_i32 s73, 1280
  v_mad_u32_u24 v54, v7, s73, v54
  s_mul_i32 s72, s29, 960
  s_add_u32 s72, s72, 320
  v_add_u32 v6, s72, v1
  s_mov_b32 s73, 43691
  v_mul_lo_u32 v7, v6, s73
  v_lshrrev_b32 v7, 18, v7
  v_mul_u32_u24 v35, 6, v7
  v_sub_u32 v35, v6, v35
  v_lshlrev_b32 v35, 4, v35
  s_movk_i32 s73, 12288
  v_mad_u32_u24 v35, v7, s73, v35
  v_add_u32 v6, 320, v1
  s_mov_b32 s73, 43691
  v_mul_lo_u32 v7, v6, s73
  v_lshrrev_b32 v7, 18, v7
  v_mul_u32_u24 v55, 6, v7
  v_sub_u32 v55, v6, v55
  v_lshlrev_b32 v55, 4, v55
  s_movk_i32 s73, 1280
  v_mad_u32_u24 v55, v7, s73, v55
  s_mul_i32 s72, s29, 960
  s_add_u32 s72, s72, 384
  v_add_u32 v6, s72, v1
  s_mov_b32 s73, 43691
  v_mul_lo_u32 v7, v6, s73
  v_lshrrev_b32 v7, 18, v7
  v_mul_u32_u24 v36, 6, v7
  v_sub_u32 v36, v6, v36
  v_lshlrev_b32 v36, 4, v36
  s_movk_i32 s73, 12288
  v_mad_u32_u24 v36, v7, s73, v36
  v_add_u32 v6, 384, v1
  s_mov_b32 s73, 43691
  v_mul_lo_u32 v7, v6, s73
  v_lshrrev_b32 v7, 18, v7
  v_mul_u32_u24 v56, 6, v7
  v_sub_u32 v56, v6, v56
  v_lshlrev_b32 v56, 4, v56
  s_movk_i32 s73, 1280
  v_mad_u32_u24 v56, v7, s73, v56
  s_mul_i32 s72, s29, 960
  s_add_u32 s72, s72, 448
  v_add_u32 v6, s72, v1
  s_mov_b32 s73, 43691
  v_mul_lo_u32 v7, v6, s73
  v_lshrrev_b32 v7, 18, v7
  v_mul_u32_u24 v37, 6, v7
  v_sub_u32 v37, v6, v37
  v_lshlrev_b32 v37, 4, v37
  s_movk_i32 s73, 12288
  v_mad_u32_u24 v37, v7, s73, v37
  v_add_u32 v6, 448, v1
  s_mov_b32 s73, 43691
  v_mul_lo_u32 v7, v6, s73
  v_lshrrev_b32 v7, 18, v7
  v_mul_u32_u24 v57, 6, v7
  v_sub_u32 v57, v6, v57
  v_lshlrev_b32 v57, 4, v57
  s_movk_i32 s73, 1280
  v_mad_u32_u24 v57, v7, s73, v57
  s_mul_i32 s72, s29, 960
  s_add_u32 s72, s72, 512
  v_add_u32 v6, s72, v1
  s_mov_b32 s73, 43691
  v_mul_lo_u32 v7, v6, s73
  v_lshrrev_b32 v7, 18, v7
  v_mul_u32_u24 v38, 6, v7
  v_sub_u32 v38, v6, v38
  v_lshlrev_b32 v38, 4, v38
  s_movk_i32 s73, 12288
  v_mad_u32_u24 v38, v7, s73, v38
  v_add_u32 v6, 512, v1
  s_mov_b32 s73, 43691
  v_mul_lo_u32 v7, v6, s73
  v_lshrrev_b32 v7, 18, v7
  v_mul_u32_u24 v58, 6, v7
  v_sub_u32 v58, v6, v58
  v_lshlrev_b32 v58, 4, v58
  s_movk_i32 s73, 1280
  v_mad_u32_u24 v58, v7, s73, v58
  s_mul_i32 s72, s29, 960
  s_add_u32 s72, s72, 576
  v_add_u32 v6, s72, v1
  s_mov_b32 s73, 43691
  v_mul_lo_u32 v7, v6, s73
  v_lshrrev_b32 v7, 18, v7
  v_mul_u32_u24 v39, 6, v7
  v_sub_u32 v39, v6, v39
  v_lshlrev_b32 v39, 4, v39
  s_movk_i32 s73, 12288
  v_mad_u32_u24 v39, v7, s73, v39
  v_add_u32 v6, 576, v1
  s_mov_b32 s73, 43691
  v_mul_lo_u32 v7, v6, s73
  v_lshrrev_b32 v7, 18, v7
  v_mul_u32_u24 v59, 6, v7
  v_sub_u32 v59, v6, v59
  v_lshlrev_b32 v59, 4, v59
  s_movk_i32 s73, 1280
  v_mad_u32_u24 v59, v7, s73, v59
  s_mul_i32 s72, s29, 960
  s_add_u32 s72, s72, 640
  v_add_u32 v6, s72, v1
  s_mov_b32 s73, 43691
  v_mul_lo_u32 v7, v6, s73
  v_lshrrev_b32 v7, 18, v7
  v_mul_u32_u24 v40, 6, v7
  v_sub_u32 v40, v6, v40
  v_lshlrev_b32 v40, 4, v40
  s_movk_i32 s73, 12288
  v_mad_u32_u24 v40, v7, s73, v40
  v_add_u32 v6, 640, v1
  s_mov_b32 s73, 43691
  v_mul_lo_u32 v7, v6, s73
  v_lshrrev_b32 v7, 18, v7
  v_mul_u32_u24 v60, 6, v7
  v_sub_u32 v60, v6, v60
  v_lshlrev_b32 v60, 4, v60
  s_movk_i32 s73, 1280
  v_mad_u32_u24 v60, v7, s73, v60
  s_mul_i32 s72, s29, 960
  s_add_u32 s72, s72, 704
  v_add_u32 v6, s72, v1
  s_mov_b32 s73, 43691
  v_mul_lo_u32 v7, v6, s73
  v_lshrrev_b32 v7, 18, v7
  v_mul_u32_u24 v41, 6, v7
  v_sub_u32 v41, v6, v41
  v_lshlrev_b32 v41, 4, v41
  s_movk_i32 s73, 12288
  v_mad_u32_u24 v41, v7, s73, v41
  v_add_u32 v6, 704, v1
  s_mov_b32 s73, 43691
  v_mul_lo_u32 v7, v6, s73
  v_lshrrev_b32 v7, 18, v7
  v_mul_u32_u24 v61, 6, v7
  v_sub_u32 v61, v6, v61
  v_lshlrev_b32 v61, 4, v61
  s_movk_i32 s73, 1280
  v_mad_u32_u24 v61, v7, s73, v61
  s_mul_i32 s72, s29, 960
  s_add_u32 s72, s72, 768
  v_add_u32 v6, s72, v1
  s_mov_b32 s73, 43691
  v_mul_lo_u32 v7, v6, s73
  v_lshrrev_b32 v7, 18, v7
  v_mul_u32_u24 v42, 6, v7
  v_sub_u32 v42, v6, v42
  v_lshlrev_b32 v42, 4, v42
  s_movk_i32 s73, 12288
  v_mad_u32_u24 v42, v7, s73, v42
  v_add_u32 v6, 768, v1
  s_mov_b32 s73, 43691
  v_mul_lo_u32 v7, v6, s73
  v_lshrrev_b32 v7, 18, v7
  v_mul_u32_u24 v62, 6, v7
  v_sub_u32 v62, v6, v62
  v_lshlrev_b32 v62, 4, v62
  s_movk_i32 s73, 1280
  v_mad_u32_u24 v62, v7, s73, v62
  s_mul_i32 s72, s29, 960
  s_add_u32 s72, s72, 832
  v_add_u32 v6, s72, v1
  s_mov_b32 s73, 43691
  v_mul_lo_u32 v7, v6, s73
  v_lshrrev_b32 v7, 18, v7
  v_mul_u32_u24 v43, 6, v7
  v_sub_u32 v43, v6, v43
  v_lshlrev_b32 v43, 4, v43
  s_movk_i32 s73, 12288
  v_mad_u32_u24 v43, v7, s73, v43
  v_add_u32 v6, 832, v1
  s_mov_b32 s73, 43691
  v_mul_lo_u32 v7, v6, s73
  v_lshrrev_b32 v7, 18, v7
  v_mul_u32_u24 v63, 6, v7
  v_sub_u32 v63, v6, v63
  v_lshlrev_b32 v63, 4, v63
  s_movk_i32 s73, 1280
  v_mad_u32_u24 v63, v7, s73, v63
  s_mul_i32 s72, s29, 960
  s_add_u32 s72, s72, 896
  v_add_u32 v6, s72, v1
  s_mov_b32 s73, 43691
  v_mul_lo_u32 v7, v6, s73
  v_lshrrev_b32 v7, 18, v7
  v_mul_u32_u24 v44, 6, v7
  v_sub_u32 v44, v6, v44
  v_lshlrev_b32 v44, 4, v44
  s_movk_i32 s73, 12288
  v_mad_u32_u24 v44, v7, s73, v44
  v_add_u32 v6, 896, v1
  s_mov_b32 s73, 43691
  v_mul_lo_u32 v7, v6, s73
  v_lshrrev_b32 v7, 18, v7
  v_mul_u32_u24 v64, 6, v7
  v_sub_u32 v64, v6, v64
  v_lshlrev_b32 v64, 4, v64
  s_movk_i32 s73, 1280
  v_mad_u32_u24 v64, v7, s73, v64
  v_add_u32 v6, 960, v1
  s_mov_b32 s73, 43691
  v_mul_lo_u32 v7, v6, s73
  v_lshrrev_b32 v7, 18, v7
  v_mul_u32_u24 v65, 6, v7
  v_sub_u32 v65, v6, v65
  v_lshlrev_b32 v65, 4, v65
  s_movk_i32 s73, 1280
  v_mad_u32_u24 v65, v7, s73, v65
  v_add_u32 v6, 1024, v1
  s_mov_b32 s73, 43691
  v_mul_lo_u32 v7, v6, s73
  v_lshrrev_b32 v7, 18, v7
  v_mul_u32_u24 v66, 6, v7
  v_sub_u32 v66, v6, v66
  v_lshlrev_b32 v66, 4, v66
  s_movk_i32 s73, 1280
  v_mad_u32_u24 v66, v7, s73, v66
  v_add_u32 v6, 1088, v1
  s_mov_b32 s73, 43691
  v_mul_lo_u32 v7, v6, s73
  v_lshrrev_b32 v7, 18, v7
  v_mul_u32_u24 v67, 6, v7
  v_sub_u32 v67, v6, v67
  v_lshlrev_b32 v67, 4, v67
  s_movk_i32 s73, 1280
  v_mad_u32_u24 v67, v7, s73, v67
  s_mul_i32 s74, s28, 384
  s_mul_i32 s72, s27, 96
  s_add_u32 s74, s74, s72
  s_mul_i32 s75, s31, 245760
  s_mul_i32 s72, s25, 80
  s_add_u32 s75, s75, s72
  v_add_u32 v22, 61440, v20
  s_mov_b32 s8, s40
  s_and_b32 s9, s41, 0xffff
  s_mul_i32 s72, s29, 15360
  s_add_u32 s72, s72, 0
  s_add_u32 m0, s72, 0
  s_nop 0
  buffer_load_dwordx4 v30, s[8:11], s74 offen lds
  s_add_u32 m0, s72, 1024
  s_nop 0
  buffer_load_dwordx4 v31, s[8:11], s74 offen lds
  s_add_u32 m0, s72, 2048
  s_nop 0
  buffer_load_dwordx4 v32, s[8:11], s74 offen lds
  s_add_u32 m0, s72, 3072
  s_nop 0
  buffer_load_dwordx4 v33, s[8:11], s74 offen lds
  s_add_u32 m0, s72, 4096
  s_nop 0
  buffer_load_dwordx4 v34, s[8:11], s74 offen lds
  s_add_u32 m0, s72, 5120
  s_nop 0
  buffer_load_dwordx4 v35, s[8:11], s74 offen lds
  s_add_u32 m0, s72, 6144
  s_nop 0
  buffer_load_dwordx4 v36, s[8:11], s74 offen lds
  s_add_u32 m0, s72, 7168
  s_nop 0
  buffer_load_dwordx4 v37, s[8:11], s74 offen lds
  s_add_u32 m0, s72, 8192
  s_nop 0
  buffer_load_dwordx4 v38, s[8:11], s74 offen lds
  s_add_u32 m0, s72, 9216
  s_nop 0
  buffer_load_dwordx4 v39, s[8:11], s74 offen lds
  s_add_u32 m0, s72, 10240
  s_nop 0
  buffer_load_dwordx4 v40, s[8:11], s74 offen lds
  s_add_u32 m0, s72, 11264
  s_nop 0
  buffer_load_dwordx4 v41, s[8:11], s74 offen lds
  s_add_u32 m0, s72, 12288
  s_nop 0
  buffer_load_dwordx4 v42, s[8:11], s74 offen lds
  s_add_u32 m0, s72, 13312
  s_nop 0
  buffer_load_dwordx4 v43, s[8:11], s74 offen lds
  s_add_u32 m0, s72, 14336
  s_nop 0
  buffer_load_dwordx4 v44, s[8:11], s74 offen lds
  s_mov_b32 s8, s42
  s_and_b32 s9, s43, 0xffff
  s_mul_i32 s72, s29, 15360
  s_add_u32 s72, s72, 61440
  s_add_u32 m0, s72, 0
  s_nop 0
  buffer_load_dwordx4 v30, s[8:11], s74 offen lds
  s_add_u32 m0, s72, 1024
  s_nop 0
  buffer_load_dwordx4 v31, s[8:11], s74 offen lds
  s_add_u32 m0, s72, 2048
  s_nop 0
  buffer_load_dwordx4 v32, s[8:11], s74 offen lds
  s_add_u32 m0, s72, 3072
  s_nop 0
  buffer_load_dwordx4 v33, s[8:11], s74 offen lds
  s_add_u32 m0, s72, 4096
  s_nop 0
  buffer_load_dwordx4 v34, s[8:11], s74 offen lds
  s_add_u32 m0, s72, 5120
  s_nop 0
  buffer_load_dwordx4 v35, s[8:11], s74 offen lds
  s_add_u32 m0, s72, 6144
  s_nop 0
  buffer_load_dwordx4 v36, s[8:11], s74 offen lds
  s_add_u32 m0, s72, 7168
  s_nop 0
  buffer_load_dwordx4 v37, s[8:11], s74 offen lds
  s_add_u32 m0, s72, 8192
  s_nop 0
  buffer_load_dwordx4 v38, s[8:11], s74 offen lds
  s_add_u32 m0, s72, 9216
  s_nop 0
  buffer_load_dwordx4 v39, s[8:11], s74 offen lds
  s_add_u32 m0, s72, 10240
  s_nop 0
  buffer_load_dwordx4 v40, s[8:11], s74 offen lds
  s_add_u32 m0, s72, 11264
  s_nop 0
  buffer_load_dwordx4 v41, s[8:11], s74 offen lds
  s_add_u32 m0, s72, 12288
  s_nop 0
  buffer_load_dwordx4 v42, s[8:11], s74 offen lds
  s_add_u32 m0, s72, 13312
  s_nop 0
  buffer_load_dwordx4 v43, s[8:11], s74 offen lds
  s_add_u32 m0, s72, 14336
  s_nop 0
  buffer_load_dwordx4 v44, s[8:11], s74 offen lds
  s_waitcnt vmcnt(15)
  s_barrier
  ds_read_b64_tr_b16 a[0:1], v20 offset:0
  ds_read_b64_tr_b16 a[2:3], v20 offset:384
  ds_read_b64_tr_b16 a[4:5], v20 offset:3072
  ds_read_b64_tr_b16 a[6:7], v20 offset:3456
  ds_read_b64_tr_b16 a[8:9], v20 offset:6144
  ds_read_b64_tr_b16 a[10:11], v20 offset:6528
  ds_read_b64_tr_b16 a[12:13], v20 offset:9216
  ds_read_b64_tr_b16 a[14:15], v20 offset:9600
  ds_read_b64_tr_b16 a[16:17], v20 offset:12288
  ds_read_b64_tr_b16 a[18:19], v20 offset:12672
  ds_read_b64_tr_b16 a[20:21], v20 offset:32
  ds_read_b64_tr_b16 a[22:23], v20 offset:416
  ds_read_b64_tr_b16 a[24:25], v20 offset:3104
  ds_read_b64_tr_b16 a[26:27], v20 offset:3488
  ds_read_b64_tr_b16 a[28:29], v20 offset:6176
  ds_read_b64_tr_b16 a[30:31], v20 offset:6560
  ds_read_b64_tr_b16 a[32:33], v20 offset:9248
  ds_read_b64_tr_b16 a[34:35], v20 offset:9632
  ds_read_b64_tr_b16 a[36:37], v20 offset:12320
  ds_read_b64_tr_b16 a[38:39], v20 offset:12704
  ds_read_b64_tr_b16 a[40:41], v20 offset:64
  ds_read_b64_tr_b16 a[42:43], v20 offset:448
  ds_read_b64_tr_b16 a[44:45], v20 offset:3136
  ds_read_b64_tr_b16 a[46:47], v20 offset:3520
  ds_read_b64_tr_b16 a[48:49], v20 offset:6208
  ds_read_b64_tr_b16 a[50:51], v20 offset:6592
  ds_read_b64_tr_b16 a[52:53], v20 offset:9280
  ds_read_b64_tr_b16 a[54:55], v20 offset:9664
  ds_read_b64_tr_b16 a[56:57], v20 offset:12352
  ds_read_b64_tr_b16 a[58:59], v20 offset:12736
  s_waitcnt lgkmcnt(0)
  s_waitcnt vmcnt(0)
  s_barrier
  s_mov_b32 s8, s44
  s_and_b32 s9, s45, 0xffff
  s_mul_i32 s72, s29, 15360
  s_add_u32 s72, s72, 0
  s_add_u32 m0, s72, 0
  s_nop 0
  buffer_load_dwordx4 v30, s[8:11], s74 offen lds
  s_add_u32 m0, s72, 1024
  s_nop 0
  buffer_load_dwordx4 v31, s[8:11], s74 offen lds
  s_add_u32 m0, s72, 2048
  s_nop 0
  buffer_load_dwordx4 v32, s[8:11], s74 offen lds
  s_add_u32 m0, s72, 3072
  s_nop 0
  buffer_load_dwordx4 v33, s[8:11], s74 offen lds
  s_add_u32 m0, s72, 4096
  s_nop 0
  buffer_load_dwordx4 v34, s[8:11], s74 offen lds
  s_add_u32 m0, s72, 5120
  s_nop 0
  buffer_load_dwordx4 v35, s[8:11], s74 offen lds
  s_add_u32 m0, s72, 6144
  s_nop 0
  buffer_load_dwordx4 v36, s[8:11], s74 offen lds
  s_add_u32 m0, s72, 7168
  s_nop 0
  buffer_load_dwordx4 v37, s[8:11], s74 offen lds
  s_add_u32 m0, s72, 8192
  s_nop 0
  buffer_load_dwordx4 v38, s[8:11], s74 offen lds
  s_add_u32 m0, s72, 9216
  s_nop 0
  buffer_load_dwordx4 v39, s[8:11], s74 offen lds
  s_add_u32 m0, s72, 10240
  s_nop 0
  buffer_load_dwordx4 v40, s[8:11], s74 offen lds
  s_add_u32 m0, s72, 11264
  s_nop 0
  buffer_load_dwordx4 v41, s[8:11], s74 offen lds
  s_add_u32 m0, s72, 12288
  s_nop 0
  buffer_load_dwordx4 v42, s[8:11], s74 offen lds
  s_add_u32 m0, s72, 13312
  s_nop 0
  buffer_load_dwordx4 v43, s[8:11], s74 offen lds
  s_add_u32 m0, s72, 14336
  s_nop 0
  buffer_load_dwordx4 v44, s[8:11], s74 offen lds
  ds_read_b64_tr_b16 a[60:61], v22 offset:0
  ds_read_b64_tr_b16 a[62:63], v22 offset:384
  ds_read_b64_tr_b16 a[64:65], v22 offset:3072
  ds_read_b64_tr_b16 a[66:67], v22 offset:3456
  ds_read_b64_tr_b16 a[68:69], v22 offset:6144
  ds_read_b64_tr_b16 a[70:71], v22 offset:6528
  ds_read_b64_tr_b16 a[72:73], v22 offset:9216
  ds_read_b64_tr_b16 a[74:75], v22 offset:9600
  ds_read_b64_tr_b16 a[76:77], v22 offset:12288
  ds_read_b64_tr_b16 a[78:79], v22 offset:12672
  ds_read_b64_tr_b16 a[80:81], v22 offset:32
  ds_read_b64_tr_b16 a[82:83], v22 offset:416
  ds_read_b64_tr_b16 a[84:85], v22 offset:3104
  ds_read_b64_tr_b16 a[86:87], v22 offset:3488
  ds_read_b64_tr_b16 a[88:89], v22 offset:6176
  ds_read_b64_tr_b16 a[90:91], v22 offset:6560
  ds_read_b64_tr_b16 a[92:93], v22 offset:9248
  ds_read_b64_tr_b16 a[94:95], v22 offset:9632
  ds_read_b64_tr_b16 a[96:97], v22 offset:12320
  ds_read_b64_tr_b16 a[98:99], v22 offset:12704
  ds_read_b64_tr_b16 a[100:101], v22 offset:64
  ds_read_b64_tr_b16 a[102:103], v22 offset:448
  ds_read_b64_tr_b16 a[104:105], v22 offset:3136
  ds_read_b64_tr_b16 a[106:107], v22 offset:3520
  ds_read_b64_tr_b16 a[108:109], v22 offset:6208
  ds_read_b64_tr_b16 a[110:111], v22 offset:6592
  ds_read_b64_tr_b16 a[112:113], v22 offset:9280
  ds_read_b64_tr_b16 a[114:115], v22 offset:9664
  ds_read_b64_tr_b16 a[116:117], v22 offset:12352
  ds_read_b64_tr_b16 a[118:119], v22 offset:12736
  s_waitcnt lgkmcnt(0)
  s_waitcnt vmcnt(0)
  s_barrier
  ds_read_b64_tr_b16 a[120:121], v20 offset:0
  ds_read_b64_tr_b16 a[122:123], v20 offset:384
  ds_read_b64_tr_b16 a[124:125], v20 offset:3072
  ds_read_b64_tr_b16 a[126:127], v20 offset:3456
  ds_read_b64_tr_b16 a[128:129], v20 offset:6144
  ds_read_b64_tr_b16 a[130:131], v20 offset:6528
  ds_read_b64_tr_b16 a[132:133], v20 offset:9216
  ds_read_b64_tr_b16 a[134:135], v20 offset:9600
  ds_read_b64_tr_b16 a[136:137], v20 offset:12288
  ds_read_b64_tr_b16 a[138:139], v20 offset:12672
  ds_read_b64_tr_b16 a[140:141], v20 offset:32
  ds_read_b64_tr_b16 a[142:143], v20 offset:416
  ds_read_b64_tr_b16 a[144:145], v20 offset:3104
  ds_read_b64_tr_b16 a[146:147], v20 offset:3488
  ds_read_b64_tr_b16 a[148:149], v20 offset:6176
  ds_read_b64_tr_b16 a[150:151], v20 offset:6560
  ds_read_b64_tr_b16 a[152:153], v20 offset:9248
  ds_read_b64_tr_b16 a[154:155], v20 offset:9632
  ds_read_b64_tr_b16 a[156:157], v20 offset:12320
  ds_read_b64_tr_b16 a[158:159], v20 offset:12704
  ds_read_b64_tr_b16 a[160:161], v20 offset:64
  ds_read_b64_tr_b16 a[162:163], v20 offset:448
  ds_read_b64_tr_b16 a[164:165], v20 offset:3136
  ds_read_b64_tr_b16 a[166:167], v20 offset:3520
  ds_read_b64_tr_b16 a[168:169], v20 offset:6208
  ds_read_b64_tr_b16 a[170:171], v20 offset:6592
  ds_read_b64_tr_b16 a[172:173], v20 offset:9280
  ds_read_b64_tr_b16 a[174:175], v20 offset:9664
  ds_read_b64_tr_b16 a[176:177], v20 offset:12352
  ds_read_b64_tr_b16 a[178:179], v20 offset:12736
  s_waitcnt lgkmcnt(0)
  s_barrier
  s_mov_b32 s8, s46
  s_and_b32 s9, s47, 0xffff
  s_mul_i32 s72, s29, 18432
  s_add_u32 s72, s72, 0
  s_add_u32 m0, s72, 0
  s_nop 0
  buffer_load_dwordx4 v50, s[8:11], s75 offen lds
  s_add_u32 m0, s72, 1024
  s_nop 0
  buffer_load_dwordx4 v51, s[8:11], s75 offen lds
  s_add_u32 m0, s72, 2048
  s_nop 0
  buffer_load_dwordx4 v52, s[8:11], s75 offen lds
  s_add_u32 m0, s72, 3072
  s_nop 0
  buffer_load_dwordx4 v53, s[8:11], s75 offen lds
  s_add_u32 m0, s72, 4096
  s_nop 0
  buffer_load_dwordx4 v54, s[8:11], s75 offen lds
  s_add_u32 m0, s72, 5120
  s_nop 0
  buffer_load_dwordx4 v55, s[8:11], s75 offen lds
  s_add_u32 m0, s72, 6144
  s_nop 0
  buffer_load_dwordx4 v56, s[8:11], s75 offen lds
  s_add_u32 m0, s72, 7168
  s_nop 0
  buffer_load_dwordx4 v57, s[8:11], s75 offen lds
  s_add_u32 m0, s72, 8192
  s_nop 0
  buffer_load_dwordx4 v58, s[8:11], s75 offen lds
  s_add_u32 m0, s72, 9216
  s_nop 0
  buffer_load_dwordx4 v59, s[8:11], s75 offen lds
  s_add_u32 m0, s72, 10240
  s_nop 0
  buffer_load_dwordx4 v60, s[8:11], s75 offen lds
  s_add_u32 m0, s72, 11264
  s_nop 0
  buffer_load_dwordx4 v61, s[8:11], s75 offen lds
  s_add_u32 m0, s72, 12288
  s_nop 0
  buffer_load_dwordx4 v62, s[8:11], s75 offen lds
  s_add_u32 m0, s72, 13312
  s_nop 0
  buffer_load_dwordx4 v63, s[8:11], s75 offen lds
  s_add_u32 m0, s72, 14336
  s_nop 0
  buffer_load_dwordx4 v64, s[8:11], s75 offen lds
  s_add_u32 m0, s72, 15360
  s_nop 0
  buffer_load_dwordx4 v65, s[8:11], s75 offen lds
  s_add_u32 m0, s72, 16384
  s_nop 0
  buffer_load_dwordx4 v66, s[8:11], s75 offen lds
  s_add_u32 m0, s72, 17408
  s_nop 0
  buffer_load_dwordx4 v67, s[8:11], s75 offen lds
  s_waitcnt vmcnt(0)
  ds_read_b64_tr_b16 a[180:181], v21 offset:0
  ds_read_b64_tr_b16 a[182:183], v21 offset:1536
  ds_read_b64_tr_b16 a[184:185], v21 offset:3072
  ds_read_b64_tr_b16 a[186:187], v21 offset:4608
  ds_read_b64_tr_b16 a[188:189], v21 offset:6144
  ds_read_b64_tr_b16 a[190:191], v21 offset:7680
  ds_read_b64_tr_b16 a[192:193], v21 offset:9216
  ds_read_b64_tr_b16 a[194:195], v21 offset:10752
  ds_read_b64_tr_b16 a[196:197], v21 offset:12288
  ds_read_b64_tr_b16 a[198:199], v21 offset:13824
  ds_read_b64_tr_b16 a[200:201], v21 offset:15360
  ds_read_b64_tr_b16 a[202:203], v21 offset:16896
  ds_read_b64_tr_b16 a[204:205], v21 offset:32
  ds_read_b64_tr_b16 a[206:207], v21 offset:1568
  ds_read_b64_tr_b16 a[208:209], v21 offset:3104
  ds_read_b64_tr_b16 a[210:211], v21 offset:4640
  ds_read_b64_tr_b16 a[212:213], v21 offset:6176
  ds_read_b64_tr_b16 a[214:215], v21 offset:7712
  ds_read_b64_tr_b16 a[216:217], v21 offset:9248
  ds_read_b64_tr_b16 a[218:219], v21 offset:10784
  ds_read_b64_tr_b16 a[220:221], v21 offset:12320
  ds_read_b64_tr_b16 a[222:223], v21 offset:13856
  ds_read_b64_tr_b16 a[224:225], v21 offset:15392
  ds_read_b64_tr_b16 a[226:227], v21 offset:16928
  ds_read_b64_tr_b16 a[228:229], v21 offset:64
  ds_read_b64_tr_b16 a[230:231], v21 offset:1600
  ds_read_b64_tr_b16 a[232:233], v21 offset:3136
  ds_read_b64_tr_b16 a[234:235], v21 offset:4672
  ds_read_b64_tr_b16 a[236:237], v21 offset:6208
  ds_read_b64_tr_b16 a[238:239], v21 offset:7744
  ds_read_b64_tr_b16 a[240:241], v21 offset:9280
  ds_read_b64_tr_b16 a[242:243], v21 offset:10816
  ds_read_b64_tr_b16 a[244:245], v21 offset:12352
  ds_read_b64_tr_b16 a[246:247], v21 offset:13888
  ds_read_b64_tr_b16 a[248:249], v21 offset:15424
  ds_read_b64_tr_b16 a[250:251], v21 offset:16960
  s_waitcnt lgkmcnt(0)
  s_barrier
  v_and_b32 v5, 7, v2
  v_lshl_add_u32 v6, v3, 3, v5
  v_lshlrev_b32 v237, 4, v6
  s_mul_i32 s72, s29, 2560
  v_add_u32 v230, s72, v237
  v_lshlrev_b32 v237, 4, v1
  v_lshlrev_b32 v238, 4, v1
  v_add_u32 v238, 6144, v238
  v_lshlrev_b32 v239, 4, v1
  v_lshl_add_u32 v6, v3, 3, v2
  v_lshlrev_b32 v6, 4, v6
  s_mul_i32 s72, s29, 4608
  v_add_u32 v231, s72, v6
  s_mul_i32 s73, s29, 1536
  s_add_u32 s73, s73, 18432
  v_add_u32 v240, s73, v6
  v_lshlrev_b32 v7, 4, v1
  v_add_u32 v7, 24576, v7
  v_cmp_gt_u32 vcc, 8, v2
  s_nop 1
  v_cndmask_b32 v231, v7, v231, vcc
  v_cndmask_b32 v240, v7, v240, vcc
  v_lshlrev_b32 v232, 4, v1
  v_add_u32 v232, s72, v232
  v_cmp_gt_u32 vcc, 32, v1
  s_nop 1
  v_cndmask_b32 v232, v7, v232, vcc
  s_mul_i32 s72, s29, 48
  v_add_u32 v7, s72, v1
  v_lshlrev_b32 v233, 4, v7
  v_lshrrev_b32 v6, 5, v7
  v_and_b32 v7, 31, v7
  v_cmp_le_u32 vcc, 3, v6
  v_mov_b32 v4, 0
  v_mov_b32 v5, 3
  v_cndmask_b32 v5, v4, v5, vcc
  v_sub_u32 v6, v6, v5
  v_mov_b32 v5, 128
  v_cndmask_b32 v235, v4, v5, vcc
  v_lshrrev_b32 v4, 3, v7
  v_lshlrev_b32 v4, 2, v4
  v_lshl_add_u32 v6, v6, 4, v4
  s_mul_i32 s72, s27, 48
  v_add_u32 v6, s72, v6
  v_and_b32 v7, 7, v7
  v_lshrrev_b32 v4, 5, v6
  v_lshl_add_u32 v235, v4, 10, v235
  v_bfe_u32 v4, v6, 3, 2
  v_lshl_add_u32 v4, v4, 4, v7
  v_lshl_add_u32 v235, v4, 4, v235
  v_bfe_u32 v4, v6, 2, 1
  v_lshl_add_u32 v235, v4, 3, v235
  s_mul_i32 s72, s29, 24
  v_add_u32 v7, s72, v1
  v_lshlrev_b32 v234, 4, v7
  v_add_u32 v234, 3072, v234
  v_lshrrev_b32 v6, 5, v7
  v_and_b32 v7, 31, v7
  s_mul_i32 s72, s27, 3
  v_add_u32 v6, s72, v6
  v_lshrrev_b32 v236, 2, v6
  v_lshlrev_b32 v236, 10, v236
  v_add_u32 v236, 6144, v236
  v_bfe_u32 v4, v6, 1, 1
  v_lshl_add_u32 v236, v4, 3, v236
  v_and_b32 v4, 1, v6
  v_xor_b32 v4, 1, v4
  v_lshlrev_b32 v4, 1, v4
  v_lshrrev_b32 v5, 4, v7
  v_add_u32 v4, v4, v5
  v_and_b32 v5, 15, v7
  v_lshl_add_u32 v4, v4, 4, v5
  v_lshl_add_u32 v236, v4, 4, v236
  s_lshl_b32 s100, s25, 1
  s_and_b32 s73, s29, 1
  s_add_u32 s100, s100, s73
  v_lshlrev_b32 v6, 4, v1
  s_mul_i32 s72, s100, 5120
  v_add_u32 v243, s72, v6
  v_add_u32 v244, 2560, v243
  s_mul_i32 s74, s24, 640
  v_add_u32 v242, s74, v243
  v_and_b32 v6, 7, v1
  v_lshrrev_b32 v7, 3, v1
  s_mul_i32 s72, s100, 20
  v_lshl_add_u32 v4, v7, 2, s72
  v_lshrrev_b32 v245, 5, v4
  v_lshlrev_b32 v245, 9, v245
  v_bfe_u32 v5, v4, 3, 2
  v_lshl_add_u32 v5, v5, 3, v6
  v_lshl_add_u32 v245, v5, 4, v245
  v_bfe_u32 v5, v4, 2, 1
  v_lshl_add_u32 v245, v5, 3, v245
  s_and_b32 s73, s29, 1
  s_mul_i32 s73, s73, 5
  v_add_u32 v7, s73, v7
  v_lshrrev_b32 v241, 2, v7
  v_lshlrev_b32 v241, 9, v241
  v_and_b32 v7, 3, v7
  v_lshl_add_u32 v7, v7, 3, v6
  v_lshl_add_u32 v241, v7, 4, v241
  v_add_u32 v241, 18432, v241
  v_min_u32 v241, 19952, v241
  v_mov_b32 v7, 0x80000000
  v_cmp_gt_u32 vcc, 8, v2
  s_nop 1
  v_cndmask_b32 v230, v7, v230, vcc
  v_cmp_gt_u32 vcc, 48, v1
  s_nop 1
  v_cndmask_b32 v235, v7, v235, vcc
  v_cmp_gt_u32 vcc, 24, v1
  s_nop 1
  v_cndmask_b32 v236, v7, v236, vcc
  v_cmp_gt_u32 vcc, 40, v1
  s_nop 1
  v_cndmask_b32 v243, v7, v243, vcc
  v_cndmask_b32 v244, v7, v244, vcc
  v_cndmask_b32 v242, v7, v242, vcc
  v_cndmask_b32 v245, v7, v245, vcc
  v_mov_b32 v126, 1
  v_mov_b32 v4, 0
  v_cmp_eq_u32 vcc, 0, v1
  s_nop 1
  v_cndmask_b32 v128, v7, v4, vcc
  v_cmp_gt_u32 vcc, 2, v3
  v_mov_b32 v6, 0
  v_mov_b32 v7, 0xf149f2ca
  v_cndmask_b32 v248, v6, v7, vcc
  v_mov_b32 v252, -1
  v_cndmask_b32 v249, v6, v7, vcc
  v_mov_b32 v253, -1
  v_cndmask_b32 v250, v6, v7, vcc
  v_mov_b32 v254, -1
  v_cndmask_b32 v251, v6, v7, vcc
  v_mov_b32 v255, -1
  v_and_b32 v246, 15, v1
  v_lshlrev_b32 v246, 2, v246
  s_mul_i32 s72, s24, 40960
  s_add_u32 s52, s72, 107741184
  s_mul_i32 s72, s28, 9216
  s_add_u32 s56, s72, 103284736
  s_mul_i32 s72, s31, 9216
  s_add_u32 s60, s72, 103284736
  s_mov_b32 s64, 107085824
  s_mul_i32 s72, s24, 40960
  s_add_u32 s53, s72, 107751424
  s_mul_i32 s72, s28, 9216
  s_add_u32 s57, s72, 103579648
  s_mul_i32 s72, s31, 9216
  s_add_u32 s61, s72, 103579648
  s_mov_b32 s65, 107249664
  s_mul_i32 s72, s24, 40960
  s_add_u32 s54, s72, 107761664
  s_mul_i32 s72, s28, 9216
  s_add_u32 s58, s72, 103874560
  s_mul_i32 s72, s31, 9216
  s_add_u32 s62, s72, 103874560
  s_mov_b32 s66, 107413504
  s_mul_i32 s72, s24, 40960
  s_add_u32 s55, s72, 107771904
  s_mul_i32 s72, s28, 9216
  s_add_u32 s59, s72, 104169472
  s_mul_i32 s72, s31, 9216
  s_add_u32 s63, s72, 104169472
  s_mov_b32 s67, 107577344
  s_mul_i32 s68, s28, 9216
  s_add_u32 s68, s68, 84410368
  s_lshl_b32 s101, s28, 12
  s_lshl_b32 s72, s27, 4
  s_lshl_b32 s73, s29, 2
  s_add_u32 s101, s101, s72
  s_add_u32 s101, s101, s73
  s_add_u32 s101, s101, 108363776
  s_mul_i32 s69, s31, 1572864
  s_add_u32 s69, s69, 27787264
  s_lshl_b32 s23, s31, 12
  s_add_u32 s23, s23, 108068864
  s_add_u32 s33, s69, 12288
  s_mul_i32 s72, s25, 6
  s_and_b32 s73, s29, 1
  s_mul_i32 s73, s73, 3
  s_add_u32 s72, s72, s73
  s_mul_i32 s73, s72, 2731
  s_lshr_b32 s73, s73, 16
  s_mul_i32 s74, s73, 24
  s_sub_u32 s72, s72, s74
  s_lshl_b32 s74, s24, 2
  s_add_u32 s73, s73, s74
  s_mul_i32 s34, s73, 1572864
  s_lshl_b32 s72, s72, 10
  s_add_u32 s34, s34, s72
  s_add_u32 s34, s34, 27836416
  s_mov_b32 s30, 0
  s_mov_b32 s71, 0
  s_mov_b32 s12, s50
  s_and_b32 s13, s51, 0xffff
  s_mov_b32 s14, 256
  s_mov_b32 s15, 0x00020000
  v_and_b32 v4, 15, v1
  v_lshlrev_b32 v4, 2, v4
L_hk_sc:
  buffer_load_dword v5, v4, s[12:15], 0 offen sc1
  s_waitcnt vmcnt(0)
  v_readlane_b32 s72, v5, 0
  v_readlane_b32 s73, v5, 1
  v_readlane_b32 s74, v5, 2
  v_readlane_b32 s75, v5, 3
  v_readlane_b32 s76, v5, 4
  v_readlane_b32 s77, v5, 5
  v_readlane_b32 s78, v5, 6
  v_readlane_b32 s79, v5, 7
  v_readlane_b32 s84, v5, 8
  s_nop 3
  s_add_u32 s80, s72, s73
  s_add_u32 s81, s74, s75
  s_add_u32 s82, s76, s77
  s_add_u32 s83, s78, s79
  s_add_u32 s80, s80, s81
  s_add_u32 s82, s82, s83
  s_add_u32 s80, s80, s82
  s_add_u32 s80, s80, s84
  s_cmp_eq_u32 s80, 512
  s_cbranch_scc1 L_hk2_sc
  s_add_u32 s71, s71, 1
  s_cmp_gt_u32 s71, 400000
  s_cbranch_scc1 L_mend
  s_sleep 2
  s_branch L_hk_sc
L_hk2_sc:
L_kv0_sc:
  buffer_load_dword v127, v246, s[4:7], s23 offen sc1
  s_waitcnt vmcnt(0)
  v_cmp_eq_u32 vcc, 0, v127
  s_cbranch_vccz L_kv0ok_sc
  s_add_u32 s71, s71, 1
  s_cmp_gt_u32 s71, 400000
  s_cbranch_scc1 L_done_sc
  s_sleep 4
  s_branch L_kv0_sc
L_kv0ok_sc:
  s_add_u32 s23, s23, 64
  buffer_load_dwordx4 v[134:137], v239, s[4:7], s69 offen offset:0 sc1
  buffer_load_dwordx4 v[138:141], v239, s[4:7], s69 offen offset:1024 sc1
  buffer_load_dwordx4 v[142:145], v239, s[4:7], s69 offen offset:2048 sc1
  buffer_load_dwordx4 v[146:149], v239, s[4:7], s69 offen offset:3072 sc1
  s_add_u32 s69, s69, 4096
  buffer_load_dwordx4 v[150:153], v239, s[4:7], s69 offen offset:0 sc1
  buffer_load_dwordx4 v[154:157], v239, s[4:7], s69 offen offset:1024 sc1
  buffer_load_dwordx4 v[158:161], v239, s[4:7], s69 offen offset:2048 sc1
  buffer_load_dwordx4 v[162:165], v239, s[4:7], s69 offen offset:3072 sc1
  s_add_u32 s69, s69, 4096
  buffer_load_dwordx4 v[166:169], v239, s[4:7], s69 offen offset:0 sc1
  buffer_load_dwordx4 v[170:173], v239, s[4:7], s69 offen offset:1024 sc1
  buffer_load_dwordx4 v[174:177], v239, s[4:7], s69 offen offset:2048 sc1
  buffer_load_dwordx4 v[178:181], v239, s[4:7], s69 offen offset:3072 sc1
  s_add_u32 s69, s69, 16384
  buffer_load_dwordx4 v[182:185], v239, s[4:7], s33 offen offset:0 sc1
  buffer_load_dwordx4 v[186:189], v239, s[4:7], s33 offen offset:1024 sc1
  buffer_load_dwordx4 v[190:193], v239, s[4:7], s33 offen offset:2048 sc1
  buffer_load_dwordx4 v[194:197], v239, s[4:7], s33 offen offset:3072 sc1
  s_add_u32 s33, s33, 4096
  buffer_load_dwordx4 v[198:201], v239, s[4:7], s33 offen offset:0 sc1
  buffer_load_dwordx4 v[202:205], v239, s[4:7], s33 offen offset:1024 sc1
  buffer_load_dwordx4 v[206:209], v239, s[4:7], s33 offen offset:2048 sc1
  buffer_load_dwordx4 v[210:213], v239, s[4:7], s33 offen offset:3072 sc1
  s_add_u32 s33, s33, 4096
  buffer_load_dwordx4 v[214:217], v239, s[4:7], s33 offen offset:0 sc1
  buffer_load_dwordx4 v[218:221], v239, s[4:7], s33 offen offset:1024 sc1
  buffer_load_dwordx4 v[222:225], v239, s[4:7], s33 offen offset:2048 sc1
  buffer_load_dwordx4 v[226:229], v239, s[4:7], s33 offen offset:3072 sc1
  s_add_u32 s33, s33, 16384
  s_waitcnt vmcnt(0)
L_loop_sc:
  buffer_load_dwordx4 v[8:11], v230, s[4:7], s52 offen offset:0 sc1
  buffer_load_dwordx4 v[12:15], v230, s[4:7], s52 offen offset:512 sc1
  buffer_load_dwordx4 v[16:19], v230, s[4:7], s52 offen offset:1024 sc1
  buffer_load_dwordx4 v[20:23], v230, s[4:7], s52 offen offset:1536 sc1
  buffer_load_dwordx4 v[24:27], v230, s[4:7], s52 offen offset:2048 sc1
  s_waitcnt vmcnt(0)
K_C_0_sc:
  v_mfma_f32_16x16x32_bf16 v[28:31], a[0:3], v[8:11], 0
  v_max3_u32 v4, v8, v9, v10
  v_max3_u32 v5, v11, v12, v13
  v_mfma_f32_16x16x32_bf16 v[28:31], a[4:7], v[12:15], v[28:31]
  v_max3_u32 v6, v14, v15, v16
  v_max3_u32 v7, v17, v18, v19
  v_mfma_f32_16x16x32_bf16 v[28:31], a[8:11], v[16:19], v[28:31]
  v_max3_u32 v4, v4, v20, v21
  v_max3_u32 v5, v5, v22, v23
  v_mfma_f32_16x16x32_bf16 v[28:31], a[12:15], v[20:23], v[28:31]
  v_max3_u32 v6, v6, v24, v25
  v_max3_u32 v7, v7, v26, v27
  v_mfma_f32_16x16x32_bf16 v[28:31], a[16:19], v[24:27], v[28:31]
  v_max3_u32 v4, v4, v5, v6
  v_max_u32 v4, v4, v7
  v_mfma_f32_16x16x32_bf16 v[32:35], a[20:23], v[8:11], 0
  v_cmp_eq_u32 vcc, -1, v4
  s_cbranch_vccnz R_C_0_sc
  v_mfma_f32_16x16x32_bf16 v[32:35], a[24:27], v[12:15], v[32:35]
  v_mfma_f32_16x16x32_bf16 v[32:35], a[28:31], v[16:19], v[32:35]
  v_mfma_f32_16x16x32_bf16 v[32:35], a[32:35], v[20:23], v[32:35]
  ds_write_b128 v231, v[28:31] offset:0
  v_mfma_f32_16x16x32_bf16 v[32:35], a[36:39], v[24:27], v[32:35]
  v_mfma_f32_16x16x32_bf16 v[36:39], a[40:43], v[8:11], 0
  v_mfma_f32_16x16x32_bf16 v[36:39], a[44:47], v[12:15], v[36:39]
  v_mfma_f32_16x16x32_bf16 v[36:39], a[48:51], v[16:19], v[36:39]
  v_mfma_f32_16x16x32_bf16 v[36:39], a[52:55], v[20:23], v[36:39]
  ds_write_b128 v231, v[32:35] offset:512
  v_mfma_f32_16x16x32_bf16 v[36:39], a[56:59], v[24:27], v[36:39]
  v_mfma_f32_16x16x32_bf16 v[40:43], a[60:63], v[8:11], 0
  v_mfma_f32_16x16x32_bf16 v[40:43], a[64:67], v[12:15], v[40:43]
  v_mfma_f32_16x16x32_bf16 v[40:43], a[68:71], v[16:19], v[40:43]
  v_mfma_f32_16x16x32_bf16 v[40:43], a[72:75], v[20:23], v[40:43]
  ds_write_b128 v231, v[36:39] offset:1024
  v_mfma_f32_16x16x32_bf16 v[40:43], a[76:79], v[24:27], v[40:43]
  v_mfma_f32_16x16x32_bf16 v[44:47], a[80:83], v[8:11], 0
  v_mfma_f32_16x16x32_bf16 v[44:47], a[84:87], v[12:15], v[44:47]
  v_mfma_f32_16x16x32_bf16 v[44:47], a[88:91], v[16:19], v[44:47]
  v_mfma_f32_16x16x32_bf16 v[44:47], a[92:95], v[20:23], v[44:47]
  ds_write_b128 v231, v[40:43] offset:1536
  v_mfma_f32_16x16x32_bf16 v[44:47], a[96:99], v[24:27], v[44:47]
  v_mfma_f32_16x16x32_bf16 v[48:51], a[100:103], v[8:11], 0
  v_mfma_f32_16x16x32_bf16 v[48:51], a[104:107], v[12:15], v[48:51]
  v_mfma_f32_16x16x32_bf16 v[48:51], a[108:111], v[16:19], v[48:51]
  v_mfma_f32_16x16x32_bf16 v[48:51], a[112:115], v[20:23], v[48:51]
  ds_write_b128 v231, v[44:47] offset:2048
  v_mfma_f32_16x16x32_bf16 v[48:51], a[116:119], v[24:27], v[48:51]
  v_mfma_f32_16x16x32_bf16 v[52:55], v[8:11], a[120:123], 0
  v_mfma_f32_16x16x32_bf16 v[52:55], v[12:15], a[124:127], v[52:55]
  v_mfma_f32_16x16x32_bf16 v[52:55], v[16:19], a[128:131], v[52:55]
  ds_write_b128 v231, v[48:51] offset:2560
  v_mfma_f32_16x16x32_bf16 v[52:55], v[20:23], a[132:135], v[52:55]
  v_mfma_f32_16x16x32_bf16 v[52:55], v[24:27], a[136:139], v[52:55]
  s_waitcnt lgkmcnt(0)
  s_barrier
  ds_read_b128 v[64:67], v233 offset:0
  ds_read_b128 v[68:71], v233 offset:4608
  ds_read_b128 v[72:75], v233 offset:9216
  ds_read_b128 v[76:79], v233 offset:13824
  v_mfma_f32_16x16x32_bf16 v[56:59], v[8:11], a[140:143], 0
  v_mfma_f32_16x16x32_bf16 v[56:59], v[12:15], a[144:147], v[56:59]
  v_mfma_f32_16x16x32_bf16 v[56:59], v[16:19], a[148:151], v[56:59]
  v_mfma_f32_16x16x32_bf16 v[56:59], v[20:23], a[152:155], v[56:59]
  ds_write_b128 v232, v[52:55] offset:3072
  v_mfma_f32_16x16x32_bf16 v[56:59], v[24:27], a[156:159], v[56:59]
  s_waitcnt lgkmcnt(1)
  v_pk_add_f32 v[64:65], v[64:65], v[68:69]
  v_pk_add_f32 v[66:67], v[66:67], v[70:71]
  v_pk_add_f32 v[72:73], v[72:73], v[76:77]
  v_pk_add_f32 v[74:75], v[74:75], v[78:79]
  v_pk_add_f32 v[64:65], v[64:65], v[72:73]
  v_pk_add_f32 v[66:67], v[66:67], v[74:75]
  v_cvt_pk_bf16_f32 v98, v64, v65
  v_cvt_pk_bf16_f32 v99, v66, v67
  buffer_store_dwordx2 v[98:99], v235, s[4:7], s56 offen sc1
  v_mfma_f32_16x16x32_bf16 v[60:63], v[8:11], a[160:163], 0
  v_mfma_f32_16x16x32_bf16 v[60:63], v[12:15], a[164:167], v[60:63]
  v_mfma_f32_16x16x32_bf16 v[60:63], v[16:19], a[168:171], v[60:63]
  ds_write_b128 v232, v[56:59] offset:3584
  v_mfma_f32_16x16x32_bf16 v[60:63], v[20:23], a[172:175], v[60:63]
  v_mfma_f32_16x16x32_bf16 v[60:63], v[24:27], a[176:179], v[60:63]
  s_add_u32 s32, s60, 4096
  s_nop 6
  ds_write_b128 v232, v[60:63] offset:4096
  buffer_load_dwordx4 v[102:105], v237, s[4:7], s60 offen offset:0 sc1
  buffer_load_dwordx4 v[106:109], v237, s[4:7], s60 offen offset:1024 sc1
  buffer_load_dwordx4 v[110:113], v237, s[4:7], s60 offen offset:2048 sc1
  buffer_load_dwordx4 v[114:117], v237, s[4:7], s60 offen offset:3072 sc1
  buffer_load_dwordx4 v[118:121], v237, s[4:7], s32 offen offset:0 sc1
  buffer_load_dwordx4 v[122:125], v237, s[4:7], s32 offen offset:1024 sc1
  buffer_load_dword v127, v246, s[4:7], s23 offen sc1
  s_waitcnt lgkmcnt(0)
  s_barrier
  ds_read_b128 v[64:67], v234 offset:0
  ds_read_b128 v[68:71], v234 offset:4608
  ds_read_b128 v[72:75], v234 offset:9216
  ds_read_b128 v[76:79], v234 offset:13824
  s_waitcnt lgkmcnt(0)
  v_pk_add_f32 v[64:65], v[64:65], v[68:69]
  v_pk_add_f32 v[66:67], v[66:67], v[70:71]
  v_pk_add_f32 v[72:73], v[72:73], v[76:77]
  v_pk_add_f32 v[74:75], v[74:75], v[78:79]
  v_pk_add_f32 v[64:65], v[64:65], v[72:73]
  v_pk_add_f32 v[66:67], v[66:67], v[74:75]
  v_cvt_pk_bf16_f32 v100, v64, v65
  v_cvt_pk_bf16_f32 v101, v66, v67
  buffer_store_dwordx2 v[100:101], v236, s[4:7], s56 offen sc1
  s_waitcnt vmcnt(1)
K_A_0_sc:
  v_mfma_f32_16x16x32_bf16 v[80:83], v[102:105], v[102:105], v[248:251]
  v_max3_u32 v4, v102, v103, v104
  v_max3_u32 v5, v105, v106, v107
  v_mfma_f32_16x16x32_bf16 v[84:87], v[134:137], v[102:105], 0
  v_max3_u32 v6, v108, v109, v110
  v_max3_u32 v7, v111, v112, v113
  v_mfma_f32_16x16x32_bf16 v[88:91], v[158:161], v[102:105], 0
  v_max3_u32 v4, v4, v114, v115
  v_max3_u32 v5, v5, v116, v117
  v_mfma_f32_16x16x32_bf16 v[80:83], v[106:109], v[106:109], v[80:83]
  v_max3_u32 v6, v6, v118, v119
  v_max3_u32 v7, v7, v120, v121
  v_mfma_f32_16x16x32_bf16 v[84:87], v[138:141], v[106:109], v[84:87]
  v_max3_u32 v4, v4, v122, v123
  v_max3_u32 v5, v5, v124, v125
  v_mfma_f32_16x16x32_bf16 v[88:91], v[162:165], v[106:109], v[88:91]
  v_max3_u32 v4, v4, v5, v6
  v_max_u32 v4, v4, v7
  v_mfma_f32_16x16x32_bf16 v[80:83], v[110:113], v[110:113], v[80:83]
  v_cmp_eq_u32 vcc, -1, v4
  v_mfma_f32_16x16x32_bf16 v[84:87], v[142:145], v[110:113], v[84:87]
  v_mfma_f32_16x16x32_bf16 v[88:91], v[166:169], v[110:113], v[88:91]
  v_mfma_f32_16x16x32_bf16 v[80:83], v[114:117], v[114:117], v[80:83]
  v_mfma_f32_16x16x32_bf16 v[84:87], v[146:149], v[114:117], v[84:87]
  v_mfma_f32_16x16x32_bf16 v[88:91], v[170:173], v[114:117], v[88:91]
  v_mfma_f32_16x16x32_bf16 v[80:83], v[118:121], v[118:121], v[80:83]
  v_mfma_f32_16x16x32_bf16 v[84:87], v[150:153], v[118:121], v[84:87]
  v_mfma_f32_16x16x32_bf16 v[88:91], v[174:177], v[118:121], v[88:91]
  v_mfma_f32_16x16x32_bf16 v[80:83], v[122:125], v[122:125], v[80:83]
  v_mfma_f32_16x16x32_bf16 v[84:87], v[154:157], v[122:125], v[84:87]
  v_mfma_f32_16x16x32_bf16 v[88:91], v[178:181], v[122:125], v[88:91]
  s_cbranch_vccnz R_A_0_sc
  buffer_load_dwordx4 v[56:59], v238, s[4:7], s60 offen offset:0 sc1
  buffer_load_dwordx4 v[60:63], v238, s[4:7], s60 offen offset:1024 sc1
  buffer_load_dwordx4 v[64:67], v238, s[4:7], s60 offen offset:2048 sc1
  s_cmp_eq_u32 s30, 63
  s_cbranch_scc1 L_last_sc
  buffer_store_dwordx2 v[252:253], v235, s[4:7], s58 offen sc1
  buffer_store_dwordx2 v[252:253], v236, s[4:7], s58 offen sc1
  buffer_store_dwordx2 v[98:99], v235, s[4:7], s68 offen sc1
  buffer_store_dwordx2 v[100:101], v236, s[4:7], s68 offen sc1
  s_add_u32 s68, s68, 294912
  s_nop 1
  v_cmp_eq_u32 vcc, 0, v127
  s_cbranch_vccnz R_F_0_sc
K_F_0_sc:
  s_add_u32 s23, s23, 64
  s_nop 3
  v_max3_f32 v4, v80, v81, v82
  v_max3_f32 v5, v83, v84, v85
  v_max3_f32 v6, v86, v87, v88
  v_max3_f32 v7, v89, v90, v91
  v_max3_f32 v4, v4, v5, v6
  v_max_f32 v4, v4, v7
  v_mov_b32 v5, v4
  s_nop 1
  v_permlane32_swap_b32 v4, v5
  v_max_f32 v4, v4, v5
  v_mov_b32 v5, v4
  s_nop 1
  v_permlane16_swap_b32 v4, v5
  v_max_f32 v4, v4, v5
  v_mul_f32 v4, s70, v4
  v_fma_f32 v80, v80, s70, -v4
  v_fma_f32 v81, v81, s70, -v4
  v_fma_f32 v82, v82, s70, -v4
  v_fma_f32 v83, v83, s70, -v4
  v_fma_f32 v84, v84, s70, -v4
  v_fma_f32 v85, v85, s70, -v4
  v_fma_f32 v86, v86, s70, -v4
  v_fma_f32 v87, v87, s70, -v4
  v_fma_f32 v88, v88, s70, -v4
  v_fma_f32 v89, v89, s70, -v4
  v_fma_f32 v90, v90, s70, -v4
  v_fma_f32 v91, v91, s70, -v4
  v_exp_f32 v80, v80
  v_exp_f32 v81, v81
  v_exp_f32 v82, v82
  v_exp_f32 v83, v83
  v_exp_f32 v84, v84
  v_exp_f32 v85, v85
  v_exp_f32 v86, v86
  v_exp_f32 v87, v87
  v_exp_f32 v88, v88
  v_exp_f32 v89, v89
  v_exp_f32 v90, v90
  v_exp_f32 v91, v91
  s_waitcnt vmcnt(4)
  v_cvt_pk_bf16_f32 v94, v84, v85
  v_cvt_pk_bf16_f32 v95, v86, v87
  v_cvt_pk_bf16_f32 v96, v88, v89
  v_cvt_pk_bf16_f32 v97, v90, v91
  v_cvt_pk_bf16_f32 v92, v80, v81
  v_cvt_pk_bf16_f32 v93, v82, v83
  v_mov_b32 v132, 0
  v_mov_b32 v133, 0
  v_mov_b32 v4, v92
  v_mov_b32 v5, v93
  s_nop 1
  v_permlane32_swap_b32 v4, v132
  v_permlane32_swap_b32 v5, v133
  v_max3_u32 v4, v56, v57, v58
  v_max3_u32 v5, v59, v60, v61
  v_max3_u32 v6, v62, v63, v64
  v_max3_u32 v7, v65, v66, v67
  v_max3_u32 v4, v4, v5, v6
  v_max_u32 v4, v4, v7
  v_cmp_eq_u32 vcc, -1, v4
  s_cbranch_vccnz R_V_0_sc
K_V_0_sc:
  v_mfma_f32_16x16x32_bf16 v[102:105], v[182:185], v[94:97], 0
  v_pk_add_f32 v[80:81], v[80:81], v[82:83]
  v_pk_add_f32 v[84:85], v[84:85], v[86:87]
  buffer_load_dwordx4 v[134:137], v239, s[4:7], s69 offen offset:0 sc1
  buffer_load_dwordx4 v[138:141], v239, s[4:7], s69 offen offset:1024 sc1
  buffer_load_dwordx4 v[142:145], v239, s[4:7], s69 offen offset:2048 sc1
  v_mfma_f32_16x16x32_bf16 v[106:109], v[186:189], v[94:97], 0
  v_pk_add_f32 v[88:89], v[88:89], v[90:91]
  v_pk_add_f32 v[80:81], v[80:81], v[84:85]
  buffer_load_dwordx4 v[146:149], v239, s[4:7], s69 offen offset:3072 sc1
  s_add_u32 s69, s69, 4096
  buffer_load_dwordx4 v[150:153], v239, s[4:7], s69 offen offset:0 sc1
  v_mfma_f32_16x16x32_bf16 v[110:113], v[190:193], v[94:97], 0
  v_pk_add_f32 v[80:81], v[80:81], v[88:89]
  v_add_f32 v4, v80, v81
  buffer_load_dwordx4 v[154:157], v239, s[4:7], s69 offen offset:1024 sc1
  buffer_load_dwordx4 v[158:161], v239, s[4:7], s69 offen offset:2048 sc1
  buffer_load_dwordx4 v[162:165], v239, s[4:7], s69 offen offset:3072 sc1
  v_mfma_f32_16x16x32_bf16 v[114:117], v[194:197], v[94:97], 0
  v_mov_b32 v5, v4
  s_nop 1
  s_add_u32 s69, s69, 4096
  buffer_load_dwordx4 v[166:169], v239, s[4:7], s69 offen offset:0 sc1
  buffer_load_dwordx4 v[170:173], v239, s[4:7], s69 offen offset:1024 sc1
  v_mfma_f32_16x16x32_bf16 v[118:121], v[198:201], v[94:97], 0
  v_permlane32_swap_b32 v4, v5
  v_add_f32 v4, v4, v5
  buffer_load_dwordx4 v[174:177], v239, s[4:7], s69 offen offset:2048 sc1
  buffer_load_dwordx4 v[178:181], v239, s[4:7], s69 offen offset:3072 sc1
  s_add_u32 s69, s69, 16384
  v_mfma_f32_16x16x32_bf16 v[122:125], v[202:205], v[94:97], 0
  v_mov_b32 v5, v4
  s_nop 1
  v_mfma_f32_16x16x16_bf16 v[102:105], v[56:57], v[92:93], v[102:105]
  v_permlane16_swap_b32 v4, v5
  v_add_f32 v4, v4, v5
  v_mfma_f32_16x16x16_bf16 v[106:109], v[56:57], v[132:133], v[106:109]
  v_rcp_f32 v130, v4
  s_nop 0
  v_mfma_f32_16x16x16_bf16 v[110:113], v[58:59], v[92:93], v[110:113]
  v_mov_b32 v131, v130
  v_mfma_f32_16x16x16_bf16 v[114:117], v[58:59], v[132:133], v[114:117]
  v_mfma_f32_16x16x16_bf16 v[118:121], v[60:61], v[92:93], v[118:121]
  v_mfma_f32_16x16x16_bf16 v[122:125], v[60:61], v[132:133], v[122:125]
  v_mfma_f32_16x16x32_bf16 v[28:31], v[206:209], v[94:97], 0
  v_cvt_pk_bf16_f32 v8, v102, v103
  v_cvt_pk_bf16_f32 v9, v104, v105
  v_mfma_f32_16x16x32_bf16 v[32:35], v[210:213], v[94:97], 0
  v_cvt_pk_bf16_f32 v10, v106, v107
  v_cvt_pk_bf16_f32 v11, v108, v109
  v_mfma_f32_16x16x32_bf16 v[36:39], v[214:217], v[94:97], 0
  v_cvt_pk_bf16_f32 v12, v110, v111
  v_cvt_pk_bf16_f32 v13, v112, v113
  v_mfma_f32_16x16x32_bf16 v[40:43], v[218:221], v[94:97], 0
  v_cvt_pk_bf16_f32 v14, v114, v115
  v_cvt_pk_bf16_f32 v15, v116, v117
  v_mfma_f32_16x16x32_bf16 v[44:47], v[222:225], v[94:97], 0
  v_cvt_pk_bf16_f32 v16, v118, v119
  v_cvt_pk_bf16_f32 v17, v120, v121
  v_mfma_f32_16x16x32_bf16 v[48:51], v[226:229], v[94:97], 0
  v_cvt_pk_bf16_f32 v18, v122, v123
  v_cvt_pk_bf16_f32 v19, v124, v125
  v_mfma_f32_16x16x16_bf16 v[28:31], v[62:63], v[92:93], v[28:31]
  v_mfma_f32_16x16x16_bf16 v[32:35], v[62:63], v[132:133], v[32:35]
  v_mfma_f32_16x16x16_bf16 v[36:39], v[64:65], v[92:93], v[36:39]
  v_mfma_f32_16x16x16_bf16 v[40:43], v[64:65], v[132:133], v[40:43]
  v_mfma_f32_16x16x16_bf16 v[44:47], v[66:67], v[92:93], v[44:47]
  v_mfma_f32_16x16x16_bf16 v[48:51], v[66:67], v[132:133], v[48:51]
  s_nop 3
  v_cvt_pk_bf16_f32 v20, v28, v29
  v_cvt_pk_bf16_f32 v21, v30, v31
  v_cvt_pk_bf16_f32 v22, v32, v33
  v_cvt_pk_bf16_f32 v23, v34, v35
  v_cvt_pk_bf16_f32 v24, v36, v37
  v_cvt_pk_bf16_f32 v25, v38, v39
  v_cvt_pk_bf16_f32 v26, v40, v41
  v_cvt_pk_bf16_f32 v27, v42, v43
  v_cvt_pk_bf16_f32 v52, v44, v45
  v_cvt_pk_bf16_f32 v53, v46, v47
  v_cvt_pk_bf16_f32 v54, v48, v49
  v_cvt_pk_bf16_f32 v55, v50, v51
  s_nop 1
  v_mfma_f32_16x16x32_bf16 v[102:105], a[180:183], v[8:11], 0
  buffer_load_dwordx4 v[182:185], v239, s[4:7], s33 offen offset:0 sc1
  v_mfma_f32_16x16x32_bf16 v[106:109], a[204:207], v[8:11], 0
  buffer_load_dwordx4 v[186:189], v239, s[4:7], s33 offen offset:1024 sc1
  v_mfma_f32_16x16x32_bf16 v[110:113], a[228:231], v[8:11], 0
  buffer_load_dwordx4 v[190:193], v239, s[4:7], s33 offen offset:2048 sc1
  v_mfma_f32_16x16x32_bf16 v[102:105], a[184:187], v[12:15], v[102:105]
  buffer_load_dwordx4 v[194:197], v239, s[4:7], s33 offen offset:3072 sc1
  v_mfma_f32_16x16x32_bf16 v[106:109], a[208:211], v[12:15], v[106:109]
  s_add_u32 s33, s33, 4096
  v_mfma_f32_16x16x32_bf16 v[110:113], a[232:235], v[12:15], v[110:113]
  buffer_load_dwordx4 v[198:201], v239, s[4:7], s33 offen offset:0 sc1
  v_mfma_f32_16x16x32_bf16 v[102:105], a[188:191], v[16:19], v[102:105]
  buffer_load_dwordx4 v[202:205], v239, s[4:7], s33 offen offset:1024 sc1
  v_mfma_f32_16x16x32_bf16 v[106:109], a[212:215], v[16:19], v[106:109]
  buffer_load_dwordx4 v[206:209], v239, s[4:7], s33 offen offset:2048 sc1
  v_mfma_f32_16x16x32_bf16 v[110:113], a[236:239], v[16:19], v[110:113]
  buffer_load_dwordx4 v[210:213], v239, s[4:7], s33 offen offset:3072 sc1
  v_mfma_f32_16x16x32_bf16 v[102:105], a[192:195], v[20:23], v[102:105]
  s_add_u32 s33, s33, 4096
  v_mfma_f32_16x16x32_bf16 v[106:109], a[216:219], v[20:23], v[106:109]
  buffer_load_dwordx4 v[214:217], v239, s[4:7], s33 offen offset:0 sc1
  v_mfma_f32_16x16x32_bf16 v[110:113], a[240:243], v[20:23], v[110:113]
  buffer_load_dwordx4 v[218:221], v239, s[4:7], s33 offen offset:1024 sc1
  v_mfma_f32_16x16x32_bf16 v[102:105], a[196:199], v[24:27], v[102:105]
  buffer_load_dwordx4 v[222:225], v239, s[4:7], s33 offen offset:2048 sc1
  v_mfma_f32_16x16x32_bf16 v[106:109], a[220:223], v[24:27], v[106:109]
  buffer_load_dwordx4 v[226:229], v239, s[4:7], s33 offen offset:3072 sc1
  v_mfma_f32_16x16x32_bf16 v[110:113], a[244:247], v[24:27], v[110:113]
  s_add_u32 s33, s33, 16384
  v_mfma_f32_16x16x32_bf16 v[102:105], a[200:203], v[52:55], v[102:105]
  v_mfma_f32_16x16x32_bf16 v[106:109], a[224:227], v[52:55], v[106:109]
  v_mfma_f32_16x16x32_bf16 v[110:113], a[248:251], v[52:55], v[110:113]
  s_nop 6
  v_pk_mul_f32 v[102:103], v[102:103], v[130:131]
  v_pk_mul_f32 v[104:105], v[104:105], v[130:131]
  v_pk_mul_f32 v[106:107], v[106:107], v[130:131]
  v_pk_mul_f32 v[108:109], v[108:109], v[130:131]
  v_pk_mul_f32 v[110:111], v[110:111], v[130:131]
  v_pk_mul_f32 v[112:113], v[112:113], v[130:131]
  ds_write_b128 v240, v[102:105] offset:0
  ds_write_b128 v240, v[106:109] offset:512
  ds_write_b128 v240, v[110:113] offset:1024
  s_waitcnt lgkmcnt(0)
  s_barrier
  s_cmp_ge_u32 s29, 2
  s_cbranch_scc1 L_idle_0_sc
  ds_read_b128 v[28:31], v241 offset:0
  ds_read_b128 v[32:35], v241 offset:1536
  ds_read_b128 v[36:39], v241 offset:3072
  ds_read_b128 v[40:43], v241 offset:4608
  s_waitcnt lgkmcnt(0)
  v_pk_add_f32 v[28:29], v[28:29], v[32:33]
  v_pk_add_f32 v[30:31], v[30:31], v[34:35]
  v_pk_add_f32 v[36:37], v[36:37], v[40:41]
  v_pk_add_f32 v[38:39], v[38:39], v[42:43]
  v_pk_add_f32 v[28:29], v[28:29], v[36:37]
  v_pk_add_f32 v[30:31], v[30:31], v[38:39]
  buffer_store_dwordx4 v[28:31], v242, s[4:7], s64 offen sc1
  s_sleep 14
  buffer_load_dwordx4 v[56:59], v243, s[4:7], s64 offen offset:0 sc1
  buffer_load_dwordx4 v[60:63], v243, s[4:7], s64 offen offset:640 sc1
  buffer_load_dwordx4 v[64:67], v243, s[4:7], s64 offen offset:1280 sc1
  buffer_load_dwordx4 v[68:71], v243, s[4:7], s64 offen offset:1920 sc1
  buffer_load_dwordx4 v[72:75], v244, s[4:7], s64 offen offset:0 sc1
  buffer_load_dwordx4 v[76:79], v244, s[4:7], s64 offen offset:640 sc1
  buffer_load_dwordx4 v[80:83], v244, s[4:7], s64 offen offset:1280 sc1
  buffer_load_dwordx4 v[84:87], v244, s[4:7], s64 offen offset:1920 sc1
  s_waitcnt vmcnt(0)
  v_pk_add_f32 v[56:57], v[56:57], v[60:61]
  v_pk_add_f32 v[58:59], v[58:59], v[62:63]
  v_pk_add_f32 v[64:65], v[64:65], v[68:69]
  v_pk_add_f32 v[66:67], v[66:67], v[70:71]
  v_pk_add_f32 v[72:73], v[72:73], v[76:77]
  v_pk_add_f32 v[74:75], v[74:75], v[78:79]
  v_pk_add_f32 v[80:81], v[80:81], v[84:85]
  v_pk_add_f32 v[82:83], v[82:83], v[86:87]
  v_pk_add_f32 v[56:57], v[56:57], v[64:65]
  v_pk_add_f32 v[58:59], v[58:59], v[66:67]
  v_pk_add_f32 v[72:73], v[72:73], v[80:81]
  v_pk_add_f32 v[74:75], v[74:75], v[82:83]
  v_pk_add_f32 v[56:57], v[56:57], v[72:73]
  v_pk_add_f32 v[58:59], v[58:59], v[74:75]
  v_cmp_u_f32 vcc, v56, v57
  v_cmp_u_f32 s[74:75], v58, v59
  s_or_b64 vcc, vcc, s[74:75]
  s_cbranch_vccnz R_B2_0_sc
K_B2_0_sc:
  v_cvt_pk_bf16_f32 v60, v56, v57
  v_cvt_pk_bf16_f32 v61, v58, v59
  buffer_store_dwordx2 v[60:61], v245, s[4:7], s53 offen sc1
  buffer_store_dword v126, v128, s[4:7], s101 offen sc1
  s_branch L_join_0_sc
L_idle_0_sc:
  buffer_load_dwordx4 v[56:59], v239, s[4:7], s34 offen offset:0
  buffer_load_dwordx4 v[60:63], v239, s[4:7], s34 offen offset:1024
  buffer_load_dwordx4 v[64:67], v239, s[4:7], s34 offen offset:2048
  buffer_store_dwordx4 v[252:255], v242, s[4:7], s66 offen sc1
  buffer_store_dwordx2 v[252:253], v245, s[4:7], s55 offen sc1
  s_waitcnt vmcnt(0)
  buffer_store_dword v126, v128, s[4:7], s101 offen sc1
L_join_0_sc:
  s_add_u32 s101, s101, 64
  s_add_u32 s34, s34, 24576
  s_add_u32 s30, s30, 1
  s_mov_b32 s72, s52
  s_mov_b32 s52, s53
  s_mov_b32 s53, s54
  s_mov_b32 s54, s55
  s_mov_b32 s55, s72
  s_mov_b32 s72, s56
  s_mov_b32 s56, s57
  s_mov_b32 s57, s58
  s_mov_b32 s58, s59
  s_mov_b32 s59, s72
  s_mov_b32 s72, s60
  s_mov_b32 s60, s61
  s_mov_b32 s61, s62
  s_mov_b32 s62, s63
  s_mov_b32 s63, s72
  s_mov_b32 s72, s64
  s_mov_b32 s64, s65
  s_mov_b32 s65, s66
  s_mov_b32 s66, s67
  s_mov_b32 s67, s72
  s_barrier
  s_branch L_loop_sc
R_C_0_sc:
  s_add_u32 s96, s96, 1
  s_add_u32 s71, s71, 1
  s_cmp_gt_u32 s71, 400000
  s_cbranch_scc1 L_done_sc
  buffer_load_dwordx4 v[8:11], v230, s[4:7], s52 offen offset:0 sc1
  buffer_load_dwordx4 v[12:15], v230, s[4:7], s52 offen offset:512 sc1
  buffer_load_dwordx4 v[16:19], v230, s[4:7], s52 offen offset:1024 sc1
  buffer_load_dwordx4 v[20:23], v230, s[4:7], s52 offen offset:1536 sc1
  buffer_load_dwordx4 v[24:27], v230, s[4:7], s52 offen offset:2048 sc1
  s_waitcnt vmcnt(0)
  s_branch K_C_0_sc
R_A_0_sc:
  s_add_u32 s97, s97, 1
  s_add_u32 s71, s71, 1
  s_cmp_gt_u32 s71, 400000
  s_cbranch_scc1 L_done_sc
  buffer_load_dwordx4 v[102:105], v237, s[4:7], s60 offen offset:0 sc1
  buffer_load_dwordx4 v[106:109], v237, s[4:7], s60 offen offset:1024 sc1
  buffer_load_dwordx4 v[110:113], v237, s[4:7], s60 offen offset:2048 sc1
  buffer_load_dwordx4 v[114:117], v237, s[4:7], s60 offen offset:3072 sc1
  buffer_load_dwordx4 v[118:121], v237, s[4:7], s32 offen offset:0 sc1
  buffer_load_dwordx4 v[122:125], v237, s[4:7], s32 offen offset:1024 sc1
  s_waitcnt vmcnt(0)
  s_branch K_A_0_sc
R_F_0_sc:
  s_add_u32 s98, s98, 1
  s_add_u32 s71, s71, 1
  s_cmp_gt_u32 s71, 400000
  s_cbranch_scc1 L_done_sc
  buffer_load_dword v127, v246, s[4:7], s23 offen sc1
  s_waitcnt vmcnt(0)
  v_cmp_eq_u32 vcc, 0, v127
  s_cbranch_vccnz R_F_0_sc
  s_branch K_F_0_sc
R_V_0_sc:
  s_add_u32 s98, s98, 1
  s_add_u32 s71, s71, 1
  s_cmp_gt_u32 s71, 400000
  s_cbranch_scc1 L_done_sc
  buffer_load_dwordx4 v[56:59], v238, s[4:7], s60 offen offset:0 sc1
  buffer_load_dwordx4 v[60:63], v238, s[4:7], s60 offen offset:1024 sc1
  buffer_load_dwordx4 v[64:67], v238, s[4:7], s60 offen offset:2048 sc1
  s_waitcnt vmcnt(0)
  v_max3_u32 v4, v56, v57, v58
  v_max3_u32 v5, v59, v60, v61
  v_max3_u32 v6, v62, v63, v64
  v_max3_u32 v7, v65, v66, v67
  v_max3_u32 v4, v4, v5, v6
  v_max_u32 v4, v4, v7
  v_cmp_eq_u32 vcc, -1, v4
  s_cbranch_vccnz R_V_0_sc
  s_branch K_V_0_sc
R_B2_0_sc:
  s_add_u32 s99, s99, 1
  s_add_u32 s71, s71, 1
  s_cmp_gt_u32 s71, 400000
  s_cbranch_scc1 L_done_sc
  buffer_load_dwordx4 v[56:59], v243, s[4:7], s64 offen offset:0 sc1
  buffer_load_dwordx4 v[60:63], v243, s[4:7], s64 offen offset:640 sc1
  buffer_load_dwordx4 v[64:67], v243, s[4:7], s64 offen offset:1280 sc1
  buffer_load_dwordx4 v[68:71], v243, s[4:7], s64 offen offset:1920 sc1
  buffer_load_dwordx4 v[72:75], v244, s[4:7], s64 offen offset:0 sc1
  buffer_load_dwordx4 v[76:79], v244, s[4:7], s64 offen offset:640 sc1
  buffer_load_dwordx4 v[80:83], v244, s[4:7], s64 offen offset:1280 sc1
  buffer_load_dwordx4 v[84:87], v244, s[4:7], s64 offen offset:1920 sc1
  s_waitcnt vmcnt(0)
  v_pk_add_f32 v[56:57], v[56:57], v[60:61]
  v_pk_add_f32 v[58:59], v[58:59], v[62:63]
  v_pk_add_f32 v[64:65], v[64:65], v[68:69]
  v_pk_add_f32 v[66:67], v[66:67], v[70:71]
  v_pk_add_f32 v[72:73], v[72:73], v[76:77]
  v_pk_add_f32 v[74:75], v[74:75], v[78:79]
  v_pk_add_f32 v[80:81], v[80:81], v[84:85]
  v_pk_add_f32 v[82:83], v[82:83], v[86:87]
  v_pk_add_f32 v[56:57], v[56:57], v[64:65]
  v_pk_add_f32 v[58:59], v[58:59], v[66:67]
  v_pk_add_f32 v[72:73], v[72:73], v[80:81]
  v_pk_add_f32 v[74:75], v[74:75], v[82:83]
  v_pk_add_f32 v[56:57], v[56:57], v[72:73]
  v_pk_add_f32 v[58:59], v[58:59], v[74:75]
  v_cmp_u_f32 vcc, v56, v57
  v_cmp_u_f32 s[74:75], v58, v59
  s_or_b64 vcc, vcc, s[74:75]
  s_cbranch_vccnz R_B2_0_sc
  s_branch K_B2_0_sc
L_last_sc:
  buffer_store_dwordx2 v[98:99], v235, s[4:7], s68 offen sc1
  buffer_store_dwordx2 v[100:101], v236, s[4:7], s68 offen sc1
  s_waitcnt vmcnt(0)
  buffer_store_dword v126, v128, s[4:7], s101 offen sc1
L_done_sc:
  s_branch L_mend
L_slowx:
  s_sub_u32 s25, s72, 16
  s_load_dwordx4 s[52:55], s[0:1], 64
  s_load_dwordx4 s[56:59], s[0:1], 80
  s_load_dwordx2 s[60:61], s[0:1], 0
  s_load_dwordx2 s[62:63], s[0:1], 96
  s_lshr_b32 s26, s25, 2
  s_and_b32 s27, s25, 3
  s_lshl_b32 s28, s24, 2
  s_add_u32 s28, s28, s26
  s_lshr_b32 s34, s29, 1
  s_and_b32 s35, s29, 1
  s_mov_b32 s71, 0
  s_waitcnt lgkmcnt(0)
  v_lshlrev_b32 v200, 4, v1
  v_mov_b32 v205, 1
  v_mov_b32 v210, 0x80000000
  v_cmp_eq_u32 vcc, 0, v1
  v_mov_b32 v4, 0
  v_cndmask_b32 v204, v210, v4, vcc
  s_mul_i32 s72, s29, 960
  s_add_u32 s72, s72, 0
  v_add_u32 v6, s72, v1
  s_mov_b32 s73, 43691
  v_mul_lo_u32 v7, v6, s73
  v_lshrrev_b32 v7, 18, v7
  v_mul_u32_u24 v30, 6, v7
  v_sub_u32 v30, v6, v30
  v_lshlrev_b32 v30, 4, v30
  s_mov_b32 s73, 12288
  v_mad_u32_u24 v30, v7, s73, v30
  s_mul_i32 s72, s29, 960
  s_add_u32 s72, s72, 64
  v_add_u32 v6, s72, v1
  s_mov_b32 s73, 43691
  v_mul_lo_u32 v7, v6, s73
  v_lshrrev_b32 v7, 18, v7
  v_mul_u32_u24 v31, 6, v7
  v_sub_u32 v31, v6, v31
  v_lshlrev_b32 v31, 4, v31
  s_mov_b32 s73, 12288
  v_mad_u32_u24 v31, v7, s73, v31
  s_mul_i32 s72, s29, 960
  s_add_u32 s72, s72, 128
  v_add_u32 v6, s72, v1
  s_mov_b32 s73, 43691
  v_mul_lo_u32 v7, v6, s73
  v_lshrrev_b32 v7, 18, v7
  v_mul_u32_u24 v32, 6, v7
  v_sub_u32 v32, v6, v32
  v_lshlrev_b32 v32, 4, v32
  s_mov_b32 s73, 12288
  v_mad_u32_u24 v32, v7, s73, v32
  s_mul_i32 s72, s29, 960
  s_add_u32 s72, s72, 192
  v_add_u32 v6, s72, v1
  s_mov_b32 s73, 43691
  v_mul_lo_u32 v7, v6, s73
  v_lshrrev_b32 v7, 18, v7
  v_mul_u32_u24 v33, 6, v7
  v_sub_u32 v33, v6, v33
  v_lshlrev_b32 v33, 4, v33
  s_mov_b32 s73, 12288
  v_mad_u32_u24 v33, v7, s73, v33
  s_mul_i32 s72, s29, 960
  s_add_u32 s72, s72, 256
  v_add_u32 v6, s72, v1
  s_mov_b32 s73, 43691
  v_mul_lo_u32 v7, v6, s73
  v_lshrrev_b32 v7, 18, v7
  v_mul_u32_u24 v34, 6, v7
  v_sub_u32 v34, v6, v34
  v_lshlrev_b32 v34, 4, v34
  s_mov_b32 s73, 12288
  v_mad_u32_u24 v34, v7, s73, v34
  s_mul_i32 s72, s29, 960
  s_add_u32 s72, s72, 320
  v_add_u32 v6, s72, v1
  s_mov_b32 s73, 43691
  v_mul_lo_u32 v7, v6, s73
  v_lshrrev_b32 v7, 18, v7
  v_mul_u32_u24 v35, 6, v7
  v_sub_u32 v35, v6, v35
  v_lshlrev_b32 v35, 4, v35
  s_mov_b32 s73, 12288
  v_mad_u32_u24 v35, v7, s73, v35
  s_mul_i32 s72, s29, 960
  s_add_u32 s72, s72, 384
  v_add_u32 v6, s72, v1
  s_mov_b32 s73, 43691
  v_mul_lo_u32 v7, v6, s73
  v_lshrrev_b32 v7, 18, v7
  v_mul_u32_u24 v36, 6, v7
  v_sub_u32 v36, v6, v36
  v_lshlrev_b32 v36, 4, v36
  s_mov_b32 s73, 12288
  v_mad_u32_u24 v36, v7, s73, v36
  s_mul_i32 s72, s29, 960
  s_add_u32 s72, s72, 448
  v_add_u32 v6, s72, v1
  s_mov_b32 s73, 43691
  v_mul_lo_u32 v7, v6, s73
  v_lshrrev_b32 v7, 18, v7
  v_mul_u32_u24 v37, 6, v7
  v_sub_u32 v37, v6, v37
  v_lshlrev_b32 v37, 4, v37
  s_mov_b32 s73, 12288
  v_mad_u32_u24 v37, v7, s73, v37
  s_mul_i32 s72, s29, 960
  s_add_u32 s72, s72, 512
  v_add_u32 v6, s72, v1
  s_mov_b32 s73, 43691
  v_mul_lo_u32 v7, v6, s73
  v_lshrrev_b32 v7, 18, v7
  v_mul_u32_u24 v38, 6, v7
  v_sub_u32 v38, v6, v38
  v_lshlrev_b32 v38, 4, v38
  s_mov_b32 s73, 12288
  v_mad_u32_u24 v38, v7, s73, v38
  s_mul_i32 s72, s29, 960
  s_add_u32 s72, s72, 576
  v_add_u32 v6, s72, v1
  s_mov_b32 s73, 43691
  v_mul_lo_u32 v7, v6, s73
  v_lshrrev_b32 v7, 18, v7
  v_mul_u32_u24 v39, 6, v7
  v_sub_u32 v39, v6, v39
  v_lshlrev_b32 v39, 4, v39
  s_mov_b32 s73, 12288
  v_mad_u32_u24 v39, v7, s73, v39
  s_mul_i32 s72, s29, 960
  s_add_u32 s72, s72, 640
  v_add_u32 v6, s72, v1
  s_mov_b32 s73, 43691
  v_mul_lo_u32 v7, v6, s73
  v_lshrrev_b32 v7, 18, v7
  v_mul_u32_u24 v40, 6, v7
  v_sub_u32 v40, v6, v40
  v_lshlrev_b32 v40, 4, v40
  s_mov_b32 s73, 12288
  v_mad_u32_u24 v40, v7, s73, v40
  s_mul_i32 s72, s29, 960
  s_add_u32 s72, s72, 704
  v_add_u32 v6, s72, v1
  s_mov_b32 s73, 43691
  v_mul_lo_u32 v7, v6, s73
  v_lshrrev_b32 v7, 18, v7
  v_mul_u32_u24 v41, 6, v7
  v_sub_u32 v41, v6, v41
  v_lshlrev_b32 v41, 4, v41
  s_mov_b32 s73, 12288
  v_mad_u32_u24 v41, v7, s73, v41
  s_mul_i32 s72, s29, 960
  s_add_u32 s72, s72, 768
  v_add_u32 v6, s72, v1
  s_mov_b32 s73, 43691
  v_mul_lo_u32 v7, v6, s73
  v_lshrrev_b32 v7, 18, v7
  v_mul_u32_u24 v42, 6, v7
  v_sub_u32 v42, v6, v42
  v_lshlrev_b32 v42, 4, v42
  s_mov_b32 s73, 12288
  v_mad_u32_u24 v42, v7, s73, v42
  s_mul_i32 s72, s29, 960
  s_add_u32 s72, s72, 832
  v_add_u32 v6, s72, v1
  s_mov_b32 s73, 43691
  v_mul_lo_u32 v7, v6, s73
  v_lshrrev_b32 v7, 18, v7
  v_mul_u32_u24 v43, 6, v7
  v_sub_u32 v43, v6, v43
  v_lshlrev_b32 v43, 4, v43
  s_mov_b32 s73, 12288
  v_mad_u32_u24 v43, v7, s73, v43
  s_mul_i32 s72, s29, 960
  s_add_u32 s72, s72, 896
  v_add_u32 v6, s72, v1
  s_mov_b32 s73, 43691
  v_mul_lo_u32 v7, v6, s73
  v_lshrrev_b32 v7, 18, v7
  v_mul_u32_u24 v44, 6, v7
  v_sub_u32 v44, v6, v44
  v_lshlrev_b32 v44, 4, v44
  s_mov_b32 s73, 12288
  v_mad_u32_u24 v44, v7, s73, v44
  s_mul_i32 s74, s28, 384
  s_mul_i32 s72, s27, 96
  s_add_u32 s74, s74, s72
  s_mov_b32 s36, s74
  s_mov_b32 s8, s42
  s_and_b32 s9, s43, 0xffff
  s_mov_b32 s10, 7864320
  s_mov_b32 s11, 0x00020000
  s_mul_i32 s72, s29, 15360
  s_add_u32 s72, s72, 0
  s_add_u32 m0, s72, 0
  s_nop 0
  buffer_load_dwordx4 v30, s[8:11], s74 offen lds
  s_add_u32 m0, s72, 1024
  s_nop 0
  buffer_load_dwordx4 v31, s[8:11], s74 offen lds
  s_add_u32 m0, s72, 2048
  s_nop 0
  buffer_load_dwordx4 v32, s[8:11], s74 offen lds
  s_add_u32 m0, s72, 3072
  s_nop 0
  buffer_load_dwordx4 v33, s[8:11], s74 offen lds
  s_add_u32 m0, s72, 4096
  s_nop 0
  buffer_load_dwordx4 v34, s[8:11], s74 offen lds
  s_add_u32 m0, s72, 5120
  s_nop 0
  buffer_load_dwordx4 v35, s[8:11], s74 offen lds
  s_add_u32 m0, s72, 6144
  s_nop 0
  buffer_load_dwordx4 v36, s[8:11], s74 offen lds
  s_add_u32 m0, s72, 7168
  s_nop 0
  buffer_load_dwordx4 v37, s[8:11], s74 offen lds
  s_add_u32 m0, s72, 8192
  s_nop 0
  buffer_load_dwordx4 v38, s[8:11], s74 offen lds
  s_add_u32 m0, s72, 9216
  s_nop 0
  buffer_load_dwordx4 v39, s[8:11], s74 offen lds
  s_add_u32 m0, s72, 10240
  s_nop 0
  buffer_load_dwordx4 v40, s[8:11], s74 offen lds
  s_add_u32 m0, s72, 11264
  s_nop 0
  buffer_load_dwordx4 v41, s[8:11], s74 offen lds
  s_add_u32 m0, s72, 12288
  s_nop 0
  buffer_load_dwordx4 v42, s[8:11], s74 offen lds
  s_add_u32 m0, s72, 13312
  s_nop 0
  buffer_load_dwordx4 v43, s[8:11], s74 offen lds
  s_add_u32 m0, s72, 14336
  s_nop 0
  buffer_load_dwordx4 v44, s[8:11], s74 offen lds
  s_mov_b32 s8, s44
  s_and_b32 s9, s45, 0xffff
  s_mov_b32 s10, 7864320
  s_mov_b32 s11, 0x00020000
  s_mul_i32 s72, s29, 15360
  s_add_u32 s72, s72, 61440
  s_add_u32 m0, s72, 0
  s_nop 0
  buffer_load_dwordx4 v30, s[8:11], s74 offen lds
  s_add_u32 m0, s72, 1024
  s_nop 0
  buffer_load_dwordx4 v31, s[8:11], s74 offen lds
  s_add_u32 m0, s72, 2048
  s_nop 0
  buffer_load_dwordx4 v32, s[8:11], s74 offen lds
  s_add_u32 m0, s72, 3072
  s_nop 0
  buffer_load_dwordx4 v33, s[8:11], s74 offen lds
  s_add_u32 m0, s72, 4096
  s_nop 0
  buffer_load_dwordx4 v34, s[8:11], s74 offen lds
  s_add_u32 m0, s72, 5120
  s_nop 0
  buffer_load_dwordx4 v35, s[8:11], s74 offen lds
  s_add_u32 m0, s72, 6144
  s_nop 0
  buffer_load_dwordx4 v36, s[8:11], s74 offen lds
  s_add_u32 m0, s72, 7168
  s_nop 0
  buffer_load_dwordx4 v37, s[8:11], s74 offen lds
  s_add_u32 m0, s72, 8192
  s_nop 0
  buffer_load_dwordx4 v38, s[8:11], s74 offen lds
  s_add_u32 m0, s72, 9216
  s_nop 0
  buffer_load_dwordx4 v39, s[8:11], s74 offen lds
  s_add_u32 m0, s72, 10240
  s_nop 0
  buffer_load_dwordx4 v40, s[8:11], s74 offen lds
  s_add_u32 m0, s72, 11264
  s_nop 0
  buffer_load_dwordx4 v41, s[8:11], s74 offen lds
  s_add_u32 m0, s72, 12288
  s_nop 0
  buffer_load_dwordx4 v42, s[8:11], s74 offen lds
  s_add_u32 m0, s72, 13312
  s_nop 0
  buffer_load_dwordx4 v43, s[8:11], s74 offen lds
  s_add_u32 m0, s72, 14336
  s_nop 0
  buffer_load_dwordx4 v44, s[8:11], s74 offen lds
  v_lshrrev_b32 v4, 2, v2
  v_and_b32 v5, 3, v2
  v_lshl_add_u32 v6, v3, 3, v4
  v_mul_u32_u24 v20, 96, v6
  v_lshl_add_u32 v20, v5, 3, v20
  v_add_u32 v21, 61440, v20
  v_lshlrev_b32 v22, 5, v6
  v_lshl_add_u32 v22, v5, 3, v22
  v_add_u32 v22, 61440, v22
  s_waitcnt vmcnt(0)
  s_barrier
  s_cmp_eq_u32 s29, 0
  s_cbranch_scc0 L_w1a_sx
  ds_read_b64_tr_b16 a[0:1], v20 offset:0
  ds_read_b64_tr_b16 a[2:3], v20 offset:384
  ds_read_b64_tr_b16 a[4:5], v20 offset:3072
  ds_read_b64_tr_b16 a[6:7], v20 offset:3456
  ds_read_b64_tr_b16 a[8:9], v20 offset:6144
  ds_read_b64_tr_b16 a[10:11], v20 offset:6528
  ds_read_b64_tr_b16 a[12:13], v20 offset:9216
  ds_read_b64_tr_b16 a[14:15], v20 offset:9600
  s_waitcnt lgkmcnt(0)
  ds_read_b64_tr_b16 a[16:17], v20 offset:12288
  ds_read_b64_tr_b16 a[18:19], v20 offset:12672
  ds_read_b64_tr_b16 a[20:21], v20 offset:15360
  ds_read_b64_tr_b16 a[22:23], v20 offset:15744
  ds_read_b64_tr_b16 a[24:25], v20 offset:18432
  ds_read_b64_tr_b16 a[26:27], v20 offset:18816
  ds_read_b64_tr_b16 a[28:29], v20 offset:21504
  ds_read_b64_tr_b16 a[30:31], v20 offset:21888
  s_waitcnt lgkmcnt(0)
  ds_read_b64_tr_b16 a[32:33], v20 offset:24576
  ds_read_b64_tr_b16 a[34:35], v20 offset:24960
  ds_read_b64_tr_b16 a[36:37], v20 offset:27648
  ds_read_b64_tr_b16 a[38:39], v20 offset:28032
  ds_read_b64_tr_b16 a[40:41], v20 offset:30720
  ds_read_b64_tr_b16 a[42:43], v20 offset:31104
  ds_read_b64_tr_b16 a[44:45], v20 offset:33792
  ds_read_b64_tr_b16 a[46:47], v20 offset:34176
  s_waitcnt lgkmcnt(0)
  ds_read_b64_tr_b16 a[48:49], v20 offset:36864
  ds_read_b64_tr_b16 a[50:51], v20 offset:37248
  ds_read_b64_tr_b16 a[52:53], v20 offset:39936
  ds_read_b64_tr_b16 a[54:55], v20 offset:40320
  ds_read_b64_tr_b16 a[56:57], v20 offset:43008
  ds_read_b64_tr_b16 a[58:59], v20 offset:43392
  ds_read_b64_tr_b16 a[60:61], v20 offset:46080
  ds_read_b64_tr_b16 a[62:63], v20 offset:46464
  s_waitcnt lgkmcnt(0)
  ds_read_b64_tr_b16 a[64:65], v20 offset:49152
  ds_read_b64_tr_b16 a[66:67], v20 offset:49536
  ds_read_b64_tr_b16 a[68:69], v20 offset:52224
  ds_read_b64_tr_b16 a[70:71], v20 offset:52608
  ds_read_b64_tr_b16 a[72:73], v20 offset:55296
  ds_read_b64_tr_b16 a[74:75], v20 offset:55680
  ds_read_b64_tr_b16 a[76:77], v20 offset:58368
  ds_read_b64_tr_b16 a[78:79], v20 offset:58752
  s_waitcnt lgkmcnt(0)
  ds_read_b64_tr_b16 a[80:81], v20 offset:32
  ds_read_b64_tr_b16 a[82:83], v20 offset:416
  ds_read_b64_tr_b16 a[84:85], v20 offset:3104
  ds_read_b64_tr_b16 a[86:87], v20 offset:3488
  ds_read_b64_tr_b16 a[88:89], v20 offset:6176
  ds_read_b64_tr_b16 a[90:91], v20 offset:6560
  ds_read_b64_tr_b16 a[92:93], v20 offset:9248
  ds_read_b64_tr_b16 a[94:95], v20 offset:9632
  s_waitcnt lgkmcnt(0)
  ds_read_b64_tr_b16 a[96:97], v20 offset:12320
  ds_read_b64_tr_b16 a[98:99], v20 offset:12704
  ds_read_b64_tr_b16 a[100:101], v20 offset:15392
  ds_read_b64_tr_b16 a[102:103], v20 offset:15776
  ds_read_b64_tr_b16 a[104:105], v20 offset:18464
  ds_read_b64_tr_b16 a[106:107], v20 offset:18848
  ds_read_b64_tr_b16 a[108:109], v20 offset:21536
  ds_read_b64_tr_b16 a[110:111], v20 offset:21920
  s_waitcnt lgkmcnt(0)
  ds_read_b64_tr_b16 a[112:113], v20 offset:24608
  ds_read_b64_tr_b16 a[114:115], v20 offset:24992
  ds_read_b64_tr_b16 a[116:117], v20 offset:27680
  ds_read_b64_tr_b16 a[118:119], v20 offset:28064
  ds_read_b64_tr_b16 a[120:121], v20 offset:30752
  ds_read_b64_tr_b16 a[122:123], v20 offset:31136
  ds_read_b64_tr_b16 a[124:125], v20 offset:33824
  ds_read_b64_tr_b16 a[126:127], v20 offset:34208
  s_waitcnt lgkmcnt(0)
  ds_read_b64_tr_b16 a[128:129], v20 offset:36896
  ds_read_b64_tr_b16 a[130:131], v20 offset:37280
  ds_read_b64_tr_b16 a[132:133], v20 offset:39968
  ds_read_b64_tr_b16 a[134:135], v20 offset:40352
  ds_read_b64_tr_b16 a[136:137], v20 offset:43040
  ds_read_b64_tr_b16 a[138:139], v20 offset:43424
  ds_read_b64_tr_b16 a[140:141], v20 offset:46112
  ds_read_b64_tr_b16 a[142:143], v20 offset:46496
  s_waitcnt lgkmcnt(0)
  ds_read_b64_tr_b16 a[144:145], v20 offset:49184
  ds_read_b64_tr_b16 a[146:147], v20 offset:49568
  ds_read_b64_tr_b16 a[148:149], v20 offset:52256
  ds_read_b64_tr_b16 a[150:151], v20 offset:52640
  ds_read_b64_tr_b16 a[152:153], v20 offset:55328
  ds_read_b64_tr_b16 a[154:155], v20 offset:55712
  ds_read_b64_tr_b16 a[156:157], v20 offset:58400
  ds_read_b64_tr_b16 a[158:159], v20 offset:58784
  s_waitcnt lgkmcnt(0)
  ds_read_b64_tr_b16 a[160:161], v20 offset:64
  ds_read_b64_tr_b16 a[162:163], v20 offset:448
  ds_read_b64_tr_b16 a[164:165], v20 offset:3136
  ds_read_b64_tr_b16 a[166:167], v20 offset:3520
  ds_read_b64_tr_b16 a[168:169], v20 offset:6208
  ds_read_b64_tr_b16 a[170:171], v20 offset:6592
  ds_read_b64_tr_b16 a[172:173], v20 offset:9280
  ds_read_b64_tr_b16 a[174:175], v20 offset:9664
  s_waitcnt lgkmcnt(0)
  ds_read_b64_tr_b16 a[176:177], v20 offset:12352
  ds_read_b64_tr_b16 a[178:179], v20 offset:12736
  ds_read_b64_tr_b16 a[180:181], v20 offset:15424
  ds_read_b64_tr_b16 a[182:183], v20 offset:15808
  ds_read_b64_tr_b16 a[184:185], v20 offset:18496
  ds_read_b64_tr_b16 a[186:187], v20 offset:18880
  ds_read_b64_tr_b16 a[188:189], v20 offset:21568
  ds_read_b64_tr_b16 a[190:191], v20 offset:21952
  s_waitcnt lgkmcnt(0)
  ds_read_b64_tr_b16 a[192:193], v20 offset:24640
  ds_read_b64_tr_b16 a[194:195], v20 offset:25024
  ds_read_b64_tr_b16 a[196:197], v20 offset:27712
  ds_read_b64_tr_b16 a[198:199], v20 offset:28096
  ds_read_b64_tr_b16 a[200:201], v20 offset:30784
  ds_read_b64_tr_b16 a[202:203], v20 offset:31168
  ds_read_b64_tr_b16 a[204:205], v20 offset:33856
  ds_read_b64_tr_b16 a[206:207], v20 offset:34240
  s_waitcnt lgkmcnt(0)
  ds_read_b64_tr_b16 a[208:209], v20 offset:36928
  ds_read_b64_tr_b16 a[210:211], v20 offset:37312
  ds_read_b64_tr_b16 a[212:213], v20 offset:40000
  ds_read_b64_tr_b16 a[214:215], v20 offset:40384
  ds_read_b64_tr_b16 a[216:217], v20 offset:43072
  ds_read_b64_tr_b16 a[218:219], v20 offset:43456
  ds_read_b64_tr_b16 a[220:221], v20 offset:46144
  ds_read_b64_tr_b16 a[222:223], v20 offset:46528
  s_waitcnt lgkmcnt(0)
  ds_read_b64_tr_b16 a[224:225], v20 offset:49216
  ds_read_b64_tr_b16 a[226:227], v20 offset:49600
  ds_read_b64_tr_b16 a[228:229], v20 offset:52288
  ds_read_b64_tr_b16 a[230:231], v20 offset:52672
  ds_read_b64_tr_b16 a[232:233], v20 offset:55360
  ds_read_b64_tr_b16 a[234:235], v20 offset:55744
  ds_read_b64_tr_b16 a[236:237], v20 offset:58432
  ds_read_b64_tr_b16 a[238:239], v20 offset:58816
  s_waitcnt lgkmcnt(0)
L_w1a_sx:
  s_cmp_eq_u32 s29, 1
  s_cbranch_scc0 L_w1b_sx
  ds_read_b64_tr_b16 a[0:1], v21 offset:0
  ds_read_b64_tr_b16 a[2:3], v21 offset:384
  ds_read_b64_tr_b16 a[4:5], v21 offset:3072
  ds_read_b64_tr_b16 a[6:7], v21 offset:3456
  ds_read_b64_tr_b16 a[8:9], v21 offset:6144
  ds_read_b64_tr_b16 a[10:11], v21 offset:6528
  ds_read_b64_tr_b16 a[12:13], v21 offset:9216
  ds_read_b64_tr_b16 a[14:15], v21 offset:9600
  s_waitcnt lgkmcnt(0)
  ds_read_b64_tr_b16 a[16:17], v21 offset:12288
  ds_read_b64_tr_b16 a[18:19], v21 offset:12672
  ds_read_b64_tr_b16 a[20:21], v21 offset:15360
  ds_read_b64_tr_b16 a[22:23], v21 offset:15744
  ds_read_b64_tr_b16 a[24:25], v21 offset:18432
  ds_read_b64_tr_b16 a[26:27], v21 offset:18816
  ds_read_b64_tr_b16 a[28:29], v21 offset:21504
  ds_read_b64_tr_b16 a[30:31], v21 offset:21888
  s_waitcnt lgkmcnt(0)
  ds_read_b64_tr_b16 a[32:33], v21 offset:24576
  ds_read_b64_tr_b16 a[34:35], v21 offset:24960
  ds_read_b64_tr_b16 a[36:37], v21 offset:27648
  ds_read_b64_tr_b16 a[38:39], v21 offset:28032
  ds_read_b64_tr_b16 a[40:41], v21 offset:30720
  ds_read_b64_tr_b16 a[42:43], v21 offset:31104
  ds_read_b64_tr_b16 a[44:45], v21 offset:33792
  ds_read_b64_tr_b16 a[46:47], v21 offset:34176
  s_waitcnt lgkmcnt(0)
  ds_read_b64_tr_b16 a[48:49], v21 offset:36864
  ds_read_b64_tr_b16 a[50:51], v21 offset:37248
  ds_read_b64_tr_b16 a[52:53], v21 offset:39936
  ds_read_b64_tr_b16 a[54:55], v21 offset:40320
  ds_read_b64_tr_b16 a[56:57], v21 offset:43008
  ds_read_b64_tr_b16 a[58:59], v21 offset:43392
  ds_read_b64_tr_b16 a[60:61], v21 offset:46080
  ds_read_b64_tr_b16 a[62:63], v21 offset:46464
  s_waitcnt lgkmcnt(0)
  ds_read_b64_tr_b16 a[64:65], v21 offset:49152
  ds_read_b64_tr_b16 a[66:67], v21 offset:49536
  ds_read_b64_tr_b16 a[68:69], v21 offset:52224
  ds_read_b64_tr_b16 a[70:71], v21 offset:52608
  ds_read_b64_tr_b16 a[72:73], v21 offset:55296
  ds_read_b64_tr_b16 a[74:75], v21 offset:55680
  ds_read_b64_tr_b16 a[76:77], v21 offset:58368
  ds_read_b64_tr_b16 a[78:79], v21 offset:58752
  s_waitcnt lgkmcnt(0)
  ds_read_b64_tr_b16 a[80:81], v21 offset:32
  ds_read_b64_tr_b16 a[82:83], v21 offset:416
  ds_read_b64_tr_b16 a[84:85], v21 offset:3104
  ds_read_b64_tr_b16 a[86:87], v21 offset:3488
  ds_read_b64_tr_b16 a[88:89], v21 offset:6176
  ds_read_b64_tr_b16 a[90:91], v21 offset:6560
  ds_read_b64_tr_b16 a[92:93], v21 offset:9248
  ds_read_b64_tr_b16 a[94:95], v21 offset:9632
  s_waitcnt lgkmcnt(0)
  ds_read_b64_tr_b16 a[96:97], v21 offset:12320
  ds_read_b64_tr_b16 a[98:99], v21 offset:12704
  ds_read_b64_tr_b16 a[100:101], v21 offset:15392
  ds_read_b64_tr_b16 a[102:103], v21 offset:15776
  ds_read_b64_tr_b16 a[104:105], v21 offset:18464
  ds_read_b64_tr_b16 a[106:107], v21 offset:18848
  ds_read_b64_tr_b16 a[108:109], v21 offset:21536
  ds_read_b64_tr_b16 a[110:111], v21 offset:21920
  s_waitcnt lgkmcnt(0)
  ds_read_b64_tr_b16 a[112:113], v21 offset:24608
  ds_read_b64_tr_b16 a[114:115], v21 offset:24992
  ds_read_b64_tr_b16 a[116:117], v21 offset:27680
  ds_read_b64_tr_b16 a[118:119], v21 offset:28064
  ds_read_b64_tr_b16 a[120:121], v21 offset:30752
  ds_read_b64_tr_b16 a[122:123], v21 offset:31136
  ds_read_b64_tr_b16 a[124:125], v21 offset:33824
  ds_read_b64_tr_b16 a[126:127], v21 offset:34208
  s_waitcnt lgkmcnt(0)
  ds_read_b64_tr_b16 a[128:129], v21 offset:36896
  ds_read_b64_tr_b16 a[130:131], v21 offset:37280
  ds_read_b64_tr_b16 a[132:133], v21 offset:39968
  ds_read_b64_tr_b16 a[134:135], v21 offset:40352
  ds_read_b64_tr_b16 a[136:137], v21 offset:43040
  ds_read_b64_tr_b16 a[138:139], v21 offset:43424
  ds_read_b64_tr_b16 a[140:141], v21 offset:46112
  ds_read_b64_tr_b16 a[142:143], v21 offset:46496
  s_waitcnt lgkmcnt(0)
  ds_read_b64_tr_b16 a[144:145], v21 offset:49184
  ds_read_b64_tr_b16 a[146:147], v21 offset:49568
  ds_read_b64_tr_b16 a[148:149], v21 offset:52256
  ds_read_b64_tr_b16 a[150:151], v21 offset:52640
  ds_read_b64_tr_b16 a[152:153], v21 offset:55328
  ds_read_b64_tr_b16 a[154:155], v21 offset:55712
  ds_read_b64_tr_b16 a[156:157], v21 offset:58400
  ds_read_b64_tr_b16 a[158:159], v21 offset:58784
  s_waitcnt lgkmcnt(0)
  ds_read_b64_tr_b16 a[160:161], v21 offset:64
  ds_read_b64_tr_b16 a[162:163], v21 offset:448
  ds_read_b64_tr_b16 a[164:165], v21 offset:3136
  ds_read_b64_tr_b16 a[166:167], v21 offset:3520
  ds_read_b64_tr_b16 a[168:169], v21 offset:6208
  ds_read_b64_tr_b16 a[170:171], v21 offset:6592
  ds_read_b64_tr_b16 a[172:173], v21 offset:9280
  ds_read_b64_tr_b16 a[174:175], v21 offset:9664
  s_waitcnt lgkmcnt(0)
  ds_read_b64_tr_b16 a[176:177], v21 offset:12352
  ds_read_b64_tr_b16 a[178:179], v21 offset:12736
  ds_read_b64_tr_b16 a[180:181], v21 offset:15424
  ds_read_b64_tr_b16 a[182:183], v21 offset:15808
  ds_read_b64_tr_b16 a[184:185], v21 offset:18496
  ds_read_b64_tr_b16 a[186:187], v21 offset:18880
  ds_read_b64_tr_b16 a[188:189], v21 offset:21568
  ds_read_b64_tr_b16 a[190:191], v21 offset:21952
  s_waitcnt lgkmcnt(0)
  ds_read_b64_tr_b16 a[192:193], v21 offset:24640
  ds_read_b64_tr_b16 a[194:195], v21 offset:25024
  ds_read_b64_tr_b16 a[196:197], v21 offset:27712
  ds_read_b64_tr_b16 a[198:199], v21 offset:28096
  ds_read_b64_tr_b16 a[200:201], v21 offset:30784
  ds_read_b64_tr_b16 a[202:203], v21 offset:31168
  ds_read_b64_tr_b16 a[204:205], v21 offset:33856
  ds_read_b64_tr_b16 a[206:207], v21 offset:34240
  s_waitcnt lgkmcnt(0)
  ds_read_b64_tr_b16 a[208:209], v21 offset:36928
  ds_read_b64_tr_b16 a[210:211], v21 offset:37312
  ds_read_b64_tr_b16 a[212:213], v21 offset:40000
  ds_read_b64_tr_b16 a[214:215], v21 offset:40384
  ds_read_b64_tr_b16 a[216:217], v21 offset:43072
  ds_read_b64_tr_b16 a[218:219], v21 offset:43456
  ds_read_b64_tr_b16 a[220:221], v21 offset:46144
  ds_read_b64_tr_b16 a[222:223], v21 offset:46528
  s_waitcnt lgkmcnt(0)
  ds_read_b64_tr_b16 a[224:225], v21 offset:49216
  ds_read_b64_tr_b16 a[226:227], v21 offset:49600
  ds_read_b64_tr_b16 a[228:229], v21 offset:52288
  ds_read_b64_tr_b16 a[230:231], v21 offset:52672
  ds_read_b64_tr_b16 a[232:233], v21 offset:55360
  ds_read_b64_tr_b16 a[234:235], v21 offset:55744
  ds_read_b64_tr_b16 a[236:237], v21 offset:58432
  ds_read_b64_tr_b16 a[238:239], v21 offset:58816
  s_waitcnt lgkmcnt(0)
L_w1b_sx:
  s_waitcnt lgkmcnt(0)
  s_barrier
  s_mov_b32 s8, s40
  s_and_b32 s9, s41, 0xffff
  s_mov_b32 s10, 7864320
  s_mov_b32 s11, 0x00020000
  s_mul_i32 s72, s29, 15360
  s_add_u32 s72, s72, 0
  s_add_u32 m0, s72, 0
  s_nop 0
  buffer_load_dwordx4 v30, s[8:11], s36 offen lds
  s_add_u32 m0, s72, 1024
  s_nop 0
  buffer_load_dwordx4 v31, s[8:11], s36 offen lds
  s_add_u32 m0, s72, 2048
  s_nop 0
  buffer_load_dwordx4 v32, s[8:11], s36 offen lds
  s_add_u32 m0, s72, 3072
  s_nop 0
  buffer_load_dwordx4 v33, s[8:11], s36 offen lds
  s_add_u32 m0, s72, 4096
  s_nop 0
  buffer_load_dwordx4 v34, s[8:11], s36 offen lds
  s_add_u32 m0, s72, 5120
  s_nop 0
  buffer_load_dwordx4 v35, s[8:11], s36 offen lds
  s_add_u32 m0, s72, 6144
  s_nop 0
  buffer_load_dwordx4 v36, s[8:11], s36 offen lds
  s_add_u32 m0, s72, 7168
  s_nop 0
  buffer_load_dwordx4 v37, s[8:11], s36 offen lds
  s_add_u32 m0, s72, 8192
  s_nop 0
  buffer_load_dwordx4 v38, s[8:11], s36 offen lds
  s_add_u32 m0, s72, 9216
  s_nop 0
  buffer_load_dwordx4 v39, s[8:11], s36 offen lds
  s_add_u32 m0, s72, 10240
  s_nop 0
  buffer_load_dwordx4 v40, s[8:11], s36 offen lds
  s_add_u32 m0, s72, 11264
  s_nop 0
  buffer_load_dwordx4 v41, s[8:11], s36 offen lds
  s_add_u32 m0, s72, 12288
  s_nop 0
  buffer_load_dwordx4 v42, s[8:11], s36 offen lds
  s_add_u32 m0, s72, 13312
  s_nop 0
  buffer_load_dwordx4 v43, s[8:11], s36 offen lds
  s_add_u32 m0, s72, 14336
  s_nop 0
  buffer_load_dwordx4 v44, s[8:11], s36 offen lds
  s_mul_i32 s72, s29, 320
  s_add_u32 s72, s72, 0
  v_add_u32 v6, s72, v1
  s_mov_b32 s73, 1
  v_mul_lo_u32 v7, v6, s73
  v_lshrrev_b32 v7, 1, v7
  v_mul_u32_u24 v50, 2, v7
  v_sub_u32 v50, v6, v50
  v_lshlrev_b32 v50, 4, v50
  s_mov_b32 s73, 3072
  v_mad_u32_u24 v50, v7, s73, v50
  s_mul_i32 s72, s29, 320
  s_add_u32 s72, s72, 64
  v_add_u32 v6, s72, v1
  s_mov_b32 s73, 1
  v_mul_lo_u32 v7, v6, s73
  v_lshrrev_b32 v7, 1, v7
  v_mul_u32_u24 v51, 2, v7
  v_sub_u32 v51, v6, v51
  v_lshlrev_b32 v51, 4, v51
  s_mov_b32 s73, 3072
  v_mad_u32_u24 v51, v7, s73, v51
  s_mul_i32 s72, s29, 320
  s_add_u32 s72, s72, 128
  v_add_u32 v6, s72, v1
  s_mov_b32 s73, 1
  v_mul_lo_u32 v7, v6, s73
  v_lshrrev_b32 v7, 1, v7
  v_mul_u32_u24 v52, 2, v7
  v_sub_u32 v52, v6, v52
  v_lshlrev_b32 v52, 4, v52
  s_mov_b32 s73, 3072
  v_mad_u32_u24 v52, v7, s73, v52
  s_mul_i32 s72, s29, 320
  s_add_u32 s72, s72, 192
  v_add_u32 v6, s72, v1
  s_mov_b32 s73, 1
  v_mul_lo_u32 v7, v6, s73
  v_lshrrev_b32 v7, 1, v7
  v_mul_u32_u24 v53, 2, v7
  v_sub_u32 v53, v6, v53
  v_lshlrev_b32 v53, 4, v53
  s_mov_b32 s73, 3072
  v_mad_u32_u24 v53, v7, s73, v53
  s_mul_i32 s72, s29, 320
  s_add_u32 s72, s72, 256
  v_add_u32 v6, s72, v1
  s_mov_b32 s73, 1
  v_mul_lo_u32 v7, v6, s73
  v_lshrrev_b32 v7, 1, v7
  v_mul_u32_u24 v54, 2, v7
  v_sub_u32 v54, v6, v54
  v_lshlrev_b32 v54, 4, v54
  s_mov_b32 s73, 3072
  v_mad_u32_u24 v54, v7, s73, v54
  s_mul_i32 s74, s28, 3
  s_add_u32 s74, s74, s27
  s_min_u32 s74, s74, 95
  s_lshl_b32 s74, s74, 5
  s_mov_b32 s75, s74
  s_mov_b32 s8, s52
  s_and_b32 s9, s53, 0xffff
  s_mov_b32 s10, 1966080
  s_mov_b32 s11, 0x00020000
  s_mul_i32 s72, s29, 5120
  s_add_u32 s72, s72, 61440
  s_add_u32 m0, s72, 0
  s_nop 0
  buffer_load_dwordx4 v50, s[8:11], s74 offen lds
  s_add_u32 m0, s72, 1024
  s_nop 0
  buffer_load_dwordx4 v51, s[8:11], s74 offen lds
  s_add_u32 m0, s72, 2048
  s_nop 0
  buffer_load_dwordx4 v52, s[8:11], s74 offen lds
  s_add_u32 m0, s72, 3072
  s_nop 0
  buffer_load_dwordx4 v53, s[8:11], s74 offen lds
  s_add_u32 m0, s72, 4096
  s_nop 0
  buffer_load_dwordx4 v54, s[8:11], s74 offen lds
  s_mov_b32 s8, s54
  s_and_b32 s9, s55, 0xffff
  s_mov_b32 s10, 3072
  v_lshlrev_b32 v4, 3, v3
  buffer_load_dwordx2 v[26:27], v4, s[8:11], s75 offen
  s_waitcnt vmcnt(0)
  s_barrier
  v_lshlrev_b32 v206, 16, v26
  v_and_b32 v207, 0xffff0000, v26
  v_lshlrev_b32 v208, 16, v27
  v_and_b32 v209, 0xffff0000, v27
  s_cmp_eq_u32 s29, 2
  s_cbranch_scc0 L_w1c_sx
  ds_read_b64_tr_b16 a[0:1], v20 offset:0
  ds_read_b64_tr_b16 a[2:3], v20 offset:384
  ds_read_b64_tr_b16 a[4:5], v20 offset:3072
  ds_read_b64_tr_b16 a[6:7], v20 offset:3456
  ds_read_b64_tr_b16 a[8:9], v20 offset:6144
  ds_read_b64_tr_b16 a[10:11], v20 offset:6528
  ds_read_b64_tr_b16 a[12:13], v20 offset:9216
  ds_read_b64_tr_b16 a[14:15], v20 offset:9600
  s_waitcnt lgkmcnt(0)
  ds_read_b64_tr_b16 a[16:17], v20 offset:12288
  ds_read_b64_tr_b16 a[18:19], v20 offset:12672
  ds_read_b64_tr_b16 a[20:21], v20 offset:15360
  ds_read_b64_tr_b16 a[22:23], v20 offset:15744
  ds_read_b64_tr_b16 a[24:25], v20 offset:18432
  ds_read_b64_tr_b16 a[26:27], v20 offset:18816
  ds_read_b64_tr_b16 a[28:29], v20 offset:21504
  ds_read_b64_tr_b16 a[30:31], v20 offset:21888
  s_waitcnt lgkmcnt(0)
  ds_read_b64_tr_b16 a[32:33], v20 offset:24576
  ds_read_b64_tr_b16 a[34:35], v20 offset:24960
  ds_read_b64_tr_b16 a[36:37], v20 offset:27648
  ds_read_b64_tr_b16 a[38:39], v20 offset:28032
  ds_read_b64_tr_b16 a[40:41], v20 offset:30720
  ds_read_b64_tr_b16 a[42:43], v20 offset:31104
  ds_read_b64_tr_b16 a[44:45], v20 offset:33792
  ds_read_b64_tr_b16 a[46:47], v20 offset:34176
  s_waitcnt lgkmcnt(0)
  ds_read_b64_tr_b16 a[48:49], v20 offset:36864
  ds_read_b64_tr_b16 a[50:51], v20 offset:37248
  ds_read_b64_tr_b16 a[52:53], v20 offset:39936
  ds_read_b64_tr_b16 a[54:55], v20 offset:40320
  ds_read_b64_tr_b16 a[56:57], v20 offset:43008
  ds_read_b64_tr_b16 a[58:59], v20 offset:43392
  ds_read_b64_tr_b16 a[60:61], v20 offset:46080
  ds_read_b64_tr_b16 a[62:63], v20 offset:46464
  s_waitcnt lgkmcnt(0)
  ds_read_b64_tr_b16 a[64:65], v20 offset:49152
  ds_read_b64_tr_b16 a[66:67], v20 offset:49536
  ds_read_b64_tr_b16 a[68:69], v20 offset:52224
  ds_read_b64_tr_b16 a[70:71], v20 offset:52608
  ds_read_b64_tr_b16 a[72:73], v20 offset:55296
  ds_read_b64_tr_b16 a[74:75], v20 offset:55680
  ds_read_b64_tr_b16 a[76:77], v20 offset:58368
  ds_read_b64_tr_b16 a[78:79], v20 offset:58752
  s_waitcnt lgkmcnt(0)
  ds_read_b64_tr_b16 a[80:81], v20 offset:32
  ds_read_b64_tr_b16 a[82:83], v20 offset:416
  ds_read_b64_tr_b16 a[84:85], v20 offset:3104
  ds_read_b64_tr_b16 a[86:87], v20 offset:3488
  ds_read_b64_tr_b16 a[88:89], v20 offset:6176
  ds_read_b64_tr_b16 a[90:91], v20 offset:6560
  ds_read_b64_tr_b16 a[92:93], v20 offset:9248
  ds_read_b64_tr_b16 a[94:95], v20 offset:9632
  s_waitcnt lgkmcnt(0)
  ds_read_b64_tr_b16 a[96:97], v20 offset:12320
  ds_read_b64_tr_b16 a[98:99], v20 offset:12704
  ds_read_b64_tr_b16 a[100:101], v20 offset:15392
  ds_read_b64_tr_b16 a[102:103], v20 offset:15776
  ds_read_b64_tr_b16 a[104:105], v20 offset:18464
  ds_read_b64_tr_b16 a[106:107], v20 offset:18848
  ds_read_b64_tr_b16 a[108:109], v20 offset:21536
  ds_read_b64_tr_b16 a[110:111], v20 offset:21920
  s_waitcnt lgkmcnt(0)
  ds_read_b64_tr_b16 a[112:113], v20 offset:24608
  ds_read_b64_tr_b16 a[114:115], v20 offset:24992
  ds_read_b64_tr_b16 a[116:117], v20 offset:27680
  ds_read_b64_tr_b16 a[118:119], v20 offset:28064
  ds_read_b64_tr_b16 a[120:121], v20 offset:30752
  ds_read_b64_tr_b16 a[122:123], v20 offset:31136
  ds_read_b64_tr_b16 a[124:125], v20 offset:33824
  ds_read_b64_tr_b16 a[126:127], v20 offset:34208
  s_waitcnt lgkmcnt(0)
  ds_read_b64_tr_b16 a[128:129], v20 offset:36896
  ds_read_b64_tr_b16 a[130:131], v20 offset:37280
  ds_read_b64_tr_b16 a[132:133], v20 offset:39968
  ds_read_b64_tr_b16 a[134:135], v20 offset:40352
  ds_read_b64_tr_b16 a[136:137], v20 offset:43040
  ds_read_b64_tr_b16 a[138:139], v20 offset:43424
  ds_read_b64_tr_b16 a[140:141], v20 offset:46112
  ds_read_b64_tr_b16 a[142:143], v20 offset:46496
  s_waitcnt lgkmcnt(0)
  ds_read_b64_tr_b16 a[144:145], v20 offset:49184
  ds_read_b64_tr_b16 a[146:147], v20 offset:49568
  ds_read_b64_tr_b16 a[148:149], v20 offset:52256
  ds_read_b64_tr_b16 a[150:151], v20 offset:52640
  ds_read_b64_tr_b16 a[152:153], v20 offset:55328
  ds_read_b64_tr_b16 a[154:155], v20 offset:55712
  ds_read_b64_tr_b16 a[156:157], v20 offset:58400
  ds_read_b64_tr_b16 a[158:159], v20 offset:58784
  s_waitcnt lgkmcnt(0)
  ds_read_b64_tr_b16 a[160:161], v20 offset:64
  ds_read_b64_tr_b16 a[162:163], v20 offset:448
  ds_read_b64_tr_b16 a[164:165], v20 offset:3136
  ds_read_b64_tr_b16 a[166:167], v20 offset:3520
  ds_read_b64_tr_b16 a[168:169], v20 offset:6208
  ds_read_b64_tr_b16 a[170:171], v20 offset:6592
  ds_read_b64_tr_b16 a[172:173], v20 offset:9280
  ds_read_b64_tr_b16 a[174:175], v20 offset:9664
  s_waitcnt lgkmcnt(0)
  ds_read_b64_tr_b16 a[176:177], v20 offset:12352
  ds_read_b64_tr_b16 a[178:179], v20 offset:12736
  ds_read_b64_tr_b16 a[180:181], v20 offset:15424
  ds_read_b64_tr_b16 a[182:183], v20 offset:15808
  ds_read_b64_tr_b16 a[184:185], v20 offset:18496
  ds_read_b64_tr_b16 a[186:187], v20 offset:18880
  ds_read_b64_tr_b16 a[188:189], v20 offset:21568
  ds_read_b64_tr_b16 a[190:191], v20 offset:21952
  s_waitcnt lgkmcnt(0)
  ds_read_b64_tr_b16 a[192:193], v20 offset:24640
  ds_read_b64_tr_b16 a[194:195], v20 offset:25024
  ds_read_b64_tr_b16 a[196:197], v20 offset:27712
  ds_read_b64_tr_b16 a[198:199], v20 offset:28096
  ds_read_b64_tr_b16 a[200:201], v20 offset:30784
  ds_read_b64_tr_b16 a[202:203], v20 offset:31168
  ds_read_b64_tr_b16 a[204:205], v20 offset:33856
  ds_read_b64_tr_b16 a[206:207], v20 offset:34240
  s_waitcnt lgkmcnt(0)
  ds_read_b64_tr_b16 a[208:209], v20 offset:36928
  ds_read_b64_tr_b16 a[210:211], v20 offset:37312
  ds_read_b64_tr_b16 a[212:213], v20 offset:40000
  ds_read_b64_tr_b16 a[214:215], v20 offset:40384
  ds_read_b64_tr_b16 a[216:217], v20 offset:43072
  ds_read_b64_tr_b16 a[218:219], v20 offset:43456
  ds_read_b64_tr_b16 a[220:221], v20 offset:46144
  ds_read_b64_tr_b16 a[222:223], v20 offset:46528
  s_waitcnt lgkmcnt(0)
  ds_read_b64_tr_b16 a[224:225], v20 offset:49216
  ds_read_b64_tr_b16 a[226:227], v20 offset:49600
  ds_read_b64_tr_b16 a[228:229], v20 offset:52288
  ds_read_b64_tr_b16 a[230:231], v20 offset:52672
  ds_read_b64_tr_b16 a[232:233], v20 offset:55360
  ds_read_b64_tr_b16 a[234:235], v20 offset:55744
  ds_read_b64_tr_b16 a[236:237], v20 offset:58432
  ds_read_b64_tr_b16 a[238:239], v20 offset:58816
  s_waitcnt lgkmcnt(0)
L_w1c_sx:
  s_cmp_eq_u32 s29, 3
  s_cbranch_scc0 L_w1d_sx
  ds_read_b64_tr_b16 a[0:1], v22 offset:0
  ds_read_b64_tr_b16 a[2:3], v22 offset:128
  ds_read_b64_tr_b16 a[4:5], v22 offset:1024
  ds_read_b64_tr_b16 a[6:7], v22 offset:1152
  ds_read_b64_tr_b16 a[8:9], v22 offset:2048
  ds_read_b64_tr_b16 a[10:11], v22 offset:2176
  ds_read_b64_tr_b16 a[12:13], v22 offset:3072
  ds_read_b64_tr_b16 a[14:15], v22 offset:3200
  s_waitcnt lgkmcnt(0)
  ds_read_b64_tr_b16 a[16:17], v22 offset:4096
  ds_read_b64_tr_b16 a[18:19], v22 offset:4224
  ds_read_b64_tr_b16 a[20:21], v22 offset:5120
  ds_read_b64_tr_b16 a[22:23], v22 offset:5248
  ds_read_b64_tr_b16 a[24:25], v22 offset:6144
  ds_read_b64_tr_b16 a[26:27], v22 offset:6272
  ds_read_b64_tr_b16 a[28:29], v22 offset:7168
  ds_read_b64_tr_b16 a[30:31], v22 offset:7296
  s_waitcnt lgkmcnt(0)
  ds_read_b64_tr_b16 a[32:33], v22 offset:8192
  ds_read_b64_tr_b16 a[34:35], v22 offset:8320
  ds_read_b64_tr_b16 a[36:37], v22 offset:9216
  ds_read_b64_tr_b16 a[38:39], v22 offset:9344
  ds_read_b64_tr_b16 a[40:41], v22 offset:10240
  ds_read_b64_tr_b16 a[42:43], v22 offset:10368
  ds_read_b64_tr_b16 a[44:45], v22 offset:11264
  ds_read_b64_tr_b16 a[46:47], v22 offset:11392
  s_waitcnt lgkmcnt(0)
  ds_read_b64_tr_b16 a[48:49], v22 offset:12288
  ds_read_b64_tr_b16 a[50:51], v22 offset:12416
  ds_read_b64_tr_b16 a[52:53], v22 offset:13312
  ds_read_b64_tr_b16 a[54:55], v22 offset:13440
  ds_read_b64_tr_b16 a[56:57], v22 offset:14336
  ds_read_b64_tr_b16 a[58:59], v22 offset:14464
  ds_read_b64_tr_b16 a[60:61], v22 offset:15360
  ds_read_b64_tr_b16 a[62:63], v22 offset:15488
  s_waitcnt lgkmcnt(0)
  ds_read_b64_tr_b16 a[64:65], v22 offset:16384
  ds_read_b64_tr_b16 a[66:67], v22 offset:16512
  ds_read_b64_tr_b16 a[68:69], v22 offset:17408
  ds_read_b64_tr_b16 a[70:71], v22 offset:17536
  ds_read_b64_tr_b16 a[72:73], v22 offset:18432
  ds_read_b64_tr_b16 a[74:75], v22 offset:18560
  ds_read_b64_tr_b16 a[76:77], v22 offset:19456
  ds_read_b64_tr_b16 a[78:79], v22 offset:19584
  s_waitcnt lgkmcnt(0)
L_w1d_sx:
  s_waitcnt lgkmcnt(0)
  s_barrier
  v_lshlrev_b32 v211, 4, v1
  v_add_u32 v219, 40960, v211
  s_mul_i32 s72, s29, 10240
  v_add_u32 v212, s72, v211
  s_mul_i32 s72, s27, 48
  s_add_u32 s72, s72, 0
  v_lshl_add_u32 v4, v3, 2, s72
  v_lshrrev_b32 v5, 5, v4
  v_lshlrev_b32 v5, 10, v5
  v_bfe_u32 v6, v4, 3, 2
  v_lshl_add_u32 v6, v6, 4, v2
  v_lshl_add_u32 v5, v6, 4, v5
  v_bfe_u32 v6, v4, 2, 1
  v_lshl_add_u32 v213, v6, 3, v5
  v_add_u32 v214, 6144, v213
  s_mul_i32 s72, s27, 48
  s_add_u32 s72, s72, 16
  v_lshl_add_u32 v4, v3, 2, s72
  v_lshrrev_b32 v5, 5, v4
  v_lshlrev_b32 v5, 10, v5
  v_bfe_u32 v6, v4, 3, 2
  v_lshl_add_u32 v6, v6, 4, v2
  v_lshl_add_u32 v5, v6, 4, v5
  v_bfe_u32 v6, v4, 2, 1
  v_lshl_add_u32 v215, v6, 3, v5
  v_add_u32 v216, 6144, v215
  s_mul_i32 s72, s27, 48
  s_add_u32 s72, s72, 32
  v_lshl_add_u32 v4, v3, 2, s72
  v_lshrrev_b32 v5, 5, v4
  v_lshlrev_b32 v5, 10, v5
  v_bfe_u32 v6, v4, 3, 2
  v_lshl_add_u32 v6, v6, 4, v2
  v_lshl_add_u32 v5, v6, 4, v5
  v_bfe_u32 v6, v4, 2, 1
  v_lshl_add_u32 v217, v6, 3, v5
  v_add_u32 v218, 6144, v217
  s_lshl_b32 s33, s28, 12
  s_lshl_b32 s72, s27, 4
  s_lshl_b32 s73, s29, 2
  s_add_u32 s33, s33, s72
  s_add_u32 s33, s33, s73
  s_add_u32 s33, s33, 108068864
  s_mov_b32 s12, s50
  s_and_b32 s13, s51, 0xffff
  s_mov_b32 s14, 256
  s_mov_b32 s15, 0x00020000
  v_and_b32 v4, 15, v1
  v_lshlrev_b32 v4, 2, v4
L_hk_sx:
  buffer_load_dword v5, v4, s[12:15], 0 offen sc1
  s_waitcnt vmcnt(0)
  v_readlane_b32 s72, v5, 0
  v_readlane_b32 s73, v5, 1
  v_readlane_b32 s74, v5, 2
  v_readlane_b32 s75, v5, 3
  v_readlane_b32 s76, v5, 4
  v_readlane_b32 s77, v5, 5
  v_readlane_b32 s78, v5, 6
  v_readlane_b32 s79, v5, 7
  v_readlane_b32 s84, v5, 8
  s_nop 3
  s_add_u32 s80, s72, s73
  s_add_u32 s81, s74, s75
  s_add_u32 s82, s76, s77
  s_add_u32 s83, s78, s79
  s_add_u32 s80, s80, s81
  s_add_u32 s82, s82, s83
  s_add_u32 s80, s80, s82
  s_add_u32 s80, s80, s84
  s_cmp_eq_u32 s80, 512
  s_cbranch_scc1 L_hk2_sx
  s_add_u32 s71, s71, 1
  s_cmp_gt_u32 s71, 400000
  s_cbranch_scc1 L_mend
  s_sleep 2
  s_branch L_hk_sx
L_hk2_sx:
  s_mul_i32 s31, s29, 10240
  s_add_u32 s31, s31, 0
  buffer_load_dwordx4 v[40:43], v200, s[4:7], s31 offen offset:0
  buffer_load_dwordx4 v[44:47], v200, s[4:7], s31 offen offset:1024
  buffer_load_dwordx4 v[48:51], v200, s[4:7], s31 offen offset:2048
  buffer_load_dwordx4 v[52:55], v200, s[4:7], s31 offen offset:3072
  s_add_u32 s31, s31, 4096
  buffer_load_dwordx4 v[56:59], v200, s[4:7], s31 offen offset:0
  buffer_load_dwordx4 v[60:63], v200, s[4:7], s31 offen offset:1024
  buffer_load_dwordx4 v[64:67], v200, s[4:7], s31 offen offset:2048
  buffer_load_dwordx4 v[68:71], v200, s[4:7], s31 offen offset:3072
  s_add_u32 s31, s31, 4096
  buffer_load_dwordx4 v[72:75], v200, s[4:7], s31 offen offset:0
  buffer_load_dwordx4 v[76:79], v200, s[4:7], s31 offen offset:1024
  s_add_u32 s31, s31, 32768
  s_waitcnt vmcnt(0)
  ds_write_b128 v212, v[40:43] offset:0
  ds_write_b128 v212, v[44:47] offset:1024
  ds_write_b128 v212, v[48:51] offset:2048
  ds_write_b128 v212, v[52:55] offset:3072
  ds_write_b128 v212, v[56:59] offset:4096
  ds_write_b128 v212, v[60:63] offset:5120
  ds_write_b128 v212, v[64:67] offset:6144
  ds_write_b128 v212, v[68:71] offset:7168
  ds_write_b128 v212, v[72:75] offset:8192
  ds_write_b128 v212, v[76:79] offset:9216
  s_waitcnt lgkmcnt(0)
  buffer_load_dwordx4 v[40:43], v200, s[4:7], s31 offen offset:0
  buffer_load_dwordx4 v[44:47], v200, s[4:7], s31 offen offset:1024
  buffer_load_dwordx4 v[48:51], v200, s[4:7], s31 offen offset:2048
  buffer_load_dwordx4 v[52:55], v200, s[4:7], s31 offen offset:3072
  s_add_u32 s31, s31, 4096
  buffer_load_dwordx4 v[56:59], v200, s[4:7], s31 offen offset:0
  buffer_load_dwordx4 v[60:63], v200, s[4:7], s31 offen offset:1024
  buffer_load_dwordx4 v[64:67], v200, s[4:7], s31 offen offset:2048
  buffer_load_dwordx4 v[68:71], v200, s[4:7], s31 offen offset:3072
  s_add_u32 s31, s31, 4096
  buffer_load_dwordx4 v[72:75], v200, s[4:7], s31 offen offset:0
  buffer_load_dwordx4 v[76:79], v200, s[4:7], s31 offen offset:1024
  s_add_u32 s31, s31, 32768
  s_waitcnt vmcnt(0)
  s_mov_b32 s30, 0
  s_cmp_eq_u32 s29, 1
  s_cbranch_scc1 L_x1V_sx
  s_cmp_eq_u32 s29, 3
  s_cbranch_scc1 L_x1F_sx
  s_cmp_eq_u32 s29, 2
  s_cbranch_scc1 L_x1Q_sx
  s_mul_i32 s32, s28, 1572864
  s_add_u32 s32, s32, 27787264
L_xlK_sx:
  s_waitcnt lgkmcnt(0)
  s_barrier
  ds_read_b128 v[8:11], v211 offset:0
  ds_read_b128 v[12:15], v211 offset:20480
  ds_read_b128 v[16:19], v211 offset:1024
  ds_read_b128 v[20:23], v211 offset:21504
  ds_read_b128 v[24:27], v211 offset:2048
  ds_read_b128 v[28:31], v211 offset:22528
  s_waitcnt lgkmcnt(5)
  v_mfma_f32_16x16x32_bf16 v[80:83], a[0:3], v[8:11], 0
  v_mfma_f32_16x16x32_bf16 v[88:91], a[80:83], v[8:11], 0
  v_mfma_f32_16x16x32_bf16 v[96:99], a[160:163], v[8:11], 0
  ds_read_b128 v[32:35], v211 offset:3072
  s_waitcnt lgkmcnt(5)
  v_mfma_f32_16x16x32_bf16 v[84:87], a[0:3], v[12:15], 0
  v_mfma_f32_16x16x32_bf16 v[92:95], a[80:83], v[12:15], 0
  v_mfma_f32_16x16x32_bf16 v[100:103], a[160:163], v[12:15], 0
  ds_read_b128 v[36:39], v211 offset:23552
  s_waitcnt lgkmcnt(5)
  v_mfma_f32_16x16x32_bf16 v[80:83], a[4:7], v[16:19], v[80:83]
  v_mfma_f32_16x16x32_bf16 v[88:91], a[84:87], v[16:19], v[88:91]
  v_mfma_f32_16x16x32_bf16 v[96:99], a[164:167], v[16:19], v[96:99]
  ds_read_b128 v[8:11], v211 offset:4096
  s_waitcnt vmcnt(7)
  ds_write_b128 v212, v[40:43] offset:40960
  s_waitcnt lgkmcnt(6)
  v_mfma_f32_16x16x32_bf16 v[84:87], a[4:7], v[20:23], v[84:87]
  v_mfma_f32_16x16x32_bf16 v[92:95], a[84:87], v[20:23], v[92:95]
  v_mfma_f32_16x16x32_bf16 v[100:103], a[164:167], v[20:23], v[100:103]
  ds_read_b128 v[12:15], v211 offset:24576
  ds_write_b128 v212, v[44:47] offset:41984
  s_waitcnt lgkmcnt(7)
  v_mfma_f32_16x16x32_bf16 v[80:83], a[8:11], v[24:27], v[80:83]
  v_mfma_f32_16x16x32_bf16 v[88:91], a[88:91], v[24:27], v[88:91]
  v_mfma_f32_16x16x32_bf16 v[96:99], a[168:171], v[24:27], v[96:99]
  ds_read_b128 v[16:19], v211 offset:5120
  ds_write_b128 v212, v[48:51] offset:43008
  s_waitcnt lgkmcnt(8)
  v_mfma_f32_16x16x32_bf16 v[84:87], a[8:11], v[28:31], v[84:87]
  v_mfma_f32_16x16x32_bf16 v[92:95], a[88:91], v[28:31], v[92:95]
  v_mfma_f32_16x16x32_bf16 v[100:103], a[168:171], v[28:31], v[100:103]
  ds_read_b128 v[20:23], v211 offset:25600
  ds_write_b128 v212, v[52:55] offset:44032
  s_waitcnt lgkmcnt(9)
  v_mfma_f32_16x16x32_bf16 v[80:83], a[12:15], v[32:35], v[80:83]
  v_mfma_f32_16x16x32_bf16 v[88:91], a[92:95], v[32:35], v[88:91]
  v_mfma_f32_16x16x32_bf16 v[96:99], a[172:175], v[32:35], v[96:99]
  ds_read_b128 v[24:27], v211 offset:6144
  ds_write_b128 v212, v[56:59] offset:45056
  s_waitcnt lgkmcnt(10)
  v_mfma_f32_16x16x32_bf16 v[84:87], a[12:15], v[36:39], v[84:87]
  v_mfma_f32_16x16x32_bf16 v[92:95], a[92:95], v[36:39], v[92:95]
  v_mfma_f32_16x16x32_bf16 v[100:103], a[172:175], v[36:39], v[100:103]
  ds_read_b128 v[28:31], v211 offset:26624
  ds_write_b128 v212, v[60:63] offset:46080
  s_waitcnt lgkmcnt(11)
  v_mfma_f32_16x16x32_bf16 v[80:83], a[16:19], v[8:11], v[80:83]
  v_mfma_f32_16x16x32_bf16 v[88:91], a[96:99], v[8:11], v[88:91]
  v_mfma_f32_16x16x32_bf16 v[96:99], a[176:179], v[8:11], v[96:99]
  ds_read_b128 v[32:35], v211 offset:7168
  ds_write_b128 v212, v[64:67] offset:47104
  s_waitcnt lgkmcnt(11)
  v_mfma_f32_16x16x32_bf16 v[84:87], a[16:19], v[12:15], v[84:87]
  v_mfma_f32_16x16x32_bf16 v[92:95], a[96:99], v[12:15], v[92:95]
  v_mfma_f32_16x16x32_bf16 v[100:103], a[176:179], v[12:15], v[100:103]
  ds_read_b128 v[36:39], v211 offset:27648
  ds_write_b128 v212, v[68:71] offset:48128
  s_waitcnt lgkmcnt(11)
  v_mfma_f32_16x16x32_bf16 v[80:83], a[20:23], v[16:19], v[80:83]
  v_mfma_f32_16x16x32_bf16 v[88:91], a[100:103], v[16:19], v[88:91]
  v_mfma_f32_16x16x32_bf16 v[96:99], a[180:183], v[16:19], v[96:99]
  ds_read_b128 v[8:11], v211 offset:8192
  ds_write_b128 v212, v[72:75] offset:49152
  s_waitcnt lgkmcnt(11)
  v_mfma_f32_16x16x32_bf16 v[84:87], a[20:23], v[20:23], v[84:87]
  v_mfma_f32_16x16x32_bf16 v[92:95], a[100:103], v[20:23], v[92:95]
  v_mfma_f32_16x16x32_bf16 v[100:103], a[180:183], v[20:23], v[100:103]
  ds_read_b128 v[12:15], v211 offset:28672
  ds_write_b128 v212, v[76:79] offset:50176
  s_waitcnt lgkmcnt(11)
  v_mfma_f32_16x16x32_bf16 v[80:83], a[24:27], v[24:27], v[80:83]
  v_mfma_f32_16x16x32_bf16 v[88:91], a[104:107], v[24:27], v[88:91]
  v_mfma_f32_16x16x32_bf16 v[96:99], a[184:187], v[24:27], v[96:99]
  ds_read_b128 v[16:19], v211 offset:9216
  s_waitcnt lgkmcnt(1)
  buffer_load_dwordx4 v[40:43], v200, s[4:7], s31 offen offset:0
  v_mfma_f32_16x16x32_bf16 v[84:87], a[24:27], v[28:31], v[84:87]
  v_mfma_f32_16x16x32_bf16 v[92:95], a[104:107], v[28:31], v[92:95]
  v_mfma_f32_16x16x32_bf16 v[100:103], a[184:187], v[28:31], v[100:103]
  ds_read_b128 v[20:23], v211 offset:29696
  buffer_load_dwordx4 v[44:47], v200, s[4:7], s31 offen offset:1024
  v_mfma_f32_16x16x32_bf16 v[80:83], a[28:31], v[32:35], v[80:83]
  v_mfma_f32_16x16x32_bf16 v[88:91], a[108:111], v[32:35], v[88:91]
  v_mfma_f32_16x16x32_bf16 v[96:99], a[188:191], v[32:35], v[96:99]
  ds_read_b128 v[24:27], v211 offset:10240
  buffer_load_dwordx4 v[48:51], v200, s[4:7], s31 offen offset:2048
  v_mfma_f32_16x16x32_bf16 v[84:87], a[28:31], v[36:39], v[84:87]
  v_mfma_f32_16x16x32_bf16 v[92:95], a[108:111], v[36:39], v[92:95]
  v_mfma_f32_16x16x32_bf16 v[100:103], a[188:191], v[36:39], v[100:103]
  ds_read_b128 v[28:31], v211 offset:30720
  buffer_load_dwordx4 v[52:55], v200, s[4:7], s31 offen offset:3072
  v_mfma_f32_16x16x32_bf16 v[80:83], a[32:35], v[8:11], v[80:83]
  v_mfma_f32_16x16x32_bf16 v[88:91], a[112:115], v[8:11], v[88:91]
  v_mfma_f32_16x16x32_bf16 v[96:99], a[192:195], v[8:11], v[96:99]
  ds_read_b128 v[32:35], v211 offset:11264
  s_add_u32 s31, s31, 4096
  buffer_load_dwordx4 v[56:59], v200, s[4:7], s31 offen offset:0
  v_mfma_f32_16x16x32_bf16 v[84:87], a[32:35], v[12:15], v[84:87]
  v_mfma_f32_16x16x32_bf16 v[92:95], a[112:115], v[12:15], v[92:95]
  v_mfma_f32_16x16x32_bf16 v[100:103], a[192:195], v[12:15], v[100:103]
  ds_read_b128 v[36:39], v211 offset:31744
  buffer_load_dwordx4 v[60:63], v200, s[4:7], s31 offen offset:1024
  s_waitcnt lgkmcnt(5)
  v_mfma_f32_16x16x32_bf16 v[80:83], a[36:39], v[16:19], v[80:83]
  v_mfma_f32_16x16x32_bf16 v[88:91], a[116:119], v[16:19], v[88:91]
  v_mfma_f32_16x16x32_bf16 v[96:99], a[196:199], v[16:19], v[96:99]
  ds_read_b128 v[8:11], v211 offset:12288
  buffer_load_dwordx4 v[64:67], v200, s[4:7], s31 offen offset:2048
  s_waitcnt lgkmcnt(5)
  v_mfma_f32_16x16x32_bf16 v[84:87], a[36:39], v[20:23], v[84:87]
  v_mfma_f32_16x16x32_bf16 v[92:95], a[116:119], v[20:23], v[92:95]
  v_mfma_f32_16x16x32_bf16 v[100:103], a[196:199], v[20:23], v[100:103]
  ds_read_b128 v[12:15], v211 offset:32768
  buffer_load_dwordx4 v[68:71], v200, s[4:7], s31 offen offset:3072
  s_waitcnt lgkmcnt(5)
  v_mfma_f32_16x16x32_bf16 v[80:83], a[40:43], v[24:27], v[80:83]
  v_mfma_f32_16x16x32_bf16 v[88:91], a[120:123], v[24:27], v[88:91]
  v_mfma_f32_16x16x32_bf16 v[96:99], a[200:203], v[24:27], v[96:99]
  ds_read_b128 v[16:19], v211 offset:13312
  s_add_u32 s31, s31, 4096
  buffer_load_dwordx4 v[72:75], v200, s[4:7], s31 offen offset:0
  s_waitcnt lgkmcnt(5)
  v_mfma_f32_16x16x32_bf16 v[84:87], a[40:43], v[28:31], v[84:87]
  v_mfma_f32_16x16x32_bf16 v[92:95], a[120:123], v[28:31], v[92:95]
  v_mfma_f32_16x16x32_bf16 v[100:103], a[200:203], v[28:31], v[100:103]
  ds_read_b128 v[20:23], v211 offset:33792
  buffer_load_dwordx4 v[76:79], v200, s[4:7], s31 offen offset:1024
  s_add_u32 s31, s31, 32768
  s_waitcnt lgkmcnt(5)
  v_mfma_f32_16x16x32_bf16 v[80:83], a[44:47], v[32:35], v[80:83]
  v_mfma_f32_16x16x32_bf16 v[88:91], a[124:127], v[32:35], v[88:91]
  v_mfma_f32_16x16x32_bf16 v[96:99], a[204:207], v[32:35], v[96:99]
  ds_read_b128 v[24:27], v211 offset:14336
  s_waitcnt lgkmcnt(5)
  v_mfma_f32_16x16x32_bf16 v[84:87], a[44:47], v[36:39], v[84:87]
  v_mfma_f32_16x16x32_bf16 v[92:95], a[124:127], v[36:39], v[92:95]
  v_mfma_f32_16x16x32_bf16 v[100:103], a[204:207], v[36:39], v[100:103]
  ds_read_b128 v[28:31], v211 offset:34816
  s_waitcnt lgkmcnt(5)
  v_mfma_f32_16x16x32_bf16 v[80:83], a[48:51], v[8:11], v[80:83]
  v_mfma_f32_16x16x32_bf16 v[88:91], a[128:131], v[8:11], v[88:91]
  v_mfma_f32_16x16x32_bf16 v[96:99], a[208:211], v[8:11], v[96:99]
  ds_read_b128 v[32:35], v211 offset:15360
  s_waitcnt lgkmcnt(5)
  v_mfma_f32_16x16x32_bf16 v[84:87], a[48:51], v[12:15], v[84:87]
  v_mfma_f32_16x16x32_bf16 v[92:95], a[128:131], v[12:15], v[92:95]
  v_mfma_f32_16x16x32_bf16 v[100:103], a[208:211], v[12:15], v[100:103]
  ds_read_b128 v[36:39], v211 offset:35840
  s_waitcnt lgkmcnt(5)
  v_mfma_f32_16x16x32_bf16 v[80:83], a[52:55], v[16:19], v[80:83]
  v_mfma_f32_16x16x32_bf16 v[88:91], a[132:135], v[16:19], v[88:91]
  v_mfma_f32_16x16x32_bf16 v[96:99], a[212:215], v[16:19], v[96:99]
  ds_read_b128 v[8:11], v211 offset:16384
  s_waitcnt lgkmcnt(5)
  v_mfma_f32_16x16x32_bf16 v[84:87], a[52:55], v[20:23], v[84:87]
  v_mfma_f32_16x16x32_bf16 v[92:95], a[132:135], v[20:23], v[92:95]
  v_mfma_f32_16x16x32_bf16 v[100:103], a[212:215], v[20:23], v[100:103]
  ds_read_b128 v[12:15], v211 offset:36864
  s_waitcnt lgkmcnt(5)
  v_mfma_f32_16x16x32_bf16 v[80:83], a[56:59], v[24:27], v[80:83]
  v_mfma_f32_16x16x32_bf16 v[88:91], a[136:139], v[24:27], v[88:91]
  v_mfma_f32_16x16x32_bf16 v[96:99], a[216:219], v[24:27], v[96:99]
  ds_read_b128 v[16:19], v211 offset:17408
  s_waitcnt lgkmcnt(5)
  v_mfma_f32_16x16x32_bf16 v[84:87], a[56:59], v[28:31], v[84:87]
  v_mfma_f32_16x16x32_bf16 v[92:95], a[136:139], v[28:31], v[92:95]
  v_mfma_f32_16x16x32_bf16 v[100:103], a[216:219], v[28:31], v[100:103]
  ds_read_b128 v[20:23], v211 offset:37888
  s_waitcnt lgkmcnt(5)
  v_mfma_f32_16x16x32_bf16 v[80:83], a[60:63], v[32:35], v[80:83]
  v_mfma_f32_16x16x32_bf16 v[88:91], a[140:143], v[32:35], v[88:91]
  v_mfma_f32_16x16x32_bf16 v[96:99], a[220:223], v[32:35], v[96:99]
  ds_read_b128 v[24:27], v211 offset:18432
  s_waitcnt lgkmcnt(5)
  v_mfma_f32_16x16x32_bf16 v[84:87], a[60:63], v[36:39], v[84:87]
  v_mfma_f32_16x16x32_bf16 v[92:95], a[140:143], v[36:39], v[92:95]
  v_mfma_f32_16x16x32_bf16 v[100:103], a[220:223], v[36:39], v[100:103]
  ds_read_b128 v[28:31], v211 offset:38912
  s_waitcnt lgkmcnt(5)
  v_mfma_f32_16x16x32_bf16 v[80:83], a[64:67], v[8:11], v[80:83]
  v_mfma_f32_16x16x32_bf16 v[88:91], a[144:147], v[8:11], v[88:91]
  v_mfma_f32_16x16x32_bf16 v[96:99], a[224:227], v[8:11], v[96:99]
  ds_read_b128 v[32:35], v211 offset:19456
  s_waitcnt lgkmcnt(5)
  v_mfma_f32_16x16x32_bf16 v[84:87], a[64:67], v[12:15], v[84:87]
  v_mfma_f32_16x16x32_bf16 v[92:95], a[144:147], v[12:15], v[92:95]
  v_mfma_f32_16x16x32_bf16 v[100:103], a[224:227], v[12:15], v[100:103]
  ds_read_b128 v[36:39], v211 offset:39936
  s_waitcnt lgkmcnt(5)
  v_mfma_f32_16x16x32_bf16 v[80:83], a[68:71], v[16:19], v[80:83]
  v_mfma_f32_16x16x32_bf16 v[88:91], a[148:151], v[16:19], v[88:91]
  v_mfma_f32_16x16x32_bf16 v[96:99], a[228:231], v[16:19], v[96:99]
  s_waitcnt lgkmcnt(4)
  v_mfma_f32_16x16x32_bf16 v[84:87], a[68:71], v[20:23], v[84:87]
  v_mfma_f32_16x16x32_bf16 v[92:95], a[148:151], v[20:23], v[92:95]
  v_mfma_f32_16x16x32_bf16 v[100:103], a[228:231], v[20:23], v[100:103]
  s_waitcnt lgkmcnt(3)
  v_mfma_f32_16x16x32_bf16 v[80:83], a[72:75], v[24:27], v[80:83]
  v_mfma_f32_16x16x32_bf16 v[88:91], a[152:155], v[24:27], v[88:91]
  v_mfma_f32_16x16x32_bf16 v[96:99], a[232:235], v[24:27], v[96:99]
  s_waitcnt lgkmcnt(2)
  v_mfma_f32_16x16x32_bf16 v[84:87], a[72:75], v[28:31], v[84:87]
  v_mfma_f32_16x16x32_bf16 v[92:95], a[152:155], v[28:31], v[92:95]
  v_mfma_f32_16x16x32_bf16 v[100:103], a[232:235], v[28:31], v[100:103]
  s_waitcnt lgkmcnt(1)
  v_mfma_f32_16x16x32_bf16 v[80:83], a[76:79], v[32:35], v[80:83]
  v_mfma_f32_16x16x32_bf16 v[88:91], a[156:159], v[32:35], v[88:91]
  v_mfma_f32_16x16x32_bf16 v[96:99], a[236:239], v[32:35], v[96:99]
  s_waitcnt lgkmcnt(0)
  v_mfma_f32_16x16x32_bf16 v[84:87], a[76:79], v[36:39], v[84:87]
  v_mfma_f32_16x16x32_bf16 v[92:95], a[156:159], v[36:39], v[92:95]
  v_mfma_f32_16x16x32_bf16 v[100:103], a[236:239], v[36:39], v[100:103]
  s_cmp_lt_u32 s30, 2
  s_cbranch_scc1 L_x1nfK0_sx
  buffer_store_dword v205, v204, s[4:7], s33 offen sc1
  s_add_u32 s33, s33, 64
  s_branch L_x1eK0_sx
L_x1nfK0_sx:
  buffer_store_dword v205, v210, s[4:7], s33 offen
L_x1eK0_sx:
  s_nop 4
  v_cvt_pk_bf16_f32 v128, v80, v81
  v_cvt_pk_bf16_f32 v129, v82, v83
  v_cvt_pk_bf16_f32 v130, v84, v85
  v_cvt_pk_bf16_f32 v131, v86, v87
  v_cvt_pk_bf16_f32 v132, v88, v89
  v_cvt_pk_bf16_f32 v133, v90, v91
  v_cvt_pk_bf16_f32 v134, v92, v93
  v_cvt_pk_bf16_f32 v135, v94, v95
  v_cvt_pk_bf16_f32 v136, v96, v97
  v_cvt_pk_bf16_f32 v137, v98, v99
  v_cvt_pk_bf16_f32 v138, v100, v101
  v_cvt_pk_bf16_f32 v139, v102, v103
  buffer_store_dwordx2 v[128:129], v213, s[4:7], s32 offen sc1
  buffer_store_dwordx2 v[130:131], v214, s[4:7], s32 offen sc1
  buffer_store_dwordx2 v[132:133], v215, s[4:7], s32 offen sc1
  buffer_store_dwordx2 v[134:135], v216, s[4:7], s32 offen sc1
  buffer_store_dwordx2 v[136:137], v217, s[4:7], s32 offen sc1
  buffer_store_dwordx2 v[138:139], v218, s[4:7], s32 offen sc1
  s_add_u32 s32, s32, 24576
  s_cmp_ge_u32 s30, 2
  s_cbranch_scc1 L_x1efK0_sx
  s_waitcnt vmcnt(0)
  buffer_store_dword v205, v204, s[4:7], s33 offen offset:0 sc1
L_x1efK0_sx:
  s_add_u32 s30, s30, 1
  s_waitcnt lgkmcnt(0)
  s_barrier
  ds_read_b128 v[8:11], v211 offset:40960
  ds_read_b128 v[12:15], v211 offset:61440
  ds_read_b128 v[16:19], v211 offset:41984
  ds_read_b128 v[20:23], v211 offset:62464
  ds_read_b128 v[24:27], v211 offset:43008
  ds_read_b128 v[28:31], v211 offset:63488
  s_waitcnt lgkmcnt(5)
  v_mfma_f32_16x16x32_bf16 v[104:107], a[0:3], v[8:11], 0
  v_mfma_f32_16x16x32_bf16 v[112:115], a[80:83], v[8:11], 0
  v_mfma_f32_16x16x32_bf16 v[120:123], a[160:163], v[8:11], 0
  ds_read_b128 v[32:35], v211 offset:44032
  s_waitcnt lgkmcnt(5)
  v_mfma_f32_16x16x32_bf16 v[108:111], a[0:3], v[12:15], 0
  v_mfma_f32_16x16x32_bf16 v[116:119], a[80:83], v[12:15], 0
  v_mfma_f32_16x16x32_bf16 v[124:127], a[160:163], v[12:15], 0
  ds_read_b128 v[36:39], v211 offset:64512
  s_waitcnt lgkmcnt(5)
  v_mfma_f32_16x16x32_bf16 v[104:107], a[4:7], v[16:19], v[104:107]
  v_mfma_f32_16x16x32_bf16 v[112:115], a[84:87], v[16:19], v[112:115]
  v_mfma_f32_16x16x32_bf16 v[120:123], a[164:167], v[16:19], v[120:123]
  ds_read_b128 v[8:11], v211 offset:45056
  s_waitcnt vmcnt(7)
  ds_write_b128 v212, v[40:43] offset:0
  s_waitcnt lgkmcnt(6)
  v_mfma_f32_16x16x32_bf16 v[108:111], a[4:7], v[20:23], v[108:111]
  v_mfma_f32_16x16x32_bf16 v[116:119], a[84:87], v[20:23], v[116:119]
  v_mfma_f32_16x16x32_bf16 v[124:127], a[164:167], v[20:23], v[124:127]
  ds_read_b128 v[12:15], v219 offset:24576
  ds_write_b128 v212, v[44:47] offset:1024
  s_waitcnt lgkmcnt(7)
  v_mfma_f32_16x16x32_bf16 v[104:107], a[8:11], v[24:27], v[104:107]
  v_mfma_f32_16x16x32_bf16 v[112:115], a[88:91], v[24:27], v[112:115]
  v_mfma_f32_16x16x32_bf16 v[120:123], a[168:171], v[24:27], v[120:123]
  ds_read_b128 v[16:19], v211 offset:46080
  ds_write_b128 v212, v[48:51] offset:2048
  s_waitcnt lgkmcnt(8)
  v_mfma_f32_16x16x32_bf16 v[108:111], a[8:11], v[28:31], v[108:111]
  v_mfma_f32_16x16x32_bf16 v[116:119], a[88:91], v[28:31], v[116:119]
  v_mfma_f32_16x16x32_bf16 v[124:127], a[168:171], v[28:31], v[124:127]
  ds_read_b128 v[20:23], v219 offset:25600
  ds_write_b128 v212, v[52:55] offset:3072
  s_waitcnt lgkmcnt(9)
  v_mfma_f32_16x16x32_bf16 v[104:107], a[12:15], v[32:35], v[104:107]
  v_mfma_f32_16x16x32_bf16 v[112:115], a[92:95], v[32:35], v[112:115]
  v_mfma_f32_16x16x32_bf16 v[120:123], a[172:175], v[32:35], v[120:123]
  ds_read_b128 v[24:27], v211 offset:47104
  ds_write_b128 v212, v[56:59] offset:4096
  s_waitcnt lgkmcnt(10)
  v_mfma_f32_16x16x32_bf16 v[108:111], a[12:15], v[36:39], v[108:111]
  v_mfma_f32_16x16x32_bf16 v[116:119], a[92:95], v[36:39], v[116:119]
  v_mfma_f32_16x16x32_bf16 v[124:127], a[172:175], v[36:39], v[124:127]
  ds_read_b128 v[28:31], v219 offset:26624
  ds_write_b128 v212, v[60:63] offset:5120
  s_waitcnt lgkmcnt(11)
  v_mfma_f32_16x16x32_bf16 v[104:107], a[16:19], v[8:11], v[104:107]
  v_mfma_f32_16x16x32_bf16 v[112:115], a[96:99], v[8:11], v[112:115]
  v_mfma_f32_16x16x32_bf16 v[120:123], a[176:179], v[8:11], v[120:123]
  ds_read_b128 v[32:35], v211 offset:48128
  ds_write_b128 v212, v[64:67] offset:6144
  s_waitcnt lgkmcnt(11)
  v_mfma_f32_16x16x32_bf16 v[108:111], a[16:19], v[12:15], v[108:111]
  v_mfma_f32_16x16x32_bf16 v[116:119], a[96:99], v[12:15], v[116:119]
  v_mfma_f32_16x16x32_bf16 v[124:127], a[176:179], v[12:15], v[124:127]
  ds_read_b128 v[36:39], v219 offset:27648
  ds_write_b128 v212, v[68:71] offset:7168
  s_waitcnt lgkmcnt(11)
  v_mfma_f32_16x16x32_bf16 v[104:107], a[20:23], v[16:19], v[104:107]
  v_mfma_f32_16x16x32_bf16 v[112:115], a[100:103], v[16:19], v[112:115]
  v_mfma_f32_16x16x32_bf16 v[120:123], a[180:183], v[16:19], v[120:123]
  ds_read_b128 v[8:11], v211 offset:49152
  ds_write_b128 v212, v[72:75] offset:8192
  s_waitcnt lgkmcnt(11)
  v_mfma_f32_16x16x32_bf16 v[108:111], a[20:23], v[20:23], v[108:111]
  v_mfma_f32_16x16x32_bf16 v[116:119], a[100:103], v[20:23], v[116:119]
  v_mfma_f32_16x16x32_bf16 v[124:127], a[180:183], v[20:23], v[124:127]
  ds_read_b128 v[12:15], v219 offset:28672
  ds_write_b128 v212, v[76:79] offset:9216
  s_waitcnt lgkmcnt(11)
  v_mfma_f32_16x16x32_bf16 v[104:107], a[24:27], v[24:27], v[104:107]
  v_mfma_f32_16x16x32_bf16 v[112:115], a[104:107], v[24:27], v[112:115]
  v_mfma_f32_16x16x32_bf16 v[120:123], a[184:187], v[24:27], v[120:123]
  ds_read_b128 v[16:19], v211 offset:50176
  s_waitcnt lgkmcnt(1)
  buffer_load_dwordx4 v[40:43], v200, s[4:7], s31 offen offset:0
  v_mfma_f32_16x16x32_bf16 v[108:111], a[24:27], v[28:31], v[108:111]
  v_mfma_f32_16x16x32_bf16 v[116:119], a[104:107], v[28:31], v[116:119]
  v_mfma_f32_16x16x32_bf16 v[124:127], a[184:187], v[28:31], v[124:127]
  ds_read_b128 v[20:23], v219 offset:29696
  buffer_load_dwordx4 v[44:47], v200, s[4:7], s31 offen offset:1024
  v_mfma_f32_16x16x32_bf16 v[104:107], a[28:31], v[32:35], v[104:107]
  v_mfma_f32_16x16x32_bf16 v[112:115], a[108:111], v[32:35], v[112:115]
  v_mfma_f32_16x16x32_bf16 v[120:123], a[188:191], v[32:35], v[120:123]
  ds_read_b128 v[24:27], v211 offset:51200
  buffer_load_dwordx4 v[48:51], v200, s[4:7], s31 offen offset:2048
  v_mfma_f32_16x16x32_bf16 v[108:111], a[28:31], v[36:39], v[108:111]
  v_mfma_f32_16x16x32_bf16 v[116:119], a[108:111], v[36:39], v[116:119]
  v_mfma_f32_16x16x32_bf16 v[124:127], a[188:191], v[36:39], v[124:127]
  ds_read_b128 v[28:31], v219 offset:30720
  buffer_load_dwordx4 v[52:55], v200, s[4:7], s31 offen offset:3072
  v_mfma_f32_16x16x32_bf16 v[104:107], a[32:35], v[8:11], v[104:107]
  v_mfma_f32_16x16x32_bf16 v[112:115], a[112:115], v[8:11], v[112:115]
  v_mfma_f32_16x16x32_bf16 v[120:123], a[192:195], v[8:11], v[120:123]
  ds_read_b128 v[32:35], v211 offset:52224
  s_add_u32 s31, s31, 4096
  buffer_load_dwordx4 v[56:59], v200, s[4:7], s31 offen offset:0
  v_mfma_f32_16x16x32_bf16 v[108:111], a[32:35], v[12:15], v[108:111]
  v_mfma_f32_16x16x32_bf16 v[116:119], a[112:115], v[12:15], v[116:119]
  v_mfma_f32_16x16x32_bf16 v[124:127], a[192:195], v[12:15], v[124:127]
  ds_read_b128 v[36:39], v219 offset:31744
  buffer_load_dwordx4 v[60:63], v200, s[4:7], s31 offen offset:1024
  s_waitcnt lgkmcnt(5)
  v_mfma_f32_16x16x32_bf16 v[104:107], a[36:39], v[16:19], v[104:107]
  v_mfma_f32_16x16x32_bf16 v[112:115], a[116:119], v[16:19], v[112:115]
  v_mfma_f32_16x16x32_bf16 v[120:123], a[196:199], v[16:19], v[120:123]
  ds_read_b128 v[8:11], v211 offset:53248
  buffer_load_dwordx4 v[64:67], v200, s[4:7], s31 offen offset:2048
  s_waitcnt lgkmcnt(5)
  v_mfma_f32_16x16x32_bf16 v[108:111], a[36:39], v[20:23], v[108:111]
  v_mfma_f32_16x16x32_bf16 v[116:119], a[116:119], v[20:23], v[116:119]
  v_mfma_f32_16x16x32_bf16 v[124:127], a[196:199], v[20:23], v[124:127]
  ds_read_b128 v[12:15], v219 offset:32768
  buffer_load_dwordx4 v[68:71], v200, s[4:7], s31 offen offset:3072
  s_waitcnt lgkmcnt(5)
  v_mfma_f32_16x16x32_bf16 v[104:107], a[40:43], v[24:27], v[104:107]
  v_mfma_f32_16x16x32_bf16 v[112:115], a[120:123], v[24:27], v[112:115]
  v_mfma_f32_16x16x32_bf16 v[120:123], a[200:203], v[24:27], v[120:123]
  ds_read_b128 v[16:19], v211 offset:54272
  s_add_u32 s31, s31, 4096
  buffer_load_dwordx4 v[72:75], v200, s[4:7], s31 offen offset:0
  s_waitcnt lgkmcnt(5)
  v_mfma_f32_16x16x32_bf16 v[108:111], a[40:43], v[28:31], v[108:111]
  v_mfma_f32_16x16x32_bf16 v[116:119], a[120:123], v[28:31], v[116:119]
  v_mfma_f32_16x16x32_bf16 v[124:127], a[200:203], v[28:31], v[124:127]
  ds_read_b128 v[20:23], v219 offset:33792
  buffer_load_dwordx4 v[76:79], v200, s[4:7], s31 offen offset:1024
  s_add_u32 s31, s31, 32768
  s_waitcnt lgkmcnt(5)
  v_mfma_f32_16x16x32_bf16 v[104:107], a[44:47], v[32:35], v[104:107]
  v_mfma_f32_16x16x32_bf16 v[112:115], a[124:127], v[32:35], v[112:115]
  v_mfma_f32_16x16x32_bf16 v[120:123], a[204:207], v[32:35], v[120:123]
  ds_read_b128 v[24:27], v211 offset:55296
  s_waitcnt lgkmcnt(5)
  v_mfma_f32_16x16x32_bf16 v[108:111], a[44:47], v[36:39], v[108:111]
  v_mfma_f32_16x16x32_bf16 v[116:119], a[124:127], v[36:39], v[116:119]
  v_mfma_f32_16x16x32_bf16 v[124:127], a[204:207], v[36:39], v[124:127]
  ds_read_b128 v[28:31], v219 offset:34816
  s_waitcnt lgkmcnt(5)
  v_mfma_f32_16x16x32_bf16 v[104:107], a[48:51], v[8:11], v[104:107]
  v_mfma_f32_16x16x32_bf16 v[112:115], a[128:131], v[8:11], v[112:115]
  v_mfma_f32_16x16x32_bf16 v[120:123], a[208:211], v[8:11], v[120:123]
  ds_read_b128 v[32:35], v211 offset:56320
  s_waitcnt lgkmcnt(5)
  v_mfma_f32_16x16x32_bf16 v[108:111], a[48:51], v[12:15], v[108:111]
  v_mfma_f32_16x16x32_bf16 v[116:119], a[128:131], v[12:15], v[116:119]
  v_mfma_f32_16x16x32_bf16 v[124:127], a[208:211], v[12:15], v[124:127]
  ds_read_b128 v[36:39], v219 offset:35840
  s_waitcnt lgkmcnt(5)
  v_mfma_f32_16x16x32_bf16 v[104:107], a[52:55], v[16:19], v[104:107]
  v_mfma_f32_16x16x32_bf16 v[112:115], a[132:135], v[16:19], v[112:115]
  v_mfma_f32_16x16x32_bf16 v[120:123], a[212:215], v[16:19], v[120:123]
  ds_read_b128 v[8:11], v211 offset:57344
  s_waitcnt lgkmcnt(5)
  v_mfma_f32_16x16x32_bf16 v[108:111], a[52:55], v[20:23], v[108:111]
  v_mfma_f32_16x16x32_bf16 v[116:119], a[132:135], v[20:23], v[116:119]
  v_mfma_f32_16x16x32_bf16 v[124:127], a[212:215], v[20:23], v[124:127]
  ds_read_b128 v[12:15], v219 offset:36864
  s_waitcnt lgkmcnt(5)
  v_mfma_f32_16x16x32_bf16 v[104:107], a[56:59], v[24:27], v[104:107]
  v_mfma_f32_16x16x32_bf16 v[112:115], a[136:139], v[24:27], v[112:115]
  v_mfma_f32_16x16x32_bf16 v[120:123], a[216:219], v[24:27], v[120:123]
  ds_read_b128 v[16:19], v211 offset:58368
  s_waitcnt lgkmcnt(5)
  v_mfma_f32_16x16x32_bf16 v[108:111], a[56:59], v[28:31], v[108:111]
  v_mfma_f32_16x16x32_bf16 v[116:119], a[136:139], v[28:31], v[116:119]
  v_mfma_f32_16x16x32_bf16 v[124:127], a[216:219], v[28:31], v[124:127]
  ds_read_b128 v[20:23], v219 offset:37888
  s_waitcnt lgkmcnt(5)
  v_mfma_f32_16x16x32_bf16 v[104:107], a[60:63], v[32:35], v[104:107]
  v_mfma_f32_16x16x32_bf16 v[112:115], a[140:143], v[32:35], v[112:115]
  v_mfma_f32_16x16x32_bf16 v[120:123], a[220:223], v[32:35], v[120:123]
  ds_read_b128 v[24:27], v211 offset:59392
  s_waitcnt lgkmcnt(5)
  v_mfma_f32_16x16x32_bf16 v[108:111], a[60:63], v[36:39], v[108:111]
  v_mfma_f32_16x16x32_bf16 v[116:119], a[140:143], v[36:39], v[116:119]
  v_mfma_f32_16x16x32_bf16 v[124:127], a[220:223], v[36:39], v[124:127]
  ds_read_b128 v[28:31], v219 offset:38912
  s_waitcnt lgkmcnt(5)
  v_mfma_f32_16x16x32_bf16 v[104:107], a[64:67], v[8:11], v[104:107]
  v_mfma_f32_16x16x32_bf16 v[112:115], a[144:147], v[8:11], v[112:115]
  v_mfma_f32_16x16x32_bf16 v[120:123], a[224:227], v[8:11], v[120:123]
  ds_read_b128 v[32:35], v211 offset:60416
  s_waitcnt lgkmcnt(5)
  v_mfma_f32_16x16x32_bf16 v[108:111], a[64:67], v[12:15], v[108:111]
  v_mfma_f32_16x16x32_bf16 v[116:119], a[144:147], v[12:15], v[116:119]
  v_mfma_f32_16x16x32_bf16 v[124:127], a[224:227], v[12:15], v[124:127]
  ds_read_b128 v[36:39], v219 offset:39936
  s_waitcnt lgkmcnt(5)
  v_mfma_f32_16x16x32_bf16 v[104:107], a[68:71], v[16:19], v[104:107]
  v_mfma_f32_16x16x32_bf16 v[112:115], a[148:151], v[16:19], v[112:115]
  v_mfma_f32_16x16x32_bf16 v[120:123], a[228:231], v[16:19], v[120:123]
  s_waitcnt lgkmcnt(4)
  v_mfma_f32_16x16x32_bf16 v[108:111], a[68:71], v[20:23], v[108:111]
  v_mfma_f32_16x16x32_bf16 v[116:119], a[148:151], v[20:23], v[116:119]
  v_mfma_f32_16x16x32_bf16 v[124:127], a[228:231], v[20:23], v[124:127]
  s_waitcnt lgkmcnt(3)
  v_mfma_f32_16x16x32_bf16 v[104:107], a[72:75], v[24:27], v[104:107]
  v_mfma_f32_16x16x32_bf16 v[112:115], a[152:155], v[24:27], v[112:115]
  v_mfma_f32_16x16x32_bf16 v[120:123], a[232:235], v[24:27], v[120:123]
  s_waitcnt lgkmcnt(2)
  v_mfma_f32_16x16x32_bf16 v[108:111], a[72:75], v[28:31], v[108:111]
  v_mfma_f32_16x16x32_bf16 v[116:119], a[152:155], v[28:31], v[116:119]
  v_mfma_f32_16x16x32_bf16 v[124:127], a[232:235], v[28:31], v[124:127]
  s_waitcnt lgkmcnt(1)
  v_mfma_f32_16x16x32_bf16 v[104:107], a[76:79], v[32:35], v[104:107]
  v_mfma_f32_16x16x32_bf16 v[112:115], a[156:159], v[32:35], v[112:115]
  v_mfma_f32_16x16x32_bf16 v[120:123], a[236:239], v[32:35], v[120:123]
  s_waitcnt lgkmcnt(0)
  v_mfma_f32_16x16x32_bf16 v[108:111], a[76:79], v[36:39], v[108:111]
  v_mfma_f32_16x16x32_bf16 v[116:119], a[156:159], v[36:39], v[116:119]
  v_mfma_f32_16x16x32_bf16 v[124:127], a[236:239], v[36:39], v[124:127]
  s_cmp_lt_u32 s30, 2
  s_cbranch_scc1 L_x1nfK1_sx
  buffer_store_dword v205, v204, s[4:7], s33 offen sc1
  s_add_u32 s33, s33, 64
  s_branch L_x1eK1_sx
L_x1nfK1_sx:
  buffer_store_dword v205, v210, s[4:7], s33 offen
L_x1eK1_sx:
  s_nop 4
  v_cvt_pk_bf16_f32 v128, v104, v105
  v_cvt_pk_bf16_f32 v129, v106, v107
  v_cvt_pk_bf16_f32 v130, v108, v109
  v_cvt_pk_bf16_f32 v131, v110, v111
  v_cvt_pk_bf16_f32 v132, v112, v113
  v_cvt_pk_bf16_f32 v133, v114, v115
  v_cvt_pk_bf16_f32 v134, v116, v117
  v_cvt_pk_bf16_f32 v135, v118, v119
  v_cvt_pk_bf16_f32 v136, v120, v121
  v_cvt_pk_bf16_f32 v137, v122, v123
  v_cvt_pk_bf16_f32 v138, v124, v125
  v_cvt_pk_bf16_f32 v139, v126, v127
  buffer_store_dwordx2 v[128:129], v213, s[4:7], s32 offen sc1
  buffer_store_dwordx2 v[130:131], v214, s[4:7], s32 offen sc1
  buffer_store_dwordx2 v[132:133], v215, s[4:7], s32 offen sc1
  buffer_store_dwordx2 v[134:135], v216, s[4:7], s32 offen sc1
  buffer_store_dwordx2 v[136:137], v217, s[4:7], s32 offen sc1
  buffer_store_dwordx2 v[138:139], v218, s[4:7], s32 offen sc1
  s_add_u32 s32, s32, 24576
  s_cmp_ge_u32 s30, 2
  s_cbranch_scc1 L_x1efK1_sx
  s_waitcnt vmcnt(0)
  buffer_store_dword v205, v204, s[4:7], s33 offen offset:64 sc1
L_x1efK1_sx:
  s_add_u32 s30, s30, 1
  s_cmp_lt_u32 s30, 64
  s_cbranch_scc1 L_xlK_sx
  s_waitcnt vmcnt(0)
  buffer_store_dword v205, v204, s[4:7], s33 offen sc1
  buffer_store_dword v205, v204, s[4:7], s33 offen offset:64 sc1
  s_branch L_x1done_sx
L_x1Q_sx:
  s_mul_i32 s32, s28, 786432
  s_add_u32 s32, s32, 2621440
L_xlQ_sx:
  s_waitcnt lgkmcnt(0)
  s_barrier
  ds_read_b128 v[8:11], v211 offset:0
  ds_read_b128 v[12:15], v211 offset:20480
  ds_read_b128 v[16:19], v211 offset:1024
  ds_read_b128 v[20:23], v211 offset:21504
  ds_read_b128 v[24:27], v211 offset:2048
  ds_read_b128 v[28:31], v211 offset:22528
  s_waitcnt lgkmcnt(5)
  v_mfma_f32_16x16x32_bf16 v[80:83], a[0:3], v[8:11], 0
  v_mfma_f32_16x16x32_bf16 v[88:91], a[80:83], v[8:11], 0
  v_mfma_f32_16x16x32_bf16 v[96:99], a[160:163], v[8:11], 0
  ds_read_b128 v[32:35], v211 offset:3072
  s_waitcnt lgkmcnt(5)
  v_mfma_f32_16x16x32_bf16 v[84:87], a[0:3], v[12:15], 0
  v_mfma_f32_16x16x32_bf16 v[92:95], a[80:83], v[12:15], 0
  v_mfma_f32_16x16x32_bf16 v[100:103], a[160:163], v[12:15], 0
  ds_read_b128 v[36:39], v211 offset:23552
  s_waitcnt lgkmcnt(5)
  v_mfma_f32_16x16x32_bf16 v[80:83], a[4:7], v[16:19], v[80:83]
  v_mfma_f32_16x16x32_bf16 v[88:91], a[84:87], v[16:19], v[88:91]
  v_mfma_f32_16x16x32_bf16 v[96:99], a[164:167], v[16:19], v[96:99]
  ds_read_b128 v[8:11], v211 offset:4096
  s_waitcnt vmcnt(7)
  ds_write_b128 v212, v[40:43] offset:40960
  s_waitcnt lgkmcnt(6)
  v_mfma_f32_16x16x32_bf16 v[84:87], a[4:7], v[20:23], v[84:87]
  v_mfma_f32_16x16x32_bf16 v[92:95], a[84:87], v[20:23], v[92:95]
  v_mfma_f32_16x16x32_bf16 v[100:103], a[164:167], v[20:23], v[100:103]
  ds_read_b128 v[12:15], v211 offset:24576
  ds_write_b128 v212, v[44:47] offset:41984
  s_waitcnt lgkmcnt(7)
  v_mfma_f32_16x16x32_bf16 v[80:83], a[8:11], v[24:27], v[80:83]
  v_mfma_f32_16x16x32_bf16 v[88:91], a[88:91], v[24:27], v[88:91]
  v_mfma_f32_16x16x32_bf16 v[96:99], a[168:171], v[24:27], v[96:99]
  ds_read_b128 v[16:19], v211 offset:5120
  ds_write_b128 v212, v[48:51] offset:43008
  s_waitcnt lgkmcnt(8)
  v_mfma_f32_16x16x32_bf16 v[84:87], a[8:11], v[28:31], v[84:87]
  v_mfma_f32_16x16x32_bf16 v[92:95], a[88:91], v[28:31], v[92:95]
  v_mfma_f32_16x16x32_bf16 v[100:103], a[168:171], v[28:31], v[100:103]
  ds_read_b128 v[20:23], v211 offset:25600
  ds_write_b128 v212, v[52:55] offset:44032
  s_waitcnt lgkmcnt(9)
  v_mfma_f32_16x16x32_bf16 v[80:83], a[12:15], v[32:35], v[80:83]
  v_mfma_f32_16x16x32_bf16 v[88:91], a[92:95], v[32:35], v[88:91]
  v_mfma_f32_16x16x32_bf16 v[96:99], a[172:175], v[32:35], v[96:99]
  ds_read_b128 v[24:27], v211 offset:6144
  ds_write_b128 v212, v[56:59] offset:45056
  s_waitcnt lgkmcnt(10)
  v_mfma_f32_16x16x32_bf16 v[84:87], a[12:15], v[36:39], v[84:87]
  v_mfma_f32_16x16x32_bf16 v[92:95], a[92:95], v[36:39], v[92:95]
  v_mfma_f32_16x16x32_bf16 v[100:103], a[172:175], v[36:39], v[100:103]
  ds_read_b128 v[28:31], v211 offset:26624
  ds_write_b128 v212, v[60:63] offset:46080
  s_waitcnt lgkmcnt(11)
  v_mfma_f32_16x16x32_bf16 v[80:83], a[16:19], v[8:11], v[80:83]
  v_mfma_f32_16x16x32_bf16 v[88:91], a[96:99], v[8:11], v[88:91]
  v_mfma_f32_16x16x32_bf16 v[96:99], a[176:179], v[8:11], v[96:99]
  ds_read_b128 v[32:35], v211 offset:7168
  ds_write_b128 v212, v[64:67] offset:47104
  s_waitcnt lgkmcnt(11)
  v_mfma_f32_16x16x32_bf16 v[84:87], a[16:19], v[12:15], v[84:87]
  v_mfma_f32_16x16x32_bf16 v[92:95], a[96:99], v[12:15], v[92:95]
  v_mfma_f32_16x16x32_bf16 v[100:103], a[176:179], v[12:15], v[100:103]
  ds_read_b128 v[36:39], v211 offset:27648
  ds_write_b128 v212, v[68:71] offset:48128
  s_waitcnt lgkmcnt(11)
  v_mfma_f32_16x16x32_bf16 v[80:83], a[20:23], v[16:19], v[80:83]
  v_mfma_f32_16x16x32_bf16 v[88:91], a[100:103], v[16:19], v[88:91]
  v_mfma_f32_16x16x32_bf16 v[96:99], a[180:183], v[16:19], v[96:99]
  ds_read_b128 v[8:11], v211 offset:8192
  ds_write_b128 v212, v[72:75] offset:49152
  s_waitcnt lgkmcnt(11)
  v_mfma_f32_16x16x32_bf16 v[84:87], a[20:23], v[20:23], v[84:87]
  v_mfma_f32_16x16x32_bf16 v[92:95], a[100:103], v[20:23], v[92:95]
  v_mfma_f32_16x16x32_bf16 v[100:103], a[180:183], v[20:23], v[100:103]
  ds_read_b128 v[12:15], v211 offset:28672
  ds_write_b128 v212, v[76:79] offset:50176
  s_waitcnt lgkmcnt(11)
  v_mfma_f32_16x16x32_bf16 v[80:83], a[24:27], v[24:27], v[80:83]
  v_mfma_f32_16x16x32_bf16 v[88:91], a[104:107], v[24:27], v[88:91]
  v_mfma_f32_16x16x32_bf16 v[96:99], a[184:187], v[24:27], v[96:99]
  ds_read_b128 v[16:19], v211 offset:9216
  s_waitcnt lgkmcnt(1)
  buffer_load_dwordx4 v[40:43], v200, s[4:7], s31 offen offset:0
  v_mfma_f32_16x16x32_bf16 v[84:87], a[24:27], v[28:31], v[84:87]
  v_mfma_f32_16x16x32_bf16 v[92:95], a[104:107], v[28:31], v[92:95]
  v_mfma_f32_16x16x32_bf16 v[100:103], a[184:187], v[28:31], v[100:103]
  ds_read_b128 v[20:23], v211 offset:29696
  buffer_load_dwordx4 v[44:47], v200, s[4:7], s31 offen offset:1024
  v_mfma_f32_16x16x32_bf16 v[80:83], a[28:31], v[32:35], v[80:83]
  v_mfma_f32_16x16x32_bf16 v[88:91], a[108:111], v[32:35], v[88:91]
  v_mfma_f32_16x16x32_bf16 v[96:99], a[188:191], v[32:35], v[96:99]
  ds_read_b128 v[24:27], v211 offset:10240
  buffer_load_dwordx4 v[48:51], v200, s[4:7], s31 offen offset:2048
  v_mfma_f32_16x16x32_bf16 v[84:87], a[28:31], v[36:39], v[84:87]
  v_mfma_f32_16x16x32_bf16 v[92:95], a[108:111], v[36:39], v[92:95]
  v_mfma_f32_16x16x32_bf16 v[100:103], a[188:191], v[36:39], v[100:103]
  ds_read_b128 v[28:31], v211 offset:30720
  buffer_load_dwordx4 v[52:55], v200, s[4:7], s31 offen offset:3072
  v_mfma_f32_16x16x32_bf16 v[80:83], a[32:35], v[8:11], v[80:83]
  v_mfma_f32_16x16x32_bf16 v[88:91], a[112:115], v[8:11], v[88:91]
  v_mfma_f32_16x16x32_bf16 v[96:99], a[192:195], v[8:11], v[96:99]
  ds_read_b128 v[32:35], v211 offset:11264
  s_add_u32 s31, s31, 4096
  buffer_load_dwordx4 v[56:59], v200, s[4:7], s31 offen offset:0
  v_mfma_f32_16x16x32_bf16 v[84:87], a[32:35], v[12:15], v[84:87]
  v_mfma_f32_16x16x32_bf16 v[92:95], a[112:115], v[12:15], v[92:95]
  v_mfma_f32_16x16x32_bf16 v[100:103], a[192:195], v[12:15], v[100:103]
  ds_read_b128 v[36:39], v211 offset:31744
  buffer_load_dwordx4 v[60:63], v200, s[4:7], s31 offen offset:1024
  s_waitcnt lgkmcnt(5)
  v_mfma_f32_16x16x32_bf16 v[80:83], a[36:39], v[16:19], v[80:83]
  v_mfma_f32_16x16x32_bf16 v[88:91], a[116:119], v[16:19], v[88:91]
  v_mfma_f32_16x16x32_bf16 v[96:99], a[196:199], v[16:19], v[96:99]
  ds_read_b128 v[8:11], v211 offset:12288
  buffer_load_dwordx4 v[64:67], v200, s[4:7], s31 offen offset:2048
  s_waitcnt lgkmcnt(5)
  v_mfma_f32_16x16x32_bf16 v[84:87], a[36:39], v[20:23], v[84:87]
  v_mfma_f32_16x16x32_bf16 v[92:95], a[116:119], v[20:23], v[92:95]
  v_mfma_f32_16x16x32_bf16 v[100:103], a[196:199], v[20:23], v[100:103]
  ds_read_b128 v[12:15], v211 offset:32768
  buffer_load_dwordx4 v[68:71], v200, s[4:7], s31 offen offset:3072
  s_waitcnt lgkmcnt(5)
  v_mfma_f32_16x16x32_bf16 v[80:83], a[40:43], v[24:27], v[80:83]
  v_mfma_f32_16x16x32_bf16 v[88:91], a[120:123], v[24:27], v[88:91]
  v_mfma_f32_16x16x32_bf16 v[96:99], a[200:203], v[24:27], v[96:99]
  ds_read_b128 v[16:19], v211 offset:13312
  s_add_u32 s31, s31, 4096
  buffer_load_dwordx4 v[72:75], v200, s[4:7], s31 offen offset:0
  s_waitcnt lgkmcnt(5)
  v_mfma_f32_16x16x32_bf16 v[84:87], a[40:43], v[28:31], v[84:87]
  v_mfma_f32_16x16x32_bf16 v[92:95], a[120:123], v[28:31], v[92:95]
  v_mfma_f32_16x16x32_bf16 v[100:103], a[200:203], v[28:31], v[100:103]
  ds_read_b128 v[20:23], v211 offset:33792
  buffer_load_dwordx4 v[76:79], v200, s[4:7], s31 offen offset:1024
  s_add_u32 s31, s31, 32768
  s_waitcnt lgkmcnt(5)
  v_mfma_f32_16x16x32_bf16 v[80:83], a[44:47], v[32:35], v[80:83]
  v_mfma_f32_16x16x32_bf16 v[88:91], a[124:127], v[32:35], v[88:91]
  v_mfma_f32_16x16x32_bf16 v[96:99], a[204:207], v[32:35], v[96:99]
  ds_read_b128 v[24:27], v211 offset:14336
  s_waitcnt lgkmcnt(5)
  v_mfma_f32_16x16x32_bf16 v[84:87], a[44:47], v[36:39], v[84:87]
  v_mfma_f32_16x16x32_bf16 v[92:95], a[124:127], v[36:39], v[92:95]
  v_mfma_f32_16x16x32_bf16 v[100:103], a[204:207], v[36:39], v[100:103]
  ds_read_b128 v[28:31], v211 offset:34816
  s_waitcnt lgkmcnt(5)
  v_mfma_f32_16x16x32_bf16 v[80:83], a[48:51], v[8:11], v[80:83]
  v_mfma_f32_16x16x32_bf16 v[88:91], a[128:131], v[8:11], v[88:91]
  v_mfma_f32_16x16x32_bf16 v[96:99], a[208:211], v[8:11], v[96:99]
  ds_read_b128 v[32:35], v211 offset:15360
  s_waitcnt lgkmcnt(5)
  v_mfma_f32_16x16x32_bf16 v[84:87], a[48:51], v[12:15], v[84:87]
  v_mfma_f32_16x16x32_bf16 v[92:95], a[128:131], v[12:15], v[92:95]
  v_mfma_f32_16x16x32_bf16 v[100:103], a[208:211], v[12:15], v[100:103]
  ds_read_b128 v[36:39], v211 offset:35840
  s_waitcnt lgkmcnt(5)
  v_mfma_f32_16x16x32_bf16 v[80:83], a[52:55], v[16:19], v[80:83]
  v_mfma_f32_16x16x32_bf16 v[88:91], a[132:135], v[16:19], v[88:91]
  v_mfma_f32_16x16x32_bf16 v[96:99], a[212:215], v[16:19], v[96:99]
  ds_read_b128 v[8:11], v211 offset:16384
  s_waitcnt lgkmcnt(5)
  v_mfma_f32_16x16x32_bf16 v[84:87], a[52:55], v[20:23], v[84:87]
  v_mfma_f32_16x16x32_bf16 v[92:95], a[132:135], v[20:23], v[92:95]
  v_mfma_f32_16x16x32_bf16 v[100:103], a[212:215], v[20:23], v[100:103]
  ds_read_b128 v[12:15], v211 offset:36864
  s_waitcnt lgkmcnt(5)
  v_mfma_f32_16x16x32_bf16 v[80:83], a[56:59], v[24:27], v[80:83]
  v_mfma_f32_16x16x32_bf16 v[88:91], a[136:139], v[24:27], v[88:91]
  v_mfma_f32_16x16x32_bf16 v[96:99], a[216:219], v[24:27], v[96:99]
  ds_read_b128 v[16:19], v211 offset:17408
  s_waitcnt lgkmcnt(5)
  v_mfma_f32_16x16x32_bf16 v[84:87], a[56:59], v[28:31], v[84:87]
  v_mfma_f32_16x16x32_bf16 v[92:95], a[136:139], v[28:31], v[92:95]
  v_mfma_f32_16x16x32_bf16 v[100:103], a[216:219], v[28:31], v[100:103]
  ds_read_b128 v[20:23], v211 offset:37888
  s_waitcnt lgkmcnt(5)
  v_mfma_f32_16x16x32_bf16 v[80:83], a[60:63], v[32:35], v[80:83]
  v_mfma_f32_16x16x32_bf16 v[88:91], a[140:143], v[32:35], v[88:91]
  v_mfma_f32_16x16x32_bf16 v[96:99], a[220:223], v[32:35], v[96:99]
  ds_read_b128 v[24:27], v211 offset:18432
  s_waitcnt lgkmcnt(5)
  v_mfma_f32_16x16x32_bf16 v[84:87], a[60:63], v[36:39], v[84:87]
  v_mfma_f32_16x16x32_bf16 v[92:95], a[140:143], v[36:39], v[92:95]
  v_mfma_f32_16x16x32_bf16 v[100:103], a[220:223], v[36:39], v[100:103]
  ds_read_b128 v[28:31], v211 offset:38912
  s_waitcnt lgkmcnt(5)
  v_mfma_f32_16x16x32_bf16 v[80:83], a[64:67], v[8:11], v[80:83]
  v_mfma_f32_16x16x32_bf16 v[88:91], a[144:147], v[8:11], v[88:91]
  v_mfma_f32_16x16x32_bf16 v[96:99], a[224:227], v[8:11], v[96:99]
  ds_read_b128 v[32:35], v211 offset:19456
  s_waitcnt lgkmcnt(5)
  v_mfma_f32_16x16x32_bf16 v[84:87], a[64:67], v[12:15], v[84:87]
  v_mfma_f32_16x16x32_bf16 v[92:95], a[144:147], v[12:15], v[92:95]
  v_mfma_f32_16x16x32_bf16 v[100:103], a[224:227], v[12:15], v[100:103]
  ds_read_b128 v[36:39], v211 offset:39936
  s_waitcnt lgkmcnt(5)
  v_mfma_f32_16x16x32_bf16 v[80:83], a[68:71], v[16:19], v[80:83]
  v_mfma_f32_16x16x32_bf16 v[88:91], a[148:151], v[16:19], v[88:91]
  v_mfma_f32_16x16x32_bf16 v[96:99], a[228:231], v[16:19], v[96:99]
  s_waitcnt lgkmcnt(4)
  v_mfma_f32_16x16x32_bf16 v[84:87], a[68:71], v[20:23], v[84:87]
  v_mfma_f32_16x16x32_bf16 v[92:95], a[148:151], v[20:23], v[92:95]
  v_mfma_f32_16x16x32_bf16 v[100:103], a[228:231], v[20:23], v[100:103]
  s_waitcnt lgkmcnt(3)
  v_mfma_f32_16x16x32_bf16 v[80:83], a[72:75], v[24:27], v[80:83]
  v_mfma_f32_16x16x32_bf16 v[88:91], a[152:155], v[24:27], v[88:91]
  v_mfma_f32_16x16x32_bf16 v[96:99], a[232:235], v[24:27], v[96:99]
  s_waitcnt lgkmcnt(2)
  v_mfma_f32_16x16x32_bf16 v[84:87], a[72:75], v[28:31], v[84:87]
  v_mfma_f32_16x16x32_bf16 v[92:95], a[152:155], v[28:31], v[92:95]
  v_mfma_f32_16x16x32_bf16 v[100:103], a[232:235], v[28:31], v[100:103]
  s_waitcnt lgkmcnt(1)
  v_mfma_f32_16x16x32_bf16 v[80:83], a[76:79], v[32:35], v[80:83]
  v_mfma_f32_16x16x32_bf16 v[88:91], a[156:159], v[32:35], v[88:91]
  v_mfma_f32_16x16x32_bf16 v[96:99], a[236:239], v[32:35], v[96:99]
  s_waitcnt lgkmcnt(0)
  v_mfma_f32_16x16x32_bf16 v[84:87], a[76:79], v[36:39], v[84:87]
  v_mfma_f32_16x16x32_bf16 v[92:95], a[156:159], v[36:39], v[92:95]
  v_mfma_f32_16x16x32_bf16 v[100:103], a[236:239], v[36:39], v[100:103]
  s_cmp_lt_u32 s30, 2
  s_cbranch_scc1 L_x1nfQ0_sx
  buffer_store_dword v205, v204, s[4:7], s33 offen sc1
  s_add_u32 s33, s33, 64
  s_branch L_x1eQ0_sx
L_x1nfQ0_sx:
  buffer_store_dword v205, v210, s[4:7], s33 offen
L_x1eQ0_sx:
  s_nop 4
  v_cvt_pk_bf16_f32 v128, v80, v81
  v_cvt_pk_bf16_f32 v129, v82, v83
  v_cvt_pk_bf16_f32 v130, v84, v85
  v_cvt_pk_bf16_f32 v131, v86, v87
  v_cvt_pk_bf16_f32 v132, v88, v89
  v_cvt_pk_bf16_f32 v133, v90, v91
  v_cvt_pk_bf16_f32 v134, v92, v93
  v_cvt_pk_bf16_f32 v135, v94, v95
  v_cvt_pk_bf16_f32 v136, v96, v97
  v_cvt_pk_bf16_f32 v137, v98, v99
  v_cvt_pk_bf16_f32 v138, v100, v101
  v_cvt_pk_bf16_f32 v139, v102, v103
  buffer_store_dwordx2 v[128:129], v213, s[4:7], s32 offen sc1
  buffer_store_dwordx2 v[130:131], v214, s[4:7], s32 offen sc1
  buffer_store_dwordx2 v[132:133], v215, s[4:7], s32 offen sc1
  buffer_store_dwordx2 v[134:135], v216, s[4:7], s32 offen sc1
  buffer_store_dwordx2 v[136:137], v217, s[4:7], s32 offen sc1
  buffer_store_dwordx2 v[138:139], v218, s[4:7], s32 offen sc1
  s_add_u32 s32, s32, 12288
  s_cmp_ge_u32 s30, 2
  s_cbranch_scc1 L_x1efQ0_sx
  s_waitcnt vmcnt(0)
  buffer_store_dword v205, v204, s[4:7], s33 offen offset:0 sc1
L_x1efQ0_sx:
  s_add_u32 s30, s30, 1
  s_waitcnt lgkmcnt(0)
  s_barrier
  ds_read_b128 v[8:11], v211 offset:40960
  ds_read_b128 v[12:15], v211 offset:61440
  ds_read_b128 v[16:19], v211 offset:41984
  ds_read_b128 v[20:23], v211 offset:62464
  ds_read_b128 v[24:27], v211 offset:43008
  ds_read_b128 v[28:31], v211 offset:63488
  s_waitcnt lgkmcnt(5)
  v_mfma_f32_16x16x32_bf16 v[104:107], a[0:3], v[8:11], 0
  v_mfma_f32_16x16x32_bf16 v[112:115], a[80:83], v[8:11], 0
  v_mfma_f32_16x16x32_bf16 v[120:123], a[160:163], v[8:11], 0
  ds_read_b128 v[32:35], v211 offset:44032
  s_waitcnt lgkmcnt(5)
  v_mfma_f32_16x16x32_bf16 v[108:111], a[0:3], v[12:15], 0
  v_mfma_f32_16x16x32_bf16 v[116:119], a[80:83], v[12:15], 0
  v_mfma_f32_16x16x32_bf16 v[124:127], a[160:163], v[12:15], 0
  ds_read_b128 v[36:39], v211 offset:64512
  s_waitcnt lgkmcnt(5)
  v_mfma_f32_16x16x32_bf16 v[104:107], a[4:7], v[16:19], v[104:107]
  v_mfma_f32_16x16x32_bf16 v[112:115], a[84:87], v[16:19], v[112:115]
  v_mfma_f32_16x16x32_bf16 v[120:123], a[164:167], v[16:19], v[120:123]
  ds_read_b128 v[8:11], v211 offset:45056
  s_waitcnt vmcnt(7)
  ds_write_b128 v212, v[40:43] offset:0
  s_waitcnt lgkmcnt(6)
  v_mfma_f32_16x16x32_bf16 v[108:111], a[4:7], v[20:23], v[108:111]
  v_mfma_f32_16x16x32_bf16 v[116:119], a[84:87], v[20:23], v[116:119]
  v_mfma_f32_16x16x32_bf16 v[124:127], a[164:167], v[20:23], v[124:127]
  ds_read_b128 v[12:15], v219 offset:24576
  ds_write_b128 v212, v[44:47] offset:1024
  s_waitcnt lgkmcnt(7)
  v_mfma_f32_16x16x32_bf16 v[104:107], a[8:11], v[24:27], v[104:107]
  v_mfma_f32_16x16x32_bf16 v[112:115], a[88:91], v[24:27], v[112:115]
  v_mfma_f32_16x16x32_bf16 v[120:123], a[168:171], v[24:27], v[120:123]
  ds_read_b128 v[16:19], v211 offset:46080
  ds_write_b128 v212, v[48:51] offset:2048
  s_waitcnt lgkmcnt(8)
  v_mfma_f32_16x16x32_bf16 v[108:111], a[8:11], v[28:31], v[108:111]
  v_mfma_f32_16x16x32_bf16 v[116:119], a[88:91], v[28:31], v[116:119]
  v_mfma_f32_16x16x32_bf16 v[124:127], a[168:171], v[28:31], v[124:127]
  ds_read_b128 v[20:23], v219 offset:25600
  ds_write_b128 v212, v[52:55] offset:3072
  s_waitcnt lgkmcnt(9)
  v_mfma_f32_16x16x32_bf16 v[104:107], a[12:15], v[32:35], v[104:107]
  v_mfma_f32_16x16x32_bf16 v[112:115], a[92:95], v[32:35], v[112:115]
  v_mfma_f32_16x16x32_bf16 v[120:123], a[172:175], v[32:35], v[120:123]
  ds_read_b128 v[24:27], v211 offset:47104
  ds_write_b128 v212, v[56:59] offset:4096
  s_waitcnt lgkmcnt(10)
  v_mfma_f32_16x16x32_bf16 v[108:111], a[12:15], v[36:39], v[108:111]
  v_mfma_f32_16x16x32_bf16 v[116:119], a[92:95], v[36:39], v[116:119]
  v_mfma_f32_16x16x32_bf16 v[124:127], a[172:175], v[36:39], v[124:127]
  ds_read_b128 v[28:31], v219 offset:26624
  ds_write_b128 v212, v[60:63] offset:5120
  s_waitcnt lgkmcnt(11)
  v_mfma_f32_16x16x32_bf16 v[104:107], a[16:19], v[8:11], v[104:107]
  v_mfma_f32_16x16x32_bf16 v[112:115], a[96:99], v[8:11], v[112:115]
  v_mfma_f32_16x16x32_bf16 v[120:123], a[176:179], v[8:11], v[120:123]
  ds_read_b128 v[32:35], v211 offset:48128
  ds_write_b128 v212, v[64:67] offset:6144
  s_waitcnt lgkmcnt(11)
  v_mfma_f32_16x16x32_bf16 v[108:111], a[16:19], v[12:15], v[108:111]
  v_mfma_f32_16x16x32_bf16 v[116:119], a[96:99], v[12:15], v[116:119]
  v_mfma_f32_16x16x32_bf16 v[124:127], a[176:179], v[12:15], v[124:127]
  ds_read_b128 v[36:39], v219 offset:27648
  ds_write_b128 v212, v[68:71] offset:7168
  s_waitcnt lgkmcnt(11)
  v_mfma_f32_16x16x32_bf16 v[104:107], a[20:23], v[16:19], v[104:107]
  v_mfma_f32_16x16x32_bf16 v[112:115], a[100:103], v[16:19], v[112:115]
  v_mfma_f32_16x16x32_bf16 v[120:123], a[180:183], v[16:19], v[120:123]
  ds_read_b128 v[8:11], v211 offset:49152
  ds_write_b128 v212, v[72:75] offset:8192
  s_waitcnt lgkmcnt(11)
  v_mfma_f32_16x16x32_bf16 v[108:111], a[20:23], v[20:23], v[108:111]
  v_mfma_f32_16x16x32_bf16 v[116:119], a[100:103], v[20:23], v[116:119]
  v_mfma_f32_16x16x32_bf16 v[124:127], a[180:183], v[20:23], v[124:127]
  ds_read_b128 v[12:15], v219 offset:28672
  ds_write_b128 v212, v[76:79] offset:9216
  s_waitcnt lgkmcnt(11)
  v_mfma_f32_16x16x32_bf16 v[104:107], a[24:27], v[24:27], v[104:107]
  v_mfma_f32_16x16x32_bf16 v[112:115], a[104:107], v[24:27], v[112:115]
  v_mfma_f32_16x16x32_bf16 v[120:123], a[184:187], v[24:27], v[120:123]
  ds_read_b128 v[16:19], v211 offset:50176
  s_waitcnt lgkmcnt(1)
  buffer_load_dwordx4 v[40:43], v200, s[4:7], s31 offen offset:0
  v_mfma_f32_16x16x32_bf16 v[108:111], a[24:27], v[28:31], v[108:111]
  v_mfma_f32_16x16x32_bf16 v[116:119], a[104:107], v[28:31], v[116:119]
  v_mfma_f32_16x16x32_bf16 v[124:127], a[184:187], v[28:31], v[124:127]
  ds_read_b128 v[20:23], v219 offset:29696
  buffer_load_dwordx4 v[44:47], v200, s[4:7], s31 offen offset:1024
  v_mfma_f32_16x16x32_bf16 v[104:107], a[28:31], v[32:35], v[104:107]
  v_mfma_f32_16x16x32_bf16 v[112:115], a[108:111], v[32:35], v[112:115]
  v_mfma_f32_16x16x32_bf16 v[120:123], a[188:191], v[32:35], v[120:123]
  ds_read_b128 v[24:27], v211 offset:51200
  buffer_load_dwordx4 v[48:51], v200, s[4:7], s31 offen offset:2048
  v_mfma_f32_16x16x32_bf16 v[108:111], a[28:31], v[36:39], v[108:111]
  v_mfma_f32_16x16x32_bf16 v[116:119], a[108:111], v[36:39], v[116:119]
  v_mfma_f32_16x16x32_bf16 v[124:127], a[188:191], v[36:39], v[124:127]
  ds_read_b128 v[28:31], v219 offset:30720
  buffer_load_dwordx4 v[52:55], v200, s[4:7], s31 offen offset:3072
  v_mfma_f32_16x16x32_bf16 v[104:107], a[32:35], v[8:11], v[104:107]
  v_mfma_f32_16x16x32_bf16 v[112:115], a[112:115], v[8:11], v[112:115]
  v_mfma_f32_16x16x32_bf16 v[120:123], a[192:195], v[8:11], v[120:123]
  ds_read_b128 v[32:35], v211 offset:52224
  s_add_u32 s31, s31, 4096
  buffer_load_dwordx4 v[56:59], v200, s[4:7], s31 offen offset:0
  v_mfma_f32_16x16x32_bf16 v[108:111], a[32:35], v[12:15], v[108:111]
  v_mfma_f32_16x16x32_bf16 v[116:119], a[112:115], v[12:15], v[116:119]
  v_mfma_f32_16x16x32_bf16 v[124:127], a[192:195], v[12:15], v[124:127]
  ds_read_b128 v[36:39], v219 offset:31744
  buffer_load_dwordx4 v[60:63], v200, s[4:7], s31 offen offset:1024
  s_waitcnt lgkmcnt(5)
  v_mfma_f32_16x16x32_bf16 v[104:107], a[36:39], v[16:19], v[104:107]
  v_mfma_f32_16x16x32_bf16 v[112:115], a[116:119], v[16:19], v[112:115]
  v_mfma_f32_16x16x32_bf16 v[120:123], a[196:199], v[16:19], v[120:123]
  ds_read_b128 v[8:11], v211 offset:53248
  buffer_load_dwordx4 v[64:67], v200, s[4:7], s31 offen offset:2048
  s_waitcnt lgkmcnt(5)
  v_mfma_f32_16x16x32_bf16 v[108:111], a[36:39], v[20:23], v[108:111]
  v_mfma_f32_16x16x32_bf16 v[116:119], a[116:119], v[20:23], v[116:119]
  v_mfma_f32_16x16x32_bf16 v[124:127], a[196:199], v[20:23], v[124:127]
  ds_read_b128 v[12:15], v219 offset:32768
  buffer_load_dwordx4 v[68:71], v200, s[4:7], s31 offen offset:3072
  s_waitcnt lgkmcnt(5)
  v_mfma_f32_16x16x32_bf16 v[104:107], a[40:43], v[24:27], v[104:107]
  v_mfma_f32_16x16x32_bf16 v[112:115], a[120:123], v[24:27], v[112:115]
  v_mfma_f32_16x16x32_bf16 v[120:123], a[200:203], v[24:27], v[120:123]
  ds_read_b128 v[16:19], v211 offset:54272
  s_add_u32 s31, s31, 4096
  buffer_load_dwordx4 v[72:75], v200, s[4:7], s31 offen offset:0
  s_waitcnt lgkmcnt(5)
  v_mfma_f32_16x16x32_bf16 v[108:111], a[40:43], v[28:31], v[108:111]
  v_mfma_f32_16x16x32_bf16 v[116:119], a[120:123], v[28:31], v[116:119]
  v_mfma_f32_16x16x32_bf16 v[124:127], a[200:203], v[28:31], v[124:127]
  ds_read_b128 v[20:23], v219 offset:33792
  buffer_load_dwordx4 v[76:79], v200, s[4:7], s31 offen offset:1024
  s_add_u32 s31, s31, 32768
  s_waitcnt lgkmcnt(5)
  v_mfma_f32_16x16x32_bf16 v[104:107], a[44:47], v[32:35], v[104:107]
  v_mfma_f32_16x16x32_bf16 v[112:115], a[124:127], v[32:35], v[112:115]
  v_mfma_f32_16x16x32_bf16 v[120:123], a[204:207], v[32:35], v[120:123]
  ds_read_b128 v[24:27], v211 offset:55296
  s_waitcnt lgkmcnt(5)
  v_mfma_f32_16x16x32_bf16 v[108:111], a[44:47], v[36:39], v[108:111]
  v_mfma_f32_16x16x32_bf16 v[116:119], a[124:127], v[36:39], v[116:119]
  v_mfma_f32_16x16x32_bf16 v[124:127], a[204:207], v[36:39], v[124:127]
  ds_read_b128 v[28:31], v219 offset:34816
  s_waitcnt lgkmcnt(5)
  v_mfma_f32_16x16x32_bf16 v[104:107], a[48:51], v[8:11], v[104:107]
  v_mfma_f32_16x16x32_bf16 v[112:115], a[128:131], v[8:11], v[112:115]
  v_mfma_f32_16x16x32_bf16 v[120:123], a[208:211], v[8:11], v[120:123]
  ds_read_b128 v[32:35], v211 offset:56320
  s_waitcnt lgkmcnt(5)
  v_mfma_f32_16x16x32_bf16 v[108:111], a[48:51], v[12:15], v[108:111]
  v_mfma_f32_16x16x32_bf16 v[116:119], a[128:131], v[12:15], v[116:119]
  v_mfma_f32_16x16x32_bf16 v[124:127], a[208:211], v[12:15], v[124:127]
  ds_read_b128 v[36:39], v219 offset:35840
  s_waitcnt lgkmcnt(5)
  v_mfma_f32_16x16x32_bf16 v[104:107], a[52:55], v[16:19], v[104:107]
  v_mfma_f32_16x16x32_bf16 v[112:115], a[132:135], v[16:19], v[112:115]
  v_mfma_f32_16x16x32_bf16 v[120:123], a[212:215], v[16:19], v[120:123]
  ds_read_b128 v[8:11], v211 offset:57344
  s_waitcnt lgkmcnt(5)
  v_mfma_f32_16x16x32_bf16 v[108:111], a[52:55], v[20:23], v[108:111]
  v_mfma_f32_16x16x32_bf16 v[116:119], a[132:135], v[20:23], v[116:119]
  v_mfma_f32_16x16x32_bf16 v[124:127], a[212:215], v[20:23], v[124:127]
  ds_read_b128 v[12:15], v219 offset:36864
  s_waitcnt lgkmcnt(5)
  v_mfma_f32_16x16x32_bf16 v[104:107], a[56:59], v[24:27], v[104:107]
  v_mfma_f32_16x16x32_bf16 v[112:115], a[136:139], v[24:27], v[112:115]
  v_mfma_f32_16x16x32_bf16 v[120:123], a[216:219], v[24:27], v[120:123]
  ds_read_b128 v[16:19], v211 offset:58368
  s_waitcnt lgkmcnt(5)
  v_mfma_f32_16x16x32_bf16 v[108:111], a[56:59], v[28:31], v[108:111]
  v_mfma_f32_16x16x32_bf16 v[116:119], a[136:139], v[28:31], v[116:119]
  v_mfma_f32_16x16x32_bf16 v[124:127], a[216:219], v[28:31], v[124:127]
  ds_read_b128 v[20:23], v219 offset:37888
  s_waitcnt lgkmcnt(5)
  v_mfma_f32_16x16x32_bf16 v[104:107], a[60:63], v[32:35], v[104:107]
  v_mfma_f32_16x16x32_bf16 v[112:115], a[140:143], v[32:35], v[112:115]
  v_mfma_f32_16x16x32_bf16 v[120:123], a[220:223], v[32:35], v[120:123]
  ds_read_b128 v[24:27], v211 offset:59392
  s_waitcnt lgkmcnt(5)
  v_mfma_f32_16x16x32_bf16 v[108:111], a[60:63], v[36:39], v[108:111]
  v_mfma_f32_16x16x32_bf16 v[116:119], a[140:143], v[36:39], v[116:119]
  v_mfma_f32_16x16x32_bf16 v[124:127], a[220:223], v[36:39], v[124:127]
  ds_read_b128 v[28:31], v219 offset:38912
  s_waitcnt lgkmcnt(5)
  v_mfma_f32_16x16x32_bf16 v[104:107], a[64:67], v[8:11], v[104:107]
  v_mfma_f32_16x16x32_bf16 v[112:115], a[144:147], v[8:11], v[112:115]
  v_mfma_f32_16x16x32_bf16 v[120:123], a[224:227], v[8:11], v[120:123]
  ds_read_b128 v[32:35], v211 offset:60416
  s_waitcnt lgkmcnt(5)
  v_mfma_f32_16x16x32_bf16 v[108:111], a[64:67], v[12:15], v[108:111]
  v_mfma_f32_16x16x32_bf16 v[116:119], a[144:147], v[12:15], v[116:119]
  v_mfma_f32_16x16x32_bf16 v[124:127], a[224:227], v[12:15], v[124:127]
  ds_read_b128 v[36:39], v219 offset:39936
  s_waitcnt lgkmcnt(5)
  v_mfma_f32_16x16x32_bf16 v[104:107], a[68:71], v[16:19], v[104:107]
  v_mfma_f32_16x16x32_bf16 v[112:115], a[148:151], v[16:19], v[112:115]
  v_mfma_f32_16x16x32_bf16 v[120:123], a[228:231], v[16:19], v[120:123]
  s_waitcnt lgkmcnt(4)
  v_mfma_f32_16x16x32_bf16 v[108:111], a[68:71], v[20:23], v[108:111]
  v_mfma_f32_16x16x32_bf16 v[116:119], a[148:151], v[20:23], v[116:119]
  v_mfma_f32_16x16x32_bf16 v[124:127], a[228:231], v[20:23], v[124:127]
  s_waitcnt lgkmcnt(3)
  v_mfma_f32_16x16x32_bf16 v[104:107], a[72:75], v[24:27], v[104:107]
  v_mfma_f32_16x16x32_bf16 v[112:115], a[152:155], v[24:27], v[112:115]
  v_mfma_f32_16x16x32_bf16 v[120:123], a[232:235], v[24:27], v[120:123]
  s_waitcnt lgkmcnt(2)
  v_mfma_f32_16x16x32_bf16 v[108:111], a[72:75], v[28:31], v[108:111]
  v_mfma_f32_16x16x32_bf16 v[116:119], a[152:155], v[28:31], v[116:119]
  v_mfma_f32_16x16x32_bf16 v[124:127], a[232:235], v[28:31], v[124:127]
  s_waitcnt lgkmcnt(1)
  v_mfma_f32_16x16x32_bf16 v[104:107], a[76:79], v[32:35], v[104:107]
  v_mfma_f32_16x16x32_bf16 v[112:115], a[156:159], v[32:35], v[112:115]
  v_mfma_f32_16x16x32_bf16 v[120:123], a[236:239], v[32:35], v[120:123]
  s_waitcnt lgkmcnt(0)
  v_mfma_f32_16x16x32_bf16 v[108:111], a[76:79], v[36:39], v[108:111]
  v_mfma_f32_16x16x32_bf16 v[116:119], a[156:159], v[36:39], v[116:119]
  v_mfma_f32_16x16x32_bf16 v[124:127], a[236:239], v[36:39], v[124:127]
  s_cmp_lt_u32 s30, 2
  s_cbranch_scc1 L_x1nfQ1_sx
  buffer_store_dword v205, v204, s[4:7], s33 offen sc1
  s_add_u32 s33, s33, 64
  s_branch L_x1eQ1_sx
L_x1nfQ1_sx:
  buffer_store_dword v205, v210, s[4:7], s33 offen
L_x1eQ1_sx:
  s_nop 4
  v_cvt_pk_bf16_f32 v128, v104, v105
  v_cvt_pk_bf16_f32 v129, v106, v107
  v_cvt_pk_bf16_f32 v130, v108, v109
  v_cvt_pk_bf16_f32 v131, v110, v111
  v_cvt_pk_bf16_f32 v132, v112, v113
  v_cvt_pk_bf16_f32 v133, v114, v115
  v_cvt_pk_bf16_f32 v134, v116, v117
  v_cvt_pk_bf16_f32 v135, v118, v119
  v_cvt_pk_bf16_f32 v136, v120, v121
  v_cvt_pk_bf16_f32 v137, v122, v123
  v_cvt_pk_bf16_f32 v138, v124, v125
  v_cvt_pk_bf16_f32 v139, v126, v127
  buffer_store_dwordx2 v[128:129], v213, s[4:7], s32 offen sc1
  buffer_store_dwordx2 v[130:131], v214, s[4:7], s32 offen sc1
  buffer_store_dwordx2 v[132:133], v215, s[4:7], s32 offen sc1
  buffer_store_dwordx2 v[134:135], v216, s[4:7], s32 offen sc1
  buffer_store_dwordx2 v[136:137], v217, s[4:7], s32 offen sc1
  buffer_store_dwordx2 v[138:139], v218, s[4:7], s32 offen sc1
  s_add_u32 s32, s32, 12288
  s_cmp_ge_u32 s30, 2
  s_cbranch_scc1 L_x1efQ1_sx
  s_waitcnt vmcnt(0)
  buffer_store_dword v205, v204, s[4:7], s33 offen offset:64 sc1
L_x1efQ1_sx:
  s_add_u32 s30, s30, 1
  s_cmp_lt_u32 s30, 64
  s_cbranch_scc1 L_xlQ_sx
  s_waitcnt vmcnt(0)
  buffer_store_dword v205, v204, s[4:7], s33 offen sc1
  buffer_store_dword v205, v204, s[4:7], s33 offen offset:64 sc1
  s_branch L_x1done_sx
L_x1V_sx:
  s_mul_i32 s32, s28, 1572864
  s_add_u32 s32, s32, 27799552
  s_mul_i32 s72, s27, 3072
  s_add_u32 s32, s32, s72
  v_mov_b32 v213, v200
L_xlV_sx:
  s_waitcnt lgkmcnt(0)
  s_barrier
  ds_read_b128 v[8:11], v211 offset:0
  ds_read_b128 v[12:15], v211 offset:20480
  ds_read_b128 v[16:19], v211 offset:1024
  ds_read_b128 v[20:23], v211 offset:21504
  ds_read_b128 v[24:27], v211 offset:2048
  ds_read_b128 v[28:31], v211 offset:22528
  s_waitcnt lgkmcnt(5)
  v_mfma_f32_16x16x32_bf16 v[80:83], v[8:11], a[0:3], 0
  v_mfma_f32_16x16x32_bf16 v[88:91], v[8:11], a[80:83], 0
  v_mfma_f32_16x16x32_bf16 v[96:99], v[8:11], a[160:163], 0
  ds_read_b128 v[32:35], v211 offset:3072
  s_waitcnt lgkmcnt(5)
  v_mfma_f32_16x16x32_bf16 v[84:87], v[12:15], a[0:3], 0
  v_mfma_f32_16x16x32_bf16 v[92:95], v[12:15], a[80:83], 0
  v_mfma_f32_16x16x32_bf16 v[100:103], v[12:15], a[160:163], 0
  ds_read_b128 v[36:39], v211 offset:23552
  s_waitcnt lgkmcnt(5)
  v_mfma_f32_16x16x32_bf16 v[80:83], v[16:19], a[4:7], v[80:83]
  v_mfma_f32_16x16x32_bf16 v[88:91], v[16:19], a[84:87], v[88:91]
  v_mfma_f32_16x16x32_bf16 v[96:99], v[16:19], a[164:167], v[96:99]
  ds_read_b128 v[8:11], v211 offset:4096
  s_waitcnt vmcnt(4)
  ds_write_b128 v212, v[40:43] offset:40960
  s_waitcnt lgkmcnt(6)
  v_mfma_f32_16x16x32_bf16 v[84:87], v[20:23], a[4:7], v[84:87]
  v_mfma_f32_16x16x32_bf16 v[92:95], v[20:23], a[84:87], v[92:95]
  v_mfma_f32_16x16x32_bf16 v[100:103], v[20:23], a[164:167], v[100:103]
  ds_read_b128 v[12:15], v211 offset:24576
  ds_write_b128 v212, v[44:47] offset:41984
  s_waitcnt lgkmcnt(7)
  v_mfma_f32_16x16x32_bf16 v[80:83], v[24:27], a[8:11], v[80:83]
  v_mfma_f32_16x16x32_bf16 v[88:91], v[24:27], a[88:91], v[88:91]
  v_mfma_f32_16x16x32_bf16 v[96:99], v[24:27], a[168:171], v[96:99]
  ds_read_b128 v[16:19], v211 offset:5120
  ds_write_b128 v212, v[48:51] offset:43008
  s_waitcnt lgkmcnt(8)
  v_mfma_f32_16x16x32_bf16 v[84:87], v[28:31], a[8:11], v[84:87]
  v_mfma_f32_16x16x32_bf16 v[92:95], v[28:31], a[88:91], v[92:95]
  v_mfma_f32_16x16x32_bf16 v[100:103], v[28:31], a[168:171], v[100:103]
  ds_read_b128 v[20:23], v211 offset:25600
  ds_write_b128 v212, v[52:55] offset:44032
  s_waitcnt lgkmcnt(9)
  v_mfma_f32_16x16x32_bf16 v[80:83], v[32:35], a[12:15], v[80:83]
  v_mfma_f32_16x16x32_bf16 v[88:91], v[32:35], a[92:95], v[88:91]
  v_mfma_f32_16x16x32_bf16 v[96:99], v[32:35], a[172:175], v[96:99]
  ds_read_b128 v[24:27], v211 offset:6144
  ds_write_b128 v212, v[56:59] offset:45056
  s_waitcnt lgkmcnt(10)
  v_mfma_f32_16x16x32_bf16 v[84:87], v[36:39], a[12:15], v[84:87]
  v_mfma_f32_16x16x32_bf16 v[92:95], v[36:39], a[92:95], v[92:95]
  v_mfma_f32_16x16x32_bf16 v[100:103], v[36:39], a[172:175], v[100:103]
  ds_read_b128 v[28:31], v211 offset:26624
  ds_write_b128 v212, v[60:63] offset:46080
  s_waitcnt lgkmcnt(11)
  v_mfma_f32_16x16x32_bf16 v[80:83], v[8:11], a[16:19], v[80:83]
  v_mfma_f32_16x16x32_bf16 v[88:91], v[8:11], a[96:99], v[88:91]
  v_mfma_f32_16x16x32_bf16 v[96:99], v[8:11], a[176:179], v[96:99]
  ds_read_b128 v[32:35], v211 offset:7168
  ds_write_b128 v212, v[64:67] offset:47104
  s_waitcnt lgkmcnt(11)
  v_mfma_f32_16x16x32_bf16 v[84:87], v[12:15], a[16:19], v[84:87]
  v_mfma_f32_16x16x32_bf16 v[92:95], v[12:15], a[96:99], v[92:95]
  v_mfma_f32_16x16x32_bf16 v[100:103], v[12:15], a[176:179], v[100:103]
  ds_read_b128 v[36:39], v211 offset:27648
  ds_write_b128 v212, v[68:71] offset:48128
  s_waitcnt lgkmcnt(11)
  v_mfma_f32_16x16x32_bf16 v[80:83], v[16:19], a[20:23], v[80:83]
  v_mfma_f32_16x16x32_bf16 v[88:91], v[16:19], a[100:103], v[88:91]
  v_mfma_f32_16x16x32_bf16 v[96:99], v[16:19], a[180:183], v[96:99]
  ds_read_b128 v[8:11], v211 offset:8192
  ds_write_b128 v212, v[72:75] offset:49152
  s_waitcnt lgkmcnt(11)
  v_mfma_f32_16x16x32_bf16 v[84:87], v[20:23], a[20:23], v[84:87]
  v_mfma_f32_16x16x32_bf16 v[92:95], v[20:23], a[100:103], v[92:95]
  v_mfma_f32_16x16x32_bf16 v[100:103], v[20:23], a[180:183], v[100:103]
  ds_read_b128 v[12:15], v211 offset:28672
  ds_write_b128 v212, v[76:79] offset:50176
  s_waitcnt lgkmcnt(11)
  v_mfma_f32_16x16x32_bf16 v[80:83], v[24:27], a[24:27], v[80:83]
  v_mfma_f32_16x16x32_bf16 v[88:91], v[24:27], a[104:107], v[88:91]
  v_mfma_f32_16x16x32_bf16 v[96:99], v[24:27], a[184:187], v[96:99]
  ds_read_b128 v[16:19], v211 offset:9216
  s_waitcnt lgkmcnt(1)
  buffer_load_dwordx4 v[40:43], v200, s[4:7], s31 offen offset:0
  v_mfma_f32_16x16x32_bf16 v[84:87], v[28:31], a[24:27], v[84:87]
  v_mfma_f32_16x16x32_bf16 v[92:95], v[28:31], a[104:107], v[92:95]
  v_mfma_f32_16x16x32_bf16 v[100:103], v[28:31], a[184:187], v[100:103]
  ds_read_b128 v[20:23], v211 offset:29696
  buffer_load_dwordx4 v[44:47], v200, s[4:7], s31 offen offset:1024
  v_mfma_f32_16x16x32_bf16 v[80:83], v[32:35], a[28:31], v[80:83]
  v_mfma_f32_16x16x32_bf16 v[88:91], v[32:35], a[108:111], v[88:91]
  v_mfma_f32_16x16x32_bf16 v[96:99], v[32:35], a[188:191], v[96:99]
  ds_read_b128 v[24:27], v211 offset:10240
  buffer_load_dwordx4 v[48:51], v200, s[4:7], s31 offen offset:2048
  v_mfma_f32_16x16x32_bf16 v[84:87], v[36:39], a[28:31], v[84:87]
  v_mfma_f32_16x16x32_bf16 v[92:95], v[36:39], a[108:111], v[92:95]
  v_mfma_f32_16x16x32_bf16 v[100:103], v[36:39], a[188:191], v[100:103]
  ds_read_b128 v[28:31], v211 offset:30720
  buffer_load_dwordx4 v[52:55], v200, s[4:7], s31 offen offset:3072
  v_mfma_f32_16x16x32_bf16 v[80:83], v[8:11], a[32:35], v[80:83]
  v_mfma_f32_16x16x32_bf16 v[88:91], v[8:11], a[112:115], v[88:91]
  v_mfma_f32_16x16x32_bf16 v[96:99], v[8:11], a[192:195], v[96:99]
  ds_read_b128 v[32:35], v211 offset:11264
  s_add_u32 s31, s31, 4096
  buffer_load_dwordx4 v[56:59], v200, s[4:7], s31 offen offset:0
  v_mfma_f32_16x16x32_bf16 v[84:87], v[12:15], a[32:35], v[84:87]
  v_mfma_f32_16x16x32_bf16 v[92:95], v[12:15], a[112:115], v[92:95]
  v_mfma_f32_16x16x32_bf16 v[100:103], v[12:15], a[192:195], v[100:103]
  ds_read_b128 v[36:39], v211 offset:31744
  buffer_load_dwordx4 v[60:63], v200, s[4:7], s31 offen offset:1024
  s_waitcnt lgkmcnt(5)
  v_mfma_f32_16x16x32_bf16 v[80:83], v[16:19], a[36:39], v[80:83]
  v_mfma_f32_16x16x32_bf16 v[88:91], v[16:19], a[116:119], v[88:91]
  v_mfma_f32_16x16x32_bf16 v[96:99], v[16:19], a[196:199], v[96:99]
  ds_read_b128 v[8:11], v211 offset:12288
  buffer_load_dwordx4 v[64:67], v200, s[4:7], s31 offen offset:2048
  s_waitcnt lgkmcnt(5)
  v_mfma_f32_16x16x32_bf16 v[84:87], v[20:23], a[36:39], v[84:87]
  v_mfma_f32_16x16x32_bf16 v[92:95], v[20:23], a[116:119], v[92:95]
  v_mfma_f32_16x16x32_bf16 v[100:103], v[20:23], a[196:199], v[100:103]
  ds_read_b128 v[12:15], v211 offset:32768
  buffer_load_dwordx4 v[68:71], v200, s[4:7], s31 offen offset:3072
  s_waitcnt lgkmcnt(5)
  v_mfma_f32_16x16x32_bf16 v[80:83], v[24:27], a[40:43], v[80:83]
  v_mfma_f32_16x16x32_bf16 v[88:91], v[24:27], a[120:123], v[88:91]
  v_mfma_f32_16x16x32_bf16 v[96:99], v[24:27], a[200:203], v[96:99]
  ds_read_b128 v[16:19], v211 offset:13312
  s_add_u32 s31, s31, 4096
  buffer_load_dwordx4 v[72:75], v200, s[4:7], s31 offen offset:0
  s_waitcnt lgkmcnt(5)
  v_mfma_f32_16x16x32_bf16 v[84:87], v[28:31], a[40:43], v[84:87]
  v_mfma_f32_16x16x32_bf16 v[92:95], v[28:31], a[120:123], v[92:95]
  v_mfma_f32_16x16x32_bf16 v[100:103], v[28:31], a[200:203], v[100:103]
  ds_read_b128 v[20:23], v211 offset:33792
  buffer_load_dwordx4 v[76:79], v200, s[4:7], s31 offen offset:1024
  s_add_u32 s31, s31, 32768
  s_waitcnt lgkmcnt(5)
  v_mfma_f32_16x16x32_bf16 v[80:83], v[32:35], a[44:47], v[80:83]
  v_mfma_f32_16x16x32_bf16 v[88:91], v[32:35], a[124:127], v[88:91]
  v_mfma_f32_16x16x32_bf16 v[96:99], v[32:35], a[204:207], v[96:99]
  ds_read_b128 v[24:27], v211 offset:14336
  s_waitcnt lgkmcnt(5)
  v_mfma_f32_16x16x32_bf16 v[84:87], v[36:39], a[44:47], v[84:87]
  v_mfma_f32_16x16x32_bf16 v[92:95], v[36:39], a[124:127], v[92:95]
  v_mfma_f32_16x16x32_bf16 v[100:103], v[36:39], a[204:207], v[100:103]
  ds_read_b128 v[28:31], v211 offset:34816
  s_waitcnt lgkmcnt(5)
  v_mfma_f32_16x16x32_bf16 v[80:83], v[8:11], a[48:51], v[80:83]
  v_mfma_f32_16x16x32_bf16 v[88:91], v[8:11], a[128:131], v[88:91]
  v_mfma_f32_16x16x32_bf16 v[96:99], v[8:11], a[208:211], v[96:99]
  ds_read_b128 v[32:35], v211 offset:15360
  s_waitcnt lgkmcnt(5)
  v_mfma_f32_16x16x32_bf16 v[84:87], v[12:15], a[48:51], v[84:87]
  v_mfma_f32_16x16x32_bf16 v[92:95], v[12:15], a[128:131], v[92:95]
  v_mfma_f32_16x16x32_bf16 v[100:103], v[12:15], a[208:211], v[100:103]
  ds_read_b128 v[36:39], v211 offset:35840
  s_waitcnt lgkmcnt(5)
  v_mfma_f32_16x16x32_bf16 v[80:83], v[16:19], a[52:55], v[80:83]
  v_mfma_f32_16x16x32_bf16 v[88:91], v[16:19], a[132:135], v[88:91]
  v_mfma_f32_16x16x32_bf16 v[96:99], v[16:19], a[212:215], v[96:99]
  ds_read_b128 v[8:11], v211 offset:16384
  s_waitcnt lgkmcnt(5)
  v_mfma_f32_16x16x32_bf16 v[84:87], v[20:23], a[52:55], v[84:87]
  v_mfma_f32_16x16x32_bf16 v[92:95], v[20:23], a[132:135], v[92:95]
  v_mfma_f32_16x16x32_bf16 v[100:103], v[20:23], a[212:215], v[100:103]
  ds_read_b128 v[12:15], v211 offset:36864
  s_waitcnt lgkmcnt(5)
  v_mfma_f32_16x16x32_bf16 v[80:83], v[24:27], a[56:59], v[80:83]
  v_mfma_f32_16x16x32_bf16 v[88:91], v[24:27], a[136:139], v[88:91]
  v_mfma_f32_16x16x32_bf16 v[96:99], v[24:27], a[216:219], v[96:99]
  ds_read_b128 v[16:19], v211 offset:17408
  s_waitcnt lgkmcnt(5)
  v_mfma_f32_16x16x32_bf16 v[84:87], v[28:31], a[56:59], v[84:87]
  v_mfma_f32_16x16x32_bf16 v[92:95], v[28:31], a[136:139], v[92:95]
  v_mfma_f32_16x16x32_bf16 v[100:103], v[28:31], a[216:219], v[100:103]
  ds_read_b128 v[20:23], v211 offset:37888
  s_waitcnt lgkmcnt(5)
  v_mfma_f32_16x16x32_bf16 v[80:83], v[32:35], a[60:63], v[80:83]
  v_mfma_f32_16x16x32_bf16 v[88:91], v[32:35], a[140:143], v[88:91]
  v_mfma_f32_16x16x32_bf16 v[96:99], v[32:35], a[220:223], v[96:99]
  ds_read_b128 v[24:27], v211 offset:18432
  s_waitcnt lgkmcnt(5)
  v_mfma_f32_16x16x32_bf16 v[84:87], v[36:39], a[60:63], v[84:87]
  v_mfma_f32_16x16x32_bf16 v[92:95], v[36:39], a[140:143], v[92:95]
  v_mfma_f32_16x16x32_bf16 v[100:103], v[36:39], a[220:223], v[100:103]
  ds_read_b128 v[28:31], v211 offset:38912
  s_waitcnt lgkmcnt(5)
  v_mfma_f32_16x16x32_bf16 v[80:83], v[8:11], a[64:67], v[80:83]
  v_mfma_f32_16x16x32_bf16 v[88:91], v[8:11], a[144:147], v[88:91]
  v_mfma_f32_16x16x32_bf16 v[96:99], v[8:11], a[224:227], v[96:99]
  ds_read_b128 v[32:35], v211 offset:19456
  s_waitcnt lgkmcnt(5)
  v_mfma_f32_16x16x32_bf16 v[84:87], v[12:15], a[64:67], v[84:87]
  v_mfma_f32_16x16x32_bf16 v[92:95], v[12:15], a[144:147], v[92:95]
  v_mfma_f32_16x16x32_bf16 v[100:103], v[12:15], a[224:227], v[100:103]
  ds_read_b128 v[36:39], v211 offset:39936
  s_waitcnt lgkmcnt(5)
  v_mfma_f32_16x16x32_bf16 v[80:83], v[16:19], a[68:71], v[80:83]
  v_mfma_f32_16x16x32_bf16 v[88:91], v[16:19], a[148:151], v[88:91]
  v_mfma_f32_16x16x32_bf16 v[96:99], v[16:19], a[228:231], v[96:99]
  s_waitcnt lgkmcnt(4)
  v_mfma_f32_16x16x32_bf16 v[84:87], v[20:23], a[68:71], v[84:87]
  v_mfma_f32_16x16x32_bf16 v[92:95], v[20:23], a[148:151], v[92:95]
  v_mfma_f32_16x16x32_bf16 v[100:103], v[20:23], a[228:231], v[100:103]
  s_waitcnt lgkmcnt(3)
  v_mfma_f32_16x16x32_bf16 v[80:83], v[24:27], a[72:75], v[80:83]
  v_mfma_f32_16x16x32_bf16 v[88:91], v[24:27], a[152:155], v[88:91]
  v_mfma_f32_16x16x32_bf16 v[96:99], v[24:27], a[232:235], v[96:99]
  s_waitcnt lgkmcnt(2)
  v_mfma_f32_16x16x32_bf16 v[84:87], v[28:31], a[72:75], v[84:87]
  v_mfma_f32_16x16x32_bf16 v[92:95], v[28:31], a[152:155], v[92:95]
  v_mfma_f32_16x16x32_bf16 v[100:103], v[28:31], a[232:235], v[100:103]
  s_waitcnt lgkmcnt(1)
  v_mfma_f32_16x16x32_bf16 v[80:83], v[32:35], a[76:79], v[80:83]
  v_mfma_f32_16x16x32_bf16 v[88:91], v[32:35], a[156:159], v[88:91]
  v_mfma_f32_16x16x32_bf16 v[96:99], v[32:35], a[236:239], v[96:99]
  s_waitcnt lgkmcnt(0)
  v_mfma_f32_16x16x32_bf16 v[84:87], v[36:39], a[76:79], v[84:87]
  v_mfma_f32_16x16x32_bf16 v[92:95], v[36:39], a[156:159], v[92:95]
  v_mfma_f32_16x16x32_bf16 v[100:103], v[36:39], a[236:239], v[100:103]
  s_cmp_lt_u32 s30, 2
  s_cbranch_scc1 L_x1nfV0_sx
  buffer_store_dword v205, v204, s[4:7], s33 offen sc1
  s_add_u32 s33, s33, 64
  s_branch L_x1eV0_sx
L_x1nfV0_sx:
  buffer_store_dword v205, v210, s[4:7], s33 offen
L_x1eV0_sx:
  s_nop 4
  v_cvt_pk_bf16_f32 v128, v80, v81
  v_cvt_pk_bf16_f32 v129, v82, v83
  v_cvt_pk_bf16_f32 v130, v84, v85
  v_cvt_pk_bf16_f32 v131, v86, v87
  v_cvt_pk_bf16_f32 v132, v88, v89
  v_cvt_pk_bf16_f32 v133, v90, v91
  v_cvt_pk_bf16_f32 v134, v92, v93
  v_cvt_pk_bf16_f32 v135, v94, v95
  v_cvt_pk_bf16_f32 v136, v96, v97
  v_cvt_pk_bf16_f32 v137, v98, v99
  v_cvt_pk_bf16_f32 v138, v100, v101
  v_cvt_pk_bf16_f32 v139, v102, v103
  buffer_store_dwordx4 v[128:131], v213, s[4:7], s32 offen offset:0 sc1
  buffer_store_dwordx4 v[132:135], v213, s[4:7], s32 offen offset:1024 sc1
  buffer_store_dwordx4 v[136:139], v213, s[4:7], s32 offen offset:2048 sc1
  s_add_u32 s32, s32, 24576
  s_cmp_ge_u32 s30, 2
  s_cbranch_scc1 L_x1efV0_sx
  s_waitcnt vmcnt(0)
  buffer_store_dword v205, v204, s[4:7], s33 offen offset:0 sc1
L_x1efV0_sx:
  s_add_u32 s30, s30, 1
  s_waitcnt lgkmcnt(0)
  s_barrier
  ds_read_b128 v[8:11], v211 offset:40960
  ds_read_b128 v[12:15], v211 offset:61440
  ds_read_b128 v[16:19], v211 offset:41984
  ds_read_b128 v[20:23], v211 offset:62464
  ds_read_b128 v[24:27], v211 offset:43008
  ds_read_b128 v[28:31], v211 offset:63488
  s_waitcnt lgkmcnt(5)
  v_mfma_f32_16x16x32_bf16 v[104:107], v[8:11], a[0:3], 0
  v_mfma_f32_16x16x32_bf16 v[112:115], v[8:11], a[80:83], 0
  v_mfma_f32_16x16x32_bf16 v[120:123], v[8:11], a[160:163], 0
  ds_read_b128 v[32:35], v211 offset:44032
  s_waitcnt lgkmcnt(5)
  v_mfma_f32_16x16x32_bf16 v[108:111], v[12:15], a[0:3], 0
  v_mfma_f32_16x16x32_bf16 v[116:119], v[12:15], a[80:83], 0
  v_mfma_f32_16x16x32_bf16 v[124:127], v[12:15], a[160:163], 0
  ds_read_b128 v[36:39], v211 offset:64512
  s_waitcnt lgkmcnt(5)
  v_mfma_f32_16x16x32_bf16 v[104:107], v[16:19], a[4:7], v[104:107]
  v_mfma_f32_16x16x32_bf16 v[112:115], v[16:19], a[84:87], v[112:115]
  v_mfma_f32_16x16x32_bf16 v[120:123], v[16:19], a[164:167], v[120:123]
  ds_read_b128 v[8:11], v211 offset:45056
  s_waitcnt vmcnt(4)
  ds_write_b128 v212, v[40:43] offset:0
  s_waitcnt lgkmcnt(6)
  v_mfma_f32_16x16x32_bf16 v[108:111], v[20:23], a[4:7], v[108:111]
  v_mfma_f32_16x16x32_bf16 v[116:119], v[20:23], a[84:87], v[116:119]
  v_mfma_f32_16x16x32_bf16 v[124:127], v[20:23], a[164:167], v[124:127]
  ds_read_b128 v[12:15], v219 offset:24576
  ds_write_b128 v212, v[44:47] offset:1024
  s_waitcnt lgkmcnt(7)
  v_mfma_f32_16x16x32_bf16 v[104:107], v[24:27], a[8:11], v[104:107]
  v_mfma_f32_16x16x32_bf16 v[112:115], v[24:27], a[88:91], v[112:115]
  v_mfma_f32_16x16x32_bf16 v[120:123], v[24:27], a[168:171], v[120:123]
  ds_read_b128 v[16:19], v211 offset:46080
  ds_write_b128 v212, v[48:51] offset:2048
  s_waitcnt lgkmcnt(8)
  v_mfma_f32_16x16x32_bf16 v[108:111], v[28:31], a[8:11], v[108:111]
  v_mfma_f32_16x16x32_bf16 v[116:119], v[28:31], a[88:91], v[116:119]
  v_mfma_f32_16x16x32_bf16 v[124:127], v[28:31], a[168:171], v[124:127]
  ds_read_b128 v[20:23], v219 offset:25600
  ds_write_b128 v212, v[52:55] offset:3072
  s_waitcnt lgkmcnt(9)
  v_mfma_f32_16x16x32_bf16 v[104:107], v[32:35], a[12:15], v[104:107]
  v_mfma_f32_16x16x32_bf16 v[112:115], v[32:35], a[92:95], v[112:115]
  v_mfma_f32_16x16x32_bf16 v[120:123], v[32:35], a[172:175], v[120:123]
  ds_read_b128 v[24:27], v211 offset:47104
  ds_write_b128 v212, v[56:59] offset:4096
  s_waitcnt lgkmcnt(10)
  v_mfma_f32_16x16x32_bf16 v[108:111], v[36:39], a[12:15], v[108:111]
  v_mfma_f32_16x16x32_bf16 v[116:119], v[36:39], a[92:95], v[116:119]
  v_mfma_f32_16x16x32_bf16 v[124:127], v[36:39], a[172:175], v[124:127]
  ds_read_b128 v[28:31], v219 offset:26624
  ds_write_b128 v212, v[60:63] offset:5120
  s_waitcnt lgkmcnt(11)
  v_mfma_f32_16x16x32_bf16 v[104:107], v[8:11], a[16:19], v[104:107]
  v_mfma_f32_16x16x32_bf16 v[112:115], v[8:11], a[96:99], v[112:115]
  v_mfma_f32_16x16x32_bf16 v[120:123], v[8:11], a[176:179], v[120:123]
  ds_read_b128 v[32:35], v211 offset:48128
  ds_write_b128 v212, v[64:67] offset:6144
  s_waitcnt lgkmcnt(11)
  v_mfma_f32_16x16x32_bf16 v[108:111], v[12:15], a[16:19], v[108:111]
  v_mfma_f32_16x16x32_bf16 v[116:119], v[12:15], a[96:99], v[116:119]
  v_mfma_f32_16x16x32_bf16 v[124:127], v[12:15], a[176:179], v[124:127]
  ds_read_b128 v[36:39], v219 offset:27648
  ds_write_b128 v212, v[68:71] offset:7168
  s_waitcnt lgkmcnt(11)
  v_mfma_f32_16x16x32_bf16 v[104:107], v[16:19], a[20:23], v[104:107]
  v_mfma_f32_16x16x32_bf16 v[112:115], v[16:19], a[100:103], v[112:115]
  v_mfma_f32_16x16x32_bf16 v[120:123], v[16:19], a[180:183], v[120:123]
  ds_read_b128 v[8:11], v211 offset:49152
  ds_write_b128 v212, v[72:75] offset:8192
  s_waitcnt lgkmcnt(11)
  v_mfma_f32_16x16x32_bf16 v[108:111], v[20:23], a[20:23], v[108:111]
  v_mfma_f32_16x16x32_bf16 v[116:119], v[20:23], a[100:103], v[116:119]
  v_mfma_f32_16x16x32_bf16 v[124:127], v[20:23], a[180:183], v[124:127]
  ds_read_b128 v[12:15], v219 offset:28672
  ds_write_b128 v212, v[76:79] offset:9216
  s_waitcnt lgkmcnt(11)
  v_mfma_f32_16x16x32_bf16 v[104:107], v[24:27], a[24:27], v[104:107]
  v_mfma_f32_16x16x32_bf16 v[112:115], v[24:27], a[104:107], v[112:115]
  v_mfma_f32_16x16x32_bf16 v[120:123], v[24:27], a[184:187], v[120:123]
  ds_read_b128 v[16:19], v211 offset:50176
  s_waitcnt lgkmcnt(1)
  buffer_load_dwordx4 v[40:43], v200, s[4:7], s31 offen offset:0
  v_mfma_f32_16x16x32_bf16 v[108:111], v[28:31], a[24:27], v[108:111]
  v_mfma_f32_16x16x32_bf16 v[116:119], v[28:31], a[104:107], v[116:119]
  v_mfma_f32_16x16x32_bf16 v[124:127], v[28:31], a[184:187], v[124:127]
  ds_read_b128 v[20:23], v219 offset:29696
  buffer_load_dwordx4 v[44:47], v200, s[4:7], s31 offen offset:1024
  v_mfma_f32_16x16x32_bf16 v[104:107], v[32:35], a[28:31], v[104:107]
  v_mfma_f32_16x16x32_bf16 v[112:115], v[32:35], a[108:111], v[112:115]
  v_mfma_f32_16x16x32_bf16 v[120:123], v[32:35], a[188:191], v[120:123]
  ds_read_b128 v[24:27], v211 offset:51200
  buffer_load_dwordx4 v[48:51], v200, s[4:7], s31 offen offset:2048
  v_mfma_f32_16x16x32_bf16 v[108:111], v[36:39], a[28:31], v[108:111]
  v_mfma_f32_16x16x32_bf16 v[116:119], v[36:39], a[108:111], v[116:119]
  v_mfma_f32_16x16x32_bf16 v[124:127], v[36:39], a[188:191], v[124:127]
  ds_read_b128 v[28:31], v219 offset:30720
  buffer_load_dwordx4 v[52:55], v200, s[4:7], s31 offen offset:3072
  v_mfma_f32_16x16x32_bf16 v[104:107], v[8:11], a[32:35], v[104:107]
  v_mfma_f32_16x16x32_bf16 v[112:115], v[8:11], a[112:115], v[112:115]
  v_mfma_f32_16x16x32_bf16 v[120:123], v[8:11], a[192:195], v[120:123]
  ds_read_b128 v[32:35], v211 offset:52224
  s_add_u32 s31, s31, 4096
  buffer_load_dwordx4 v[56:59], v200, s[4:7], s31 offen offset:0
  v_mfma_f32_16x16x32_bf16 v[108:111], v[12:15], a[32:35], v[108:111]
  v_mfma_f32_16x16x32_bf16 v[116:119], v[12:15], a[112:115], v[116:119]
  v_mfma_f32_16x16x32_bf16 v[124:127], v[12:15], a[192:195], v[124:127]
  ds_read_b128 v[36:39], v219 offset:31744
  buffer_load_dwordx4 v[60:63], v200, s[4:7], s31 offen offset:1024
  s_waitcnt lgkmcnt(5)
  v_mfma_f32_16x16x32_bf16 v[104:107], v[16:19], a[36:39], v[104:107]
  v_mfma_f32_16x16x32_bf16 v[112:115], v[16:19], a[116:119], v[112:115]
  v_mfma_f32_16x16x32_bf16 v[120:123], v[16:19], a[196:199], v[120:123]
  ds_read_b128 v[8:11], v211 offset:53248
  buffer_load_dwordx4 v[64:67], v200, s[4:7], s31 offen offset:2048
  s_waitcnt lgkmcnt(5)
  v_mfma_f32_16x16x32_bf16 v[108:111], v[20:23], a[36:39], v[108:111]
  v_mfma_f32_16x16x32_bf16 v[116:119], v[20:23], a[116:119], v[116:119]
  v_mfma_f32_16x16x32_bf16 v[124:127], v[20:23], a[196:199], v[124:127]
  ds_read_b128 v[12:15], v219 offset:32768
  buffer_load_dwordx4 v[68:71], v200, s[4:7], s31 offen offset:3072
  s_waitcnt lgkmcnt(5)
  v_mfma_f32_16x16x32_bf16 v[104:107], v[24:27], a[40:43], v[104:107]
  v_mfma_f32_16x16x32_bf16 v[112:115], v[24:27], a[120:123], v[112:115]
  v_mfma_f32_16x16x32_bf16 v[120:123], v[24:27], a[200:203], v[120:123]
  ds_read_b128 v[16:19], v211 offset:54272
  s_add_u32 s31, s31, 4096
  buffer_load_dwordx4 v[72:75], v200, s[4:7], s31 offen offset:0
  s_waitcnt lgkmcnt(5)
  v_mfma_f32_16x16x32_bf16 v[108:111], v[28:31], a[40:43], v[108:111]
  v_mfma_f32_16x16x32_bf16 v[116:119], v[28:31], a[120:123], v[116:119]
  v_mfma_f32_16x16x32_bf16 v[124:127], v[28:31], a[200:203], v[124:127]
  ds_read_b128 v[20:23], v219 offset:33792
  buffer_load_dwordx4 v[76:79], v200, s[4:7], s31 offen offset:1024
  s_add_u32 s31, s31, 32768
  s_waitcnt lgkmcnt(5)
  v_mfma_f32_16x16x32_bf16 v[104:107], v[32:35], a[44:47], v[104:107]
  v_mfma_f32_16x16x32_bf16 v[112:115], v[32:35], a[124:127], v[112:115]
  v_mfma_f32_16x16x32_bf16 v[120:123], v[32:35], a[204:207], v[120:123]
  ds_read_b128 v[24:27], v211 offset:55296
  s_waitcnt lgkmcnt(5)
  v_mfma_f32_16x16x32_bf16 v[108:111], v[36:39], a[44:47], v[108:111]
  v_mfma_f32_16x16x32_bf16 v[116:119], v[36:39], a[124:127], v[116:119]
  v_mfma_f32_16x16x32_bf16 v[124:127], v[36:39], a[204:207], v[124:127]
  ds_read_b128 v[28:31], v219 offset:34816
  s_waitcnt lgkmcnt(5)
  v_mfma_f32_16x16x32_bf16 v[104:107], v[8:11], a[48:51], v[104:107]
  v_mfma_f32_16x16x32_bf16 v[112:115], v[8:11], a[128:131], v[112:115]
  v_mfma_f32_16x16x32_bf16 v[120:123], v[8:11], a[208:211], v[120:123]
  ds_read_b128 v[32:35], v211 offset:56320
  s_waitcnt lgkmcnt(5)
  v_mfma_f32_16x16x32_bf16 v[108:111], v[12:15], a[48:51], v[108:111]
  v_mfma_f32_16x16x32_bf16 v[116:119], v[12:15], a[128:131], v[116:119]
  v_mfma_f32_16x16x32_bf16 v[124:127], v[12:15], a[208:211], v[124:127]
  ds_read_b128 v[36:39], v219 offset:35840
  s_waitcnt lgkmcnt(5)
  v_mfma_f32_16x16x32_bf16 v[104:107], v[16:19], a[52:55], v[104:107]
  v_mfma_f32_16x16x32_bf16 v[112:115], v[16:19], a[132:135], v[112:115]
  v_mfma_f32_16x16x32_bf16 v[120:123], v[16:19], a[212:215], v[120:123]
  ds_read_b128 v[8:11], v211 offset:57344
  s_waitcnt lgkmcnt(5)
  v_mfma_f32_16x16x32_bf16 v[108:111], v[20:23], a[52:55], v[108:111]
  v_mfma_f32_16x16x32_bf16 v[116:119], v[20:23], a[132:135], v[116:119]
  v_mfma_f32_16x16x32_bf16 v[124:127], v[20:23], a[212:215], v[124:127]
  ds_read_b128 v[12:15], v219 offset:36864
  s_waitcnt lgkmcnt(5)
  v_mfma_f32_16x16x32_bf16 v[104:107], v[24:27], a[56:59], v[104:107]
  v_mfma_f32_16x16x32_bf16 v[112:115], v[24:27], a[136:139], v[112:115]
  v_mfma_f32_16x16x32_bf16 v[120:123], v[24:27], a[216:219], v[120:123]
  ds_read_b128 v[16:19], v211 offset:58368
  s_waitcnt lgkmcnt(5)
  v_mfma_f32_16x16x32_bf16 v[108:111], v[28:31], a[56:59], v[108:111]
  v_mfma_f32_16x16x32_bf16 v[116:119], v[28:31], a[136:139], v[116:119]
  v_mfma_f32_16x16x32_bf16 v[124:127], v[28:31], a[216:219], v[124:127]
  ds_read_b128 v[20:23], v219 offset:37888
  s_waitcnt lgkmcnt(5)
  v_mfma_f32_16x16x32_bf16 v[104:107], v[32:35], a[60:63], v[104:107]
  v_mfma_f32_16x16x32_bf16 v[112:115], v[32:35], a[140:143], v[112:115]
  v_mfma_f32_16x16x32_bf16 v[120:123], v[32:35], a[220:223], v[120:123]
  ds_read_b128 v[24:27], v211 offset:59392
  s_waitcnt lgkmcnt(5)
  v_mfma_f32_16x16x32_bf16 v[108:111], v[36:39], a[60:63], v[108:111]
  v_mfma_f32_16x16x32_bf16 v[116:119], v[36:39], a[140:143], v[116:119]
  v_mfma_f32_16x16x32_bf16 v[124:127], v[36:39], a[220:223], v[124:127]
  ds_read_b128 v[28:31], v219 offset:38912
  s_waitcnt lgkmcnt(5)
  v_mfma_f32_16x16x32_bf16 v[104:107], v[8:11], a[64:67], v[104:107]
  v_mfma_f32_16x16x32_bf16 v[112:115], v[8:11], a[144:147], v[112:115]
  v_mfma_f32_16x16x32_bf16 v[120:123], v[8:11], a[224:227], v[120:123]
  ds_read_b128 v[32:35], v211 offset:60416
  s_waitcnt lgkmcnt(5)
  v_mfma_f32_16x16x32_bf16 v[108:111], v[12:15], a[64:67], v[108:111]
  v_mfma_f32_16x16x32_bf16 v[116:119], v[12:15], a[144:147], v[116:119]
  v_mfma_f32_16x16x32_bf16 v[124:127], v[12:15], a[224:227], v[124:127]
  ds_read_b128 v[36:39], v219 offset:39936
  s_waitcnt lgkmcnt(5)
  v_mfma_f32_16x16x32_bf16 v[104:107], v[16:19], a[68:71], v[104:107]
  v_mfma_f32_16x16x32_bf16 v[112:115], v[16:19], a[148:151], v[112:115]
  v_mfma_f32_16x16x32_bf16 v[120:123], v[16:19], a[228:231], v[120:123]
  s_waitcnt lgkmcnt(4)
  v_mfma_f32_16x16x32_bf16 v[108:111], v[20:23], a[68:71], v[108:111]
  v_mfma_f32_16x16x32_bf16 v[116:119], v[20:23], a[148:151], v[116:119]
  v_mfma_f32_16x16x32_bf16 v[124:127], v[20:23], a[228:231], v[124:127]
  s_waitcnt lgkmcnt(3)
  v_mfma_f32_16x16x32_bf16 v[104:107], v[24:27], a[72:75], v[104:107]
  v_mfma_f32_16x16x32_bf16 v[112:115], v[24:27], a[152:155], v[112:115]
  v_mfma_f32_16x16x32_bf16 v[120:123], v[24:27], a[232:235], v[120:123]
  s_waitcnt lgkmcnt(2)
  v_mfma_f32_16x16x32_bf16 v[108:111], v[28:31], a[72:75], v[108:111]
  v_mfma_f32_16x16x32_bf16 v[116:119], v[28:31], a[152:155], v[116:119]
  v_mfma_f32_16x16x32_bf16 v[124:127], v[28:31], a[232:235], v[124:127]
  s_waitcnt lgkmcnt(1)
  v_mfma_f32_16x16x32_bf16 v[104:107], v[32:35], a[76:79], v[104:107]
  v_mfma_f32_16x16x32_bf16 v[112:115], v[32:35], a[156:159], v[112:115]
  v_mfma_f32_16x16x32_bf16 v[120:123], v[32:35], a[236:239], v[120:123]
  s_waitcnt lgkmcnt(0)
  v_mfma_f32_16x16x32_bf16 v[108:111], v[36:39], a[76:79], v[108:111]
  v_mfma_f32_16x16x32_bf16 v[116:119], v[36:39], a[156:159], v[116:119]
  v_mfma_f32_16x16x32_bf16 v[124:127], v[36:39], a[236:239], v[124:127]
  s_cmp_lt_u32 s30, 2
  s_cbranch_scc1 L_x1nfV1_sx
  buffer_store_dword v205, v204, s[4:7], s33 offen sc1
  s_add_u32 s33, s33, 64
  s_branch L_x1eV1_sx
L_x1nfV1_sx:
  buffer_store_dword v205, v210, s[4:7], s33 offen
L_x1eV1_sx:
  s_nop 4
  v_cvt_pk_bf16_f32 v128, v104, v105
  v_cvt_pk_bf16_f32 v129, v106, v107
  v_cvt_pk_bf16_f32 v130, v108, v109
  v_cvt_pk_bf16_f32 v131, v110, v111
  v_cvt_pk_bf16_f32 v132, v112, v113
  v_cvt_pk_bf16_f32 v133, v114, v115
  v_cvt_pk_bf16_f32 v134, v116, v117
  v_cvt_pk_bf16_f32 v135, v118, v119
  v_cvt_pk_bf16_f32 v136, v120, v121
  v_cvt_pk_bf16_f32 v137, v122, v123
  v_cvt_pk_bf16_f32 v138, v124, v125
  v_cvt_pk_bf16_f32 v139, v126, v127
  buffer_store_dwordx4 v[128:131], v213, s[4:7], s32 offen offset:0 sc1
  buffer_store_dwordx4 v[132:135], v213, s[4:7], s32 offen offset:1024 sc1
  buffer_store_dwordx4 v[136:139], v213, s[4:7], s32 offen offset:2048 sc1
  s_add_u32 s32, s32, 24576
  s_cmp_ge_u32 s30, 2
  s_cbranch_scc1 L_x1efV1_sx
  s_waitcnt vmcnt(0)
  buffer_store_dword v205, v204, s[4:7], s33 offen offset:64 sc1
L_x1efV1_sx:
  s_add_u32 s30, s30, 1
  s_cmp_lt_u32 s30, 64
  s_cbranch_scc1 L_xlV_sx
  s_waitcnt vmcnt(0)
  buffer_store_dword v205, v204, s[4:7], s33 offen sc1
  buffer_store_dword v205, v204, s[4:7], s33 offen offset:64 sc1
  s_branch L_x1done_sx
L_x1F_sx:
  s_mul_i32 s32, s28, 196608
  s_add_u32 s32, s32, 78118912
  v_lshlrev_b32 v213, 4, v1
  s_cmp_eq_u32 s27, 1
  s_cselect_b32 s72, 8, 0
  v_add_u32 v213, s72, v213
  v_lshlrev_b32 v4, 3, v1
  v_add_u32 v4, 1024, v4
  s_cmp_eq_u32 s27, 2
  s_cselect_b64 vcc, -1, 0
  v_cndmask_b32 v213, v213, v4, vcc
  v_add_u32 v214, 1536, v213
  s_cmp_eq_u32 s27, 3
  s_cselect_b64 vcc, -1, 0
  v_cndmask_b32 v213, v213, v210, vcc
  v_cndmask_b32 v214, v214, v210, vcc
L_xlF_sx:
  s_waitcnt lgkmcnt(0)
  s_barrier
  ds_read_b128 v[8:11], v211 offset:0
  ds_read_b128 v[12:15], v211 offset:20480
  ds_read_b128 v[16:19], v211 offset:1024
  ds_read_b128 v[20:23], v211 offset:21504
  ds_read_b128 v[24:27], v211 offset:2048
  ds_read_b128 v[28:31], v211 offset:22528
  s_waitcnt lgkmcnt(5)
  v_mfma_f32_16x16x32_bf16 v[80:83], a[0:3], v[8:11], 0
  ds_read_b128 v[32:35], v211 offset:3072
  s_waitcnt lgkmcnt(5)
  v_mfma_f32_16x16x32_bf16 v[84:87], a[0:3], v[12:15], 0
  ds_read_b128 v[36:39], v211 offset:23552
  s_waitcnt lgkmcnt(5)
  v_mfma_f32_16x16x32_bf16 v[80:83], a[4:7], v[16:19], v[80:83]
  ds_read_b128 v[8:11], v211 offset:4096
  s_waitcnt vmcnt(3)
  ds_write_b128 v212, v[40:43] offset:40960
  s_waitcnt lgkmcnt(6)
  v_mfma_f32_16x16x32_bf16 v[84:87], a[4:7], v[20:23], v[84:87]
  ds_read_b128 v[12:15], v211 offset:24576
  ds_write_b128 v212, v[44:47] offset:41984
  s_waitcnt lgkmcnt(7)
  v_mfma_f32_16x16x32_bf16 v[80:83], a[8:11], v[24:27], v[80:83]
  ds_read_b128 v[16:19], v211 offset:5120
  ds_write_b128 v212, v[48:51] offset:43008
  s_waitcnt lgkmcnt(8)
  v_mfma_f32_16x16x32_bf16 v[84:87], a[8:11], v[28:31], v[84:87]
  ds_read_b128 v[20:23], v211 offset:25600
  ds_write_b128 v212, v[52:55] offset:44032
  s_waitcnt lgkmcnt(9)
  v_mfma_f32_16x16x32_bf16 v[80:83], a[12:15], v[32:35], v[80:83]
  ds_read_b128 v[24:27], v211 offset:6144
  ds_write_b128 v212, v[56:59] offset:45056
  s_waitcnt lgkmcnt(10)
  v_mfma_f32_16x16x32_bf16 v[84:87], a[12:15], v[36:39], v[84:87]
  ds_read_b128 v[28:31], v211 offset:26624
  ds_write_b128 v212, v[60:63] offset:46080
  s_waitcnt lgkmcnt(11)
  v_mfma_f32_16x16x32_bf16 v[80:83], a[16:19], v[8:11], v[80:83]
  ds_read_b128 v[32:35], v211 offset:7168
  ds_write_b128 v212, v[64:67] offset:47104
  s_waitcnt lgkmcnt(11)
  v_mfma_f32_16x16x32_bf16 v[84:87], a[16:19], v[12:15], v[84:87]
  ds_read_b128 v[36:39], v211 offset:27648
  ds_write_b128 v212, v[68:71] offset:48128
  s_waitcnt lgkmcnt(11)
  v_mfma_f32_16x16x32_bf16 v[80:83], a[20:23], v[16:19], v[80:83]
  ds_read_b128 v[8:11], v211 offset:8192
  ds_write_b128 v212, v[72:75] offset:49152
  s_waitcnt lgkmcnt(11)
  v_mfma_f32_16x16x32_bf16 v[84:87], a[20:23], v[20:23], v[84:87]
  ds_read_b128 v[12:15], v211 offset:28672
  ds_write_b128 v212, v[76:79] offset:50176
  s_waitcnt lgkmcnt(11)
  v_mfma_f32_16x16x32_bf16 v[80:83], a[24:27], v[24:27], v[80:83]
  ds_read_b128 v[16:19], v211 offset:9216
  s_waitcnt lgkmcnt(1)
  buffer_load_dwordx4 v[40:43], v200, s[4:7], s31 offen offset:0
  v_mfma_f32_16x16x32_bf16 v[84:87], a[24:27], v[28:31], v[84:87]
  ds_read_b128 v[20:23], v211 offset:29696
  buffer_load_dwordx4 v[44:47], v200, s[4:7], s31 offen offset:1024
  v_mfma_f32_16x16x32_bf16 v[80:83], a[28:31], v[32:35], v[80:83]
  ds_read_b128 v[24:27], v211 offset:10240
  buffer_load_dwordx4 v[48:51], v200, s[4:7], s31 offen offset:2048
  v_mfma_f32_16x16x32_bf16 v[84:87], a[28:31], v[36:39], v[84:87]
  ds_read_b128 v[28:31], v211 offset:30720
  buffer_load_dwordx4 v[52:55], v200, s[4:7], s31 offen offset:3072
  v_mfma_f32_16x16x32_bf16 v[80:83], a[32:35], v[8:11], v[80:83]
  ds_read_b128 v[32:35], v211 offset:11264
  s_add_u32 s31, s31, 4096
  buffer_load_dwordx4 v[56:59], v200, s[4:7], s31 offen offset:0
  v_mfma_f32_16x16x32_bf16 v[84:87], a[32:35], v[12:15], v[84:87]
  ds_read_b128 v[36:39], v211 offset:31744
  buffer_load_dwordx4 v[60:63], v200, s[4:7], s31 offen offset:1024
  s_waitcnt lgkmcnt(5)
  v_mfma_f32_16x16x32_bf16 v[80:83], a[36:39], v[16:19], v[80:83]
  ds_read_b128 v[8:11], v211 offset:12288
  buffer_load_dwordx4 v[64:67], v200, s[4:7], s31 offen offset:2048
  s_waitcnt lgkmcnt(5)
  v_mfma_f32_16x16x32_bf16 v[84:87], a[36:39], v[20:23], v[84:87]
  ds_read_b128 v[12:15], v211 offset:32768
  buffer_load_dwordx4 v[68:71], v200, s[4:7], s31 offen offset:3072
  s_waitcnt lgkmcnt(5)
  v_mfma_f32_16x16x32_bf16 v[80:83], a[40:43], v[24:27], v[80:83]
  ds_read_b128 v[16:19], v211 offset:13312
  s_add_u32 s31, s31, 4096
  buffer_load_dwordx4 v[72:75], v200, s[4:7], s31 offen offset:0
  s_waitcnt lgkmcnt(5)
  v_mfma_f32_16x16x32_bf16 v[84:87], a[40:43], v[28:31], v[84:87]
  ds_read_b128 v[20:23], v211 offset:33792
  buffer_load_dwordx4 v[76:79], v200, s[4:7], s31 offen offset:1024
  s_add_u32 s31, s31, 32768
  s_waitcnt lgkmcnt(5)
  v_mfma_f32_16x16x32_bf16 v[80:83], a[44:47], v[32:35], v[80:83]
  ds_read_b128 v[24:27], v211 offset:14336
  s_waitcnt lgkmcnt(5)
  v_mfma_f32_16x16x32_bf16 v[84:87], a[44:47], v[36:39], v[84:87]
  ds_read_b128 v[28:31], v211 offset:34816
  s_waitcnt lgkmcnt(5)
  v_mfma_f32_16x16x32_bf16 v[80:83], a[48:51], v[8:11], v[80:83]
  ds_read_b128 v[32:35], v211 offset:15360
  s_waitcnt lgkmcnt(5)
  v_mfma_f32_16x16x32_bf16 v[84:87], a[48:51], v[12:15], v[84:87]
  ds_read_b128 v[36:39], v211 offset:35840
  s_waitcnt lgkmcnt(5)
  v_mfma_f32_16x16x32_bf16 v[80:83], a[52:55], v[16:19], v[80:83]
  ds_read_b128 v[8:11], v211 offset:16384
  s_waitcnt lgkmcnt(5)
  v_mfma_f32_16x16x32_bf16 v[84:87], a[52:55], v[20:23], v[84:87]
  ds_read_b128 v[12:15], v211 offset:36864
  s_waitcnt lgkmcnt(5)
  v_mfma_f32_16x16x32_bf16 v[80:83], a[56:59], v[24:27], v[80:83]
  ds_read_b128 v[16:19], v211 offset:17408
  s_waitcnt lgkmcnt(5)
  v_mfma_f32_16x16x32_bf16 v[84:87], a[56:59], v[28:31], v[84:87]
  ds_read_b128 v[20:23], v211 offset:37888
  s_waitcnt lgkmcnt(5)
  v_mfma_f32_16x16x32_bf16 v[80:83], a[60:63], v[32:35], v[80:83]
  ds_read_b128 v[24:27], v211 offset:18432
  s_waitcnt lgkmcnt(5)
  v_mfma_f32_16x16x32_bf16 v[84:87], a[60:63], v[36:39], v[84:87]
  ds_read_b128 v[28:31], v211 offset:38912
  s_waitcnt lgkmcnt(5)
  v_mfma_f32_16x16x32_bf16 v[80:83], a[64:67], v[8:11], v[80:83]
  ds_read_b128 v[32:35], v211 offset:19456
  s_waitcnt lgkmcnt(5)
  v_mfma_f32_16x16x32_bf16 v[84:87], a[64:67], v[12:15], v[84:87]
  ds_read_b128 v[36:39], v211 offset:39936
  s_waitcnt lgkmcnt(5)
  v_mfma_f32_16x16x32_bf16 v[80:83], a[68:71], v[16:19], v[80:83]
  s_waitcnt lgkmcnt(4)
  v_mfma_f32_16x16x32_bf16 v[84:87], a[68:71], v[20:23], v[84:87]
  s_waitcnt lgkmcnt(3)
  v_mfma_f32_16x16x32_bf16 v[80:83], a[72:75], v[24:27], v[80:83]
  s_waitcnt lgkmcnt(2)
  v_mfma_f32_16x16x32_bf16 v[84:87], a[72:75], v[28:31], v[84:87]
  s_waitcnt lgkmcnt(1)
  v_mfma_f32_16x16x32_bf16 v[80:83], a[76:79], v[32:35], v[80:83]
  s_waitcnt lgkmcnt(0)
  v_mfma_f32_16x16x32_bf16 v[84:87], a[76:79], v[36:39], v[84:87]
  s_cmp_lt_u32 s30, 2
  s_cbranch_scc1 L_x1nfF0_sx
  buffer_store_dword v205, v204, s[4:7], s33 offen sc1
  s_add_u32 s33, s33, 64
  s_branch L_x1eF0_sx
L_x1nfF0_sx:
  buffer_store_dword v205, v210, s[4:7], s33 offen
L_x1eF0_sx:
  s_nop 4
  v_cvt_pk_bf16_f32 v128, v80, v81
  v_cvt_pk_bf16_f32 v129, v82, v83
  v_lshlrev_b32 v80, 16, v128
  v_and_b32 v81, 0xffff0000, v128
  v_lshlrev_b32 v82, 16, v129
  v_and_b32 v83, 0xffff0000, v129
  v_pk_add_f32 v[80:81], v[80:81], v[206:207]
  v_pk_add_f32 v[82:83], v[82:83], v[208:209]
  v_cvt_pk_bf16_f32 v128, v80, v81
  v_cvt_pk_bf16_f32 v129, v82, v83
  v_lshlrev_b32 v80, 16, v128
  v_and_b32 v81, 0xffff0000, v128
  v_lshlrev_b32 v82, 16, v129
  v_and_b32 v83, 0xffff0000, v129
  v_max_f32 v80, 0, v80
  v_max_f32 v81, 0, v81
  v_max_f32 v82, 0, v82
  v_max_f32 v83, 0, v83
  v_pk_mul_f32 v[80:81], v[80:81], v[80:81]
  v_pk_mul_f32 v[82:83], v[82:83], v[82:83]
  v_cvt_pk_bf16_f32 v128, v80, v81
  v_cvt_pk_bf16_f32 v129, v82, v83
  buffer_store_dwordx2 v[128:129], v213, s[4:7], s32 offen sc1
  v_cvt_pk_bf16_f32 v130, v84, v85
  v_cvt_pk_bf16_f32 v131, v86, v87
  v_lshlrev_b32 v84, 16, v130
  v_and_b32 v85, 0xffff0000, v130
  v_lshlrev_b32 v86, 16, v131
  v_and_b32 v87, 0xffff0000, v131
  v_pk_add_f32 v[84:85], v[84:85], v[206:207]
  v_pk_add_f32 v[86:87], v[86:87], v[208:209]
  v_cvt_pk_bf16_f32 v130, v84, v85
  v_cvt_pk_bf16_f32 v131, v86, v87
  v_lshlrev_b32 v84, 16, v130
  v_and_b32 v85, 0xffff0000, v130
  v_lshlrev_b32 v86, 16, v131
  v_and_b32 v87, 0xffff0000, v131
  v_max_f32 v84, 0, v84
  v_max_f32 v85, 0, v85
  v_max_f32 v86, 0, v86
  v_max_f32 v87, 0, v87
  v_pk_mul_f32 v[84:85], v[84:85], v[84:85]
  v_pk_mul_f32 v[86:87], v[86:87], v[86:87]
  v_cvt_pk_bf16_f32 v130, v84, v85
  v_cvt_pk_bf16_f32 v131, v86, v87
  buffer_store_dwordx2 v[130:131], v214, s[4:7], s32 offen sc1
  s_add_u32 s32, s32, 3072
  s_cmp_ge_u32 s30, 2
  s_cbranch_scc1 L_x1efF0_sx
  s_waitcnt vmcnt(0)
  buffer_store_dword v205, v204, s[4:7], s33 offen offset:0 sc1
L_x1efF0_sx:
  s_add_u32 s30, s30, 1
  s_waitcnt lgkmcnt(0)
  s_barrier
  ds_read_b128 v[8:11], v211 offset:40960
  ds_read_b128 v[12:15], v211 offset:61440
  ds_read_b128 v[16:19], v211 offset:41984
  ds_read_b128 v[20:23], v211 offset:62464
  ds_read_b128 v[24:27], v211 offset:43008
  ds_read_b128 v[28:31], v211 offset:63488
  s_waitcnt lgkmcnt(5)
  v_mfma_f32_16x16x32_bf16 v[104:107], a[0:3], v[8:11], 0
  ds_read_b128 v[32:35], v211 offset:44032
  s_waitcnt lgkmcnt(5)
  v_mfma_f32_16x16x32_bf16 v[108:111], a[0:3], v[12:15], 0
  ds_read_b128 v[36:39], v211 offset:64512
  s_waitcnt lgkmcnt(5)
  v_mfma_f32_16x16x32_bf16 v[104:107], a[4:7], v[16:19], v[104:107]
  ds_read_b128 v[8:11], v211 offset:45056
  s_waitcnt vmcnt(3)
  ds_write_b128 v212, v[40:43] offset:0
  s_waitcnt lgkmcnt(6)
  v_mfma_f32_16x16x32_bf16 v[108:111], a[4:7], v[20:23], v[108:111]
  ds_read_b128 v[12:15], v219 offset:24576
  ds_write_b128 v212, v[44:47] offset:1024
  s_waitcnt lgkmcnt(7)
  v_mfma_f32_16x16x32_bf16 v[104:107], a[8:11], v[24:27], v[104:107]
  ds_read_b128 v[16:19], v211 offset:46080
  ds_write_b128 v212, v[48:51] offset:2048
  s_waitcnt lgkmcnt(8)
  v_mfma_f32_16x16x32_bf16 v[108:111], a[8:11], v[28:31], v[108:111]
  ds_read_b128 v[20:23], v219 offset:25600
  ds_write_b128 v212, v[52:55] offset:3072
  s_waitcnt lgkmcnt(9)
  v_mfma_f32_16x16x32_bf16 v[104:107], a[12:15], v[32:35], v[104:107]
  ds_read_b128 v[24:27], v211 offset:47104
  ds_write_b128 v212, v[56:59] offset:4096
  s_waitcnt lgkmcnt(10)
  v_mfma_f32_16x16x32_bf16 v[108:111], a[12:15], v[36:39], v[108:111]
  ds_read_b128 v[28:31], v219 offset:26624
  ds_write_b128 v212, v[60:63] offset:5120
  s_waitcnt lgkmcnt(11)
  v_mfma_f32_16x16x32_bf16 v[104:107], a[16:19], v[8:11], v[104:107]
  ds_read_b128 v[32:35], v211 offset:48128
  ds_write_b128 v212, v[64:67] offset:6144
  s_waitcnt lgkmcnt(11)
  v_mfma_f32_16x16x32_bf16 v[108:111], a[16:19], v[12:15], v[108:111]
  ds_read_b128 v[36:39], v219 offset:27648
  ds_write_b128 v212, v[68:71] offset:7168
  s_waitcnt lgkmcnt(11)
  v_mfma_f32_16x16x32_bf16 v[104:107], a[20:23], v[16:19], v[104:107]
  ds_read_b128 v[8:11], v211 offset:49152
  ds_write_b128 v212, v[72:75] offset:8192
  s_waitcnt lgkmcnt(11)
  v_mfma_f32_16x16x32_bf16 v[108:111], a[20:23], v[20:23], v[108:111]
  ds_read_b128 v[12:15], v219 offset:28672
  ds_write_b128 v212, v[76:79] offset:9216
  s_waitcnt lgkmcnt(11)
  v_mfma_f32_16x16x32_bf16 v[104:107], a[24:27], v[24:27], v[104:107]
  ds_read_b128 v[16:19], v211 offset:50176
  s_waitcnt lgkmcnt(1)
  buffer_load_dwordx4 v[40:43], v200, s[4:7], s31 offen offset:0
  v_mfma_f32_16x16x32_bf16 v[108:111], a[24:27], v[28:31], v[108:111]
  ds_read_b128 v[20:23], v219 offset:29696
  buffer_load_dwordx4 v[44:47], v200, s[4:7], s31 offen offset:1024
  v_mfma_f32_16x16x32_bf16 v[104:107], a[28:31], v[32:35], v[104:107]
  ds_read_b128 v[24:27], v211 offset:51200
  buffer_load_dwordx4 v[48:51], v200, s[4:7], s31 offen offset:2048
  v_mfma_f32_16x16x32_bf16 v[108:111], a[28:31], v[36:39], v[108:111]
  ds_read_b128 v[28:31], v219 offset:30720
  buffer_load_dwordx4 v[52:55], v200, s[4:7], s31 offen offset:3072
  v_mfma_f32_16x16x32_bf16 v[104:107], a[32:35], v[8:11], v[104:107]
  ds_read_b128 v[32:35], v211 offset:52224
  s_add_u32 s31, s31, 4096
  buffer_load_dwordx4 v[56:59], v200, s[4:7], s31 offen offset:0
  v_mfma_f32_16x16x32_bf16 v[108:111], a[32:35], v[12:15], v[108:111]
  ds_read_b128 v[36:39], v219 offset:31744
  buffer_load_dwordx4 v[60:63], v200, s[4:7], s31 offen offset:1024
  s_waitcnt lgkmcnt(5)
  v_mfma_f32_16x16x32_bf16 v[104:107], a[36:39], v[16:19], v[104:107]
  ds_read_b128 v[8:11], v211 offset:53248
  buffer_load_dwordx4 v[64:67], v200, s[4:7], s31 offen offset:2048
  s_waitcnt lgkmcnt(5)
  v_mfma_f32_16x16x32_bf16 v[108:111], a[36:39], v[20:23], v[108:111]
  ds_read_b128 v[12:15], v219 offset:32768
  buffer_load_dwordx4 v[68:71], v200, s[4:7], s31 offen offset:3072
  s_waitcnt lgkmcnt(5)
  v_mfma_f32_16x16x32_bf16 v[104:107], a[40:43], v[24:27], v[104:107]
  ds_read_b128 v[16:19], v211 offset:54272
  s_add_u32 s31, s31, 4096
  buffer_load_dwordx4 v[72:75], v200, s[4:7], s31 offen offset:0
  s_waitcnt lgkmcnt(5)
  v_mfma_f32_16x16x32_bf16 v[108:111], a[40:43], v[28:31], v[108:111]
  ds_read_b128 v[20:23], v219 offset:33792
  buffer_load_dwordx4 v[76:79], v200, s[4:7], s31 offen offset:1024
  s_add_u32 s31, s31, 32768
  s_waitcnt lgkmcnt(5)
  v_mfma_f32_16x16x32_bf16 v[104:107], a[44:47], v[32:35], v[104:107]
  ds_read_b128 v[24:27], v211 offset:55296
  s_waitcnt lgkmcnt(5)
  v_mfma_f32_16x16x32_bf16 v[108:111], a[44:47], v[36:39], v[108:111]
  ds_read_b128 v[28:31], v219 offset:34816
  s_waitcnt lgkmcnt(5)
  v_mfma_f32_16x16x32_bf16 v[104:107], a[48:51], v[8:11], v[104:107]
  ds_read_b128 v[32:35], v211 offset:56320
  s_waitcnt lgkmcnt(5)
  v_mfma_f32_16x16x32_bf16 v[108:111], a[48:51], v[12:15], v[108:111]
  ds_read_b128 v[36:39], v219 offset:35840
  s_waitcnt lgkmcnt(5)
  v_mfma_f32_16x16x32_bf16 v[104:107], a[52:55], v[16:19], v[104:107]
  ds_read_b128 v[8:11], v211 offset:57344
  s_waitcnt lgkmcnt(5)
  v_mfma_f32_16x16x32_bf16 v[108:111], a[52:55], v[20:23], v[108:111]
  ds_read_b128 v[12:15], v219 offset:36864
  s_waitcnt lgkmcnt(5)
  v_mfma_f32_16x16x32_bf16 v[104:107], a[56:59], v[24:27], v[104:107]
  ds_read_b128 v[16:19], v211 offset:58368
  s_waitcnt lgkmcnt(5)
  v_mfma_f32_16x16x32_bf16 v[108:111], a[56:59], v[28:31], v[108:111]
  ds_read_b128 v[20:23], v219 offset:37888
  s_waitcnt lgkmcnt(5)
  v_mfma_f32_16x16x32_bf16 v[104:107], a[60:63], v[32:35], v[104:107]
  ds_read_b128 v[24:27], v211 offset:59392
  s_waitcnt lgkmcnt(5)
  v_mfma_f32_16x16x32_bf16 v[108:111], a[60:63], v[36:39], v[108:111]
  ds_read_b128 v[28:31], v219 offset:38912
  s_waitcnt lgkmcnt(5)
  v_mfma_f32_16x16x32_bf16 v[104:107], a[64:67], v[8:11], v[104:107]
  ds_read_b128 v[32:35], v211 offset:60416
  s_waitcnt lgkmcnt(5)
  v_mfma_f32_16x16x32_bf16 v[108:111], a[64:67], v[12:15], v[108:111]
  ds_read_b128 v[36:39], v219 offset:39936
  s_waitcnt lgkmcnt(5)
  v_mfma_f32_16x16x32_bf16 v[104:107], a[68:71], v[16:19], v[104:107]
  s_waitcnt lgkmcnt(4)
  v_mfma_f32_16x16x32_bf16 v[108:111], a[68:71], v[20:23], v[108:111]
  s_waitcnt lgkmcnt(3)
  v_mfma_f32_16x16x32_bf16 v[104:107], a[72:75], v[24:27], v[104:107]
  s_waitcnt lgkmcnt(2)
  v_mfma_f32_16x16x32_bf16 v[108:111], a[72:75], v[28:31], v[108:111]
  s_waitcnt lgkmcnt(1)
  v_mfma_f32_16x16x32_bf16 v[104:107], a[76:79], v[32:35], v[104:107]
  s_waitcnt lgkmcnt(0)
  v_mfma_f32_16x16x32_bf16 v[108:111], a[76:79], v[36:39], v[108:111]
  s_cmp_lt_u32 s30, 2
  s_cbranch_scc1 L_x1nfF1_sx
  buffer_store_dword v205, v204, s[4:7], s33 offen sc1
  s_add_u32 s33, s33, 64
  s_branch L_x1eF1_sx
L_x1nfF1_sx:
  buffer_store_dword v205, v210, s[4:7], s33 offen
L_x1eF1_sx:
  s_nop 4
  v_cvt_pk_bf16_f32 v128, v104, v105
  v_cvt_pk_bf16_f32 v129, v106, v107
  v_lshlrev_b32 v104, 16, v128
  v_and_b32 v105, 0xffff0000, v128
  v_lshlrev_b32 v106, 16, v129
  v_and_b32 v107, 0xffff0000, v129
  v_pk_add_f32 v[104:105], v[104:105], v[206:207]
  v_pk_add_f32 v[106:107], v[106:107], v[208:209]
  v_cvt_pk_bf16_f32 v128, v104, v105
  v_cvt_pk_bf16_f32 v129, v106, v107
  v_lshlrev_b32 v104, 16, v128
  v_and_b32 v105, 0xffff0000, v128
  v_lshlrev_b32 v106, 16, v129
  v_and_b32 v107, 0xffff0000, v129
  v_max_f32 v104, 0, v104
  v_max_f32 v105, 0, v105
  v_max_f32 v106, 0, v106
  v_max_f32 v107, 0, v107
  v_pk_mul_f32 v[104:105], v[104:105], v[104:105]
  v_pk_mul_f32 v[106:107], v[106:107], v[106:107]
  v_cvt_pk_bf16_f32 v128, v104, v105
  v_cvt_pk_bf16_f32 v129, v106, v107
  buffer_store_dwordx2 v[128:129], v213, s[4:7], s32 offen sc1
  v_cvt_pk_bf16_f32 v130, v108, v109
  v_cvt_pk_bf16_f32 v131, v110, v111
  v_lshlrev_b32 v108, 16, v130
  v_and_b32 v109, 0xffff0000, v130
  v_lshlrev_b32 v110, 16, v131
  v_and_b32 v111, 0xffff0000, v131
  v_pk_add_f32 v[108:109], v[108:109], v[206:207]
  v_pk_add_f32 v[110:111], v[110:111], v[208:209]
  v_cvt_pk_bf16_f32 v130, v108, v109
  v_cvt_pk_bf16_f32 v131, v110, v111
  v_lshlrev_b32 v108, 16, v130
  v_and_b32 v109, 0xffff0000, v130
  v_lshlrev_b32 v110, 16, v131
  v_and_b32 v111, 0xffff0000, v131
  v_max_f32 v108, 0, v108
  v_max_f32 v109, 0, v109
  v_max_f32 v110, 0, v110
  v_max_f32 v111, 0, v111
  v_pk_mul_f32 v[108:109], v[108:109], v[108:109]
  v_pk_mul_f32 v[110:111], v[110:111], v[110:111]
  v_cvt_pk_bf16_f32 v130, v108, v109
  v_cvt_pk_bf16_f32 v131, v110, v111
  buffer_store_dwordx2 v[130:131], v214, s[4:7], s32 offen sc1
  s_add_u32 s32, s32, 3072
  s_cmp_ge_u32 s30, 2
  s_cbranch_scc1 L_x1efF1_sx
  s_waitcnt vmcnt(0)
  buffer_store_dword v205, v204, s[4:7], s33 offen offset:64 sc1
L_x1efF1_sx:
  s_add_u32 s30, s30, 1
  s_cmp_lt_u32 s30, 64
  s_cbranch_scc1 L_xlF_sx
  s_waitcnt vmcnt(0)
  buffer_store_dword v205, v204, s[4:7], s33 offen sc1
  buffer_store_dword v205, v204, s[4:7], s33 offen offset:64 sc1
L_x1done_sx:
  s_lshr_b32 s31, s25, 1
  s_and_b32 s32, s25, 1
  s_and_b32 s33, s29, 1
  s_lshr_b32 s34, s29, 1
  s_lshl_b32 s36, s24, 2
  s_add_u32 s36, s36, s29
  s_mov_b32 s35, 0x3dd53b95
  s_cmp_eq_u32 s33, 0
  s_cselect_b32 s65, 0xf149f2ca, 0
  s_mov_b32 s12, s60
  s_and_b32 s13, s61, 0xffff
  s_mov_b32 s14, 2621440
  s_mov_b32 s15, 0x00020000
  s_mov_b32 s16, s62
  s_and_b32 s17, s63, 0xffff
  s_mov_b32 s18, 2621440
  s_mov_b32 s19, 0x00020000
  s_barrier
  v_add_u32 v6, 0, v1
  s_mov_b32 s73, 52429
  v_mul_lo_u32 v7, v6, s73
  v_lshrrev_b32 v7, 19, v7
  v_mul_u32_u24 v8, 10, v7
  v_sub_u32 v8, v6, v8
  v_lshlrev_b32 v8, 4, v8
  s_movk_i32 s73, 1280
  v_mad_u32_u24 v8, v7, s73, v8
  v_add_u32 v6, 64, v1
  s_mov_b32 s73, 52429
  v_mul_lo_u32 v7, v6, s73
  v_lshrrev_b32 v7, 19, v7
  v_mul_u32_u24 v9, 10, v7
  v_sub_u32 v9, v6, v9
  v_lshlrev_b32 v9, 4, v9
  s_movk_i32 s73, 1280
  v_mad_u32_u24 v9, v7, s73, v9
  v_add_u32 v6, 128, v1
  s_mov_b32 s73, 52429
  v_mul_lo_u32 v7, v6, s73
  v_lshrrev_b32 v7, 19, v7
  v_mul_u32_u24 v10, 10, v7
  v_sub_u32 v10, v6, v10
  v_lshlrev_b32 v10, 4, v10
  s_movk_i32 s73, 1280
  v_mad_u32_u24 v10, v7, s73, v10
  v_add_u32 v6, 192, v1
  s_mov_b32 s73, 52429
  v_mul_lo_u32 v7, v6, s73
  v_lshrrev_b32 v7, 19, v7
  v_mul_u32_u24 v11, 10, v7
  v_sub_u32 v11, v6, v11
  v_lshlrev_b32 v11, 4, v11
  s_movk_i32 s73, 1280
  v_mad_u32_u24 v11, v7, s73, v11
  v_add_u32 v6, 256, v1
  s_mov_b32 s73, 52429
  v_mul_lo_u32 v7, v6, s73
  v_lshrrev_b32 v7, 19, v7
  v_mul_u32_u24 v12, 10, v7
  v_sub_u32 v12, v6, v12
  v_lshlrev_b32 v12, 4, v12
  s_movk_i32 s73, 1280
  v_mad_u32_u24 v12, v7, s73, v12
  v_add_u32 v6, 320, v1
  s_mov_b32 s73, 52429
  v_mul_lo_u32 v7, v6, s73
  v_lshrrev_b32 v7, 19, v7
  v_mul_u32_u24 v13, 10, v7
  v_sub_u32 v13, v6, v13
  v_lshlrev_b32 v13, 4, v13
  s_movk_i32 s73, 1280
  v_mad_u32_u24 v13, v7, s73, v13
  v_add_u32 v6, 384, v1
  s_mov_b32 s73, 52429
  v_mul_lo_u32 v7, v6, s73
  v_lshrrev_b32 v7, 19, v7
  v_mul_u32_u24 v14, 10, v7
  v_sub_u32 v14, v6, v14
  v_lshlrev_b32 v14, 4, v14
  s_movk_i32 s73, 1280
  v_mad_u32_u24 v14, v7, s73, v14
  v_add_u32 v6, 448, v1
  s_mov_b32 s73, 52429
  v_mul_lo_u32 v7, v6, s73
  v_lshrrev_b32 v7, 19, v7
  v_mul_u32_u24 v15, 10, v7
  v_sub_u32 v15, v6, v15
  v_lshlrev_b32 v15, 4, v15
  s_movk_i32 s73, 1280
  v_mad_u32_u24 v15, v7, s73, v15
  v_add_u32 v6, 512, v1
  s_mov_b32 s73, 52429
  v_mul_lo_u32 v7, v6, s73
  v_lshrrev_b32 v7, 19, v7
  v_mul_u32_u24 v16, 10, v7
  v_sub_u32 v16, v6, v16
  v_lshlrev_b32 v16, 4, v16
  s_movk_i32 s73, 1280
  v_mad_u32_u24 v16, v7, s73, v16
  v_add_u32 v6, 576, v1
  s_mov_b32 s73, 52429
  v_mul_lo_u32 v7, v6, s73
  v_lshrrev_b32 v7, 19, v7
  v_mul_u32_u24 v17, 10, v7
  v_sub_u32 v17, v6, v17
  v_lshlrev_b32 v17, 4, v17
  s_movk_i32 s73, 1280
  v_mad_u32_u24 v17, v7, s73, v17
  v_add_u32 v6, 640, v1
  s_mov_b32 s73, 52429
  v_mul_lo_u32 v7, v6, s73
  v_lshrrev_b32 v7, 19, v7
  v_mul_u32_u24 v18, 10, v7
  v_sub_u32 v18, v6, v18
  v_lshlrev_b32 v18, 4, v18
  s_movk_i32 s73, 1280
  v_mad_u32_u24 v18, v7, s73, v18
  v_add_u32 v6, 704, v1
  s_mov_b32 s73, 52429
  v_mul_lo_u32 v7, v6, s73
  v_lshrrev_b32 v7, 19, v7
  v_mul_u32_u24 v19, 10, v7
  v_sub_u32 v19, v6, v19
  v_lshlrev_b32 v19, 4, v19
  s_movk_i32 s73, 1280
  v_mad_u32_u24 v19, v7, s73, v19
  v_add_u32 v6, 768, v1
  s_mov_b32 s73, 52429
  v_mul_lo_u32 v7, v6, s73
  v_lshrrev_b32 v7, 19, v7
  v_mul_u32_u24 v20, 10, v7
  v_sub_u32 v20, v6, v20
  v_lshlrev_b32 v20, 4, v20
  s_movk_i32 s73, 1280
  v_mad_u32_u24 v20, v7, s73, v20
  v_add_u32 v6, 832, v1
  s_mov_b32 s73, 52429
  v_mul_lo_u32 v7, v6, s73
  v_lshrrev_b32 v7, 19, v7
  v_mul_u32_u24 v21, 10, v7
  v_sub_u32 v21, v6, v21
  v_lshlrev_b32 v21, 4, v21
  s_movk_i32 s73, 1280
  v_mad_u32_u24 v21, v7, s73, v21
  v_add_u32 v6, 896, v1
  s_mov_b32 s73, 52429
  v_mul_lo_u32 v7, v6, s73
  v_lshrrev_b32 v7, 19, v7
  v_mul_u32_u24 v22, 10, v7
  v_sub_u32 v22, v6, v22
  v_lshlrev_b32 v22, 4, v22
  s_movk_i32 s73, 1280
  v_mad_u32_u24 v22, v7, s73, v22
  v_add_u32 v6, 960, v1
  s_mov_b32 s73, 52429
  v_mul_lo_u32 v7, v6, s73
  v_lshrrev_b32 v7, 19, v7
  v_mul_u32_u24 v23, 10, v7
  v_sub_u32 v23, v6, v23
  v_lshlrev_b32 v23, 4, v23
  s_movk_i32 s73, 1280
  v_mad_u32_u24 v23, v7, s73, v23
  v_add_u32 v6, 1024, v1
  s_mov_b32 s73, 52429
  v_mul_lo_u32 v7, v6, s73
  v_lshrrev_b32 v7, 19, v7
  v_mul_u32_u24 v24, 10, v7
  v_sub_u32 v24, v6, v24
  v_lshlrev_b32 v24, 4, v24
  s_movk_i32 s73, 1280
  v_mad_u32_u24 v24, v7, s73, v24
  v_add_u32 v6, 1088, v1
  s_mov_b32 s73, 52429
  v_mul_lo_u32 v7, v6, s73
  v_lshrrev_b32 v7, 19, v7
  v_mul_u32_u24 v25, 10, v7
  v_sub_u32 v25, v6, v25
  v_lshlrev_b32 v25, 4, v25
  s_movk_i32 s73, 1280
  v_mad_u32_u24 v25, v7, s73, v25
  v_add_u32 v6, 1152, v1
  s_mov_b32 s73, 52429
  v_mul_lo_u32 v7, v6, s73
  v_lshrrev_b32 v7, 19, v7
  v_mul_u32_u24 v26, 10, v7
  v_sub_u32 v26, v6, v26
  v_lshlrev_b32 v26, 4, v26
  s_movk_i32 s73, 1280
  v_mad_u32_u24 v26, v7, s73, v26
  v_add_u32 v6, 1216, v1
  s_mov_b32 s73, 52429
  v_mul_lo_u32 v7, v6, s73
  v_lshrrev_b32 v7, 19, v7
  v_mul_u32_u24 v27, 10, v7
  v_sub_u32 v27, v6, v27
  v_lshlrev_b32 v27, 4, v27
  s_movk_i32 s73, 1280
  v_mad_u32_u24 v27, v7, s73, v27
  v_add_u32 v6, 1280, v1
  s_mov_b32 s73, 52429
  v_mul_lo_u32 v7, v6, s73
  v_lshrrev_b32 v7, 19, v7
  v_mul_u32_u24 v28, 10, v7
  v_sub_u32 v28, v6, v28
  v_lshlrev_b32 v28, 4, v28
  s_movk_i32 s73, 1280
  v_mad_u32_u24 v28, v7, s73, v28
  v_add_u32 v6, 1344, v1
  s_mov_b32 s73, 52429
  v_mul_lo_u32 v7, v6, s73
  v_lshrrev_b32 v7, 19, v7
  v_mul_u32_u24 v29, 10, v7
  v_sub_u32 v29, v6, v29
  v_lshlrev_b32 v29, 4, v29
  s_movk_i32 s73, 1280
  v_mad_u32_u24 v29, v7, s73, v29
  v_add_u32 v6, 1408, v1
  s_mov_b32 s73, 52429
  v_mul_lo_u32 v7, v6, s73
  v_lshrrev_b32 v7, 19, v7
  v_mul_u32_u24 v30, 10, v7
  v_sub_u32 v30, v6, v30
  v_lshlrev_b32 v30, 4, v30
  s_movk_i32 s73, 1280
  v_mad_u32_u24 v30, v7, s73, v30
  v_add_u32 v6, 1472, v1
  s_mov_b32 s73, 52429
  v_mul_lo_u32 v7, v6, s73
  v_lshrrev_b32 v7, 19, v7
  v_mul_u32_u24 v31, 10, v7
  v_sub_u32 v31, v6, v31
  v_lshlrev_b32 v31, 4, v31
  s_movk_i32 s73, 1280
  v_mad_u32_u24 v31, v7, s73, v31
  v_add_u32 v6, 1536, v1
  s_mov_b32 s73, 52429
  v_mul_lo_u32 v7, v6, s73
  v_lshrrev_b32 v7, 19, v7
  v_mul_u32_u24 v32, 10, v7
  v_sub_u32 v32, v6, v32
  v_lshlrev_b32 v32, 4, v32
  s_movk_i32 s73, 1280
  v_mad_u32_u24 v32, v7, s73, v32
  v_add_u32 v6, 1600, v1
  s_mov_b32 s73, 52429
  v_mul_lo_u32 v7, v6, s73
  v_lshrrev_b32 v7, 19, v7
  v_mul_u32_u24 v33, 10, v7
  v_sub_u32 v33, v6, v33
  v_lshlrev_b32 v33, 4, v33
  s_movk_i32 s73, 1280
  v_mad_u32_u24 v33, v7, s73, v33
  v_add_u32 v6, 1664, v1
  s_mov_b32 s73, 52429
  v_mul_lo_u32 v7, v6, s73
  v_lshrrev_b32 v7, 19, v7
  v_mul_u32_u24 v34, 10, v7
  v_sub_u32 v34, v6, v34
  v_lshlrev_b32 v34, 4, v34
  s_movk_i32 s73, 1280
  v_mad_u32_u24 v34, v7, s73, v34
  v_add_u32 v6, 1728, v1
  s_mov_b32 s73, 52429
  v_mul_lo_u32 v7, v6, s73
  v_lshrrev_b32 v7, 19, v7
  v_mul_u32_u24 v35, 10, v7
  v_sub_u32 v35, v6, v35
  v_lshlrev_b32 v35, 4, v35
  s_movk_i32 s73, 1280
  v_mad_u32_u24 v35, v7, s73, v35
  v_add_u32 v6, 1792, v1
  s_mov_b32 s73, 52429
  v_mul_lo_u32 v7, v6, s73
  v_lshrrev_b32 v7, 19, v7
  v_mul_u32_u24 v36, 10, v7
  v_sub_u32 v36, v6, v36
  v_lshlrev_b32 v36, 4, v36
  s_movk_i32 s73, 1280
  v_mad_u32_u24 v36, v7, s73, v36
  v_add_u32 v6, 1856, v1
  s_mov_b32 s73, 52429
  v_mul_lo_u32 v7, v6, s73
  v_lshrrev_b32 v7, 19, v7
  v_mul_u32_u24 v37, 10, v7
  v_sub_u32 v37, v6, v37
  v_lshlrev_b32 v37, 4, v37
  s_movk_i32 s73, 1280
  v_mad_u32_u24 v37, v7, s73, v37
  s_mov_b32 s8, s46
  s_and_b32 s9, s47, 0xffff
  s_mov_b32 s10, 7864320
  s_mov_b32 s11, 0x00020000
  s_mul_i32 s74, s36, 245760
  s_mul_i32 s72, s31, 160
  s_add_u32 s74, s74, s72
  s_mul_i32 s72, s29, 30720
  s_add_u32 m0, s72, 0
  s_nop 0
  buffer_load_dwordx4 v8, s[8:11], s74 offen lds
  s_add_u32 m0, s72, 1024
  s_nop 0
  buffer_load_dwordx4 v9, s[8:11], s74 offen lds
  s_add_u32 m0, s72, 2048
  s_nop 0
  buffer_load_dwordx4 v10, s[8:11], s74 offen lds
  s_add_u32 m0, s72, 3072
  s_nop 0
  buffer_load_dwordx4 v11, s[8:11], s74 offen lds
  s_add_u32 m0, s72, 4096
  s_nop 0
  buffer_load_dwordx4 v12, s[8:11], s74 offen lds
  s_add_u32 m0, s72, 5120
  s_nop 0
  buffer_load_dwordx4 v13, s[8:11], s74 offen lds
  s_add_u32 m0, s72, 6144
  s_nop 0
  buffer_load_dwordx4 v14, s[8:11], s74 offen lds
  s_add_u32 m0, s72, 7168
  s_nop 0
  buffer_load_dwordx4 v15, s[8:11], s74 offen lds
  s_add_u32 m0, s72, 8192
  s_nop 0
  buffer_load_dwordx4 v16, s[8:11], s74 offen lds
  s_add_u32 m0, s72, 9216
  s_nop 0
  buffer_load_dwordx4 v17, s[8:11], s74 offen lds
  s_add_u32 m0, s72, 10240
  s_nop 0
  buffer_load_dwordx4 v18, s[8:11], s74 offen lds
  s_add_u32 m0, s72, 11264
  s_nop 0
  buffer_load_dwordx4 v19, s[8:11], s74 offen lds
  s_add_u32 m0, s72, 12288
  s_nop 0
  buffer_load_dwordx4 v20, s[8:11], s74 offen lds
  s_add_u32 m0, s72, 13312
  s_nop 0
  buffer_load_dwordx4 v21, s[8:11], s74 offen lds
  s_add_u32 m0, s72, 14336
  s_nop 0
  buffer_load_dwordx4 v22, s[8:11], s74 offen lds
  s_add_u32 m0, s72, 15360
  s_nop 0
  buffer_load_dwordx4 v23, s[8:11], s74 offen lds
  s_add_u32 m0, s72, 16384
  s_nop 0
  buffer_load_dwordx4 v24, s[8:11], s74 offen lds
  s_add_u32 m0, s72, 17408
  s_nop 0
  buffer_load_dwordx4 v25, s[8:11], s74 offen lds
  s_add_u32 m0, s72, 18432
  s_nop 0
  buffer_load_dwordx4 v26, s[8:11], s74 offen lds
  s_add_u32 m0, s72, 19456
  s_nop 0
  buffer_load_dwordx4 v27, s[8:11], s74 offen lds
  s_add_u32 m0, s72, 20480
  s_nop 0
  buffer_load_dwordx4 v28, s[8:11], s74 offen lds
  s_add_u32 m0, s72, 21504
  s_nop 0
  buffer_load_dwordx4 v29, s[8:11], s74 offen lds
  s_add_u32 m0, s72, 22528
  s_nop 0
  buffer_load_dwordx4 v30, s[8:11], s74 offen lds
  s_add_u32 m0, s72, 23552
  s_nop 0
  buffer_load_dwordx4 v31, s[8:11], s74 offen lds
  s_add_u32 m0, s72, 24576
  s_nop 0
  buffer_load_dwordx4 v32, s[8:11], s74 offen lds
  s_add_u32 m0, s72, 25600
  s_nop 0
  buffer_load_dwordx4 v33, s[8:11], s74 offen lds
  s_add_u32 m0, s72, 26624
  s_nop 0
  buffer_load_dwordx4 v34, s[8:11], s74 offen lds
  s_add_u32 m0, s72, 27648
  s_nop 0
  buffer_load_dwordx4 v35, s[8:11], s74 offen lds
  s_add_u32 m0, s72, 28672
  s_nop 0
  buffer_load_dwordx4 v36, s[8:11], s74 offen lds
  s_add_u32 m0, s72, 29696
  s_nop 0
  buffer_load_dwordx4 v37, s[8:11], s74 offen lds
  v_lshrrev_b32 v4, 2, v2
  v_and_b32 v5, 3, v2
  v_lshl_add_u32 v6, v3, 2, v4
  v_mul_u32_u24 v40, 160, v6
  v_lshl_add_u32 v40, v5, 3, v40
  v_add_u32 v40, s72, v40
  s_waitcnt vmcnt(0)
  ds_read_b64_tr_b16 a[0:1], v40 offset:0
  ds_read_b64_tr_b16 a[2:3], v40 offset:2560
  ds_read_b64_tr_b16 a[4:5], v40 offset:5120
  ds_read_b64_tr_b16 a[6:7], v40 offset:7680
  ds_read_b64_tr_b16 a[8:9], v40 offset:10240
  ds_read_b64_tr_b16 a[10:11], v40 offset:12800
  ds_read_b64_tr_b16 a[12:13], v40 offset:15360
  ds_read_b64_tr_b16 a[14:15], v40 offset:17920
  ds_read_b64_tr_b16 a[16:17], v40 offset:20480
  ds_read_b64_tr_b16 a[18:19], v40 offset:23040
  ds_read_b64_tr_b16 a[20:21], v40 offset:25600
  ds_read_b64_tr_b16 a[22:23], v40 offset:28160
  s_waitcnt lgkmcnt(0)
  ds_read_b64_tr_b16 a[30:31], v40 offset:32
  ds_read_b64_tr_b16 a[32:33], v40 offset:2592
  ds_read_b64_tr_b16 a[34:35], v40 offset:5152
  ds_read_b64_tr_b16 a[36:37], v40 offset:7712
  ds_read_b64_tr_b16 a[38:39], v40 offset:10272
  ds_read_b64_tr_b16 a[40:41], v40 offset:12832
  ds_read_b64_tr_b16 a[42:43], v40 offset:15392
  ds_read_b64_tr_b16 a[44:45], v40 offset:17952
  ds_read_b64_tr_b16 a[46:47], v40 offset:20512
  ds_read_b64_tr_b16 a[48:49], v40 offset:23072
  ds_read_b64_tr_b16 a[50:51], v40 offset:25632
  ds_read_b64_tr_b16 a[52:53], v40 offset:28192
  s_waitcnt lgkmcnt(0)
  ds_read_b64_tr_b16 a[60:61], v40 offset:64
  ds_read_b64_tr_b16 a[62:63], v40 offset:2624
  ds_read_b64_tr_b16 a[64:65], v40 offset:5184
  ds_read_b64_tr_b16 a[66:67], v40 offset:7744
  ds_read_b64_tr_b16 a[68:69], v40 offset:10304
  ds_read_b64_tr_b16 a[70:71], v40 offset:12864
  ds_read_b64_tr_b16 a[72:73], v40 offset:15424
  ds_read_b64_tr_b16 a[74:75], v40 offset:17984
  ds_read_b64_tr_b16 a[76:77], v40 offset:20544
  ds_read_b64_tr_b16 a[78:79], v40 offset:23104
  ds_read_b64_tr_b16 a[80:81], v40 offset:25664
  ds_read_b64_tr_b16 a[82:83], v40 offset:28224
  s_waitcnt lgkmcnt(0)
  ds_read_b64_tr_b16 a[90:91], v40 offset:96
  ds_read_b64_tr_b16 a[92:93], v40 offset:2656
  ds_read_b64_tr_b16 a[94:95], v40 offset:5216
  ds_read_b64_tr_b16 a[96:97], v40 offset:7776
  ds_read_b64_tr_b16 a[98:99], v40 offset:10336
  ds_read_b64_tr_b16 a[100:101], v40 offset:12896
  ds_read_b64_tr_b16 a[102:103], v40 offset:15456
  ds_read_b64_tr_b16 a[104:105], v40 offset:18016
  ds_read_b64_tr_b16 a[106:107], v40 offset:20576
  ds_read_b64_tr_b16 a[108:109], v40 offset:23136
  ds_read_b64_tr_b16 a[110:111], v40 offset:25696
  ds_read_b64_tr_b16 a[112:113], v40 offset:28256
  s_waitcnt lgkmcnt(0)
  ds_read_b64_tr_b16 a[120:121], v40 offset:128
  ds_read_b64_tr_b16 a[122:123], v40 offset:2688
  ds_read_b64_tr_b16 a[124:125], v40 offset:5248
  ds_read_b64_tr_b16 a[126:127], v40 offset:7808
  ds_read_b64_tr_b16 a[128:129], v40 offset:10368
  ds_read_b64_tr_b16 a[130:131], v40 offset:12928
  ds_read_b64_tr_b16 a[132:133], v40 offset:15488
  ds_read_b64_tr_b16 a[134:135], v40 offset:18048
  ds_read_b64_tr_b16 a[136:137], v40 offset:20608
  ds_read_b64_tr_b16 a[138:139], v40 offset:23168
  ds_read_b64_tr_b16 a[140:141], v40 offset:25728
  ds_read_b64_tr_b16 a[142:143], v40 offset:28288
  s_waitcnt lgkmcnt(0)
  s_mov_b32 s8, s56
  s_and_b32 s9, s57, 0xffff
  s_mov_b32 s10, 1966080
  s_mul_i32 s74, s36, 61440
  s_mul_i32 s73, s31, 160
  s_add_u32 s74, s74, s73
  s_add_u32 m0, s72, 0
  s_nop 0
  buffer_load_dwordx4 v8, s[8:11], s74 offen lds
  s_add_u32 m0, s72, 1024
  s_nop 0
  buffer_load_dwordx4 v9, s[8:11], s74 offen lds
  s_add_u32 m0, s72, 2048
  s_nop 0
  buffer_load_dwordx4 v10, s[8:11], s74 offen lds
  s_add_u32 m0, s72, 3072
  s_nop 0
  buffer_load_dwordx4 v11, s[8:11], s74 offen lds
  s_add_u32 m0, s72, 4096
  s_nop 0
  buffer_load_dwordx4 v12, s[8:11], s74 offen lds
  s_add_u32 m0, s72, 5120
  s_nop 0
  buffer_load_dwordx4 v13, s[8:11], s74 offen lds
  s_add_u32 m0, s72, 6144
  s_nop 0
  buffer_load_dwordx4 v14, s[8:11], s74 offen lds
  s_add_u32 m0, s72, 7168
  s_nop 0
  buffer_load_dwordx4 v15, s[8:11], s74 offen lds
  s_waitcnt vmcnt(0)
  ds_read_b64_tr_b16 a[24:25], v40 offset:0
  ds_read_b64_tr_b16 a[26:27], v40 offset:2560
  ds_read_b64_tr_b16 a[28:29], v40 offset:5120
  ds_read_b64_tr_b16 a[54:55], v40 offset:32
  ds_read_b64_tr_b16 a[56:57], v40 offset:2592
  ds_read_b64_tr_b16 a[58:59], v40 offset:5152
  ds_read_b64_tr_b16 a[84:85], v40 offset:64
  ds_read_b64_tr_b16 a[86:87], v40 offset:2624
  ds_read_b64_tr_b16 a[88:89], v40 offset:5184
  ds_read_b64_tr_b16 a[114:115], v40 offset:96
  ds_read_b64_tr_b16 a[116:117], v40 offset:2656
  ds_read_b64_tr_b16 a[118:119], v40 offset:5216
  ds_read_b64_tr_b16 a[144:145], v40 offset:128
  ds_read_b64_tr_b16 a[146:147], v40 offset:2688
  ds_read_b64_tr_b16 a[148:149], v40 offset:5248
  s_waitcnt lgkmcnt(0)
  s_barrier
  v_mov_b32 v216, 0x80000000
  v_mov_b32 v217, 1
  v_lshlrev_b32 v200, 4, v1
  v_lshlrev_b32 v201, 3, v1
  s_mul_i32 s72, s34, 3072
  v_add_u32 v202, s72, v200
  v_add_u32 v204, 6144, v200
  s_mul_i32 s72, s29, 3072
  v_add_u32 v205, s72, v200
  s_xor_b32 s72, s29, 2
  s_mul_i32 s72, s72, 3072
  v_add_u32 v206, s72, v200
  v_and_b32 v207, 15, v1
  v_lshlrev_b32 v207, 2, v207
  v_and_b32 v208, 7, v1
  v_lshlrev_b32 v208, 2, v208
  v_and_b32 v209, 31, v1
  v_lshlrev_b32 v209, 2, v209
  v_cmp_eq_u32 vcc, 0, v1
  v_mov_b32 v4, 0
  v_cndmask_b32 v210, v216, v4, vcc
  s_mul_i32 s72, s29, 10240
  s_add_u32 s72, s72, 24576
  v_add_u32 v212, s72, v200
  s_lshl_b32 s72, s29, 10
  s_add_u32 s72, s72, 24576
  v_add_u32 v213, s72, v200
  s_lshl_b32 s72, s32, 4
  v_add_u32 v6, s72, v2
  s_movk_i32 s73, 1280
  v_mul_lo_u32 v214, v6, s73
  s_mul_i32 s72, s31, 160
  s_lshl_b32 s73, s29, 5
  s_add_u32 s72, s72, s73
  v_lshl_add_u32 v215, v3, 3, s72
  v_add_u32 v214, v214, v215
  s_mov_b32 s8, s58
  s_and_b32 s9, s59, 0xffff
  s_mov_b32 s10, 1280
  buffer_load_dwordx2 v[8:9], v215, s[8:11], 0 offen
  s_mul_i32 s72, s31, 160
  s_add_u32 s72, s72, 128
  v_lshlrev_b32 v6, 3, v3
  buffer_load_dwordx2 v[10:11], v6, s[8:11], s72 offen
  s_waitcnt vmcnt(0)
  v_lshlrev_b32 v218, 16, v8
  v_and_b32 v219, 0xffff0000, v8
  v_lshlrev_b32 v220, 16, v9
  v_and_b32 v221, 0xffff0000, v9
  v_lshlrev_b32 v222, 16, v10
  v_and_b32 v223, 0xffff0000, v10
  v_lshlrev_b32 v224, 16, v11
  v_and_b32 v225, 0xffff0000, v11
  v_mov_b32 v6, 0
  v_mov_b32 v7, 0xf149f2ca
  v_cmp_gt_u32 vcc, 2, v3
  s_nop 1
  v_cndmask_b32 v188, v6, v7, vcc
  v_cndmask_b32 v189, v6, v7, vcc
  v_cndmask_b32 v190, v6, v7, vcc
  v_cndmask_b32 v191, v6, v7, vcc
  s_cmp_eq_u32 s33, 0
  s_cselect_b64 s[74:75], -1, 0
  v_lshl_add_u32 v4, v3, 2, 0
  v_cmp_gt_u32 vcc, v4, v2
  s_nop 1
  v_cndmask_b32 v5, v6, v7, vcc
  v_cndmask_b32 v192, v6, v5, s[74:75]
  v_cndmask_b32 v196, v5, v7, s[74:75]
  v_lshl_add_u32 v4, v3, 2, 1
  v_cmp_gt_u32 vcc, v4, v2
  s_nop 1
  v_cndmask_b32 v5, v6, v7, vcc
  v_cndmask_b32 v193, v6, v5, s[74:75]
  v_cndmask_b32 v197, v5, v7, s[74:75]
  v_lshl_add_u32 v4, v3, 2, 2
  v_cmp_gt_u32 vcc, v4, v2
  s_nop 1
  v_cndmask_b32 v5, v6, v7, vcc
  v_cndmask_b32 v194, v6, v5, s[74:75]
  v_cndmask_b32 v198, v5, v7, s[74:75]
  v_lshl_add_u32 v4, v3, 2, 3
  v_cmp_gt_u32 vcc, v4, v2
  s_nop 1
  v_cndmask_b32 v5, v6, v7, vcc
  v_cndmask_b32 v195, v6, v5, s[74:75]
  v_cndmask_b32 v199, v5, v7, s[74:75]
  s_mov_b32 s30, 0
  s_mov_b32 s66, 0
  s_mov_b32 s67, 0
L_p2loop_sx:
  s_cmp_ge_u32 s30, 64
  s_cbranch_scc1 L_noat_sx
  s_and_b32 s72, s30, 3
  s_cmp_lg_u32 s72, s27
  s_cbranch_scc1 L_noat_sx
  s_lshl_b32 s37, s28, 6
  s_add_u32 s37, s37, s30
  s_lshl_b32 s72, s37, 6
  s_add_u32 s38, s72, 108068864
L_wfkv_1_sx:
  buffer_load_dword v4, v207, s[4:7], s38 offen sc1
  s_waitcnt vmcnt(0)
  s_cmp_eq_u32 s66, 0
  s_cbranch_scc1 L_fl_3_sx
  buffer_store_dword v217, v210, s[4:7], s66 offen sc1
  s_mov_b32 s66, 0
L_fl_3_sx:
  s_cmp_eq_u32 s67, 0
  s_cbranch_scc1 L_fl_4_sx
  buffer_store_dword v217, v210, s[4:7], s67 offen sc1
  buffer_store_dword v217, v210, s[4:7], s67 offen offset:2048 sc1
  s_mov_b32 s67, 0
L_fl_4_sx:
  v_cmp_eq_u32 vcc, 0, v4
  s_cbranch_vccz L_wkkv_2_sx
  s_add_u32 s71, s71, 1
  s_cmp_gt_u32 s71, 1600000
  s_cbranch_scc1 L_p2done_sx
  s_sleep 6
  s_branch L_wfkv_1_sx
L_wkkv_2_sx:
  s_lshl_b32 s72, s37, 6
  s_add_u32 s38, s72, 108363776
L_wfh_5_sx:
  buffer_load_dword v4, v207, s[4:7], s38 offen sc1
  s_waitcnt vmcnt(0)
  s_cmp_eq_u32 s66, 0
  s_cbranch_scc1 L_fl_7_sx
  buffer_store_dword v217, v210, s[4:7], s66 offen sc1
  s_mov_b32 s66, 0
L_fl_7_sx:
  s_cmp_eq_u32 s67, 0
  s_cbranch_scc1 L_fl_8_sx
  buffer_store_dword v217, v210, s[4:7], s67 offen sc1
  buffer_store_dword v217, v210, s[4:7], s67 offen offset:2048 sc1
  s_mov_b32 s67, 0
L_fl_8_sx:
  v_cmp_eq_u32 vcc, 0, v4
  s_cbranch_vccz L_wkh_6_sx
  s_add_u32 s71, s71, 1
  s_cmp_gt_u32 s71, 1600000
  s_cbranch_scc1 L_p2done_sx
  s_sleep 6
  s_branch L_wfh_5_sx
L_wkh_6_sx:
  s_mul_i32 s72, s34, 3072
  s_mul_i32 s38, s37, 12288
  s_mul_i32 s73, s33, 6144
  s_add_u32 s38, s38, s73
  s_add_u32 s38, s38, s72
  s_add_u32 s38, s38, 2621440
  s_mul_i32 s39, s37, 24576
  s_add_u32 s39, s39, 27787264
  s_add_u32 s64, s39, s72
  s_mul_i32 s73, s30, 294912
  s_mul_i32 s74, s28, 9216
  s_add_u32 s73, s73, s74
  s_add_u32 s73, s73, 84410368
  buffer_load_dwordx4 v[8:11], v200, s[4:7], s38 offen offset:0 sc1
  buffer_load_dwordx4 v[12:15], v200, s[4:7], s38 offen offset:1024 sc1
  buffer_load_dwordx4 v[16:19], v200, s[4:7], s38 offen offset:2048 sc1
  buffer_load_dwordx4 v[228:231], v200, s[4:7], s64 offen offset:0 sc1
  buffer_load_dwordx4 v[232:235], v200, s[4:7], s64 offen offset:1024 sc1
  buffer_load_dwordx4 v[236:239], v200, s[4:7], s64 offen offset:2048 sc1
  s_add_u32 s64, s64, 6144
  buffer_load_dwordx4 v[240:243], v200, s[4:7], s64 offen offset:0 sc1
  buffer_load_dwordx4 v[244:247], v200, s[4:7], s64 offen offset:1024 sc1
  buffer_load_dwordx4 v[248:251], v200, s[4:7], s64 offen offset:2048 sc1
  buffer_load_dwordx4 v[20:23], v202, s[4:7], s73 offen offset:0 sc1
  buffer_load_dwordx4 v[24:27], v202, s[4:7], s73 offen offset:1024 sc1
  buffer_load_dwordx4 v[28:31], v202, s[4:7], s73 offen offset:2048 sc1
  buffer_load_dwordx4 v[36:39], v204, s[4:7], s73 offen offset:0 sc1
  buffer_load_dwordx4 v[40:43], v204, s[4:7], s73 offen offset:1024 sc1
  buffer_load_dwordx4 v[44:47], v204, s[4:7], s73 offen offset:2048 sc1
  s_mul_i32 s72, s34, 6144
  s_add_u32 s39, s39, s72
  s_add_u32 s39, s39, 12288
  s_add_u32 s72, s39, 4096
  buffer_load_dwordx4 v[52:55], v200, s[4:7], s39 offen offset:0 sc1
  buffer_load_dwordx4 v[56:59], v200, s[4:7], s39 offen offset:1024 sc1
  buffer_load_dwordx4 v[60:63], v200, s[4:7], s39 offen offset:2048 sc1
  buffer_load_dwordx4 v[64:67], v200, s[4:7], s39 offen offset:3072 sc1
  buffer_load_dwordx4 v[68:71], v200, s[4:7], s72 offen offset:0 sc1
  buffer_load_dwordx4 v[72:75], v200, s[4:7], s72 offen offset:1024 sc1
  s_waitcnt vmcnt(9)
  v_mfma_f32_16x16x32_bf16 v[76:79], v[20:23], v[8:11], v[188:191]
  v_mfma_f32_16x16x32_bf16 v[80:83], v[228:231], v[8:11], v[192:195]
  v_mfma_f32_16x16x32_bf16 v[84:87], v[240:243], v[8:11], v[196:199]
  v_mfma_f32_16x16x32_bf16 v[76:79], v[24:27], v[12:15], v[76:79]
  v_mfma_f32_16x16x32_bf16 v[80:83], v[232:235], v[12:15], v[80:83]
  v_mfma_f32_16x16x32_bf16 v[84:87], v[244:247], v[12:15], v[84:87]
  v_mfma_f32_16x16x32_bf16 v[76:79], v[28:31], v[16:19], v[76:79]
  v_mfma_f32_16x16x32_bf16 v[80:83], v[236:239], v[16:19], v[80:83]
  v_mfma_f32_16x16x32_bf16 v[84:87], v[248:251], v[16:19], v[84:87]
  s_nop 7
  ds_write_b128 v205, v[76:79] offset:0
  ds_write_b128 v205, v[80:83] offset:1024
  ds_write_b128 v205, v[84:87] offset:2048
  s_waitcnt lgkmcnt(0)
  s_barrier
  ds_read_b128 v[96:99], v206 offset:0
  ds_read_b128 v[100:103], v206 offset:1024
  ds_read_b128 v[104:107], v206 offset:2048
  s_waitcnt lgkmcnt(0)
  v_pk_add_f32 v[96:97], v[96:97], v[76:77]
  v_pk_add_f32 v[98:99], v[98:99], v[78:79]
  v_pk_add_f32 v[100:101], v[100:101], v[80:81]
  v_pk_add_f32 v[102:103], v[102:103], v[82:83]
  v_pk_add_f32 v[104:105], v[104:105], v[84:85]
  v_pk_add_f32 v[106:107], v[106:107], v[86:87]
  v_max3_f32 v4, v96, v97, v98
  v_max3_f32 v5, v99, v100, v101
  v_max3_f32 v6, v102, v103, v104
  v_max3_f32 v7, v105, v106, v107
  v_max3_f32 v4, v4, v5, v6
  v_max_f32 v4, v4, v7
  v_mov_b32 v5, v4
  s_nop 1
  v_permlane32_swap_b32 v4, v5
  v_max_f32 v4, v4, v5
  v_mov_b32 v5, v4
  s_nop 1
  v_permlane16_swap_b32 v4, v5
  v_max_f32 v4, v4, v5
  v_mul_f32 v4, s35, v4
  v_fma_f32 v76, v96, s35, -v4
  v_fma_f32 v77, v97, s35, -v4
  v_fma_f32 v78, v98, s35, -v4
  v_fma_f32 v79, v99, s35, -v4
  v_fma_f32 v80, v100, s35, -v4
  v_fma_f32 v81, v101, s35, -v4
  v_fma_f32 v82, v102, s35, -v4
  v_fma_f32 v83, v103, s35, -v4
  v_fma_f32 v84, v104, s35, -v4
  v_fma_f32 v85, v105, s35, -v4
  v_fma_f32 v86, v106, s35, -v4
  v_fma_f32 v87, v107, s35, -v4
  v_exp_f32 v76, v76
  v_exp_f32 v77, v77
  v_exp_f32 v78, v78
  v_exp_f32 v79, v79
  v_exp_f32 v80, v80
  v_exp_f32 v81, v81
  v_exp_f32 v82, v82
  v_exp_f32 v83, v83
  v_exp_f32 v84, v84
  v_exp_f32 v85, v85
  v_exp_f32 v86, v86
  v_exp_f32 v87, v87
  s_nop 0
  v_pk_add_f32 v[96:97], v[76:77], v[78:79]
  v_pk_add_f32 v[98:99], v[80:81], v[82:83]
  v_pk_add_f32 v[100:101], v[84:85], v[86:87]
  v_pk_add_f32 v[96:97], v[96:97], v[98:99]
  v_pk_add_f32 v[96:97], v[96:97], v[100:101]
  v_add_f32 v4, v96, v97
  v_mov_b32 v5, v4
  s_nop 1
  v_permlane32_swap_b32 v4, v5
  v_add_f32 v4, v4, v5
  v_mov_b32 v5, v4
  s_nop 1
  v_permlane16_swap_b32 v4, v5
  v_add_f32 v4, v4, v5
  v_rcp_f32 v4, v4
  s_nop 0
  v_mov_b32 v5, v4
  v_pk_mul_f32 v[76:77], v[76:77], v[4:5]
  v_pk_mul_f32 v[78:79], v[78:79], v[4:5]
  v_pk_mul_f32 v[80:81], v[80:81], v[4:5]
  v_pk_mul_f32 v[82:83], v[82:83], v[4:5]
  v_pk_mul_f32 v[84:85], v[84:85], v[4:5]
  v_pk_mul_f32 v[86:87], v[86:87], v[4:5]
  v_cvt_pk_bf16_f32 v144, v76, v77
  v_cvt_pk_bf16_f32 v145, v78, v79
  v_cvt_pk_bf16_f32 v146, v80, v81
  v_cvt_pk_bf16_f32 v147, v82, v83
  v_cvt_pk_bf16_f32 v148, v84, v85
  v_cvt_pk_bf16_f32 v149, v86, v87
  v_mov_b32 v48, 0
  v_mov_b32 v49, 0
  v_mov_b32 v4, v144
  v_mov_b32 v5, v145
  s_nop 1
  v_permlane32_swap_b32 v4, v48
  v_permlane32_swap_b32 v5, v49
  s_waitcnt vmcnt(0)
  s_nop 1
  v_mfma_f32_16x16x32_bf16 v[152:155], v[52:55], v[146:149], 0
  v_mfma_f32_16x16x32_bf16 v[156:159], v[56:59], v[146:149], 0
  v_mfma_f32_16x16x32_bf16 v[160:163], v[60:63], v[146:149], 0
  v_mfma_f32_16x16x32_bf16 v[164:167], v[64:67], v[146:149], 0
  v_mfma_f32_16x16x32_bf16 v[168:171], v[68:71], v[146:149], 0
  v_mfma_f32_16x16x32_bf16 v[172:175], v[72:75], v[146:149], 0
  s_cmp_eq_u32 s34, 1
  s_cbranch_scc1 L_pvh1_sx
  v_mfma_f32_16x16x16_bf16 v[152:155], v[36:37], v[144:145], v[152:155]
  v_mfma_f32_16x16x16_bf16 v[156:159], v[36:37], v[48:49], v[156:159]
  v_mfma_f32_16x16x16_bf16 v[160:163], v[38:39], v[144:145], v[160:163]
  v_mfma_f32_16x16x16_bf16 v[164:167], v[38:39], v[48:49], v[164:167]
  v_mfma_f32_16x16x16_bf16 v[168:171], v[40:41], v[144:145], v[168:171]
  v_mfma_f32_16x16x16_bf16 v[172:175], v[40:41], v[48:49], v[172:175]
  s_branch L_pvd_sx
L_pvh1_sx:
  v_mfma_f32_16x16x16_bf16 v[152:155], v[42:43], v[144:145], v[152:155]
  v_mfma_f32_16x16x16_bf16 v[156:159], v[42:43], v[48:49], v[156:159]
  v_mfma_f32_16x16x16_bf16 v[160:163], v[44:45], v[144:145], v[160:163]
  v_mfma_f32_16x16x16_bf16 v[164:167], v[44:45], v[48:49], v[164:167]
  v_mfma_f32_16x16x16_bf16 v[168:171], v[46:47], v[144:145], v[168:171]
  v_mfma_f32_16x16x16_bf16 v[172:175], v[46:47], v[48:49], v[172:175]
L_pvd_sx:
  s_nop 7
  v_cvt_pk_bf16_f32 v176, v152, v153
  v_cvt_pk_bf16_f32 v177, v154, v155
  v_cvt_pk_bf16_f32 v178, v156, v157
  v_cvt_pk_bf16_f32 v179, v158, v159
  v_cvt_pk_bf16_f32 v180, v160, v161
  v_cvt_pk_bf16_f32 v181, v162, v163
  v_cvt_pk_bf16_f32 v182, v164, v165
  v_cvt_pk_bf16_f32 v183, v166, v167
  v_cvt_pk_bf16_f32 v184, v168, v169
  v_cvt_pk_bf16_f32 v185, v170, v171
  v_cvt_pk_bf16_f32 v186, v172, v173
  v_cvt_pk_bf16_f32 v187, v174, v175
  s_lshl_b32 s72, s37, 1
  s_add_u32 s72, s72, s33
  s_mul_i32 s72, s72, 6144
  s_add_u32 s72, s72, 109117440
  s_mul_i32 s73, s34, 3072
  s_add_u32 s73, s73, s72
  buffer_store_dwordx4 v[176:179], v200, s[4:7], s73 offen offset:0 sc1
  buffer_store_dwordx4 v[180:183], v200, s[4:7], s73 offen offset:1024 sc1
  buffer_store_dwordx4 v[184:187], v200, s[4:7], s73 offen offset:2048 sc1
  s_lshl_b32 s72, s37, 4
  s_lshl_b32 s73, s29, 2
  s_add_u32 s72, s72, s73
  s_add_u32 s66, s72, 108331008
  s_barrier
L_noat_sx:
  s_and_b32 s72, s30, 1
  s_cmp_eq_u32 s72, 1
  s_cbranch_scc1 L_nog2_sx
  s_cmp_lt_u32 s30, 6
  s_cbranch_scc1 L_nog2_sx
  s_cmp_gt_u32 s30, 68
  s_cbranch_scc1 L_nog2_sx
  s_sub_u32 s64, s30, 6
  s_lshl_b32 s37, s36, 6
  s_add_u32 s37, s37, s64
  s_lshl_b32 s72, s37, 4
  s_add_u32 s38, s72, 108331008
L_wfat_9_sx:
  buffer_load_dword v4, v208, s[4:7], s38 offen sc1
  s_waitcnt vmcnt(0)
  s_cmp_eq_u32 s66, 0
  s_cbranch_scc1 L_fl_11_sx
  buffer_store_dword v217, v210, s[4:7], s66 offen sc1
  s_mov_b32 s66, 0
L_fl_11_sx:
  s_cmp_eq_u32 s67, 0
  s_cbranch_scc1 L_fl_12_sx
  buffer_store_dword v217, v210, s[4:7], s67 offen sc1
  buffer_store_dword v217, v210, s[4:7], s67 offen offset:2048 sc1
  s_mov_b32 s67, 0
L_fl_12_sx:
  v_cmp_eq_u32 vcc, 0, v4
  s_cbranch_vccz L_wkat_10_sx
  s_add_u32 s71, s71, 1
  s_cmp_gt_u32 s71, 1600000
  s_cbranch_scc1 L_p2done_sx
  s_sleep 6
  s_branch L_wfat_9_sx
L_wkat_10_sx:
  s_lshl_b32 s72, s37, 1
  s_add_u32 s72, s72, s32
  s_mul_i32 s38, s72, 6144
  s_add_u32 s38, s38, 109117440
  s_mul_i32 s73, s72, 1536
  s_add_u32 s73, s73, 78118912
  s_add_u32 s39, s38, 4096
  buffer_load_dwordx4 v[8:11], v200, s[4:7], s38 offen offset:0 sc1
  buffer_load_dwordx4 v[12:15], v200, s[4:7], s38 offen offset:1024 sc1
  buffer_load_dwordx4 v[16:19], v200, s[4:7], s38 offen offset:2048 sc1
  buffer_load_dwordx4 v[20:23], v200, s[4:7], s38 offen offset:3072 sc1
  buffer_load_dwordx4 v[24:27], v200, s[4:7], s39 offen offset:0 sc1
  buffer_load_dwordx4 v[28:31], v200, s[4:7], s39 offen offset:1024 sc1
  buffer_load_dwordx4 v[32:35], v200, s[4:7], s73 offen sc1
  buffer_load_dwordx2 v[36:37], v201, s[4:7], s73 offen offset:1024 sc1
  s_add_u32 s38, s38, 12288
  s_add_u32 s73, s73, 3072
  s_add_u32 s39, s38, 4096
  buffer_load_dwordx4 v[80:83], v200, s[4:7], s38 offen offset:0 sc1
  buffer_load_dwordx4 v[84:87], v200, s[4:7], s38 offen offset:1024 sc1
  buffer_load_dwordx4 v[88:91], v200, s[4:7], s38 offen offset:2048 sc1
  buffer_load_dwordx4 v[92:95], v200, s[4:7], s38 offen offset:3072 sc1
  buffer_load_dwordx4 v[96:99], v200, s[4:7], s39 offen offset:0 sc1
  buffer_load_dwordx4 v[100:103], v200, s[4:7], s39 offen offset:1024 sc1
  buffer_load_dwordx4 v[104:107], v200, s[4:7], s73 offen sc1
  buffer_load_dwordx2 v[108:109], v201, s[4:7], s73 offen offset:1024 sc1
  s_waitcnt vmcnt(8)
  v_mfma_f32_16x16x32_bf16 v[40:43], a[0:3], v[8:11], 0
  v_mfma_f32_16x16x32_bf16 v[44:47], a[30:33], v[8:11], 0
  v_mfma_f32_16x16x32_bf16 v[48:51], a[60:63], v[8:11], 0
  v_mfma_f32_16x16x32_bf16 v[52:55], a[90:93], v[8:11], 0
  v_mfma_f32_16x16x32_bf16 v[56:59], a[120:123], v[8:11], 0
  v_mfma_f32_16x16x32_bf16 v[40:43], a[4:7], v[12:15], v[40:43]
  v_mfma_f32_16x16x32_bf16 v[44:47], a[34:37], v[12:15], v[44:47]
  v_mfma_f32_16x16x32_bf16 v[48:51], a[64:67], v[12:15], v[48:51]
  v_mfma_f32_16x16x32_bf16 v[52:55], a[94:97], v[12:15], v[52:55]
  v_mfma_f32_16x16x32_bf16 v[56:59], a[124:127], v[12:15], v[56:59]
  v_mfma_f32_16x16x32_bf16 v[40:43], a[8:11], v[16:19], v[40:43]
  v_mfma_f32_16x16x32_bf16 v[44:47], a[38:41], v[16:19], v[44:47]
  v_mfma_f32_16x16x32_bf16 v[48:51], a[68:71], v[16:19], v[48:51]
  v_mfma_f32_16x16x32_bf16 v[52:55], a[98:101], v[16:19], v[52:55]
  v_mfma_f32_16x16x32_bf16 v[56:59], a[128:131], v[16:19], v[56:59]
  v_mfma_f32_16x16x32_bf16 v[40:43], a[12:15], v[20:23], v[40:43]
  v_mfma_f32_16x16x32_bf16 v[44:47], a[42:45], v[20:23], v[44:47]
  v_mfma_f32_16x16x32_bf16 v[48:51], a[72:75], v[20:23], v[48:51]
  v_mfma_f32_16x16x32_bf16 v[52:55], a[102:105], v[20:23], v[52:55]
  v_mfma_f32_16x16x32_bf16 v[56:59], a[132:135], v[20:23], v[56:59]
  v_mfma_f32_16x16x32_bf16 v[40:43], a[16:19], v[24:27], v[40:43]
  v_mfma_f32_16x16x32_bf16 v[44:47], a[46:49], v[24:27], v[44:47]
  v_mfma_f32_16x16x32_bf16 v[48:51], a[76:79], v[24:27], v[48:51]
  v_mfma_f32_16x16x32_bf16 v[52:55], a[106:109], v[24:27], v[52:55]
  v_mfma_f32_16x16x32_bf16 v[56:59], a[136:139], v[24:27], v[56:59]
  v_mfma_f32_16x16x32_bf16 v[40:43], a[20:23], v[28:31], v[40:43]
  v_mfma_f32_16x16x32_bf16 v[44:47], a[50:53], v[28:31], v[44:47]
  v_mfma_f32_16x16x32_bf16 v[48:51], a[80:83], v[28:31], v[48:51]
  v_mfma_f32_16x16x32_bf16 v[52:55], a[110:113], v[28:31], v[52:55]
  v_mfma_f32_16x16x32_bf16 v[56:59], a[140:143], v[28:31], v[56:59]
  v_mfma_f32_16x16x32_bf16 v[40:43], a[24:27], v[32:35], v[40:43]
  v_mfma_f32_16x16x32_bf16 v[44:47], a[54:57], v[32:35], v[44:47]
  v_mfma_f32_16x16x32_bf16 v[48:51], a[84:87], v[32:35], v[48:51]
  v_mfma_f32_16x16x32_bf16 v[52:55], a[114:117], v[32:35], v[52:55]
  v_mfma_f32_16x16x32_bf16 v[56:59], a[144:147], v[32:35], v[56:59]
  v_mfma_f32_16x16x16_bf16 v[40:43], a[28:29], v[36:37], v[40:43]
  v_mfma_f32_16x16x16_bf16 v[44:47], a[58:59], v[36:37], v[44:47]
  v_mfma_f32_16x16x16_bf16 v[48:51], a[88:89], v[36:37], v[48:51]
  v_mfma_f32_16x16x16_bf16 v[52:55], a[118:119], v[36:37], v[52:55]
  v_mfma_f32_16x16x16_bf16 v[56:59], a[148:149], v[36:37], v[56:59]
  s_waitcnt vmcnt(0)
  v_mfma_f32_16x16x32_bf16 v[60:63], a[0:3], v[80:83], 0
  v_mfma_f32_16x16x32_bf16 v[64:67], a[30:33], v[80:83], 0
  v_mfma_f32_16x16x32_bf16 v[68:71], a[60:63], v[80:83], 0
  v_mfma_f32_16x16x32_bf16 v[72:75], a[90:93], v[80:83], 0
  v_mfma_f32_16x16x32_bf16 v[76:79], a[120:123], v[80:83], 0
  v_mfma_f32_16x16x32_bf16 v[60:63], a[4:7], v[84:87], v[60:63]
  v_mfma_f32_16x16x32_bf16 v[64:67], a[34:37], v[84:87], v[64:67]
  v_mfma_f32_16x16x32_bf16 v[68:71], a[64:67], v[84:87], v[68:71]
  v_mfma_f32_16x16x32_bf16 v[72:75], a[94:97], v[84:87], v[72:75]
  v_mfma_f32_16x16x32_bf16 v[76:79], a[124:127], v[84:87], v[76:79]
  v_mfma_f32_16x16x32_bf16 v[60:63], a[8:11], v[88:91], v[60:63]
  v_mfma_f32_16x16x32_bf16 v[64:67], a[38:41], v[88:91], v[64:67]
  v_mfma_f32_16x16x32_bf16 v[68:71], a[68:71], v[88:91], v[68:71]
  v_mfma_f32_16x16x32_bf16 v[72:75], a[98:101], v[88:91], v[72:75]
  v_mfma_f32_16x16x32_bf16 v[76:79], a[128:131], v[88:91], v[76:79]
  v_mfma_f32_16x16x32_bf16 v[60:63], a[12:15], v[92:95], v[60:63]
  v_mfma_f32_16x16x32_bf16 v[64:67], a[42:45], v[92:95], v[64:67]
  v_mfma_f32_16x16x32_bf16 v[68:71], a[72:75], v[92:95], v[68:71]
  v_mfma_f32_16x16x32_bf16 v[72:75], a[102:105], v[92:95], v[72:75]
  v_mfma_f32_16x16x32_bf16 v[76:79], a[132:135], v[92:95], v[76:79]
  v_mfma_f32_16x16x32_bf16 v[60:63], a[16:19], v[96:99], v[60:63]
  v_mfma_f32_16x16x32_bf16 v[64:67], a[46:49], v[96:99], v[64:67]
  v_mfma_f32_16x16x32_bf16 v[68:71], a[76:79], v[96:99], v[68:71]
  v_mfma_f32_16x16x32_bf16 v[72:75], a[106:109], v[96:99], v[72:75]
  v_mfma_f32_16x16x32_bf16 v[76:79], a[136:139], v[96:99], v[76:79]
  v_mfma_f32_16x16x32_bf16 v[60:63], a[20:23], v[100:103], v[60:63]
  v_mfma_f32_16x16x32_bf16 v[64:67], a[50:53], v[100:103], v[64:67]
  v_mfma_f32_16x16x32_bf16 v[68:71], a[80:83], v[100:103], v[68:71]
  v_mfma_f32_16x16x32_bf16 v[72:75], a[110:113], v[100:103], v[72:75]
  v_mfma_f32_16x16x32_bf16 v[76:79], a[140:143], v[100:103], v[76:79]
  v_mfma_f32_16x16x32_bf16 v[60:63], a[24:27], v[104:107], v[60:63]
  v_mfma_f32_16x16x32_bf16 v[64:67], a[54:57], v[104:107], v[64:67]
  v_mfma_f32_16x16x32_bf16 v[68:71], a[84:87], v[104:107], v[68:71]
  v_mfma_f32_16x16x32_bf16 v[72:75], a[114:117], v[104:107], v[72:75]
  v_mfma_f32_16x16x32_bf16 v[76:79], a[144:147], v[104:107], v[76:79]
  v_mfma_f32_16x16x16_bf16 v[60:63], a[28:29], v[108:109], v[60:63]
  v_mfma_f32_16x16x16_bf16 v[64:67], a[58:59], v[108:109], v[64:67]
  v_mfma_f32_16x16x16_bf16 v[68:71], a[88:89], v[108:109], v[68:71]
  v_mfma_f32_16x16x16_bf16 v[72:75], a[118:119], v[108:109], v[72:75]
  v_mfma_f32_16x16x16_bf16 v[76:79], a[148:149], v[108:109], v[76:79]
  s_nop 7
  ds_write_b128 v212, v[40:43] offset:0
  ds_write_b128 v212, v[44:47] offset:1024
  ds_write_b128 v212, v[48:51] offset:2048
  ds_write_b128 v212, v[52:55] offset:3072
  ds_write_b128 v212, v[56:59] offset:4096
  ds_write_b128 v212, v[60:63] offset:5120
  ds_write_b128 v212, v[64:67] offset:6144
  ds_write_b128 v212, v[68:71] offset:7168
  ds_write_b128 v212, v[72:75] offset:8192
  ds_write_b128 v212, v[76:79] offset:9216
  s_waitcnt lgkmcnt(0)
  s_barrier
  s_lshl_b32 s72, s64, 4
  s_add_u32 s72, s72, s25
  s_lshl_b32 s72, s72, 3
  s_add_u32 s72, s72, s24
  s_mul_i32 s38, s72, 5120
  s_add_u32 s38, s38, 134283264
  s_lshl_b32 s74, s29, 10
  s_add_u32 s73, s38, s74
  ds_read_b128 v[112:115], v213 offset:0
  ds_read_b128 v[116:119], v213 offset:10240
  ds_read_b128 v[120:123], v213 offset:20480
  ds_read_b128 v[124:127], v213 offset:30720
  s_waitcnt lgkmcnt(0)
  v_pk_add_f32 v[112:113], v[112:113], v[116:117]
  v_pk_add_f32 v[114:115], v[114:115], v[118:119]
  v_pk_add_f32 v[120:121], v[120:121], v[124:125]
  v_pk_add_f32 v[122:123], v[122:123], v[126:127]
  v_pk_add_f32 v[112:113], v[112:113], v[120:121]
  v_pk_add_f32 v[114:115], v[114:115], v[122:123]
  buffer_store_dwordx4 v[112:115], v200, s[4:7], s73 offen sc1
  s_nop 1
  s_add_u32 s73, s73, 655360
  ds_read_b128 v[112:115], v213 offset:5120
  ds_read_b128 v[116:119], v213 offset:15360
  ds_read_b128 v[120:123], v213 offset:25600
  ds_read_b128 v[124:127], v213 offset:35840
  s_waitcnt lgkmcnt(0)
  v_pk_add_f32 v[112:113], v[112:113], v[116:117]
  v_pk_add_f32 v[114:115], v[114:115], v[118:119]
  v_pk_add_f32 v[120:121], v[120:121], v[124:125]
  v_pk_add_f32 v[122:123], v[122:123], v[126:127]
  v_pk_add_f32 v[112:113], v[112:113], v[120:121]
  v_pk_add_f32 v[114:115], v[114:115], v[122:123]
  buffer_store_dwordx4 v[112:115], v200, s[4:7], s73 offen sc1
  s_nop 1
  s_cmp_ge_u32 s29, 2
  s_cbranch_scc1 L_g2f_sx
  s_cmp_eq_u32 s29, 1
  s_cbranch_scc1 L_g2f1_sx
  s_add_u32 s73, s38, 4096
  ds_read_b128 v[112:115], v213 offset:4096
  ds_read_b128 v[116:119], v213 offset:14336
  ds_read_b128 v[120:123], v213 offset:24576
  ds_read_b128 v[124:127], v213 offset:34816
  s_waitcnt lgkmcnt(0)
  v_pk_add_f32 v[112:113], v[112:113], v[116:117]
  v_pk_add_f32 v[114:115], v[114:115], v[118:119]
  v_pk_add_f32 v[120:121], v[120:121], v[124:125]
  v_pk_add_f32 v[122:123], v[122:123], v[126:127]
  v_pk_add_f32 v[112:113], v[112:113], v[120:121]
  v_pk_add_f32 v[114:115], v[114:115], v[122:123]
  buffer_store_dwordx4 v[112:115], v200, s[4:7], s73 offen sc1
  s_nop 1
  s_branch L_g2f_sx
L_g2f1_sx:
  s_add_u32 s73, s38, 659456
  ds_read_b128 v[112:115], v213 offset:8192
  ds_read_b128 v[116:119], v213 offset:18432
  ds_read_b128 v[120:123], v213 offset:28672
  ds_read_b128 v[124:127], v213 offset:38912
  s_waitcnt lgkmcnt(0)
  v_pk_add_f32 v[112:113], v[112:113], v[116:117]
  v_pk_add_f32 v[114:115], v[114:115], v[118:119]
  v_pk_add_f32 v[120:121], v[120:121], v[124:125]
  v_pk_add_f32 v[122:123], v[122:123], v[126:127]
  v_pk_add_f32 v[112:113], v[112:113], v[120:121]
  v_pk_add_f32 v[114:115], v[114:115], v[122:123]
  buffer_store_dwordx4 v[112:115], v200, s[4:7], s73 offen sc1
  s_nop 1
L_g2f_sx:
  s_lshl_b32 s72, s72, 4
  s_lshl_b32 s73, s29, 2
  s_add_u32 s72, s72, s73
  s_add_u32 s67, s72, 108494848
  s_barrier
L_nog2_sx:
  s_cmp_lt_u32 s30, 8
  s_cbranch_scc1 L_nox4_sx
  s_sub_u32 s64, s30, 8
  s_and_b32 s72, s64, 7
  s_cmp_lg_u32 s72, s24
  s_cbranch_scc1 L_nox4_sx
  s_lshl_b32 s72, s64, 4
  s_add_u32 s72, s72, s25
  s_lshl_b32 s38, s72, 7
  s_add_u32 s38, s38, 108494848
L_wfg2_13_sx:
  buffer_load_dword v4, v209, s[4:7], s38 offen sc1
  s_waitcnt vmcnt(0)
  s_cmp_eq_u32 s66, 0
  s_cbranch_scc1 L_fl_15_sx
  buffer_store_dword v217, v210, s[4:7], s66 offen sc1
  s_mov_b32 s66, 0
L_fl_15_sx:
  s_cmp_eq_u32 s67, 0
  s_cbranch_scc1 L_fl_16_sx
  buffer_store_dword v217, v210, s[4:7], s67 offen sc1
  buffer_store_dword v217, v210, s[4:7], s67 offen offset:2048 sc1
  s_mov_b32 s67, 0
L_fl_16_sx:
  v_cmp_eq_u32 vcc, 0, v4
  s_cbranch_vccz L_wkg2_14_sx
  s_add_u32 s71, s71, 1
  s_cmp_gt_u32 s71, 1600000
  s_cbranch_scc1 L_p2done_sx
  s_sleep 6
  s_branch L_wfg2_13_sx
L_wkg2_14_sx:
  s_mul_i32 s38, s72, 40960
  s_add_u32 s38, s38, 134283264
  s_mul_i32 s39, s64, 40960
  s_lshl_b32 s74, s29, 10
  s_mov_b32 s75, 0
  s_add_u32 s73, s38, 0
  s_add_u32 s73, s73, s74
  buffer_load_dwordx4 v[8:11], v200, s[4:7], s73 offen sc1
  s_add_u32 s73, s38, 5120
  s_add_u32 s73, s73, s74
  buffer_load_dwordx4 v[12:15], v200, s[4:7], s73 offen sc1
  s_add_u32 s73, s38, 10240
  s_add_u32 s73, s73, s74
  buffer_load_dwordx4 v[16:19], v200, s[4:7], s73 offen sc1
  s_add_u32 s73, s38, 15360
  s_add_u32 s73, s73, s74
  buffer_load_dwordx4 v[20:23], v200, s[4:7], s73 offen sc1
  s_add_u32 s73, s38, 20480
  s_add_u32 s73, s73, s74
  buffer_load_dwordx4 v[24:27], v200, s[4:7], s73 offen sc1
  s_add_u32 s73, s38, 25600
  s_add_u32 s73, s73, s74
  buffer_load_dwordx4 v[28:31], v200, s[4:7], s73 offen sc1
  s_add_u32 s73, s38, 30720
  s_add_u32 s73, s73, s74
  buffer_load_dwordx4 v[32:35], v200, s[4:7], s73 offen sc1
  s_add_u32 s73, s38, 35840
  s_add_u32 s73, s73, s74
  buffer_load_dwordx4 v[36:39], v200, s[4:7], s73 offen sc1
  s_add_u32 s73, s39, s75
  buffer_load_dwordx2 v[40:41], v214, s[12:15], s73 offen
  s_waitcnt vmcnt(0)
  v_pk_add_f32 v[8:9], v[8:9], v[12:13]
  v_pk_add_f32 v[10:11], v[10:11], v[14:15]
  v_pk_add_f32 v[16:17], v[16:17], v[20:21]
  v_pk_add_f32 v[18:19], v[18:19], v[22:23]
  v_pk_add_f32 v[24:25], v[24:25], v[28:29]
  v_pk_add_f32 v[26:27], v[26:27], v[30:31]
  v_pk_add_f32 v[32:33], v[32:33], v[36:37]
  v_pk_add_f32 v[34:35], v[34:35], v[38:39]
  v_pk_add_f32 v[8:9], v[8:9], v[16:17]
  v_pk_add_f32 v[10:11], v[10:11], v[18:19]
  v_pk_add_f32 v[24:25], v[24:25], v[32:33]
  v_pk_add_f32 v[26:27], v[26:27], v[34:35]
  v_pk_add_f32 v[8:9], v[8:9], v[24:25]
  v_pk_add_f32 v[10:11], v[10:11], v[26:27]
  v_lshlrev_b32 v44, 16, v40
  v_and_b32 v45, 0xffff0000, v40
  v_lshlrev_b32 v46, 16, v41
  v_and_b32 v47, 0xffff0000, v41
  v_pk_add_f32 v[8:9], v[8:9], v[218:219]
  v_pk_add_f32 v[10:11], v[10:11], v[220:221]
  v_pk_add_f32 v[8:9], v[8:9], v[44:45]
  v_pk_add_f32 v[10:11], v[10:11], v[46:47]
  v_cvt_pk_bf16_f32 v48, v8, v9
  v_cvt_pk_bf16_f32 v49, v10, v11
  buffer_store_dwordx2 v[48:49], v214, s[16:19], s73 offen
  s_cmp_lg_u32 s29, 0
  s_cbranch_scc1 L_nox4_sx
  s_movk_i32 s74, 4096
  s_movk_i32 s75, 128
  s_add_u32 s73, s38, 0
  s_add_u32 s73, s73, s74
  buffer_load_dwordx4 v[8:11], v200, s[4:7], s73 offen sc1
  s_add_u32 s73, s38, 5120
  s_add_u32 s73, s73, s74
  buffer_load_dwordx4 v[12:15], v200, s[4:7], s73 offen sc1
  s_add_u32 s73, s38, 10240
  s_add_u32 s73, s73, s74
  buffer_load_dwordx4 v[16:19], v200, s[4:7], s73 offen sc1
  s_add_u32 s73, s38, 15360
  s_add_u32 s73, s73, s74
  buffer_load_dwordx4 v[20:23], v200, s[4:7], s73 offen sc1
  s_add_u32 s73, s38, 20480
  s_add_u32 s73, s73, s74
  buffer_load_dwordx4 v[24:27], v200, s[4:7], s73 offen sc1
  s_add_u32 s73, s38, 25600
  s_add_u32 s73, s73, s74
  buffer_load_dwordx4 v[28:31], v200, s[4:7], s73 offen sc1
  s_add_u32 s73, s38, 30720
  s_add_u32 s73, s73, s74
  buffer_load_dwordx4 v[32:35], v200, s[4:7], s73 offen sc1
  s_add_u32 s73, s38, 35840
  s_add_u32 s73, s73, s74
  buffer_load_dwordx4 v[36:39], v200, s[4:7], s73 offen sc1
  s_add_u32 s73, s39, s75
  buffer_load_dwordx2 v[40:41], v214, s[12:15], s73 offen
  s_waitcnt vmcnt(0)
  v_pk_add_f32 v[8:9], v[8:9], v[12:13]
  v_pk_add_f32 v[10:11], v[10:11], v[14:15]
  v_pk_add_f32 v[16:17], v[16:17], v[20:21]
  v_pk_add_f32 v[18:19], v[18:19], v[22:23]
  v_pk_add_f32 v[24:25], v[24:25], v[28:29]
  v_pk_add_f32 v[26:27], v[26:27], v[30:31]
  v_pk_add_f32 v[32:33], v[32:33], v[36:37]
  v_pk_add_f32 v[34:35], v[34:35], v[38:39]
  v_pk_add_f32 v[8:9], v[8:9], v[16:17]
  v_pk_add_f32 v[10:11], v[10:11], v[18:19]
  v_pk_add_f32 v[24:25], v[24:25], v[32:33]
  v_pk_add_f32 v[26:27], v[26:27], v[34:35]
  v_pk_add_f32 v[8:9], v[8:9], v[24:25]
  v_pk_add_f32 v[10:11], v[10:11], v[26:27]
  v_lshlrev_b32 v44, 16, v40
  v_and_b32 v45, 0xffff0000, v40
  v_lshlrev_b32 v46, 16, v41
  v_and_b32 v47, 0xffff0000, v41
  v_pk_add_f32 v[8:9], v[8:9], v[222:223]
  v_pk_add_f32 v[10:11], v[10:11], v[224:225]
  v_pk_add_f32 v[8:9], v[8:9], v[44:45]
  v_pk_add_f32 v[10:11], v[10:11], v[46:47]
  v_cvt_pk_bf16_f32 v48, v8, v9
  v_cvt_pk_bf16_f32 v49, v10, v11
  buffer_store_dwordx2 v[48:49], v214, s[16:19], s73 offen
L_nox4_sx:
  s_cmp_lt_u32 s30, 63
  s_cbranch_scc1 L_p2nf_sx
  s_waitcnt vmcnt(0)
  s_cmp_eq_u32 s66, 0
  s_cbranch_scc1 L_fl_17_sx
  buffer_store_dword v217, v210, s[4:7], s66 offen sc1
  s_mov_b32 s66, 0
L_fl_17_sx:
  s_cmp_eq_u32 s67, 0
  s_cbranch_scc1 L_fl_18_sx
  buffer_store_dword v217, v210, s[4:7], s67 offen sc1
  buffer_store_dword v217, v210, s[4:7], s67 offen offset:2048 sc1
  s_mov_b32 s67, 0
L_fl_18_sx:
L_p2nf_sx:
  s_add_u32 s30, s30, 1
  s_cmp_lt_u32 s30, 72
  s_cbranch_scc1 L_p2loop_sx
L_p2done_sx:
  s_branch L_mend
L_mend:
  s_endpgm
.section .rodata,"a"
.p2align 6
.amdhsa_kernel main_kernel
  .amdhsa_next_free_vgpr 512
  .amdhsa_next_free_sgpr 102
  .amdhsa_accum_offset 256
  .amdhsa_group_segment_fixed_size 0
  .amdhsa_kernarg_size 120
  .amdhsa_user_sgpr_count 2
  .amdhsa_user_sgpr_kernarg_segment_ptr 1
  .amdhsa_system_sgpr_workgroup_id_x 1
  .amdhsa_float_denorm_mode_32 3
  .amdhsa_float_denorm_mode_16_64 3
.end_amdhsa_kernel
.text
```
